```python
import torch

def _softmax(x, axis=-1):
    return torch.softmax(x, dim=axis)
def _gelu(x):
    return torch.nn.functional.gelu(x, approximate="tanh")
def _silu(x):
    return torch.nn.functional.silu(x)
def _sigmoid(x):
    return torch.sigmoid(x)
def _layernorm(x, axis=-1, eps=1e-5):
    m = x.mean(dim=axis, keepdim=True)
    v = x.var(dim=axis, keepdim=True, unbiased=False)
    return (x - m) / torch.sqrt(v + eps)
def _scatter_add(tgt, idx, src, axis=0):
    return tgt.clone().index_add_(axis, idx, src)
def _segment_sum(src, seg, n):
    out = torch.zeros((n,) + src.shape[1:], dtype=src.dtype)
    return out.index_add_(0, seg, src)
def _pad(x, pw):
    flat = tuple(v for pair in reversed(pw) for v in pair)
    return torch.nn.functional.pad(x, flat)

kernel_name = 'recurrent_scan__sliding_block_cached__glu_gated_bilinear__prompt'

def setup_inputs():

    _w = (lambda a: (lambda t: t.to(torch.bfloat16) if t.is_floating_point() else t)(torch.as_tensor(a)))
    def _A_setup():
        B, Sq, D = 1, 2048, 448
        Hq, Hkv, Sk, Dh = 16, 8, 2048, 256
        assert Hq % Hkv == 0, (Hq, Hkv)
        return {
            "x": _w((lambda *s: torch.randn(*s, dtype=torch.bfloat16) * 0.05)(B, Sq, D)),
            "k_cache": _w((lambda *s: torch.randn(*s, dtype=torch.bfloat16) * 1.6)(B, Hkv, Sk, Dh)),
            "v_cache": _w((lambda *s: torch.randn(*s, dtype=torch.bfloat16) * 1.6)(B, Hkv, Sk, Dh)),
            "wq": _w((lambda *s: torch.randn(*s, dtype=torch.bfloat16) * 1.6)(D, Hq * Dh) * (D ** -0.5)),
            "wo": _w((lambda *s: torch.randn(*s, dtype=torch.bfloat16) * 1.6)(Hq * Dh, D) * ((Hq * Dh) ** -0.5)),
        }
    _A_in = _A_setup()

    def _B_setup():
        B, S, D, F = 1, 2048, 448, 1792
        return {
            "x": _w((lambda *s: torch.randn(*s, dtype=torch.bfloat16) * 0.05)(B, S, D)),
            "w_gate": _w((lambda *s: torch.randn(*s, dtype=torch.bfloat16) * 0.2)(D, F) * (D ** -0.5)),
            "w_up": _w((lambda *s: torch.randn(*s, dtype=torch.bfloat16) * 0.2)(D, F) * (D ** -0.5)),
            "w_down": _w((lambda *s: torch.randn(*s, dtype=torch.bfloat16) * 0.2)(F, D) * (F ** -0.5)),
        }
    _B_in = _B_setup()

    return {
        "A_x": _A_in["x"],
        "A_k_cache": _A_in["k_cache"],
        "A_v_cache": _A_in["v_cache"],
        "A_wq": _A_in["wq"],
        "A_wo": _A_in["wo"],
        "B_x": _B_in["x"],
        "B_w_gate": _B_in["w_gate"],
        "B_w_up": _B_in["w_up"],
        "B_w_down": _B_in["w_down"],
    }

def reference(A_x, A_k_cache, A_v_cache, A_wq, A_wo, B_x, B_w_gate, B_w_up, B_w_down):
    def _A_ref(x, k_cache, v_cache, wq, wo):
        B, Sq, D = x.shape
        Hq, Dh = 16, 256
        Hkv, Sk = k_cache.shape[1], k_cache.shape[2]
        W = min(4096, max(256, Sk // 4))
        rep = Hq // Hkv
        q = (lambda x, *d: x.permute(*d))((x @ wq).reshape(B, Sq, Hq, Dh), 0, 2, 1, 3)
        k = (lambda x, n, axis: torch.repeat_interleave(x, n, dim=axis))(k_cache[:, :, Sk - W:, :], rep, axis=1)
        v = (lambda x, n, axis: torch.repeat_interleave(x, n, dim=axis))(v_cache[:, :, Sk - W:, :], rep, axis=1)
        scores = torch.einsum("bhqd,bhkd->bhqk", q, k) * (Dh ** -0.5)
        p = _softmax(scores, axis=-1)
        o = torch.einsum("bhqk,bhkd->bhqd", p, v)
        return (lambda x, *d: x.permute(*d))(o, 0, 2, 1, 3).reshape(B, Sq, Hq * Dh) @ wo

    def _B_ref(x, w_gate, w_up, w_down):
        g = torch.einsum("bsd,df->bsf", x, w_gate)
        u = torch.einsum("bsd,df->bsf", x, w_up)
        h = g * u
        return torch.einsum("bsf,fd->bsd", h, w_down)

    x = A_x
    xn = _layernorm(x, axis=-1)
    s = _A_ref(xn, A_k_cache, A_v_cache, A_wq, A_wo)
    g = _silu(_B_ref(xn, B_w_gate, B_w_up, B_w_down))
    return x + s * g
```

```asm
; @launch grid=(256,1,1) block=(256,1,1) lds=163840
.amdgcn_target "amdgcn-amd-amdhsa--gfx950"
.text
.globl recurrent_scan__sliding_block_cached__glu_gated_bilinear__prompt_kernel
.p2align 8
.type recurrent_scan__sliding_block_cached__glu_gated_bilinear__prompt_kernel,@function
recurrent_scan__sliding_block_cached__glu_gated_bilinear__prompt_kernel:
  s_cmp_ge_u32 s2, 256
  s_cbranch_scc1 K1_END
  s_load_dwordx16 s[32:47], s[0:1], 0
  s_load_dwordx8 s[48:55], s[0:1], 64
  v_lshrrev_b32 v26, 6, v0
  v_and_b32 v0, 63, v0
  v_readfirstlane_b32 s56, v26
  s_and_b32 s7, s2, 3
  s_lshr_b32 s5, s2, 3
  s_and_b32 s6, s5, 3
  s_lshl_b32 s3, s7, 2
  s_add_u32 s6, s6, s3
  s_lshr_b32 s3, s6, 1
  s_and_b32 s4, s2, 4
  s_lshl_b32 s4, s4, 1
  s_lshr_b32 s61, s5, 2
  s_add_u32 s4, s4, s61
  s_lshl_b32 s57, s56, 13
  s_lshl_b32 s60, s56, 12
  s_mul_i32 s59, s56, 7168
  s_lshr_b32 s58, s56, 1
  s_lshl_b32 s58, s58, 7
  s_add_u32 s58, s58, s57
  s_mov_b32 s67, 0xffff0000
  s_and_b32 s7, s5, 3
  s_lshl_b32 s7, s7, 1
  s_add_u32 s7, s7, s61
  s_sub_u32 s62, s7, 7
  s_cmp_ge_u32 s7, 7
  s_cselect_b32 s7, s62, s7
  s_lshl_b32 s63, s7, 7
  v_lshrrev_b32 v27, 3, v0
  v_and_b32 v28, 7, v0
  v_lshrrev_b32 v29, 4, v0
  v_xor_b32 v30, v28, v29
  v_lshlrev_b32 v30, 4, v30
  v_xor_b32 v31, 64, v30
  s_mul_i32 s61, s56, 28672
  v_mul_u32_u24 v16, 896, v27
  v_add_u32 v16, s61, v16
  v_add_u32 v1, v16, v30
  v_add_u32 v2, v16, v31
  v_add_u32 v2, 6144, v2
  v_add_u32 v3, 12288, v1
  v_add_u32 v4, 12288, v2
  s_waitcnt lgkmcnt(0)
  s_mul_i32 s61, s4, 114688
  s_add_u32 s8, s32, s61
  s_addc_u32 s9, s33, 0
  s_sub_u32 s10, 0x1c0000, s61
  s_mov_b32 s11, 0x20000
  s_add_u32 m0, s57, 32768
  s_nop 0
  buffer_load_dwordx4 v1, s[8:11], s63 offen offset:0 lds
  buffer_load_dwordx4 v2, s[8:11], s63 offen offset:1024 lds
  buffer_load_dwordx4 v3, s[8:11], s63 offen offset:2048 lds
  v_lshrrev_b32 v20, 5, v0
  v_bfe_u32 v21, v0, 4, 1
  v_bfe_u32 v22, v0, 2, 2
  v_and_b32 v23, 3, v0
  v_lshl_add_u32 v17, v20, 3, v22
  v_mul_u32_u24 v17, 224, v17
  v_lshl_add_u32 v17, v23, 3, v17
  v_mul_u32_u24 v18, 16512, v21
  v_add_u32 v25, v17, v18
  v_bfe_u32 v16, v0, 3, 2
  v_lshlrev_b32 v16, 10, v16
  v_lshl_add_u32 v16, v28, 7, v16
  v_bfe_u32 v17, v0, 1, 3
  v_xor_b32 v17, v17, v20
  v_lshl_add_u32 v16, v17, 4, v16
  s_add_u32 s61, s57, 32768
  v_xor_b32 v17, 0, v16
  buffer_load_dwordx4 v4, s[8:11], s63 offen offset:3072 lds
  v_accvgpr_write_b32 a126, v17
  v_add_u32 v8, s61, v17
  v_xor_b32 v17, 32, v16
  v_accvgpr_write_b32 a127, v17
  v_add_u32 v9, s61, v17
  v_xor_b32 v17, 64, v16
  v_accvgpr_write_b32 a128, v17
  v_add_u32 v10, s61, v17
  v_xor_b32 v17, 96, v16
  v_accvgpr_write_b32 a129, v17
  v_add_u32 v11, s61, v17
  s_mul_i32 s61, s56, 376832
  v_lshlrev_b32 v24, 4, v0
  v_add_u32 v24, s61, v24
  v_mov_b32 v26, 0x3f803f80
  v_mov_b32 v12, 0
  v_mov_b32 v13, 0
  s_add_u32 s63, s63, 128
  s_cmp_ge_u32 s63, 896
  s_cselect_b32 s63, 0, s63
  s_add_u32 m0, s57, 36864
  s_nop 0
  buffer_load_dwordx4 v1, s[8:11], s63 offen offset:0 lds
  v_mov_b32 v14, 0
  v_mov_b32 v15, 0
  s_cmp_ge_u32 s56, 2
  s_cselect_b32 s68, s46, s44
  s_cselect_b32 s69, s47, s45
  s_mul_i32 s61, s6, 224
  s_add_u32 s12, s68, s61
  s_addc_u32 s13, s69, 0
  s_sub_u32 s14, 0x188000, s61
  s_mov_b32 s15, 0x20000
  s_mul_i32 s68, s7, 229376
  s_lshl_b32 s61, s6, 9
  s_sub_u32 s16, s38, 4096
  s_subb_u32 s17, s39, 0
  s_add_u32 s16, s16, s61
  s_addc_u32 s17, s17, 0
  s_sub_u32 s18, 0x381000, s61
  buffer_load_dwordx4 v2, s[8:11], s63 offen offset:1024 lds
  s_mov_b32 s19, 0x20000
  s_lshl_b32 s61, s3, 20
  s_add_u32 s61, s61, 786432
  s_add_u32 s20, s34, s61
  s_addc_u32 s21, s35, 0
  s_sub_u32 s22, 0x800000, s61
  s_mov_b32 s23, 0x20000
  s_add_u32 s24, s36, s61
  s_addc_u32 s25, s37, 0
  s_sub_u32 s26, 0x800000, s61
  s_mov_b32 s27, 0x20000
  s_mul_i32 s61, s4, 1507328
  s_add_u32 s28, s54, s61
  s_addc_u32 s29, s55, 0
  s_sub_u32 s30, 0x1700000, s61
  s_mov_b32 s31, 0x20000
  s_lshl_b32 s70, s6, 14
  buffer_load_dwordx4 v3, s[8:11], s63 offen offset:2048 lds
  s_mul_i32 s71, s6, 7168
  s_add_u32 s71, s71, 262144
  s_and_b32 s61, s56, 1
  s_mul_i32 s61, s61, 114688
  v_add_u32 v16, 0, v0
  v_mul_u32_u24 v17, 4682, v16
  v_lshrrev_b32 v17, 16, v17
  v_mul_u32_u24 v18, 14, v17
  v_sub_u32 v18, v16, v18
  v_mul_u32_u24 v17, 3584, v17
  v_lshl_add_u32 v17, v18, 4, v17
  v_add_u32 v17, s61, v17
  v_subrev_u32 v248, 0, v17
  v_add_u32 v16, 64, v0
  v_mul_u32_u24 v17, 4682, v16
  v_lshrrev_b32 v17, 16, v17
  v_mul_u32_u24 v18, 14, v17
  buffer_load_dwordx4 v4, s[8:11], s63 offen offset:3072 lds
  v_sub_u32 v18, v16, v18
  v_mul_u32_u24 v17, 3584, v17
  v_lshl_add_u32 v17, v18, 4, v17
  v_add_u32 v17, s61, v17
  v_subrev_u32 v249, 1024, v17
  v_add_u32 v16, 128, v0
  v_mul_u32_u24 v17, 4682, v16
  v_lshrrev_b32 v17, 16, v17
  v_mul_u32_u24 v18, 14, v17
  v_sub_u32 v18, v16, v18
  v_mul_u32_u24 v17, 3584, v17
  v_lshl_add_u32 v17, v18, 4, v17
  v_add_u32 v17, s61, v17
  v_subrev_u32 v250, 2048, v17
  v_add_u32 v16, 192, v0
  v_mul_u32_u24 v17, 4682, v16
  v_lshrrev_b32 v17, 16, v17
  s_add_u32 s63, s63, 128
  s_cmp_ge_u32 s63, 896
  s_cselect_b32 s63, 0, s63
  s_add_u32 m0, s57, 65536
  s_nop 0
  buffer_load_dwordx4 v1, s[8:11], s63 offen offset:0 lds
  v_mul_u32_u24 v18, 14, v17
  v_sub_u32 v18, v16, v18
  v_mul_u32_u24 v17, 3584, v17
  v_lshl_add_u32 v17, v18, 4, v17
  v_add_u32 v17, s61, v17
  v_subrev_u32 v251, 3072, v17
  v_add_u32 v16, 256, v0
  v_mul_u32_u24 v17, 4682, v16
  v_lshrrev_b32 v17, 16, v17
  v_mul_u32_u24 v18, 14, v17
  v_sub_u32 v18, v16, v18
  v_mul_u32_u24 v17, 3584, v17
  v_lshl_add_u32 v17, v18, 4, v17
  v_add_u32 v17, s61, v17
  v_subrev_u32 v252, 0, v17
  v_add_u32 v16, 320, v0
  v_mul_u32_u24 v17, 4682, v16
  buffer_load_dwordx4 v2, s[8:11], s63 offen offset:1024 lds
  v_lshrrev_b32 v17, 16, v17
  v_mul_u32_u24 v18, 14, v17
  v_sub_u32 v18, v16, v18
  v_mul_u32_u24 v17, 3584, v17
  v_lshl_add_u32 v17, v18, 4, v17
  v_add_u32 v17, s61, v17
  v_subrev_u32 v253, 1024, v17
  v_add_u32 v16, 384, v0
  v_mul_u32_u24 v17, 4682, v16
  v_lshrrev_b32 v17, 16, v17
  v_mul_u32_u24 v18, 14, v17
  v_sub_u32 v18, v16, v18
  v_mul_u32_u24 v17, 3584, v17
  v_lshl_add_u32 v17, v18, 4, v17
  v_add_u32 v17, s61, v17
  v_subrev_u32 v254, 2048, v17
  buffer_load_dwordx4 v3, s[8:11], s63 offen offset:2048 lds
  s_lshr_b32 s61, s5, 2
  s_lshl_b32 s61, s61, 2
  s_add_u32 s61, s61, s56
  v_mov_b32 v244, 0x80000000
  s_mul_i32 s66, s61, 14
  v_add_u32 v240, s66, v0
  v_lshlrev_b32 v241, 13, v240
  v_add_u32 v241, 4096, v241
  v_cmp_gt_u32 vcc, 14, v0
  s_nop 1
  v_cndmask_b32 v241, v244, v241, vcc
  v_accvgpr_write_b32 a132, v241
  s_and_b32 s66, s6, 1
  s_lshl_b32 s66, s66, 5
  s_add_u32 s66, s66, s61
  s_lshl_b32 s66, s66, 4
  v_add_u32 v240, s66, v0
  v_cmp_gt_u32 vcc, 16, v0
  v_lshlrev_b32 v242, 7, v240
  s_nop 0
  v_cndmask_b32 v242, v244, v242, vcc
  v_accvgpr_write_b32 a133, v242
  v_lshrrev_b32 v242, 1, v240
  v_lshlrev_b32 v241, 9, v242
  v_and_b32 v240, 1, v240
  v_lshl_add_u32 v242, v240, 7, v241
  v_cndmask_b32 v242, v244, v242, vcc
  v_accvgpr_write_b32 a134, v242
  s_lshl_b32 s66, s2, 2
  s_add_u32 s66, s66, s56
  s_lshl_b32 s66, s66, 4
  v_add_u32 v240, s66, v0
  v_lshlrev_b32 v240, 7, v240
  v_cndmask_b32 v240, v244, v240, vcc
  v_accvgpr_write_b32 a135, v240
  v_add_u32 v240, 0x200000, v240
  v_accvgpr_write_b32 a136, v240
  s_mov_b32 s92, s40
  s_mov_b32 s93, s41
  s_mov_b32 s94, 3670016
  s_mov_b32 s95, 0x20000
  s_mov_b32 s96, s48
  s_mov_b32 s97, s49
  s_mov_b32 s98, 1605632
  s_mov_b32 s99, 0x20000
  s_mov_b32 s66, 131072
  v_lshrrev_b32 v243, 2, v0
  v_and_b32 v243, 4, v243
  v_xor_b32 v243, v28, v243
  v_lshlrev_b32 v243, 4, v243
  v_lshl_add_u32 v240, v27, 13, v243
  s_mul_i32 s61, s56, 7
  s_lshl_b32 s4, s7, 3
  s_add_u32 s61, s61, s4
  s_add_u32 s4, s61, 0
  s_sub_u32 s3, s4, 56
  s_cmp_ge_u32 s4, 56
  s_cselect_b32 s4, s3, s4
  s_lshl_b32 s4, s4, 16
  s_add_u32 s4, s4, 4096
  v_add_u32 v241, s4, v240
  v_accvgpr_write_b32 a137, v241
  s_add_u32 s4, s61, 1
  s_sub_u32 s3, s4, 56
  s_cmp_ge_u32 s4, 56
  s_cselect_b32 s4, s3, s4
  s_lshl_b32 s4, s4, 16
  s_add_u32 s4, s4, 3072
  v_add_u32 v241, s4, v240
  v_accvgpr_write_b32 a138, v241
  s_add_u32 s4, s61, 2
  s_sub_u32 s3, s4, 56
  s_cmp_ge_u32 s4, 56
  s_cselect_b32 s4, s3, s4
  s_lshl_b32 s4, s4, 16
  s_add_u32 s4, s4, 2048
  v_add_u32 v241, s4, v240
  v_accvgpr_write_b32 a139, v241
  s_add_u32 s4, s61, 3
  s_sub_u32 s3, s4, 56
  s_cmp_ge_u32 s4, 56
  s_cselect_b32 s4, s3, s4
  s_lshl_b32 s4, s4, 16
  s_add_u32 s4, s4, 1024
  v_add_u32 v241, s4, v240
  v_accvgpr_write_b32 a140, v241
  s_add_u32 s4, s61, 4
  s_sub_u32 s3, s4, 56
  s_cmp_ge_u32 s4, 56
  s_cselect_b32 s4, s3, s4
  s_lshl_b32 s4, s4, 16
  s_add_u32 s4, s4, 4096
  v_add_u32 v241, s4, v240
  v_accvgpr_write_b32 a141, v241
  s_add_u32 s4, s61, 5
  s_sub_u32 s3, s4, 56
  s_cmp_ge_u32 s4, 56
  s_cselect_b32 s4, s3, s4
  s_lshl_b32 s4, s4, 16
  s_add_u32 s4, s4, 3072
  v_add_u32 v241, s4, v240
  v_accvgpr_write_b32 a142, v241
  s_add_u32 s4, s61, 6
  s_sub_u32 s3, s4, 56
  s_cmp_ge_u32 s4, 56
  s_cselect_b32 s4, s3, s4
  s_lshl_b32 s4, s4, 16
  s_add_u32 s4, s4, 2048
  v_add_u32 v241, s4, v240
  v_accvgpr_write_b32 a143, v241
  s_add_u32 s4, s61, 28
  s_sub_u32 s3, s4, 56
  s_cmp_ge_u32 s4, 56
  s_cselect_b32 s4, s3, s4
  s_lshl_b32 s4, s4, 16
  s_add_u32 s4, s4, 4096
  v_add_u32 v241, s4, v240
  v_accvgpr_write_b32 a144, v241
  s_add_u32 s4, s61, 29
  s_sub_u32 s3, s4, 56
  s_cmp_ge_u32 s4, 56
  s_cselect_b32 s4, s3, s4
  s_lshl_b32 s4, s4, 16
  s_add_u32 s4, s4, 3072
  v_add_u32 v241, s4, v240
  v_accvgpr_write_b32 a145, v241
  s_add_u32 s4, s61, 30
  s_sub_u32 s3, s4, 56
  s_cmp_ge_u32 s4, 56
  s_cselect_b32 s4, s3, s4
  s_lshl_b32 s4, s4, 16
  s_add_u32 s4, s4, 2048
  v_add_u32 v241, s4, v240
  v_accvgpr_write_b32 a146, v241
  s_add_u32 s4, s61, 31
  s_sub_u32 s3, s4, 56
  s_cmp_ge_u32 s4, 56
  s_cselect_b32 s4, s3, s4
  s_lshl_b32 s4, s4, 16
  s_add_u32 s4, s4, 1024
  v_add_u32 v241, s4, v240
  v_accvgpr_write_b32 a147, v241
  s_add_u32 s4, s61, 32
  s_sub_u32 s3, s4, 56
  s_cmp_ge_u32 s4, 56
  s_cselect_b32 s4, s3, s4
  s_lshl_b32 s4, s4, 16
  s_add_u32 s4, s4, 4096
  v_add_u32 v241, s4, v240
  v_accvgpr_write_b32 a148, v241
  s_add_u32 s4, s61, 33
  s_sub_u32 s3, s4, 56
  s_cmp_ge_u32 s4, 56
  s_cselect_b32 s4, s3, s4
  s_lshl_b32 s4, s4, 16
  s_add_u32 s4, s4, 3072
  v_add_u32 v241, s4, v240
  v_accvgpr_write_b32 a149, v241
  s_add_u32 s4, s61, 34
  s_sub_u32 s3, s4, 56
  s_cmp_ge_u32 s4, 56
  s_cselect_b32 s4, s3, s4
  s_lshl_b32 s4, s4, 16
  s_add_u32 s4, s4, 2048
  v_add_u32 v241, s4, v240
  v_accvgpr_write_b32 a150, v241
  s_lshl_b32 s61, s56, 7
  v_lshlrev_b32 v240, 9, v27
  v_add_u32 v240, s61, v240
  v_add_u32 v241, v240, v30
  v_accvgpr_write_b32 a116, v241
  v_add_u32 v241, 6144, v241
  v_accvgpr_write_b32 a118, v241
  v_add_u32 v241, v240, v31
  v_add_u32 v241, 3072, v241
  v_accvgpr_write_b32 a117, v241
  v_add_u32 v241, 6144, v241
  v_accvgpr_write_b32 a119, v241
  s_lshl_b32 s61, s56, 15
  v_lshl_add_u32 v240, v27, 9, v243
  v_add_u32 v240, s61, v240
  v_accvgpr_write_b32 a120, v240
  v_add_u32 v240, 3072, v240
  v_accvgpr_write_b32 a121, v240
  v_add_u32 v240, 3072, v240
  v_accvgpr_write_b32 a122, v240
  v_add_u32 v240, 3072, v240
  v_accvgpr_write_b32 a123, v240
  v_lshlrev_b32 v240, 7, v22
  v_lshrrev_b32 v241, 1, v22
  v_lshl_add_u32 v240, v241, 6, v240
  v_lshl_add_u32 v240, v21, 5, v240
  v_lshl_add_u32 v241, v20, 9, v240
  v_lshl_add_u32 v241, v23, 3, v241
  v_accvgpr_write_b32 a130, v241
  v_xor_b32 v241, 64, v241
  v_accvgpr_write_b32 a131, v241
  v_and_b32 v242, 1, v23
  v_lshlrev_b32 v242, 1, v242
  v_lshrrev_b32 v241, 1, v23
  v_or_b32 v242, v242, v241
  v_lshl_add_u32 v241, v20, 10, v240
  v_lshl_add_u32 v241, v242, 3, v241
  v_accvgpr_write_b32 a124, v241
  v_xor_b32 v241, 64, v241
  v_accvgpr_write_b32 a125, v241
  buffer_load_dwordx4 v4, s[8:11], s63 offen offset:3072 lds
  s_waitcnt vmcnt(8)
  ds_read_b128 v[32:35], v8 offset:0
  ds_read_b128 v[36:39], v9 offset:0
  ds_read_b128 v[40:43], v10 offset:0
  ds_read_b128 v[44:47], v11 offset:0
  s_add_u32 s63, s63, 128
  s_cmp_ge_u32 s63, 896
  s_cselect_b32 s63, 0, s63
  s_add_u32 m0, s57, 69632
  s_nop 0
  buffer_load_dwordx4 v1, s[8:11], s63 offen offset:0 lds
  s_waitcnt lgkmcnt(0)
  v_dot2_f32_bf16 v12, v32, v26, v12
  v_dot2_f32_bf16 v14, v32, v32, v14
  v_dot2_f32_bf16 v13, v33, v26, v13
  v_dot2_f32_bf16 v15, v33, v33, v15
  v_dot2_f32_bf16 v12, v34, v26, v12
  v_dot2_f32_bf16 v14, v34, v34, v14
  v_dot2_f32_bf16 v13, v35, v26, v13
  v_dot2_f32_bf16 v15, v35, v35, v15
  v_dot2_f32_bf16 v12, v36, v26, v12
  v_dot2_f32_bf16 v14, v36, v36, v14
  buffer_load_dwordx4 v2, s[8:11], s63 offen offset:1024 lds
  v_dot2_f32_bf16 v13, v37, v26, v13
  v_dot2_f32_bf16 v15, v37, v37, v15
  v_dot2_f32_bf16 v12, v38, v26, v12
  v_dot2_f32_bf16 v14, v38, v38, v14
  v_dot2_f32_bf16 v13, v39, v26, v13
  v_dot2_f32_bf16 v15, v39, v39, v15
  v_dot2_f32_bf16 v12, v40, v26, v12
  v_dot2_f32_bf16 v14, v40, v40, v14
  v_dot2_f32_bf16 v13, v41, v26, v13
  v_dot2_f32_bf16 v15, v41, v41, v15
  v_dot2_f32_bf16 v12, v42, v26, v12
  buffer_load_dwordx4 v3, s[8:11], s63 offen offset:2048 lds
  v_dot2_f32_bf16 v14, v42, v42, v14
  v_dot2_f32_bf16 v13, v43, v26, v13
  v_dot2_f32_bf16 v15, v43, v43, v15
  v_dot2_f32_bf16 v12, v44, v26, v12
  v_dot2_f32_bf16 v14, v44, v44, v14
  v_dot2_f32_bf16 v13, v45, v26, v13
  v_dot2_f32_bf16 v15, v45, v45, v15
  v_dot2_f32_bf16 v12, v46, v26, v12
  v_dot2_f32_bf16 v14, v46, v46, v14
  v_dot2_f32_bf16 v13, v47, v26, v13
  v_dot2_f32_bf16 v15, v47, v47, v15
  buffer_load_dwordx4 v4, s[8:11], s63 offen offset:3072 lds
  s_waitcnt vmcnt(8)
  ds_read_b128 v[48:51], v8 offset:4096
  ds_read_b128 v[52:55], v9 offset:4096
  ds_read_b128 v[56:59], v10 offset:4096
  ds_read_b128 v[60:63], v11 offset:4096
  s_add_u32 s63, s63, 128
  s_cmp_ge_u32 s63, 896
  s_cselect_b32 s63, 0, s63
  s_add_u32 m0, s57, 98304
  s_nop 0
  buffer_load_dwordx4 v1, s[8:11], s63 offen offset:0 lds
  s_waitcnt lgkmcnt(0)
  v_dot2_f32_bf16 v12, v48, v26, v12
  v_dot2_f32_bf16 v14, v48, v48, v14
  v_dot2_f32_bf16 v13, v49, v26, v13
  v_dot2_f32_bf16 v15, v49, v49, v15
  v_dot2_f32_bf16 v12, v50, v26, v12
  v_dot2_f32_bf16 v14, v50, v50, v14
  v_dot2_f32_bf16 v13, v51, v26, v13
  v_dot2_f32_bf16 v15, v51, v51, v15
  v_dot2_f32_bf16 v12, v52, v26, v12
  v_dot2_f32_bf16 v14, v52, v52, v14
  buffer_load_dwordx4 v2, s[8:11], s63 offen offset:1024 lds
  v_dot2_f32_bf16 v13, v53, v26, v13
  v_dot2_f32_bf16 v15, v53, v53, v15
  v_dot2_f32_bf16 v12, v54, v26, v12
  v_dot2_f32_bf16 v14, v54, v54, v14
  v_dot2_f32_bf16 v13, v55, v26, v13
  v_dot2_f32_bf16 v15, v55, v55, v15
  v_dot2_f32_bf16 v12, v56, v26, v12
  v_dot2_f32_bf16 v14, v56, v56, v14
  v_dot2_f32_bf16 v13, v57, v26, v13
  v_dot2_f32_bf16 v15, v57, v57, v15
  v_dot2_f32_bf16 v12, v58, v26, v12
  buffer_load_dwordx4 v3, s[8:11], s63 offen offset:2048 lds
  v_dot2_f32_bf16 v14, v58, v58, v14
  v_dot2_f32_bf16 v13, v59, v26, v13
  v_dot2_f32_bf16 v15, v59, v59, v15
  v_dot2_f32_bf16 v12, v60, v26, v12
  v_dot2_f32_bf16 v14, v60, v60, v14
  v_dot2_f32_bf16 v13, v61, v26, v13
  v_dot2_f32_bf16 v15, v61, v61, v15
  v_dot2_f32_bf16 v12, v62, v26, v12
  v_dot2_f32_bf16 v14, v62, v62, v14
  v_dot2_f32_bf16 v13, v63, v26, v13
  v_dot2_f32_bf16 v15, v63, v63, v15
  buffer_load_dwordx4 v4, s[8:11], s63 offen offset:3072 lds
  s_waitcnt vmcnt(8)
  ds_read_b128 v[64:67], v8 offset:32768
  ds_read_b128 v[68:71], v9 offset:32768
  ds_read_b128 v[72:75], v10 offset:32768
  ds_read_b128 v[76:79], v11 offset:32768
  s_add_u32 s63, s63, 128
  s_cmp_ge_u32 s63, 896
  s_cselect_b32 s63, 0, s63
  s_add_u32 m0, s57, 102400
  s_nop 0
  buffer_load_dwordx4 v1, s[8:11], s63 offen offset:0 lds
  s_waitcnt lgkmcnt(0)
  v_dot2_f32_bf16 v12, v64, v26, v12
  v_dot2_f32_bf16 v14, v64, v64, v14
  v_dot2_f32_bf16 v13, v65, v26, v13
  v_dot2_f32_bf16 v15, v65, v65, v15
  v_dot2_f32_bf16 v12, v66, v26, v12
  v_dot2_f32_bf16 v14, v66, v66, v14
  v_dot2_f32_bf16 v13, v67, v26, v13
  v_dot2_f32_bf16 v15, v67, v67, v15
  v_dot2_f32_bf16 v12, v68, v26, v12
  v_dot2_f32_bf16 v14, v68, v68, v14
  buffer_load_dwordx4 v2, s[8:11], s63 offen offset:1024 lds
  v_dot2_f32_bf16 v13, v69, v26, v13
  v_dot2_f32_bf16 v15, v69, v69, v15
  v_dot2_f32_bf16 v12, v70, v26, v12
  v_dot2_f32_bf16 v14, v70, v70, v14
  v_dot2_f32_bf16 v13, v71, v26, v13
  v_dot2_f32_bf16 v15, v71, v71, v15
  v_dot2_f32_bf16 v12, v72, v26, v12
  v_dot2_f32_bf16 v14, v72, v72, v14
  v_dot2_f32_bf16 v13, v73, v26, v13
  v_dot2_f32_bf16 v15, v73, v73, v15
  v_dot2_f32_bf16 v12, v74, v26, v12
  buffer_load_dwordx4 v3, s[8:11], s63 offen offset:2048 lds
  v_dot2_f32_bf16 v14, v74, v74, v14
  v_dot2_f32_bf16 v13, v75, v26, v13
  v_dot2_f32_bf16 v15, v75, v75, v15
  v_dot2_f32_bf16 v12, v76, v26, v12
  v_dot2_f32_bf16 v14, v76, v76, v14
  v_dot2_f32_bf16 v13, v77, v26, v13
  v_dot2_f32_bf16 v15, v77, v77, v15
  v_dot2_f32_bf16 v12, v78, v26, v12
  v_dot2_f32_bf16 v14, v78, v78, v14
  v_dot2_f32_bf16 v13, v79, v26, v13
  v_dot2_f32_bf16 v15, v79, v79, v15
  buffer_load_dwordx4 v4, s[8:11], s63 offen offset:3072 lds
  s_waitcnt vmcnt(8)
  ds_read_b128 v[80:83], v8 offset:36864
  ds_read_b128 v[84:87], v9 offset:36864
  ds_read_b128 v[88:91], v10 offset:36864
  ds_read_b128 v[92:95], v11 offset:36864
  s_add_u32 s63, s63, 128
  s_cmp_ge_u32 s63, 896
  s_cselect_b32 s63, 0, s63
  s_add_u32 m0, s57, 131072
  s_nop 0
  buffer_load_dwordx4 v1, s[8:11], s63 offen offset:0 lds
  s_waitcnt lgkmcnt(0)
  v_dot2_f32_bf16 v12, v80, v26, v12
  v_dot2_f32_bf16 v14, v80, v80, v14
  v_dot2_f32_bf16 v13, v81, v26, v13
  v_dot2_f32_bf16 v15, v81, v81, v15
  v_dot2_f32_bf16 v12, v82, v26, v12
  v_dot2_f32_bf16 v14, v82, v82, v14
  v_dot2_f32_bf16 v13, v83, v26, v13
  v_dot2_f32_bf16 v15, v83, v83, v15
  v_dot2_f32_bf16 v12, v84, v26, v12
  v_dot2_f32_bf16 v14, v84, v84, v14
  buffer_load_dwordx4 v2, s[8:11], s63 offen offset:1024 lds
  v_dot2_f32_bf16 v13, v85, v26, v13
  v_dot2_f32_bf16 v15, v85, v85, v15
  v_dot2_f32_bf16 v12, v86, v26, v12
  v_dot2_f32_bf16 v14, v86, v86, v14
  v_dot2_f32_bf16 v13, v87, v26, v13
  v_dot2_f32_bf16 v15, v87, v87, v15
  v_dot2_f32_bf16 v12, v88, v26, v12
  v_dot2_f32_bf16 v14, v88, v88, v14
  v_dot2_f32_bf16 v13, v89, v26, v13
  v_dot2_f32_bf16 v15, v89, v89, v15
  v_dot2_f32_bf16 v12, v90, v26, v12
  buffer_load_dwordx4 v3, s[8:11], s63 offen offset:2048 lds
  v_dot2_f32_bf16 v14, v90, v90, v14
  v_dot2_f32_bf16 v13, v91, v26, v13
  v_dot2_f32_bf16 v15, v91, v91, v15
  v_dot2_f32_bf16 v12, v92, v26, v12
  v_dot2_f32_bf16 v14, v92, v92, v14
  v_dot2_f32_bf16 v13, v93, v26, v13
  v_dot2_f32_bf16 v15, v93, v93, v15
  v_dot2_f32_bf16 v12, v94, v26, v12
  v_dot2_f32_bf16 v14, v94, v94, v14
  v_dot2_f32_bf16 v13, v95, v26, v13
  v_dot2_f32_bf16 v15, v95, v95, v15
  buffer_load_dwordx4 v4, s[8:11], s63 offen offset:3072 lds
  s_waitcnt vmcnt(8)
  v_add_u32 v8, 0x10000, v8
  ds_read_b128 v[96:99], v8 offset:0
  v_add_u32 v9, 0x10000, v9
  ds_read_b128 v[100:103], v9 offset:0
  v_add_u32 v10, 0x10000, v10
  ds_read_b128 v[104:107], v10 offset:0
  v_add_u32 v11, 0x10000, v11
  ds_read_b128 v[108:111], v11 offset:0
  s_add_u32 m0, s58, 0
  s_nop 0
  buffer_load_dwordx4 v248, s[12:15], s68 offen offset:0 lds
  s_waitcnt lgkmcnt(0)
  v_dot2_f32_bf16 v12, v96, v26, v12
  v_dot2_f32_bf16 v14, v96, v96, v14
  v_dot2_f32_bf16 v13, v97, v26, v13
  v_dot2_f32_bf16 v15, v97, v97, v15
  v_dot2_f32_bf16 v12, v98, v26, v12
  v_dot2_f32_bf16 v14, v98, v98, v14
  v_dot2_f32_bf16 v13, v99, v26, v13
  v_dot2_f32_bf16 v15, v99, v99, v15
  v_dot2_f32_bf16 v12, v100, v26, v12
  v_dot2_f32_bf16 v14, v100, v100, v14
  buffer_load_dwordx4 v249, s[12:15], s68 offen offset:1024 lds
  v_dot2_f32_bf16 v13, v101, v26, v13
  v_dot2_f32_bf16 v15, v101, v101, v15
  v_dot2_f32_bf16 v12, v102, v26, v12
  v_dot2_f32_bf16 v14, v102, v102, v14
  v_dot2_f32_bf16 v13, v103, v26, v13
  v_dot2_f32_bf16 v15, v103, v103, v15
  v_dot2_f32_bf16 v12, v104, v26, v12
  v_dot2_f32_bf16 v14, v104, v104, v14
  v_dot2_f32_bf16 v13, v105, v26, v13
  v_dot2_f32_bf16 v15, v105, v105, v15
  v_dot2_f32_bf16 v12, v106, v26, v12
  buffer_load_dwordx4 v250, s[12:15], s68 offen offset:2048 lds
  v_dot2_f32_bf16 v14, v106, v106, v14
  v_dot2_f32_bf16 v13, v107, v26, v13
  v_dot2_f32_bf16 v15, v107, v107, v15
  v_dot2_f32_bf16 v12, v108, v26, v12
  v_dot2_f32_bf16 v14, v108, v108, v14
  v_dot2_f32_bf16 v13, v109, v26, v13
  v_dot2_f32_bf16 v15, v109, v109, v15
  v_dot2_f32_bf16 v12, v110, v26, v12
  v_dot2_f32_bf16 v14, v110, v110, v14
  v_dot2_f32_bf16 v13, v111, v26, v13
  v_dot2_f32_bf16 v15, v111, v111, v15
  buffer_load_dwordx4 v251, s[12:15], s68 offen offset:3072 lds
  s_waitcnt vmcnt(8)
  ds_read_b128 v[112:115], v8 offset:4096
  ds_read_b128 v[116:119], v9 offset:4096
  ds_read_b128 v[120:123], v10 offset:4096
  ds_read_b128 v[124:127], v11 offset:4096
  s_add_u32 m0, s58, 4096
  s_nop 0
  buffer_load_dwordx4 v252, s[12:15], s68 offen offset:0 lds
  s_waitcnt lgkmcnt(0)
  v_dot2_f32_bf16 v12, v112, v26, v12
  v_dot2_f32_bf16 v14, v112, v112, v14
  v_dot2_f32_bf16 v13, v113, v26, v13
  v_dot2_f32_bf16 v15, v113, v113, v15
  v_dot2_f32_bf16 v12, v114, v26, v12
  v_dot2_f32_bf16 v14, v114, v114, v14
  v_dot2_f32_bf16 v13, v115, v26, v13
  v_dot2_f32_bf16 v15, v115, v115, v15
  v_dot2_f32_bf16 v12, v116, v26, v12
  v_dot2_f32_bf16 v14, v116, v116, v14
  buffer_load_dwordx4 v253, s[12:15], s68 offen offset:1024 lds
  v_dot2_f32_bf16 v13, v117, v26, v13
  v_dot2_f32_bf16 v15, v117, v117, v15
  v_dot2_f32_bf16 v12, v118, v26, v12
  v_dot2_f32_bf16 v14, v118, v118, v14
  v_dot2_f32_bf16 v13, v119, v26, v13
  v_dot2_f32_bf16 v15, v119, v119, v15
  v_dot2_f32_bf16 v12, v120, v26, v12
  v_dot2_f32_bf16 v14, v120, v120, v14
  v_dot2_f32_bf16 v13, v121, v26, v13
  v_dot2_f32_bf16 v15, v121, v121, v15
  v_dot2_f32_bf16 v12, v122, v26, v12
  buffer_load_dwordx4 v254, s[12:15], s68 offen offset:2048 lds
  v_dot2_f32_bf16 v14, v122, v122, v14
  v_dot2_f32_bf16 v13, v123, v26, v13
  v_dot2_f32_bf16 v15, v123, v123, v15
  v_dot2_f32_bf16 v12, v124, v26, v12
  v_dot2_f32_bf16 v14, v124, v124, v14
  v_dot2_f32_bf16 v13, v125, v26, v13
  v_dot2_f32_bf16 v15, v125, v125, v15
  v_dot2_f32_bf16 v12, v126, v26, v12
  v_dot2_f32_bf16 v14, v126, v126, v14
  v_dot2_f32_bf16 v13, v127, v26, v13
  v_dot2_f32_bf16 v15, v127, v127, v15
  s_add_u32 s68, s68, 229376
  s_cmp_ge_u32 s68, 1605632
  s_cselect_b32 s68, 0, s68
  s_add_u32 m0, s58, 32768
  s_nop 0
  buffer_load_dwordx4 v248, s[12:15], s68 offen offset:0 lds
  s_waitcnt vmcnt(8)
  ds_read_b128 v[128:131], v8 offset:32768
  ds_read_b128 v[132:135], v9 offset:32768
  ds_read_b128 v[136:139], v10 offset:32768
  ds_read_b128 v[140:143], v11 offset:32768
  v_mov_b32 v8, v25
  buffer_load_dwordx4 v249, s[12:15], s68 offen offset:1024 lds
  s_waitcnt lgkmcnt(0)
  v_dot2_f32_bf16 v12, v128, v26, v12
  v_dot2_f32_bf16 v14, v128, v128, v14
  v_dot2_f32_bf16 v13, v129, v26, v13
  v_dot2_f32_bf16 v15, v129, v129, v15
  v_dot2_f32_bf16 v12, v130, v26, v12
  v_dot2_f32_bf16 v14, v130, v130, v14
  v_dot2_f32_bf16 v13, v131, v26, v13
  v_dot2_f32_bf16 v15, v131, v131, v15
  v_dot2_f32_bf16 v12, v132, v26, v12
  v_dot2_f32_bf16 v14, v132, v132, v14
  buffer_load_dwordx4 v250, s[12:15], s68 offen offset:2048 lds
  v_dot2_f32_bf16 v13, v133, v26, v13
  v_dot2_f32_bf16 v15, v133, v133, v15
  v_dot2_f32_bf16 v12, v134, v26, v12
  v_dot2_f32_bf16 v14, v134, v134, v14
  v_dot2_f32_bf16 v13, v135, v26, v13
  v_dot2_f32_bf16 v15, v135, v135, v15
  s_waitcnt vmcnt(3)
  s_barrier
  ds_read_b64_tr_b16 a[224:225], v8 offset:0
  ds_read_b64_tr_b16 a[226:227], v8 offset:896
  ds_read_b64_tr_b16 a[228:229], v8 offset:32
  ds_read_b64_tr_b16 a[230:231], v8 offset:928
  ds_read_b64_tr_b16 a[232:233], v8 offset:64
  ds_read_b64_tr_b16 a[234:235], v8 offset:960
  ds_read_b64_tr_b16 a[236:237], v8 offset:96
  ds_read_b64_tr_b16 a[238:239], v8 offset:992
  ds_read_b64_tr_b16 a[240:241], v8 offset:128
  ds_read_b64_tr_b16 a[242:243], v8 offset:1024
  ds_read_b64_tr_b16 a[244:245], v8 offset:160
  ds_read_b64_tr_b16 a[246:247], v8 offset:1056
  ds_read_b64_tr_b16 a[248:249], v8 offset:192
  ds_read_b64_tr_b16 a[250:251], v8 offset:1088
  v_dot2_f32_bf16 v12, v136, v26, v12
  v_dot2_f32_bf16 v14, v136, v136, v14
  buffer_load_dwordx4 v251, s[12:15], s68 offen offset:3072 lds
  v_dot2_f32_bf16 v13, v137, v26, v13
  v_dot2_f32_bf16 v15, v137, v137, v15
  v_dot2_f32_bf16 v12, v138, v26, v12
  v_dot2_f32_bf16 v14, v138, v138, v14
  v_dot2_f32_bf16 v13, v139, v26, v13
  v_dot2_f32_bf16 v15, v139, v139, v15
  v_dot2_f32_bf16 v12, v140, v26, v12
  v_dot2_f32_bf16 v14, v140, v140, v14
  v_dot2_f32_bf16 v13, v141, v26, v13
  v_dot2_f32_bf16 v15, v141, v141, v15
  v_dot2_f32_bf16 v12, v142, v26, v12
  v_dot2_f32_bf16 v14, v142, v142, v14
  v_dot2_f32_bf16 v13, v143, v26, v13
  v_dot2_f32_bf16 v15, v143, v143, v15
  s_nop 1
  v_add_f32 v12, v12, v13
  v_add_f32 v14, v14, v15
  v_mov_b32 v13, v12
  v_mov_b32 v15, v14
  s_nop 0
  v_permlane32_swap_b32 v12, v13
  v_permlane32_swap_b32 v14, v15
  v_add_f32 v12, v12, v13
  v_add_f32 v14, v14, v15
  v_mul_f32 v13, 0x3b124925, v12
  v_mul_f32 v14, 0x3b124925, v14
  v_fma_f32 v14, -v13, v13, v14
  v_max_f32 v14, 0, v14
  v_add_f32 v14, 0x3727c5ac, v14
  v_rsq_f32 v12, v14
  s_nop 0
  v_mul_f32 v12, 0x3db8aa3b, v12
  v_mul_f32 v13, v13, v12
  v_sub_f32 v13, 0, v13
  v_mov_b32 v14, 0
  v_mov_b32 v15, 0
  s_add_u32 m0, s58, 36864
  s_nop 0
  buffer_load_dwordx4 v252, s[12:15], s68 offen offset:0 lds
  v_lshlrev_b32 v18, 16, v32
  v_and_b32 v19, s67, v32
  v_fma_f32 v18, v18, v12, v13
  v_fma_f32 v19, v19, v12, v13
  v_cvt_pk_bf16_f32 v32, v18, v19
  v_lshlrev_b32 v16, 16, v33
  v_and_b32 v17, s67, v33
  v_fma_f32 v16, v16, v12, v13
  v_fma_f32 v17, v17, v12, v13
  v_cvt_pk_bf16_f32 v33, v16, v17
  v_lshlrev_b32 v18, 16, v34
  v_and_b32 v19, s67, v34
  v_fma_f32 v18, v18, v12, v13
  v_fma_f32 v19, v19, v12, v13
  v_cvt_pk_bf16_f32 v34, v18, v19
  v_lshlrev_b32 v16, 16, v35
  v_and_b32 v17, s67, v35
  v_fma_f32 v16, v16, v12, v13
  v_fma_f32 v17, v17, v12, v13
  v_cvt_pk_bf16_f32 v35, v16, v17
  s_waitcnt lgkmcnt(6)
  s_nop 0
  v_mfma_f32_32x32x16_bf16 a[0:15], a[224:227], v[32:35], 0
  ds_read_b64_tr_b16 a[252:253], v8 offset:3584
  ds_read_b64_tr_b16 a[254:255], v8 offset:4480
  buffer_load_dwordx4 v253, s[12:15], s68 offen offset:1024 lds
  v_lshlrev_b32 v18, 16, v36
  v_mfma_f32_32x32x16_bf16 a[16:31], a[228:231], v[32:35], 0
  ds_read_b64_tr_b16 a[224:225], v8 offset:3616
  ds_read_b64_tr_b16 a[226:227], v8 offset:4512
  buffer_load_dwordx4 v254, s[12:15], s68 offen offset:2048 lds
  v_and_b32 v19, s67, v36
  v_mfma_f32_32x32x16_bf16 a[32:47], a[232:235], v[32:35], 0
  ds_read_b64_tr_b16 a[228:229], v8 offset:3648
  ds_read_b64_tr_b16 a[230:231], v8 offset:4544
  s_add_u32 s68, s68, 229376
  s_cmp_ge_u32 s68, 1605632
  s_cselect_b32 s68, 0, s68
  s_add_u32 m0, s58, 65536
  s_nop 0
  buffer_load_dwordx4 v248, s[12:15], s68 offen offset:0 lds
  v_mfma_f32_32x32x16_bf16 a[48:63], a[236:239], v[32:35], 0
  ds_read_b64_tr_b16 a[232:233], v8 offset:3680
  ds_read_b64_tr_b16 a[234:235], v8 offset:4576
  s_add_u32 s8, s54, 0x1800000
  s_addc_u32 s9, s55, 0
  s_mov_b32 s10, 65536
  s_waitcnt lgkmcnt(6)
  v_mfma_f32_32x32x16_bf16 a[64:79], a[240:243], v[32:35], 0
  ds_read_b64_tr_b16 a[236:237], v8 offset:3712
  ds_read_b64_tr_b16 a[238:239], v8 offset:4608
  buffer_load_dwordx4 v249, s[12:15], s68 offen offset:1024 lds
  v_fma_f32 v18, v18, v12, v13
  v_mfma_f32_32x32x16_bf16 a[80:95], a[244:247], v[32:35], 0
  ds_read_b64_tr_b16 a[240:241], v8 offset:3744
  ds_read_b64_tr_b16 a[242:243], v8 offset:4640
  buffer_load_dwordx4 v250, s[12:15], s68 offen offset:2048 lds
  v_fma_f32 v19, v19, v12, v13
  v_mfma_f32_32x32x16_bf16 a[96:111], a[248:251], v[32:35], 0
  ds_read_b64_tr_b16 a[244:245], v8 offset:3776
  ds_read_b64_tr_b16 a[246:247], v8 offset:4672
  buffer_load_dwordx4 v251, s[12:15], s68 offen offset:3072 lds
  v_cvt_pk_bf16_f32 v36, v18, v19
  v_lshlrev_b32 v16, 16, v37
  v_and_b32 v17, s67, v37
  v_fma_f32 v16, v16, v12, v13
  v_fma_f32 v17, v17, v12, v13
  v_cvt_pk_bf16_f32 v37, v16, v17
  v_lshlrev_b32 v18, 16, v38
  v_and_b32 v19, s67, v38
  v_fma_f32 v18, v18, v12, v13
  v_fma_f32 v19, v19, v12, v13
  v_cvt_pk_bf16_f32 v38, v18, v19
  v_lshlrev_b32 v16, 16, v39
  v_and_b32 v17, s67, v39
  v_fma_f32 v16, v16, v12, v13
  v_fma_f32 v17, v17, v12, v13
  v_cvt_pk_bf16_f32 v39, v16, v17
  s_nop 1
  v_mfma_f32_32x32x16_bf16 a[0:15], a[252:255], v[36:39], a[0:15]
  ds_read_b64_tr_b16 a[248:249], v8 offset:8192
  ds_read_b64_tr_b16 a[250:251], v8 offset:9088
  s_add_u32 m0, s58, 69632
  v_lshlrev_b32 v18, 16, v40
  v_and_b32 v19, s67, v40
  s_waitcnt lgkmcnt(6)
  v_mfma_f32_32x32x16_bf16 a[16:31], a[224:227], v[36:39], a[16:31]
  ds_read_b64_tr_b16 a[252:253], v8 offset:8224
  ds_read_b64_tr_b16 a[254:255], v8 offset:9120
  buffer_load_dwordx4 v252, s[12:15], s68 offen offset:0 lds
  v_fma_f32 v18, v18, v12, v13
  v_mfma_f32_32x32x16_bf16 a[32:47], a[228:231], v[36:39], a[32:47]
  ds_read_b64_tr_b16 a[224:225], v8 offset:8256
  ds_read_b64_tr_b16 a[226:227], v8 offset:9152
  buffer_load_dwordx4 v253, s[12:15], s68 offen offset:1024 lds
  v_fma_f32 v19, v19, v12, v13
  v_mfma_f32_32x32x16_bf16 a[48:63], a[232:235], v[36:39], a[48:63]
  ds_read_b64_tr_b16 a[228:229], v8 offset:8288
  ds_read_b64_tr_b16 a[230:231], v8 offset:9184
  buffer_load_dwordx4 v254, s[12:15], s68 offen offset:2048 lds
  s_and_b32 s5, s2, 4
  s_lshl_b32 s5, s5, 5
  s_lshr_b32 s61, s2, 5
  s_lshl_b32 s61, s61, 4
  v_mfma_f32_32x32x16_bf16 a[64:79], a[236:239], v[36:39], a[64:79]
  ds_read_b64_tr_b16 a[232:233], v8 offset:8320
  ds_read_b64_tr_b16 a[234:235], v8 offset:9216
  s_add_u32 s68, s68, 229376
  s_cmp_ge_u32 s68, 1605632
  s_cselect_b32 s68, 0, s68
  s_add_u32 m0, s58, 98304
  s_waitcnt lgkmcnt(6)
  v_mfma_f32_32x32x16_bf16 a[80:95], a[240:243], v[36:39], a[80:95]
  ds_read_b64_tr_b16 a[236:237], v8 offset:8352
  ds_read_b64_tr_b16 a[238:239], v8 offset:9248
  buffer_load_dwordx4 v248, s[12:15], s68 offen offset:0 lds
  v_cvt_pk_bf16_f32 v40, v18, v19
  v_mfma_f32_32x32x16_bf16 a[96:111], a[244:247], v[36:39], a[96:111]
  ds_read_b64_tr_b16 a[240:241], v8 offset:8384
  ds_read_b64_tr_b16 a[242:243], v8 offset:9280
  buffer_load_dwordx4 v249, s[12:15], s68 offen offset:1024 lds
  v_lshlrev_b32 v16, 16, v41
  v_and_b32 v17, s67, v41
  v_fma_f32 v16, v16, v12, v13
  v_fma_f32 v17, v17, v12, v13
  v_cvt_pk_bf16_f32 v41, v16, v17
  v_lshlrev_b32 v18, 16, v42
  v_and_b32 v19, s67, v42
  v_fma_f32 v18, v18, v12, v13
  v_fma_f32 v19, v19, v12, v13
  v_cvt_pk_bf16_f32 v42, v18, v19
  v_lshlrev_b32 v16, 16, v43
  v_and_b32 v17, s67, v43
  v_fma_f32 v16, v16, v12, v13
  v_fma_f32 v17, v17, v12, v13
  v_cvt_pk_bf16_f32 v43, v16, v17
  s_nop 1
  v_mfma_f32_32x32x16_bf16 a[0:15], a[248:251], v[40:43], a[0:15]
  ds_read_b64_tr_b16 a[244:245], v8 offset:11776
  ds_read_b64_tr_b16 a[246:247], v8 offset:12672
  s_add_u32 s5, s5, s61
  s_add_u32 s5, s5, s6
  s_lshl_b32 s61, s5, 8
  v_lshlrev_b32 v240, 2, v0
  v_mfma_f32_32x32x16_bf16 a[16:31], a[252:255], v[40:43], a[16:31]
  ds_read_b64_tr_b16 a[248:249], v8 offset:11808
  ds_read_b64_tr_b16 a[250:251], v8 offset:12704
  v_lshlrev_b32 v18, 16, v44
  v_and_b32 v19, s67, v44
  v_fma_f32 v18, v18, v12, v13
  s_waitcnt lgkmcnt(6)
  v_mfma_f32_32x32x16_bf16 a[32:47], a[224:227], v[40:43], a[32:47]
  ds_read_b64_tr_b16 a[252:253], v8 offset:11840
  ds_read_b64_tr_b16 a[254:255], v8 offset:12736
  buffer_load_dwordx4 v250, s[12:15], s68 offen offset:2048 lds
  v_fma_f32 v19, v19, v12, v13
  v_mfma_f32_32x32x16_bf16 a[48:63], a[228:231], v[40:43], a[48:63]
  ds_read_b64_tr_b16 a[224:225], v8 offset:11872
  ds_read_b64_tr_b16 a[226:227], v8 offset:12768
  buffer_load_dwordx4 v251, s[12:15], s68 offen offset:3072 lds
  s_add_u32 m0, s58, 102400
  v_mfma_f32_32x32x16_bf16 a[64:79], a[232:235], v[40:43], a[64:79]
  ds_read_b64_tr_b16 a[228:229], v8 offset:11904
  ds_read_b64_tr_b16 a[230:231], v8 offset:12800
  buffer_load_dwordx4 v252, s[12:15], s68 offen offset:0 lds
  v_cvt_pk_bf16_f32 v44, v18, v19
  v_mfma_f32_32x32x16_bf16 a[80:95], a[236:239], v[40:43], a[80:95]
  ds_read_b64_tr_b16 a[232:233], v8 offset:11936
  ds_read_b64_tr_b16 a[234:235], v8 offset:12832
  v_lshlrev_b32 v16, 16, v45
  v_and_b32 v17, s67, v45
  v_fma_f32 v16, v16, v12, v13
  s_waitcnt lgkmcnt(6)
  v_mfma_f32_32x32x16_bf16 a[96:111], a[240:243], v[40:43], a[96:111]
  ds_read_b64_tr_b16 a[236:237], v8 offset:11968
  ds_read_b64_tr_b16 a[238:239], v8 offset:12864
  buffer_load_dwordx4 v253, s[12:15], s68 offen offset:1024 lds
  v_fma_f32 v17, v17, v12, v13
  v_cvt_pk_bf16_f32 v45, v16, v17
  v_lshlrev_b32 v18, 16, v46
  v_and_b32 v19, s67, v46
  v_fma_f32 v18, v18, v12, v13
  v_fma_f32 v19, v19, v12, v13
  v_cvt_pk_bf16_f32 v46, v18, v19
  v_lshlrev_b32 v16, 16, v47
  v_and_b32 v17, s67, v47
  v_fma_f32 v16, v16, v12, v13
  v_fma_f32 v17, v17, v12, v13
  v_cvt_pk_bf16_f32 v47, v16, v17
  s_nop 1
  v_mfma_f32_32x32x16_bf16 a[0:15], a[244:247], v[44:47], a[0:15]
  s_waitcnt vmcnt(13)
  s_barrier
  ds_read_b64_tr_b16 a[240:241], v8 offset:32768
  ds_read_b64_tr_b16 a[242:243], v8 offset:33664
  v_mov_b32 v241, 0
  v_mfma_f32_32x32x16_bf16 a[16:31], a[248:251], v[44:47], a[16:31]
  ds_read_b64_tr_b16 a[244:245], v8 offset:32800
  ds_read_b64_tr_b16 a[246:247], v8 offset:33696
  buffer_load_dwordx4 v254, s[12:15], s68 offen offset:2048 lds
  v_lshlrev_b32 v18, 16, v48
  v_mfma_f32_32x32x16_bf16 a[32:47], a[252:255], v[44:47], a[32:47]
  ds_read_b64_tr_b16 a[248:249], v8 offset:32832
  ds_read_b64_tr_b16 a[250:251], v8 offset:33728
  s_add_u32 s68, s68, 229376
  s_cmp_ge_u32 s68, 1605632
  s_cselect_b32 s68, 0, s68
  s_waitcnt lgkmcnt(6)
  v_mfma_f32_32x32x16_bf16 a[48:63], a[224:227], v[44:47], a[48:63]
  ds_read_b64_tr_b16 a[252:253], v8 offset:32864
  ds_read_b64_tr_b16 a[254:255], v8 offset:33760
  s_add_u32 m0, s58, 131072
  v_and_b32 v19, s67, v48
  v_fma_f32 v18, v18, v12, v13
  v_fma_f32 v19, v19, v12, v13
  v_mfma_f32_32x32x16_bf16 a[64:79], a[228:231], v[44:47], a[64:79]
  ds_read_b64_tr_b16 a[224:225], v8 offset:32896
  ds_read_b64_tr_b16 a[226:227], v8 offset:33792
  v_cvt_pk_bf16_f32 v48, v18, v19
  v_lshlrev_b32 v16, 16, v49
  v_and_b32 v17, s67, v49
  v_fma_f32 v16, v16, v12, v13
  v_mfma_f32_32x32x16_bf16 a[80:95], a[232:235], v[44:47], a[80:95]
  ds_read_b64_tr_b16 a[228:229], v8 offset:32928
  ds_read_b64_tr_b16 a[230:231], v8 offset:33824
  buffer_load_dwordx4 v248, s[12:15], s68 offen offset:0 lds
  v_fma_f32 v17, v17, v12, v13
  v_mfma_f32_32x32x16_bf16 a[96:111], a[236:239], v[44:47], a[96:111]
  ds_read_b64_tr_b16 a[232:233], v8 offset:32960
  ds_read_b64_tr_b16 a[234:235], v8 offset:33856
  v_cvt_pk_bf16_f32 v49, v16, v17
  v_lshlrev_b32 v18, 16, v50
  v_and_b32 v19, s67, v50
  v_fma_f32 v18, v18, v12, v13
  v_fma_f32 v19, v19, v12, v13
  v_cvt_pk_bf16_f32 v50, v18, v19
  v_lshlrev_b32 v16, 16, v51
  v_and_b32 v17, s67, v51
  v_fma_f32 v16, v16, v12, v13
  v_fma_f32 v17, v17, v12, v13
  v_cvt_pk_bf16_f32 v51, v16, v17
  s_waitcnt lgkmcnt(6)
  s_nop 0
  v_mfma_f32_32x32x16_bf16 a[0:15], a[240:243], v[48:51], a[0:15]
  ds_read_b64_tr_b16 a[236:237], v8 offset:36352
  ds_read_b64_tr_b16 a[238:239], v8 offset:37248
  buffer_load_dwordx4 v249, s[12:15], s68 offen offset:1024 lds
  v_lshlrev_b32 v18, 16, v52
  v_mfma_f32_32x32x16_bf16 a[16:31], a[244:247], v[48:51], a[16:31]
  ds_read_b64_tr_b16 a[240:241], v8 offset:36384
  ds_read_b64_tr_b16 a[242:243], v8 offset:37280
  buffer_load_dwordx4 v250, s[12:15], s68 offen offset:2048 lds
  buffer_store_dword v241, v240, s[8:11], s61 offen offset:0 sc1
  v_mfma_f32_32x32x16_bf16 a[32:47], a[248:251], v[48:51], a[32:47]
  ds_read_b64_tr_b16 a[244:245], v8 offset:36416
  ds_read_b64_tr_b16 a[246:247], v8 offset:37312
  v_and_b32 v19, s67, v52
  v_fma_f32 v18, v18, v12, v13
  v_fma_f32 v19, v19, v12, v13
  v_cvt_pk_bf16_f32 v52, v18, v19
  v_mfma_f32_32x32x16_bf16 a[48:63], a[252:255], v[48:51], a[48:63]
  ds_read_b64_tr_b16 a[248:249], v8 offset:36448
  ds_read_b64_tr_b16 a[250:251], v8 offset:37344
  v_lshlrev_b32 v16, 16, v53
  v_and_b32 v17, s67, v53
  v_fma_f32 v16, v16, v12, v13
  s_waitcnt lgkmcnt(6)
  v_mfma_f32_32x32x16_bf16 a[64:79], a[224:227], v[48:51], a[64:79]
  ds_read_b64_tr_b16 a[252:253], v8 offset:36480
  ds_read_b64_tr_b16 a[254:255], v8 offset:37376
  buffer_load_dwordx4 v251, s[12:15], s68 offen offset:3072 lds
  s_add_u32 m0, s58, 135168
  v_mfma_f32_32x32x16_bf16 a[80:95], a[228:231], v[48:51], a[80:95]
  ds_read_b64_tr_b16 a[224:225], v8 offset:36512
  ds_read_b64_tr_b16 a[226:227], v8 offset:37408
  buffer_load_dwordx4 v252, s[12:15], s68 offen offset:0 lds
  v_fma_f32 v17, v17, v12, v13
  v_mfma_f32_32x32x16_bf16 a[96:111], a[232:235], v[48:51], a[96:111]
  ds_read_b64_tr_b16 a[228:229], v8 offset:36544
  ds_read_b64_tr_b16 a[230:231], v8 offset:37440
  buffer_load_dwordx4 v253, s[12:15], s68 offen offset:1024 lds
  v_cvt_pk_bf16_f32 v53, v16, v17
  v_lshlrev_b32 v18, 16, v54
  v_and_b32 v19, s67, v54
  v_fma_f32 v18, v18, v12, v13
  v_fma_f32 v19, v19, v12, v13
  v_cvt_pk_bf16_f32 v54, v18, v19
  v_lshlrev_b32 v16, 16, v55
  v_and_b32 v17, s67, v55
  v_fma_f32 v16, v16, v12, v13
  v_fma_f32 v17, v17, v12, v13
  v_cvt_pk_bf16_f32 v55, v16, v17
  s_nop 1
  v_mfma_f32_32x32x16_bf16 a[0:15], a[236:239], v[52:55], a[0:15]
  ds_read_b64_tr_b16 a[232:233], v8 offset:40960
  ds_read_b64_tr_b16 a[234:235], v8 offset:41856
  v_accvgpr_read_b32 v5, a132
  v_lshlrev_b32 v18, 16, v56
  v_and_b32 v19, s67, v56
  s_waitcnt lgkmcnt(6)
  v_mfma_f32_32x32x16_bf16 a[16:31], a[240:243], v[52:55], a[16:31]
  ds_read_b64_tr_b16 a[236:237], v8 offset:40992
  ds_read_b64_tr_b16 a[238:239], v8 offset:41888
  buffer_load_dwordx4 v254, s[12:15], s68 offen offset:2048 lds
  v_fma_f32 v18, v18, v12, v13
  v_mfma_f32_32x32x16_bf16 a[32:47], a[244:247], v[52:55], a[32:47]
  ds_read_b64_tr_b16 a[240:241], v8 offset:41024
  ds_read_b64_tr_b16 a[242:243], v8 offset:41920
  buffer_load_dword a200, v5, s[16:19], 0 offen offset:0
  v_fma_f32 v19, v19, v12, v13
  v_mfma_f32_32x32x16_bf16 a[48:63], a[248:251], v[52:55], a[48:63]
  ds_read_b64_tr_b16 a[244:245], v8 offset:41056
  ds_read_b64_tr_b16 a[246:247], v8 offset:41952
  v_cvt_pk_bf16_f32 v56, v18, v19
  v_lshlrev_b32 v16, 16, v57
  v_and_b32 v17, s67, v57
  v_fma_f32 v16, v16, v12, v13
  v_mfma_f32_32x32x16_bf16 a[64:79], a[252:255], v[52:55], a[64:79]
  ds_read_b64_tr_b16 a[248:249], v8 offset:41088
  ds_read_b64_tr_b16 a[250:251], v8 offset:41984
  v_fma_f32 v17, v17, v12, v13
  v_cvt_pk_bf16_f32 v57, v16, v17
  v_lshlrev_b32 v18, 16, v58
  s_waitcnt lgkmcnt(6)
  v_mfma_f32_32x32x16_bf16 a[80:95], a[224:227], v[52:55], a[80:95]
  ds_read_b64_tr_b16 a[252:253], v8 offset:41120
  ds_read_b64_tr_b16 a[254:255], v8 offset:42016
  v_and_b32 v19, s67, v58
  v_fma_f32 v18, v18, v12, v13
  v_fma_f32 v19, v19, v12, v13
  v_cvt_pk_bf16_f32 v58, v18, v19
  v_mfma_f32_32x32x16_bf16 a[96:111], a[228:231], v[52:55], a[96:111]
  ds_read_b64_tr_b16 a[224:225], v8 offset:41152
  ds_read_b64_tr_b16 a[226:227], v8 offset:42048
  v_lshlrev_b32 v16, 16, v59
  v_and_b32 v17, s67, v59
  v_fma_f32 v16, v16, v12, v13
  v_fma_f32 v17, v17, v12, v13
  v_cvt_pk_bf16_f32 v59, v16, v17
  s_nop 1
  v_mfma_f32_32x32x16_bf16 a[0:15], a[232:235], v[56:59], a[0:15]
  ds_read_b64_tr_b16 a[228:229], v8 offset:44544
  ds_read_b64_tr_b16 a[230:231], v8 offset:45440
  v_lshlrev_b32 v18, 16, v60
  v_and_b32 v19, s67, v60
  v_fma_f32 v18, v18, v12, v13
  v_fma_f32 v19, v19, v12, v13
  v_mfma_f32_32x32x16_bf16 a[16:31], a[236:239], v[56:59], a[16:31]
  ds_read_b64_tr_b16 a[232:233], v8 offset:44576
  ds_read_b64_tr_b16 a[234:235], v8 offset:45472
  v_cvt_pk_bf16_f32 v60, v18, v19
  v_lshlrev_b32 v16, 16, v61
  v_and_b32 v17, s67, v61
  s_waitcnt lgkmcnt(6)
  v_mfma_f32_32x32x16_bf16 a[32:47], a[240:243], v[56:59], a[32:47]
  ds_read_b64_tr_b16 a[236:237], v8 offset:44608
  ds_read_b64_tr_b16 a[238:239], v8 offset:45504
  v_fma_f32 v16, v16, v12, v13
  v_fma_f32 v17, v17, v12, v13
  v_cvt_pk_bf16_f32 v61, v16, v17
  v_lshlrev_b32 v18, 16, v62
  v_mfma_f32_32x32x16_bf16 a[48:63], a[244:247], v[56:59], a[48:63]
  ds_read_b64_tr_b16 a[240:241], v8 offset:44640
  ds_read_b64_tr_b16 a[242:243], v8 offset:45536
  v_and_b32 v19, s67, v62
  v_fma_f32 v18, v18, v12, v13
  v_fma_f32 v19, v19, v12, v13
  v_cvt_pk_bf16_f32 v62, v18, v19
  v_mfma_f32_32x32x16_bf16 a[64:79], a[248:251], v[56:59], a[64:79]
  ds_read_b64_tr_b16 a[244:245], v8 offset:44672
  ds_read_b64_tr_b16 a[246:247], v8 offset:45568
  v_lshlrev_b32 v16, 16, v63
  v_and_b32 v17, s67, v63
  v_fma_f32 v16, v16, v12, v13
  v_fma_f32 v17, v17, v12, v13
  v_mfma_f32_32x32x16_bf16 a[80:95], a[252:255], v[56:59], a[80:95]
  ds_read_b64_tr_b16 a[248:249], v8 offset:44704
  ds_read_b64_tr_b16 a[250:251], v8 offset:45600
  v_cvt_pk_bf16_f32 v63, v16, v17
  v_lshlrev_b32 v18, 16, v64
  v_and_b32 v19, s67, v64
  s_waitcnt lgkmcnt(6)
  v_mfma_f32_32x32x16_bf16 a[96:111], a[224:227], v[56:59], a[96:111]
  ds_read_b64_tr_b16 a[252:253], v8 offset:44736
  ds_read_b64_tr_b16 a[254:255], v8 offset:45632
  v_fma_f32 v18, v18, v12, v13
  v_fma_f32 v19, v19, v12, v13
  v_cvt_pk_bf16_f32 v64, v18, v19
  v_lshlrev_b32 v16, 16, v65
  v_mfma_f32_32x32x16_bf16 a[0:15], a[228:231], v[60:63], a[0:15]
  s_waitcnt vmcnt(16)
  s_barrier
  v_add_u32 v8, 0x10000, v8
  ds_read_b64_tr_b16 a[224:225], v8 offset:0
  ds_read_b64_tr_b16 a[226:227], v8 offset:896
  v_mfma_f32_32x32x16_bf16 a[16:31], a[232:235], v[60:63], a[16:31]
  ds_read_b64_tr_b16 a[228:229], v8 offset:32
  ds_read_b64_tr_b16 a[230:231], v8 offset:928
  s_add_u32 s68, s68, 229376
  s_cmp_ge_u32 s68, 1605632
  s_cselect_b32 s68, 0, s68
  s_add_u32 m0, s58, 0
  v_mfma_f32_32x32x16_bf16 a[32:47], a[236:239], v[60:63], a[32:47]
  ds_read_b64_tr_b16 a[232:233], v8 offset:64
  ds_read_b64_tr_b16 a[234:235], v8 offset:960
  v_and_b32 v17, s67, v65
  v_fma_f32 v16, v16, v12, v13
  v_fma_f32 v17, v17, v12, v13
  s_waitcnt lgkmcnt(6)
  v_mfma_f32_32x32x16_bf16 a[48:63], a[240:243], v[60:63], a[48:63]
  ds_read_b64_tr_b16 a[236:237], v8 offset:96
  ds_read_b64_tr_b16 a[238:239], v8 offset:992
  buffer_load_dwordx4 v248, s[12:15], s68 offen offset:0 lds
  v_cvt_pk_bf16_f32 v65, v16, v17
  v_mfma_f32_32x32x16_bf16 a[64:79], a[244:247], v[60:63], a[64:79]
  ds_read_b64_tr_b16 a[240:241], v8 offset:128
  ds_read_b64_tr_b16 a[242:243], v8 offset:1024
  v_lshlrev_b32 v18, 16, v66
  v_and_b32 v19, s67, v66
  v_fma_f32 v18, v18, v12, v13
  v_fma_f32 v19, v19, v12, v13
  v_mfma_f32_32x32x16_bf16 a[80:95], a[248:251], v[60:63], a[80:95]
  ds_read_b64_tr_b16 a[244:245], v8 offset:160
  ds_read_b64_tr_b16 a[246:247], v8 offset:1056
  buffer_load_dwordx4 v249, s[12:15], s68 offen offset:1024 lds
  v_cvt_pk_bf16_f32 v66, v18, v19
  v_mfma_f32_32x32x16_bf16 a[96:111], a[252:255], v[60:63], a[96:111]
  ds_read_b64_tr_b16 a[248:249], v8 offset:192
  ds_read_b64_tr_b16 a[250:251], v8 offset:1088
  v_lshlrev_b32 v16, 16, v67
  v_and_b32 v17, s67, v67
  v_fma_f32 v16, v16, v12, v13
  v_fma_f32 v17, v17, v12, v13
  v_cvt_pk_bf16_f32 v67, v16, v17
  s_waitcnt lgkmcnt(6)
  s_nop 0
  v_mfma_f32_32x32x16_bf16 a[0:15], a[224:227], v[64:67], a[0:15]
  ds_read_b64_tr_b16 a[252:253], v8 offset:3584
  ds_read_b64_tr_b16 a[254:255], v8 offset:4480
  v_lshlrev_b32 v18, 16, v68
  v_and_b32 v19, s67, v68
  v_fma_f32 v18, v18, v12, v13
  v_fma_f32 v19, v19, v12, v13
  v_mfma_f32_32x32x16_bf16 a[16:31], a[228:231], v[64:67], a[16:31]
  ds_read_b64_tr_b16 a[224:225], v8 offset:3616
  ds_read_b64_tr_b16 a[226:227], v8 offset:4512
  v_cvt_pk_bf16_f32 v68, v18, v19
  v_lshlrev_b32 v16, 16, v69
  v_and_b32 v17, s67, v69
  v_fma_f32 v16, v16, v12, v13
  v_mfma_f32_32x32x16_bf16 a[32:47], a[232:235], v[64:67], a[32:47]
  ds_read_b64_tr_b16 a[228:229], v8 offset:3648
  ds_read_b64_tr_b16 a[230:231], v8 offset:4544
  buffer_load_dwordx4 v250, s[12:15], s68 offen offset:2048 lds
  v_fma_f32 v17, v17, v12, v13
  v_mfma_f32_32x32x16_bf16 a[48:63], a[236:239], v[64:67], a[48:63]
  ds_read_b64_tr_b16 a[232:233], v8 offset:3680
  ds_read_b64_tr_b16 a[234:235], v8 offset:4576
  v_cvt_pk_bf16_f32 v69, v16, v17
  v_lshlrev_b32 v18, 16, v70
  v_and_b32 v19, s67, v70
  s_waitcnt lgkmcnt(6)
  v_mfma_f32_32x32x16_bf16 a[64:79], a[240:243], v[64:67], a[64:79]
  ds_read_b64_tr_b16 a[236:237], v8 offset:3712
  ds_read_b64_tr_b16 a[238:239], v8 offset:4608
  v_fma_f32 v18, v18, v12, v13
  v_fma_f32 v19, v19, v12, v13
  v_cvt_pk_bf16_f32 v70, v18, v19
  v_lshlrev_b32 v16, 16, v71
  v_mfma_f32_32x32x16_bf16 a[80:95], a[244:247], v[64:67], a[80:95]
  ds_read_b64_tr_b16 a[240:241], v8 offset:3744
  ds_read_b64_tr_b16 a[242:243], v8 offset:4640
  buffer_load_dwordx4 v251, s[12:15], s68 offen offset:3072 lds
  v_and_b32 v17, s67, v71
  v_mfma_f32_32x32x16_bf16 a[96:111], a[248:251], v[64:67], a[96:111]
  ds_read_b64_tr_b16 a[244:245], v8 offset:3776
  ds_read_b64_tr_b16 a[246:247], v8 offset:4672
  v_fma_f32 v16, v16, v12, v13
  v_fma_f32 v17, v17, v12, v13
  v_cvt_pk_bf16_f32 v71, v16, v17
  s_add_u32 m0, s58, 4096
  s_nop 0
  v_mfma_f32_32x32x16_bf16 a[0:15], a[252:255], v[68:71], a[0:15]
  ds_read_b64_tr_b16 a[248:249], v8 offset:8192
  ds_read_b64_tr_b16 a[250:251], v8 offset:9088
  v_lshlrev_b32 v18, 16, v72
  v_and_b32 v19, s67, v72
  v_fma_f32 v18, v18, v12, v13
  s_waitcnt lgkmcnt(6)
  v_mfma_f32_32x32x16_bf16 a[16:31], a[224:227], v[68:71], a[16:31]
  ds_read_b64_tr_b16 a[252:253], v8 offset:8224
  ds_read_b64_tr_b16 a[254:255], v8 offset:9120
  v_fma_f32 v19, v19, v12, v13
  v_cvt_pk_bf16_f32 v72, v18, v19
  v_lshlrev_b32 v16, 16, v73
  v_and_b32 v17, s67, v73
  v_mfma_f32_32x32x16_bf16 a[32:47], a[228:231], v[68:71], a[32:47]
  ds_read_b64_tr_b16 a[224:225], v8 offset:8256
  ds_read_b64_tr_b16 a[226:227], v8 offset:9152
  buffer_load_dwordx4 v252, s[12:15], s68 offen offset:0 lds
  v_fma_f32 v16, v16, v12, v13
  v_mfma_f32_32x32x16_bf16 a[48:63], a[232:235], v[68:71], a[48:63]
  ds_read_b64_tr_b16 a[228:229], v8 offset:8288
  ds_read_b64_tr_b16 a[230:231], v8 offset:9184
  v_fma_f32 v17, v17, v12, v13
  v_cvt_pk_bf16_f32 v73, v16, v17
  v_lshlrev_b32 v18, 16, v74
  v_and_b32 v19, s67, v74
  v_mfma_f32_32x32x16_bf16 a[64:79], a[236:239], v[68:71], a[64:79]
  ds_read_b64_tr_b16 a[232:233], v8 offset:8320
  ds_read_b64_tr_b16 a[234:235], v8 offset:9216
  v_fma_f32 v18, v18, v12, v13
  v_fma_f32 v19, v19, v12, v13
  v_cvt_pk_bf16_f32 v74, v18, v19
  s_waitcnt lgkmcnt(6)
  v_mfma_f32_32x32x16_bf16 a[80:95], a[240:243], v[68:71], a[80:95]
  ds_read_b64_tr_b16 a[236:237], v8 offset:8352
  ds_read_b64_tr_b16 a[238:239], v8 offset:9248
  buffer_load_dwordx4 v253, s[12:15], s68 offen offset:1024 lds
  v_lshlrev_b32 v16, 16, v75
  v_mfma_f32_32x32x16_bf16 a[96:111], a[244:247], v[68:71], a[96:111]
  ds_read_b64_tr_b16 a[240:241], v8 offset:8384
  ds_read_b64_tr_b16 a[242:243], v8 offset:9280
  v_and_b32 v17, s67, v75
  v_fma_f32 v16, v16, v12, v13
  v_fma_f32 v17, v17, v12, v13
  v_cvt_pk_bf16_f32 v75, v16, v17
  s_nop 1
  v_mfma_f32_32x32x16_bf16 a[0:15], a[248:251], v[72:75], a[0:15]
  ds_read_b64_tr_b16 a[244:245], v8 offset:11776
  ds_read_b64_tr_b16 a[246:247], v8 offset:12672
  v_lshlrev_b32 v18, 16, v76
  v_and_b32 v19, s67, v76
  v_fma_f32 v18, v18, v12, v13
  v_fma_f32 v19, v19, v12, v13
  v_mfma_f32_32x32x16_bf16 a[16:31], a[252:255], v[72:75], a[16:31]
  ds_read_b64_tr_b16 a[248:249], v8 offset:11808
  ds_read_b64_tr_b16 a[250:251], v8 offset:12704
  v_cvt_pk_bf16_f32 v76, v18, v19
  v_lshlrev_b32 v16, 16, v77
  v_and_b32 v17, s67, v77
  s_waitcnt lgkmcnt(6)
  v_mfma_f32_32x32x16_bf16 a[32:47], a[224:227], v[72:75], a[32:47]
  ds_read_b64_tr_b16 a[252:253], v8 offset:11840
  ds_read_b64_tr_b16 a[254:255], v8 offset:12736
  buffer_load_dwordx4 v254, s[12:15], s68 offen offset:2048 lds
  v_fma_f32 v16, v16, v12, v13
  v_mfma_f32_32x32x16_bf16 a[48:63], a[228:231], v[72:75], a[48:63]
  ds_read_b64_tr_b16 a[224:225], v8 offset:11872
  ds_read_b64_tr_b16 a[226:227], v8 offset:12768
  v_fma_f32 v17, v17, v12, v13
  v_cvt_pk_bf16_f32 v77, v16, v17
  v_lshlrev_b32 v18, 16, v78
  v_and_b32 v19, s67, v78
  v_mfma_f32_32x32x16_bf16 a[64:79], a[232:235], v[72:75], a[64:79]
  ds_read_b64_tr_b16 a[228:229], v8 offset:11904
  ds_read_b64_tr_b16 a[230:231], v8 offset:12800
  v_fma_f32 v18, v18, v12, v13
  v_fma_f32 v19, v19, v12, v13
  v_cvt_pk_bf16_f32 v78, v18, v19
  v_lshlrev_b32 v16, 16, v79
  v_mfma_f32_32x32x16_bf16 a[80:95], a[236:239], v[72:75], a[80:95]
  ds_read_b64_tr_b16 a[232:233], v8 offset:11936
  ds_read_b64_tr_b16 a[234:235], v8 offset:12832
  v_and_b32 v17, s67, v79
  v_fma_f32 v16, v16, v12, v13
  v_fma_f32 v17, v17, v12, v13
  s_waitcnt lgkmcnt(6)
  v_mfma_f32_32x32x16_bf16 a[96:111], a[240:243], v[72:75], a[96:111]
  ds_read_b64_tr_b16 a[236:237], v8 offset:11968
  ds_read_b64_tr_b16 a[238:239], v8 offset:12864
  v_cvt_pk_bf16_f32 v79, v16, v17
  v_lshlrev_b32 v18, 16, v80
  v_and_b32 v19, s67, v80
  v_fma_f32 v18, v18, v12, v13
  v_mfma_f32_32x32x16_bf16 a[0:15], a[244:247], v[76:79], a[0:15]
  s_waitcnt vmcnt(16)
  s_barrier
  ds_read_b64_tr_b16 a[240:241], v8 offset:32768
  ds_read_b64_tr_b16 a[242:243], v8 offset:33664
  v_fma_f32 v19, v19, v12, v13
  v_mfma_f32_32x32x16_bf16 a[16:31], a[248:251], v[76:79], a[16:31]
  ds_read_b64_tr_b16 a[244:245], v8 offset:32800
  ds_read_b64_tr_b16 a[246:247], v8 offset:33696
  s_add_u32 s68, s68, 229376
  s_cmp_ge_u32 s68, 1605632
  s_cselect_b32 s68, 0, s68
  s_add_u32 m0, s58, 32768
  v_mfma_f32_32x32x16_bf16 a[32:47], a[252:255], v[76:79], a[32:47]
  ds_read_b64_tr_b16 a[248:249], v8 offset:32832
  ds_read_b64_tr_b16 a[250:251], v8 offset:33728
  v_cvt_pk_bf16_f32 v80, v18, v19
  v_lshlrev_b32 v16, 16, v81
  v_and_b32 v17, s67, v81
  s_waitcnt lgkmcnt(6)
  v_mfma_f32_32x32x16_bf16 a[48:63], a[224:227], v[76:79], a[48:63]
  ds_read_b64_tr_b16 a[252:253], v8 offset:32864
  ds_read_b64_tr_b16 a[254:255], v8 offset:33760
  buffer_load_dwordx4 v248, s[12:15], s68 offen offset:0 lds
  v_fma_f32 v16, v16, v12, v13
  v_mfma_f32_32x32x16_bf16 a[64:79], a[228:231], v[76:79], a[64:79]
  ds_read_b64_tr_b16 a[224:225], v8 offset:32896
  ds_read_b64_tr_b16 a[226:227], v8 offset:33792
  v_fma_f32 v17, v17, v12, v13
  v_cvt_pk_bf16_f32 v81, v16, v17
  v_lshlrev_b32 v18, 16, v82
  v_and_b32 v19, s67, v82
  v_mfma_f32_32x32x16_bf16 a[80:95], a[232:235], v[76:79], a[80:95]
  ds_read_b64_tr_b16 a[228:229], v8 offset:32928
  ds_read_b64_tr_b16 a[230:231], v8 offset:33824
  buffer_load_dwordx4 v249, s[12:15], s68 offen offset:1024 lds
  v_fma_f32 v18, v18, v12, v13
  v_mfma_f32_32x32x16_bf16 a[96:111], a[236:239], v[76:79], a[96:111]
  ds_read_b64_tr_b16 a[232:233], v8 offset:32960
  ds_read_b64_tr_b16 a[234:235], v8 offset:33856
  v_fma_f32 v19, v19, v12, v13
  v_cvt_pk_bf16_f32 v82, v18, v19
  v_lshlrev_b32 v16, 16, v83
  v_and_b32 v17, s67, v83
  v_fma_f32 v16, v16, v12, v13
  v_fma_f32 v17, v17, v12, v13
  v_cvt_pk_bf16_f32 v83, v16, v17
  s_waitcnt lgkmcnt(6)
  s_nop 0
  v_mfma_f32_32x32x16_bf16 a[0:15], a[240:243], v[80:83], a[0:15]
  ds_read_b64_tr_b16 a[236:237], v8 offset:36352
  ds_read_b64_tr_b16 a[238:239], v8 offset:37248
  v_accvgpr_read_b32 v5, a132
  buffer_load_dword a200, v5, s[16:19], 0 offen offset:128
  v_mfma_f32_32x32x16_bf16 a[16:31], a[244:247], v[80:83], a[16:31]
  ds_read_b64_tr_b16 a[240:241], v8 offset:36384
  ds_read_b64_tr_b16 a[242:243], v8 offset:37280
  v_lshlrev_b32 v18, 16, v84
  v_and_b32 v19, s67, v84
  v_fma_f32 v18, v18, v12, v13
  v_fma_f32 v19, v19, v12, v13
  v_mfma_f32_32x32x16_bf16 a[32:47], a[248:251], v[80:83], a[32:47]
  ds_read_b64_tr_b16 a[244:245], v8 offset:36416
  ds_read_b64_tr_b16 a[246:247], v8 offset:37312
  buffer_load_dwordx4 v250, s[12:15], s68 offen offset:2048 lds
  v_cvt_pk_bf16_f32 v84, v18, v19
  v_mfma_f32_32x32x16_bf16 a[48:63], a[252:255], v[80:83], a[48:63]
  ds_read_b64_tr_b16 a[248:249], v8 offset:36448
  ds_read_b64_tr_b16 a[250:251], v8 offset:37344
  v_lshlrev_b32 v16, 16, v85
  v_and_b32 v17, s67, v85
  v_fma_f32 v16, v16, v12, v13
  s_waitcnt lgkmcnt(6)
  v_mfma_f32_32x32x16_bf16 a[64:79], a[224:227], v[80:83], a[64:79]
  ds_read_b64_tr_b16 a[252:253], v8 offset:36480
  ds_read_b64_tr_b16 a[254:255], v8 offset:37376
  v_fma_f32 v17, v17, v12, v13
  v_cvt_pk_bf16_f32 v85, v16, v17
  v_lshlrev_b32 v18, 16, v86
  v_and_b32 v19, s67, v86
  v_mfma_f32_32x32x16_bf16 a[80:95], a[228:231], v[80:83], a[80:95]
  ds_read_b64_tr_b16 a[224:225], v8 offset:36512
  ds_read_b64_tr_b16 a[226:227], v8 offset:37408
  buffer_load_dwordx4 v251, s[12:15], s68 offen offset:3072 lds
  v_fma_f32 v18, v18, v12, v13
  v_mfma_f32_32x32x16_bf16 a[96:111], a[232:235], v[80:83], a[96:111]
  ds_read_b64_tr_b16 a[228:229], v8 offset:36544
  ds_read_b64_tr_b16 a[230:231], v8 offset:37440
  v_fma_f32 v19, v19, v12, v13
  v_cvt_pk_bf16_f32 v86, v18, v19
  v_lshlrev_b32 v16, 16, v87
  v_and_b32 v17, s67, v87
  v_fma_f32 v16, v16, v12, v13
  v_fma_f32 v17, v17, v12, v13
  v_cvt_pk_bf16_f32 v87, v16, v17
  s_nop 1
  v_mfma_f32_32x32x16_bf16 a[0:15], a[236:239], v[84:87], a[0:15]
  ds_read_b64_tr_b16 a[232:233], v8 offset:40960
  ds_read_b64_tr_b16 a[234:235], v8 offset:41856
  s_add_u32 m0, s58, 36864
  v_lshlrev_b32 v18, 16, v88
  v_and_b32 v19, s67, v88
  s_waitcnt lgkmcnt(6)
  v_mfma_f32_32x32x16_bf16 a[16:31], a[240:243], v[84:87], a[16:31]
  ds_read_b64_tr_b16 a[236:237], v8 offset:40992
  ds_read_b64_tr_b16 a[238:239], v8 offset:41888
  v_fma_f32 v18, v18, v12, v13
  v_fma_f32 v19, v19, v12, v13
  v_cvt_pk_bf16_f32 v88, v18, v19
  v_lshlrev_b32 v16, 16, v89
  v_mfma_f32_32x32x16_bf16 a[32:47], a[244:247], v[84:87], a[32:47]
  ds_read_b64_tr_b16 a[240:241], v8 offset:41024
  ds_read_b64_tr_b16 a[242:243], v8 offset:41920
  buffer_load_dwordx4 v252, s[12:15], s68 offen offset:0 lds
  v_and_b32 v17, s67, v89
  v_mfma_f32_32x32x16_bf16 a[48:63], a[248:251], v[84:87], a[48:63]
  ds_read_b64_tr_b16 a[244:245], v8 offset:41056
  ds_read_b64_tr_b16 a[246:247], v8 offset:41952
  v_fma_f32 v16, v16, v12, v13
  v_fma_f32 v17, v17, v12, v13
  v_cvt_pk_bf16_f32 v89, v16, v17
  v_lshlrev_b32 v18, 16, v90
  v_mfma_f32_32x32x16_bf16 a[64:79], a[252:255], v[84:87], a[64:79]
  ds_read_b64_tr_b16 a[248:249], v8 offset:41088
  ds_read_b64_tr_b16 a[250:251], v8 offset:41984
  v_and_b32 v19, s67, v90
  v_fma_f32 v18, v18, v12, v13
  v_fma_f32 v19, v19, v12, v13
  s_waitcnt lgkmcnt(6)
  v_mfma_f32_32x32x16_bf16 a[80:95], a[224:227], v[84:87], a[80:95]
  ds_read_b64_tr_b16 a[252:253], v8 offset:41120
  ds_read_b64_tr_b16 a[254:255], v8 offset:42016
  buffer_load_dwordx4 v253, s[12:15], s68 offen offset:1024 lds
  v_cvt_pk_bf16_f32 v90, v18, v19
  v_mfma_f32_32x32x16_bf16 a[96:111], a[228:231], v[84:87], a[96:111]
  ds_read_b64_tr_b16 a[224:225], v8 offset:41152
  ds_read_b64_tr_b16 a[226:227], v8 offset:42048
  v_lshlrev_b32 v16, 16, v91
  v_and_b32 v17, s67, v91
  v_fma_f32 v16, v16, v12, v13
  v_fma_f32 v17, v17, v12, v13
  v_cvt_pk_bf16_f32 v91, v16, v17
  s_nop 1
  v_mfma_f32_32x32x16_bf16 a[0:15], a[232:235], v[88:91], a[0:15]
  ds_read_b64_tr_b16 a[228:229], v8 offset:44544
  ds_read_b64_tr_b16 a[230:231], v8 offset:45440
  v_lshlrev_b32 v18, 16, v92
  v_and_b32 v19, s67, v92
  v_fma_f32 v18, v18, v12, v13
  v_fma_f32 v19, v19, v12, v13
  v_mfma_f32_32x32x16_bf16 a[16:31], a[236:239], v[88:91], a[16:31]
  ds_read_b64_tr_b16 a[232:233], v8 offset:44576
  ds_read_b64_tr_b16 a[234:235], v8 offset:45472
  v_cvt_pk_bf16_f32 v92, v18, v19
  v_lshlrev_b32 v16, 16, v93
  v_and_b32 v17, s67, v93
  s_waitcnt lgkmcnt(6)
  v_mfma_f32_32x32x16_bf16 a[32:47], a[240:243], v[88:91], a[32:47]
  ds_read_b64_tr_b16 a[236:237], v8 offset:44608
  ds_read_b64_tr_b16 a[238:239], v8 offset:45504
  buffer_load_dwordx4 v254, s[12:15], s68 offen offset:2048 lds
  v_fma_f32 v16, v16, v12, v13
  v_mfma_f32_32x32x16_bf16 a[48:63], a[244:247], v[88:91], a[48:63]
  ds_read_b64_tr_b16 a[240:241], v8 offset:44640
  ds_read_b64_tr_b16 a[242:243], v8 offset:45536
  v_fma_f32 v17, v17, v12, v13
  v_cvt_pk_bf16_f32 v93, v16, v17
  v_lshlrev_b32 v18, 16, v94
  v_and_b32 v19, s67, v94
  v_mfma_f32_32x32x16_bf16 a[64:79], a[248:251], v[88:91], a[64:79]
  ds_read_b64_tr_b16 a[244:245], v8 offset:44672
  ds_read_b64_tr_b16 a[246:247], v8 offset:45568
  v_fma_f32 v18, v18, v12, v13
  v_fma_f32 v19, v19, v12, v13
  v_cvt_pk_bf16_f32 v94, v18, v19
  v_lshlrev_b32 v16, 16, v95
  v_mfma_f32_32x32x16_bf16 a[80:95], a[252:255], v[88:91], a[80:95]
  ds_read_b64_tr_b16 a[248:249], v8 offset:44704
  ds_read_b64_tr_b16 a[250:251], v8 offset:45600
  v_and_b32 v17, s67, v95
  v_fma_f32 v16, v16, v12, v13
  v_fma_f32 v17, v17, v12, v13
  s_waitcnt lgkmcnt(6)
  v_mfma_f32_32x32x16_bf16 a[96:111], a[224:227], v[88:91], a[96:111]
  ds_read_b64_tr_b16 a[252:253], v8 offset:44736
  ds_read_b64_tr_b16 a[254:255], v8 offset:45632
  v_cvt_pk_bf16_f32 v95, v16, v17
  v_lshlrev_b32 v18, 16, v96
  v_and_b32 v19, s67, v96
  v_fma_f32 v18, v18, v12, v13
  v_mfma_f32_32x32x16_bf16 a[0:15], a[228:231], v[92:95], a[0:15]
  s_waitcnt vmcnt(16)
  s_barrier
  v_add_u32 v8, 0x10000, v8
  ds_read_b64_tr_b16 a[224:225], v8 offset:0
  ds_read_b64_tr_b16 a[226:227], v8 offset:896
  v_mfma_f32_32x32x16_bf16 a[16:31], a[232:235], v[92:95], a[16:31]
  ds_read_b64_tr_b16 a[228:229], v8 offset:32
  ds_read_b64_tr_b16 a[230:231], v8 offset:928
  v_accvgpr_read_b32 v240, a137
  v_accvgpr_read_b32 v241, a138
  v_accvgpr_read_b32 v242, a139
  v_accvgpr_read_b32 v243, a140
  v_mfma_f32_32x32x16_bf16 a[32:47], a[236:239], v[92:95], a[32:47]
  ds_read_b64_tr_b16 a[232:233], v8 offset:64
  ds_read_b64_tr_b16 a[234:235], v8 offset:960
  v_accvgpr_read_b32 v244, a141
  v_accvgpr_read_b32 v245, a142
  v_accvgpr_read_b32 v246, a143
  s_waitcnt lgkmcnt(6)
  v_mfma_f32_32x32x16_bf16 a[48:63], a[240:243], v[92:95], a[48:63]
  ds_read_b64_tr_b16 a[236:237], v8 offset:96
  ds_read_b64_tr_b16 a[238:239], v8 offset:992
  v_accvgpr_read_b32 v247, a144
  v_accvgpr_read_b32 v248, a145
  v_accvgpr_read_b32 v249, a146
  v_accvgpr_read_b32 v250, a147
  v_mfma_f32_32x32x16_bf16 a[64:79], a[244:247], v[92:95], a[64:79]
  ds_read_b64_tr_b16 a[240:241], v8 offset:128
  ds_read_b64_tr_b16 a[242:243], v8 offset:1024
  v_accvgpr_read_b32 v251, a148
  v_accvgpr_read_b32 v252, a149
  v_accvgpr_read_b32 v253, a150
  s_add_u32 m0, s59, 65536
  v_mfma_f32_32x32x16_bf16 a[80:95], a[248:251], v[92:95], a[80:95]
  ds_read_b64_tr_b16 a[244:245], v8 offset:160
  ds_read_b64_tr_b16 a[246:247], v8 offset:1056
  buffer_load_dwordx4 v240, s[16:19], 0 offen offset:0 lds
  v_fma_f32 v19, v19, v12, v13
  v_mfma_f32_32x32x16_bf16 a[96:111], a[252:255], v[92:95], a[96:111]
  ds_read_b64_tr_b16 a[248:249], v8 offset:192
  ds_read_b64_tr_b16 a[250:251], v8 offset:1088
  v_cvt_pk_bf16_f32 v96, v18, v19
  v_lshlrev_b32 v16, 16, v97
  v_and_b32 v17, s67, v97
  v_fma_f32 v16, v16, v12, v13
  v_fma_f32 v17, v17, v12, v13
  v_cvt_pk_bf16_f32 v97, v16, v17
  v_lshlrev_b32 v18, 16, v98
  v_and_b32 v19, s67, v98
  v_fma_f32 v18, v18, v12, v13
  v_fma_f32 v19, v19, v12, v13
  v_cvt_pk_bf16_f32 v98, v18, v19
  v_lshlrev_b32 v16, 16, v99
  v_and_b32 v17, s67, v99
  v_fma_f32 v16, v16, v12, v13
  v_fma_f32 v17, v17, v12, v13
  v_cvt_pk_bf16_f32 v99, v16, v17
  s_waitcnt lgkmcnt(6)
  s_nop 0
  v_mfma_f32_32x32x16_bf16 a[0:15], a[224:227], v[96:99], a[0:15]
  ds_read_b64_tr_b16 a[252:253], v8 offset:3584
  ds_read_b64_tr_b16 a[254:255], v8 offset:4480
  v_lshlrev_b32 v18, 16, v100
  v_and_b32 v19, s67, v100
  v_fma_f32 v18, v18, v12, v13
  v_fma_f32 v19, v19, v12, v13
  v_mfma_f32_32x32x16_bf16 a[16:31], a[228:231], v[96:99], a[16:31]
  ds_read_b64_tr_b16 a[224:225], v8 offset:3616
  ds_read_b64_tr_b16 a[226:227], v8 offset:4512
  buffer_load_dwordx4 v241, s[16:19], 0 offen offset:1024 lds
  v_cvt_pk_bf16_f32 v100, v18, v19
  v_mfma_f32_32x32x16_bf16 a[32:47], a[232:235], v[96:99], a[32:47]
  ds_read_b64_tr_b16 a[228:229], v8 offset:3648
  ds_read_b64_tr_b16 a[230:231], v8 offset:4544
  v_lshlrev_b32 v16, 16, v101
  v_and_b32 v17, s67, v101
  v_fma_f32 v16, v16, v12, v13
  v_fma_f32 v17, v17, v12, v13
  v_mfma_f32_32x32x16_bf16 a[48:63], a[236:239], v[96:99], a[48:63]
  ds_read_b64_tr_b16 a[232:233], v8 offset:3680
  ds_read_b64_tr_b16 a[234:235], v8 offset:4576
  v_cvt_pk_bf16_f32 v101, v16, v17
  v_lshlrev_b32 v18, 16, v102
  v_and_b32 v19, s67, v102
  s_waitcnt lgkmcnt(6)
  v_mfma_f32_32x32x16_bf16 a[64:79], a[240:243], v[96:99], a[64:79]
  ds_read_b64_tr_b16 a[236:237], v8 offset:3712
  ds_read_b64_tr_b16 a[238:239], v8 offset:4608
  buffer_load_dwordx4 v242, s[16:19], 0 offen offset:2048 lds
  v_fma_f32 v18, v18, v12, v13
  v_mfma_f32_32x32x16_bf16 a[80:95], a[244:247], v[96:99], a[80:95]
  ds_read_b64_tr_b16 a[240:241], v8 offset:3744
  ds_read_b64_tr_b16 a[242:243], v8 offset:4640
  v_fma_f32 v19, v19, v12, v13
  v_cvt_pk_bf16_f32 v102, v18, v19
  v_lshlrev_b32 v16, 16, v103
  v_and_b32 v17, s67, v103
  v_mfma_f32_32x32x16_bf16 a[96:111], a[248:251], v[96:99], a[96:111]
  ds_read_b64_tr_b16 a[244:245], v8 offset:3776
  ds_read_b64_tr_b16 a[246:247], v8 offset:4672
  v_fma_f32 v16, v16, v12, v13
  v_fma_f32 v17, v17, v12, v13
  v_cvt_pk_bf16_f32 v103, v16, v17
  v_lshlrev_b32 v18, 16, v104
  s_nop 0
  v_mfma_f32_32x32x16_bf16 a[0:15], a[252:255], v[100:103], a[0:15]
  ds_read_b64_tr_b16 a[248:249], v8 offset:8192
  ds_read_b64_tr_b16 a[250:251], v8 offset:9088
  v_and_b32 v19, s67, v104
  v_fma_f32 v18, v18, v12, v13
  v_fma_f32 v19, v19, v12, v13
  s_waitcnt lgkmcnt(6)
  v_mfma_f32_32x32x16_bf16 a[16:31], a[224:227], v[100:103], a[16:31]
  ds_read_b64_tr_b16 a[252:253], v8 offset:8224
  ds_read_b64_tr_b16 a[254:255], v8 offset:9120
  buffer_load_dwordx4 v243, s[16:19], 0 offen offset:3072 lds
  s_add_u32 m0, s59, 69632
  v_mfma_f32_32x32x16_bf16 a[32:47], a[228:231], v[100:103], a[32:47]
  ds_read_b64_tr_b16 a[224:225], v8 offset:8256
  ds_read_b64_tr_b16 a[226:227], v8 offset:9152
  v_cvt_pk_bf16_f32 v104, v18, v19
  v_lshlrev_b32 v16, 16, v105
  v_and_b32 v17, s67, v105
  v_fma_f32 v16, v16, v12, v13
  v_mfma_f32_32x32x16_bf16 a[48:63], a[232:235], v[100:103], a[48:63]
  ds_read_b64_tr_b16 a[228:229], v8 offset:8288
  ds_read_b64_tr_b16 a[230:231], v8 offset:9184
  buffer_load_dwordx4 v244, s[16:19], 0 offen offset:0 lds
  v_fma_f32 v17, v17, v12, v13
  v_mfma_f32_32x32x16_bf16 a[64:79], a[236:239], v[100:103], a[64:79]
  ds_read_b64_tr_b16 a[232:233], v8 offset:8320
  ds_read_b64_tr_b16 a[234:235], v8 offset:9216
  v_cvt_pk_bf16_f32 v105, v16, v17
  v_lshlrev_b32 v18, 16, v106
  v_and_b32 v19, s67, v106
  s_waitcnt lgkmcnt(6)
  v_mfma_f32_32x32x16_bf16 a[80:95], a[240:243], v[100:103], a[80:95]
  ds_read_b64_tr_b16 a[236:237], v8 offset:8352
  ds_read_b64_tr_b16 a[238:239], v8 offset:9248
  v_fma_f32 v18, v18, v12, v13
  v_fma_f32 v19, v19, v12, v13
  v_cvt_pk_bf16_f32 v106, v18, v19
  v_lshlrev_b32 v16, 16, v107
  v_mfma_f32_32x32x16_bf16 a[96:111], a[244:247], v[100:103], a[96:111]
  ds_read_b64_tr_b16 a[240:241], v8 offset:8384
  ds_read_b64_tr_b16 a[242:243], v8 offset:9280
  buffer_load_dwordx4 v245, s[16:19], 0 offen offset:1024 lds
  v_and_b32 v17, s67, v107
  v_fma_f32 v16, v16, v12, v13
  v_fma_f32 v17, v17, v12, v13
  v_cvt_pk_bf16_f32 v107, v16, v17
  s_nop 1
  v_mfma_f32_32x32x16_bf16 a[0:15], a[248:251], v[104:107], a[0:15]
  ds_read_b64_tr_b16 a[244:245], v8 offset:11776
  ds_read_b64_tr_b16 a[246:247], v8 offset:12672
  v_lshlrev_b32 v18, 16, v108
  v_and_b32 v19, s67, v108
  v_fma_f32 v18, v18, v12, v13
  v_fma_f32 v19, v19, v12, v13
  v_mfma_f32_32x32x16_bf16 a[16:31], a[252:255], v[104:107], a[16:31]
  ds_read_b64_tr_b16 a[248:249], v8 offset:11808
  ds_read_b64_tr_b16 a[250:251], v8 offset:12704
  v_cvt_pk_bf16_f32 v108, v18, v19
  v_lshlrev_b32 v16, 16, v109
  v_and_b32 v17, s67, v109
  s_waitcnt lgkmcnt(6)
  v_mfma_f32_32x32x16_bf16 a[32:47], a[224:227], v[104:107], a[32:47]
  ds_read_b64_tr_b16 a[252:253], v8 offset:11840
  ds_read_b64_tr_b16 a[254:255], v8 offset:12736
  buffer_load_dwordx4 v246, s[16:19], 0 offen offset:2048 lds
  v_fma_f32 v16, v16, v12, v13
  v_mfma_f32_32x32x16_bf16 a[48:63], a[228:231], v[104:107], a[48:63]
  ds_read_b64_tr_b16 a[224:225], v8 offset:11872
  ds_read_b64_tr_b16 a[226:227], v8 offset:12768
  v_fma_f32 v17, v17, v12, v13
  v_cvt_pk_bf16_f32 v109, v16, v17
  v_lshlrev_b32 v18, 16, v110
  v_and_b32 v19, s67, v110
  v_mfma_f32_32x32x16_bf16 a[64:79], a[232:235], v[104:107], a[64:79]
  ds_read_b64_tr_b16 a[228:229], v8 offset:11904
  ds_read_b64_tr_b16 a[230:231], v8 offset:12800
  v_fma_f32 v18, v18, v12, v13
  v_fma_f32 v19, v19, v12, v13
  v_cvt_pk_bf16_f32 v110, v18, v19
  v_lshlrev_b32 v16, 16, v111
  v_mfma_f32_32x32x16_bf16 a[80:95], a[236:239], v[104:107], a[80:95]
  ds_read_b64_tr_b16 a[232:233], v8 offset:11936
  ds_read_b64_tr_b16 a[234:235], v8 offset:12832
  v_and_b32 v17, s67, v111
  v_fma_f32 v16, v16, v12, v13
  v_fma_f32 v17, v17, v12, v13
  s_waitcnt lgkmcnt(6)
  v_mfma_f32_32x32x16_bf16 a[96:111], a[240:243], v[104:107], a[96:111]
  ds_read_b64_tr_b16 a[236:237], v8 offset:11968
  ds_read_b64_tr_b16 a[238:239], v8 offset:12864
  v_cvt_pk_bf16_f32 v111, v16, v17
  v_accvgpr_read_b32 v5, a132
  v_lshlrev_b32 v18, 16, v112
  v_and_b32 v19, s67, v112
  v_mfma_f32_32x32x16_bf16 a[0:15], a[244:247], v[108:111], a[0:15]
  s_waitcnt vmcnt(15)
  s_barrier
  v_add_u32 v8, 0xfffe0000, v8
  ds_read_b64_tr_b16 a[240:241], v8 offset:0
  ds_read_b64_tr_b16 a[242:243], v8 offset:896
  v_mfma_f32_32x32x16_bf16 a[16:31], a[248:251], v[108:111], a[16:31]
  ds_read_b64_tr_b16 a[244:245], v8 offset:32
  ds_read_b64_tr_b16 a[246:247], v8 offset:928
  s_add_u32 m0, s59, 98304
  buffer_load_dword a200, v5, s[16:19], 0 offen offset:256
  v_mfma_f32_32x32x16_bf16 a[32:47], a[252:255], v[108:111], a[32:47]
  ds_read_b64_tr_b16 a[248:249], v8 offset:64
  ds_read_b64_tr_b16 a[250:251], v8 offset:960
  v_fma_f32 v18, v18, v12, v13
  v_fma_f32 v19, v19, v12, v13
  v_cvt_pk_bf16_f32 v112, v18, v19
  s_waitcnt lgkmcnt(6)
  v_mfma_f32_32x32x16_bf16 a[48:63], a[224:227], v[108:111], a[48:63]
  ds_read_b64_tr_b16 a[252:253], v8 offset:96
  ds_read_b64_tr_b16 a[254:255], v8 offset:992
  buffer_load_dwordx4 v247, s[16:19], 0 offen offset:0 lds
  v_lshlrev_b32 v16, 16, v113
  v_mfma_f32_32x32x16_bf16 a[64:79], a[228:231], v[108:111], a[64:79]
  ds_read_b64_tr_b16 a[224:225], v8 offset:128
  ds_read_b64_tr_b16 a[226:227], v8 offset:1024
  v_and_b32 v17, s67, v113
  v_fma_f32 v16, v16, v12, v13
  v_fma_f32 v17, v17, v12, v13
  v_cvt_pk_bf16_f32 v113, v16, v17
  v_mfma_f32_32x32x16_bf16 a[80:95], a[232:235], v[108:111], a[80:95]
  ds_read_b64_tr_b16 a[228:229], v8 offset:160
  ds_read_b64_tr_b16 a[230:231], v8 offset:1056
  buffer_load_dwordx4 v248, s[16:19], 0 offen offset:1024 lds
  v_lshlrev_b32 v18, 16, v114
  v_mfma_f32_32x32x16_bf16 a[96:111], a[236:239], v[108:111], a[96:111]
  ds_read_b64_tr_b16 a[232:233], v8 offset:192
  ds_read_b64_tr_b16 a[234:235], v8 offset:1088
  v_and_b32 v19, s67, v114
  v_fma_f32 v18, v18, v12, v13
  v_fma_f32 v19, v19, v12, v13
  v_cvt_pk_bf16_f32 v114, v18, v19
  v_lshlrev_b32 v16, 16, v115
  v_and_b32 v17, s67, v115
  v_fma_f32 v16, v16, v12, v13
  v_fma_f32 v17, v17, v12, v13
  v_cvt_pk_bf16_f32 v115, v16, v17
  s_waitcnt lgkmcnt(6)
  s_nop 0
  v_mfma_f32_32x32x16_bf16 a[0:15], a[240:243], v[112:115], a[0:15]
  ds_read_b64_tr_b16 a[236:237], v8 offset:3584
  ds_read_b64_tr_b16 a[238:239], v8 offset:4480
  v_lshlrev_b32 v18, 16, v116
  v_and_b32 v19, s67, v116
  v_fma_f32 v18, v18, v12, v13
  v_fma_f32 v19, v19, v12, v13
  v_mfma_f32_32x32x16_bf16 a[16:31], a[244:247], v[112:115], a[16:31]
  ds_read_b64_tr_b16 a[240:241], v8 offset:3616
  ds_read_b64_tr_b16 a[242:243], v8 offset:4512
  v_cvt_pk_bf16_f32 v116, v18, v19
  v_lshlrev_b32 v16, 16, v117
  v_and_b32 v17, s67, v117
  v_fma_f32 v16, v16, v12, v13
  v_mfma_f32_32x32x16_bf16 a[32:47], a[248:251], v[112:115], a[32:47]
  ds_read_b64_tr_b16 a[244:245], v8 offset:3648
  ds_read_b64_tr_b16 a[246:247], v8 offset:4544
  buffer_load_dwordx4 v249, s[16:19], 0 offen offset:2048 lds
  v_fma_f32 v17, v17, v12, v13
  v_mfma_f32_32x32x16_bf16 a[48:63], a[252:255], v[112:115], a[48:63]
  ds_read_b64_tr_b16 a[248:249], v8 offset:3680
  ds_read_b64_tr_b16 a[250:251], v8 offset:4576
  v_cvt_pk_bf16_f32 v117, v16, v17
  v_lshlrev_b32 v18, 16, v118
  v_and_b32 v19, s67, v118
  s_waitcnt lgkmcnt(6)
  v_mfma_f32_32x32x16_bf16 a[64:79], a[224:227], v[112:115], a[64:79]
  ds_read_b64_tr_b16 a[252:253], v8 offset:3712
  ds_read_b64_tr_b16 a[254:255], v8 offset:4608
  v_fma_f32 v18, v18, v12, v13
  v_fma_f32 v19, v19, v12, v13
  v_cvt_pk_bf16_f32 v118, v18, v19
  v_lshlrev_b32 v16, 16, v119
  v_mfma_f32_32x32x16_bf16 a[80:95], a[228:231], v[112:115], a[80:95]
  ds_read_b64_tr_b16 a[224:225], v8 offset:3744
  ds_read_b64_tr_b16 a[226:227], v8 offset:4640
  buffer_load_dwordx4 v250, s[16:19], 0 offen offset:3072 lds
  v_and_b32 v17, s67, v119
  v_mfma_f32_32x32x16_bf16 a[96:111], a[232:235], v[112:115], a[96:111]
  ds_read_b64_tr_b16 a[228:229], v8 offset:3776
  ds_read_b64_tr_b16 a[230:231], v8 offset:4672
  v_fma_f32 v16, v16, v12, v13
  v_fma_f32 v17, v17, v12, v13
  v_cvt_pk_bf16_f32 v119, v16, v17
  s_add_u32 m0, s59, 102400
  s_nop 0
  v_mfma_f32_32x32x16_bf16 a[0:15], a[236:239], v[116:119], a[0:15]
  ds_read_b64_tr_b16 a[232:233], v8 offset:8192
  ds_read_b64_tr_b16 a[234:235], v8 offset:9088
  v_lshlrev_b32 v18, 16, v120
  v_and_b32 v19, s67, v120
  v_fma_f32 v18, v18, v12, v13
  s_waitcnt lgkmcnt(6)
  v_mfma_f32_32x32x16_bf16 a[16:31], a[240:243], v[116:119], a[16:31]
  ds_read_b64_tr_b16 a[236:237], v8 offset:8224
  ds_read_b64_tr_b16 a[238:239], v8 offset:9120
  v_fma_f32 v19, v19, v12, v13
  v_cvt_pk_bf16_f32 v120, v18, v19
  v_lshlrev_b32 v16, 16, v121
  v_and_b32 v17, s67, v121
  v_mfma_f32_32x32x16_bf16 a[32:47], a[244:247], v[116:119], a[32:47]
  ds_read_b64_tr_b16 a[240:241], v8 offset:8256
  ds_read_b64_tr_b16 a[242:243], v8 offset:9152
  buffer_load_dwordx4 v251, s[16:19], 0 offen offset:0 lds
  v_fma_f32 v16, v16, v12, v13
  v_mfma_f32_32x32x16_bf16 a[48:63], a[248:251], v[116:119], a[48:63]
  ds_read_b64_tr_b16 a[244:245], v8 offset:8288
  ds_read_b64_tr_b16 a[246:247], v8 offset:9184
  v_fma_f32 v17, v17, v12, v13
  v_cvt_pk_bf16_f32 v121, v16, v17
  v_lshlrev_b32 v18, 16, v122
  v_and_b32 v19, s67, v122
  v_mfma_f32_32x32x16_bf16 a[64:79], a[252:255], v[116:119], a[64:79]
  ds_read_b64_tr_b16 a[248:249], v8 offset:8320
  ds_read_b64_tr_b16 a[250:251], v8 offset:9216
  v_fma_f32 v18, v18, v12, v13
  v_fma_f32 v19, v19, v12, v13
  v_cvt_pk_bf16_f32 v122, v18, v19
  s_waitcnt lgkmcnt(6)
  v_mfma_f32_32x32x16_bf16 a[80:95], a[224:227], v[116:119], a[80:95]
  ds_read_b64_tr_b16 a[252:253], v8 offset:8352
  ds_read_b64_tr_b16 a[254:255], v8 offset:9248
  buffer_load_dwordx4 v252, s[16:19], 0 offen offset:1024 lds
  v_lshlrev_b32 v16, 16, v123
  v_mfma_f32_32x32x16_bf16 a[96:111], a[228:231], v[116:119], a[96:111]
  ds_read_b64_tr_b16 a[224:225], v8 offset:8384
  ds_read_b64_tr_b16 a[226:227], v8 offset:9280
  v_and_b32 v17, s67, v123
  v_fma_f32 v16, v16, v12, v13
  v_fma_f32 v17, v17, v12, v13
  v_cvt_pk_bf16_f32 v123, v16, v17
  s_nop 1
  v_mfma_f32_32x32x16_bf16 a[0:15], a[232:235], v[120:123], a[0:15]
  ds_read_b64_tr_b16 a[228:229], v8 offset:11776
  ds_read_b64_tr_b16 a[230:231], v8 offset:12672
  v_lshlrev_b32 v18, 16, v124
  v_and_b32 v19, s67, v124
  v_fma_f32 v18, v18, v12, v13
  v_fma_f32 v19, v19, v12, v13
  v_mfma_f32_32x32x16_bf16 a[16:31], a[236:239], v[120:123], a[16:31]
  ds_read_b64_tr_b16 a[232:233], v8 offset:11808
  ds_read_b64_tr_b16 a[234:235], v8 offset:12704
  v_cvt_pk_bf16_f32 v124, v18, v19
  v_lshlrev_b32 v16, 16, v125
  v_and_b32 v17, s67, v125
  s_waitcnt lgkmcnt(6)
  v_mfma_f32_32x32x16_bf16 a[32:47], a[240:243], v[120:123], a[32:47]
  ds_read_b64_tr_b16 a[236:237], v8 offset:11840
  ds_read_b64_tr_b16 a[238:239], v8 offset:12736
  buffer_load_dwordx4 v253, s[16:19], 0 offen offset:2048 lds
  v_fma_f32 v16, v16, v12, v13
  v_mfma_f32_32x32x16_bf16 a[48:63], a[244:247], v[120:123], a[48:63]
  ds_read_b64_tr_b16 a[240:241], v8 offset:11872
  ds_read_b64_tr_b16 a[242:243], v8 offset:12768
  v_fma_f32 v17, v17, v12, v13
  v_cvt_pk_bf16_f32 v125, v16, v17
  v_lshlrev_b32 v18, 16, v126
  v_and_b32 v19, s67, v126
  v_mfma_f32_32x32x16_bf16 a[64:79], a[248:251], v[120:123], a[64:79]
  ds_read_b64_tr_b16 a[244:245], v8 offset:11904
  ds_read_b64_tr_b16 a[246:247], v8 offset:12800
  v_fma_f32 v18, v18, v12, v13
  v_fma_f32 v19, v19, v12, v13
  v_cvt_pk_bf16_f32 v126, v18, v19
  v_lshlrev_b32 v16, 16, v127
  v_mfma_f32_32x32x16_bf16 a[80:95], a[252:255], v[120:123], a[80:95]
  ds_read_b64_tr_b16 a[248:249], v8 offset:11936
  ds_read_b64_tr_b16 a[250:251], v8 offset:12832
  v_and_b32 v17, s67, v127
  v_fma_f32 v16, v16, v12, v13
  v_fma_f32 v17, v17, v12, v13
  s_waitcnt lgkmcnt(6)
  v_mfma_f32_32x32x16_bf16 a[96:111], a[224:227], v[120:123], a[96:111]
  ds_read_b64_tr_b16 a[252:253], v8 offset:11968
  ds_read_b64_tr_b16 a[254:255], v8 offset:12864
  v_cvt_pk_bf16_f32 v127, v16, v17
  v_lshlrev_b32 v18, 16, v128
  v_and_b32 v19, s67, v128
  v_fma_f32 v18, v18, v12, v13
  v_mfma_f32_32x32x16_bf16 a[0:15], a[228:231], v[124:127], a[0:15]
  s_waitcnt vmcnt(15)
  s_barrier
  ds_read_b64_tr_b16 a[224:225], v8 offset:32768
  ds_read_b64_tr_b16 a[226:227], v8 offset:33664
  s_add_u32 m0, s59, 131072
  v_mfma_f32_32x32x16_bf16 a[16:31], a[232:235], v[124:127], a[16:31]
  ds_read_b64_tr_b16 a[228:229], v8 offset:32800
  ds_read_b64_tr_b16 a[230:231], v8 offset:33696
  s_mov_b32 s64, 0x80
  v_fma_f32 v19, v19, v12, v13
  v_cvt_pk_bf16_f32 v128, v18, v19
  v_lshlrev_b32 v16, 16, v129
  v_mfma_f32_32x32x16_bf16 a[32:47], a[236:239], v[124:127], a[32:47]
  ds_read_b64_tr_b16 a[232:233], v8 offset:32832
  ds_read_b64_tr_b16 a[234:235], v8 offset:33728
  v_and_b32 v17, s67, v129
  v_fma_f32 v16, v16, v12, v13
  v_fma_f32 v17, v17, v12, v13
  s_waitcnt lgkmcnt(6)
  v_mfma_f32_32x32x16_bf16 a[48:63], a[240:243], v[124:127], a[48:63]
  ds_read_b64_tr_b16 a[236:237], v8 offset:32864
  ds_read_b64_tr_b16 a[238:239], v8 offset:33760
  buffer_load_dwordx4 v240, s[16:19], s64 offen offset:0 lds
  v_cvt_pk_bf16_f32 v129, v16, v17
  v_mfma_f32_32x32x16_bf16 a[64:79], a[244:247], v[124:127], a[64:79]
  ds_read_b64_tr_b16 a[240:241], v8 offset:32896
  ds_read_b64_tr_b16 a[242:243], v8 offset:33792
  v_lshlrev_b32 v18, 16, v130
  v_and_b32 v19, s67, v130
  v_fma_f32 v18, v18, v12, v13
  v_fma_f32 v19, v19, v12, v13
  v_mfma_f32_32x32x16_bf16 a[80:95], a[248:251], v[124:127], a[80:95]
  ds_read_b64_tr_b16 a[244:245], v8 offset:32928
  ds_read_b64_tr_b16 a[246:247], v8 offset:33824
  buffer_load_dwordx4 v241, s[16:19], s64 offen offset:1024 lds
  v_cvt_pk_bf16_f32 v130, v18, v19
  v_mfma_f32_32x32x16_bf16 a[96:111], a[252:255], v[124:127], a[96:111]
  ds_read_b64_tr_b16 a[248:249], v8 offset:32960
  ds_read_b64_tr_b16 a[250:251], v8 offset:33856
  v_lshlrev_b32 v16, 16, v131
  v_and_b32 v17, s67, v131
  v_fma_f32 v16, v16, v12, v13
  v_fma_f32 v17, v17, v12, v13
  v_cvt_pk_bf16_f32 v131, v16, v17
  s_waitcnt lgkmcnt(6)
  s_nop 0
  v_mfma_f32_32x32x16_bf16 a[0:15], a[224:227], v[128:131], a[0:15]
  ds_read_b64_tr_b16 a[252:253], v8 offset:36352
  ds_read_b64_tr_b16 a[254:255], v8 offset:37248
  v_lshlrev_b32 v18, 16, v132
  v_and_b32 v19, s67, v132
  v_fma_f32 v18, v18, v12, v13
  v_fma_f32 v19, v19, v12, v13
  v_mfma_f32_32x32x16_bf16 a[16:31], a[228:231], v[128:131], a[16:31]
  ds_read_b64_tr_b16 a[224:225], v8 offset:36384
  ds_read_b64_tr_b16 a[226:227], v8 offset:37280
  v_cvt_pk_bf16_f32 v132, v18, v19
  v_lshlrev_b32 v16, 16, v133
  v_and_b32 v17, s67, v133
  v_fma_f32 v16, v16, v12, v13
  v_mfma_f32_32x32x16_bf16 a[32:47], a[232:235], v[128:131], a[32:47]
  ds_read_b64_tr_b16 a[228:229], v8 offset:36416
  ds_read_b64_tr_b16 a[230:231], v8 offset:37312
  buffer_load_dwordx4 v242, s[16:19], s64 offen offset:2048 lds
  v_fma_f32 v17, v17, v12, v13
  v_mfma_f32_32x32x16_bf16 a[48:63], a[236:239], v[128:131], a[48:63]
  ds_read_b64_tr_b16 a[232:233], v8 offset:36448
  ds_read_b64_tr_b16 a[234:235], v8 offset:37344
  v_cvt_pk_bf16_f32 v133, v16, v17
  v_lshlrev_b32 v18, 16, v134
  v_and_b32 v19, s67, v134
  s_waitcnt lgkmcnt(6)
  v_mfma_f32_32x32x16_bf16 a[64:79], a[240:243], v[128:131], a[64:79]
  ds_read_b64_tr_b16 a[236:237], v8 offset:36480
  ds_read_b64_tr_b16 a[238:239], v8 offset:37376
  v_fma_f32 v18, v18, v12, v13
  v_fma_f32 v19, v19, v12, v13
  v_cvt_pk_bf16_f32 v134, v18, v19
  v_lshlrev_b32 v16, 16, v135
  v_mfma_f32_32x32x16_bf16 a[80:95], a[244:247], v[128:131], a[80:95]
  ds_read_b64_tr_b16 a[240:241], v8 offset:36512
  ds_read_b64_tr_b16 a[242:243], v8 offset:37408
  buffer_load_dwordx4 v243, s[16:19], s64 offen offset:3072 lds
  v_and_b32 v17, s67, v135
  v_mfma_f32_32x32x16_bf16 a[96:111], a[248:251], v[128:131], a[96:111]
  ds_read_b64_tr_b16 a[244:245], v8 offset:36544
  ds_read_b64_tr_b16 a[246:247], v8 offset:37440
  v_fma_f32 v16, v16, v12, v13
  v_fma_f32 v17, v17, v12, v13
  v_cvt_pk_bf16_f32 v135, v16, v17
  s_add_u32 m0, s59, 135168
  s_nop 0
  v_mfma_f32_32x32x16_bf16 a[0:15], a[252:255], v[132:135], a[0:15]
  ds_read_b64_tr_b16 a[248:249], v8 offset:40960
  ds_read_b64_tr_b16 a[250:251], v8 offset:41856
  v_lshlrev_b32 v18, 16, v136
  v_and_b32 v19, s67, v136
  v_fma_f32 v18, v18, v12, v13
  s_waitcnt lgkmcnt(6)
  v_mfma_f32_32x32x16_bf16 a[16:31], a[224:227], v[132:135], a[16:31]
  ds_read_b64_tr_b16 a[252:253], v8 offset:40992
  ds_read_b64_tr_b16 a[254:255], v8 offset:41888
  v_fma_f32 v19, v19, v12, v13
  v_cvt_pk_bf16_f32 v136, v18, v19
  v_lshlrev_b32 v16, 16, v137
  v_and_b32 v17, s67, v137
  v_mfma_f32_32x32x16_bf16 a[32:47], a[228:231], v[132:135], a[32:47]
  ds_read_b64_tr_b16 a[224:225], v8 offset:41024
  ds_read_b64_tr_b16 a[226:227], v8 offset:41920
  buffer_load_dwordx4 v244, s[16:19], s64 offen offset:0 lds
  v_fma_f32 v16, v16, v12, v13
  v_mfma_f32_32x32x16_bf16 a[48:63], a[232:235], v[132:135], a[48:63]
  ds_read_b64_tr_b16 a[228:229], v8 offset:41056
  ds_read_b64_tr_b16 a[230:231], v8 offset:41952
  v_fma_f32 v17, v17, v12, v13
  v_cvt_pk_bf16_f32 v137, v16, v17
  v_lshlrev_b32 v18, 16, v138
  v_and_b32 v19, s67, v138
  v_mfma_f32_32x32x16_bf16 a[64:79], a[236:239], v[132:135], a[64:79]
  ds_read_b64_tr_b16 a[232:233], v8 offset:41088
  ds_read_b64_tr_b16 a[234:235], v8 offset:41984
  v_fma_f32 v18, v18, v12, v13
  v_fma_f32 v19, v19, v12, v13
  v_cvt_pk_bf16_f32 v138, v18, v19
  s_waitcnt lgkmcnt(6)
  v_mfma_f32_32x32x16_bf16 a[80:95], a[240:243], v[132:135], a[80:95]
  ds_read_b64_tr_b16 a[236:237], v8 offset:41120
  ds_read_b64_tr_b16 a[238:239], v8 offset:42016
  buffer_load_dwordx4 v245, s[16:19], s64 offen offset:1024 lds
  v_lshlrev_b32 v16, 16, v139
  v_mfma_f32_32x32x16_bf16 a[96:111], a[244:247], v[132:135], a[96:111]
  ds_read_b64_tr_b16 a[240:241], v8 offset:41152
  ds_read_b64_tr_b16 a[242:243], v8 offset:42048
  v_and_b32 v17, s67, v139
  v_fma_f32 v16, v16, v12, v13
  v_fma_f32 v17, v17, v12, v13
  v_cvt_pk_bf16_f32 v139, v16, v17
  s_nop 1
  v_mfma_f32_32x32x16_bf16 a[0:15], a[248:251], v[136:139], a[0:15]
  ds_read_b64_tr_b16 a[244:245], v8 offset:44544
  ds_read_b64_tr_b16 a[246:247], v8 offset:45440
  v_accvgpr_read_b32 v5, a132
  buffer_load_dword a200, v5, s[16:19], 0 offen offset:384
  v_mfma_f32_32x32x16_bf16 a[16:31], a[252:255], v[136:139], a[16:31]
  ds_read_b64_tr_b16 a[248:249], v8 offset:44576
  ds_read_b64_tr_b16 a[250:251], v8 offset:45472
  v_lshlrev_b32 v18, 16, v140
  v_and_b32 v19, s67, v140
  v_fma_f32 v18, v18, v12, v13
  s_waitcnt lgkmcnt(6)
  v_mfma_f32_32x32x16_bf16 a[32:47], a[224:227], v[136:139], a[32:47]
  ds_read_b64_tr_b16 a[252:253], v8 offset:44608
  ds_read_b64_tr_b16 a[254:255], v8 offset:45504
  buffer_load_dwordx4 v246, s[16:19], s64 offen offset:2048 lds
  v_fma_f32 v19, v19, v12, v13
  v_mfma_f32_32x32x16_bf16 a[48:63], a[228:231], v[136:139], a[48:63]
  ds_read_b64_tr_b16 a[224:225], v8 offset:44640
  ds_read_b64_tr_b16 a[226:227], v8 offset:45536
  v_cvt_pk_bf16_f32 v140, v18, v19
  v_lshlrev_b32 v16, 16, v141
  v_and_b32 v17, s67, v141
  v_fma_f32 v16, v16, v12, v13
  v_mfma_f32_32x32x16_bf16 a[64:79], a[232:235], v[136:139], a[64:79]
  ds_read_b64_tr_b16 a[228:229], v8 offset:44672
  ds_read_b64_tr_b16 a[230:231], v8 offset:45568
  v_fma_f32 v17, v17, v12, v13
  v_cvt_pk_bf16_f32 v141, v16, v17
  v_lshlrev_b32 v18, 16, v142
  v_and_b32 v19, s67, v142
  v_mfma_f32_32x32x16_bf16 a[80:95], a[236:239], v[136:139], a[80:95]
  ds_read_b64_tr_b16 a[232:233], v8 offset:44704
  ds_read_b64_tr_b16 a[234:235], v8 offset:45600
  v_fma_f32 v18, v18, v12, v13
  v_fma_f32 v19, v19, v12, v13
  v_cvt_pk_bf16_f32 v142, v18, v19
  s_waitcnt lgkmcnt(6)
  v_mfma_f32_32x32x16_bf16 a[96:111], a[240:243], v[136:139], a[96:111]
  ds_read_b64_tr_b16 a[236:237], v8 offset:44736
  ds_read_b64_tr_b16 a[238:239], v8 offset:45632
  v_lshlrev_b32 v16, 16, v143
  v_and_b32 v17, s67, v143
  v_fma_f32 v16, v16, v12, v13
  v_fma_f32 v17, v17, v12, v13
  v_cvt_pk_bf16_f32 v143, v16, v17
  s_nop 1
  v_mfma_f32_32x32x16_bf16 a[0:15], a[244:247], v[140:143], a[0:15]
  v_accvgpr_read_b32 v8, a124
  v_accvgpr_read_b32 v9, a125
  s_waitcnt vmcnt(16)
  s_barrier
  v_add_u32 v8, 0x10000, v8
  ds_read_b64_tr_b16 a[240:241], v8 offset:0
  ds_read_b64_tr_b16 a[242:243], v8 offset:512
  v_mfma_f32_32x32x16_bf16 a[16:31], a[248:251], v[140:143], a[16:31]
  v_add_u32 v9, 0x10000, v9
  ds_read_b64_tr_b16 a[244:245], v9 offset:0
  ds_read_b64_tr_b16 a[246:247], v9 offset:512
  s_add_u32 m0, s59, 0
  s_mov_b32 s62, 0x80
  v_mfma_f32_32x32x16_bf16 a[32:47], a[252:255], v[140:143], a[32:47]
  ds_read_b64_tr_b16 a[248:249], v8 offset:2048
  ds_read_b64_tr_b16 a[250:251], v8 offset:2560
  s_waitcnt lgkmcnt(6)
  v_mfma_f32_32x32x16_bf16 a[48:63], a[224:227], v[140:143], a[48:63]
  ds_read_b64_tr_b16 a[252:253], v9 offset:2048
  ds_read_b64_tr_b16 a[254:255], v9 offset:2560
  buffer_load_dwordx4 v247, s[16:19], s62 offen offset:0 lds
  v_mfma_f32_32x32x16_bf16 a[64:79], a[228:231], v[140:143], a[64:79]
  ds_read_b64_tr_b16 a[224:225], v8 offset:4096
  ds_read_b64_tr_b16 a[226:227], v8 offset:4608
  v_mfma_f32_32x32x16_bf16 a[80:95], a[232:235], v[140:143], a[80:95]
  ds_read_b64_tr_b16 a[228:229], v9 offset:4096
  ds_read_b64_tr_b16 a[230:231], v9 offset:4608
  buffer_load_dwordx4 v248, s[16:19], s62 offen offset:1024 lds
  v_mfma_f32_32x32x16_bf16 a[96:111], a[236:239], v[140:143], a[96:111]
  ds_read_b64_tr_b16 a[232:233], v8 offset:6144
  ds_read_b64_tr_b16 a[234:235], v8 offset:6656
  s_waitcnt lgkmcnt(6)
  v_mfma_f32_32x32x16_bf16 v[144:159], a[240:243], v[32:35], 0
  ds_read_b64_tr_b16 a[236:237], v9 offset:6144
  ds_read_b64_tr_b16 a[238:239], v9 offset:6656
  v_mfma_f32_32x32x16_bf16 v[160:175], a[244:247], v[32:35], 0
  ds_read_b64_tr_b16 a[240:241], v8 offset:8192
  ds_read_b64_tr_b16 a[242:243], v8 offset:8704
  v_accvgpr_read_b32 v26, a0
  v_accvgpr_read_b32 v27, a8
  v_accvgpr_read_b32 v28, a1
  v_accvgpr_read_b32 v29, a9
  v_mfma_f32_32x32x16_bf16 v[144:159], a[248:251], v[36:39], v[144:159]
  ds_read_b64_tr_b16 a[244:245], v9 offset:8192
  ds_read_b64_tr_b16 a[246:247], v9 offset:8704
  buffer_load_dwordx4 v249, s[16:19], s62 offen offset:2048 lds
  v_mul_f32 v26, v26, v27
  v_mfma_f32_32x32x16_bf16 v[160:175], a[252:255], v[36:39], v[160:175]
  ds_read_b64_tr_b16 a[248:249], v8 offset:10240
  ds_read_b64_tr_b16 a[250:251], v8 offset:10752
  v_mul_f32 v28, v28, v29
  v_cvt_pk_bf16_f32 v16, v26, v28
  v_accvgpr_read_b32 v26, a2
  s_waitcnt lgkmcnt(6)
  v_mfma_f32_32x32x16_bf16 v[144:159], a[224:227], v[40:43], v[144:159]
  ds_read_b64_tr_b16 a[252:253], v9 offset:10240
  ds_read_b64_tr_b16 a[254:255], v9 offset:10752
  v_accvgpr_read_b32 v27, a10
  v_accvgpr_read_b32 v28, a3
  v_accvgpr_read_b32 v29, a11
  v_mul_f32 v26, v26, v27
  v_mfma_f32_32x32x16_bf16 v[160:175], a[228:231], v[40:43], v[160:175]
  ds_read_b64_tr_b16 a[224:225], v8 offset:12288
  ds_read_b64_tr_b16 a[226:227], v8 offset:12800
  buffer_load_dwordx4 v250, s[16:19], s62 offen offset:3072 lds
  v_mul_f32 v28, v28, v29
  v_mfma_f32_32x32x16_bf16 v[144:159], a[232:235], v[44:47], v[144:159]
  ds_read_b64_tr_b16 a[228:229], v9 offset:12288
  ds_read_b64_tr_b16 a[230:231], v9 offset:12800
  s_add_u32 m0, s59, 4096
  v_cvt_pk_bf16_f32 v17, v26, v28
  v_accvgpr_read_b32 v26, a4
  v_accvgpr_read_b32 v27, a12
  v_mfma_f32_32x32x16_bf16 v[160:175], a[236:239], v[44:47], v[160:175]
  ds_read_b64_tr_b16 a[232:233], v8 offset:14336
  ds_read_b64_tr_b16 a[234:235], v8 offset:14848
  v_accvgpr_read_b32 v28, a5
  v_accvgpr_read_b32 v29, a13
  v_mul_f32 v26, v26, v27
  s_waitcnt lgkmcnt(6)
  v_mfma_f32_32x32x16_bf16 v[144:159], a[240:243], v[48:51], v[144:159]
  ds_read_b64_tr_b16 a[236:237], v9 offset:14336
  ds_read_b64_tr_b16 a[238:239], v9 offset:14848
  v_mul_f32 v28, v28, v29
  v_cvt_pk_bf16_f32 v18, v26, v28
  v_accvgpr_read_b32 v26, a6
  v_accvgpr_read_b32 v27, a14
  v_mfma_f32_32x32x16_bf16 v[160:175], a[244:247], v[48:51], v[160:175]
  ds_read_b64_tr_b16 a[240:241], v8 offset:16384
  ds_read_b64_tr_b16 a[242:243], v8 offset:16896
  buffer_load_dwordx4 v251, s[16:19], s62 offen offset:0 lds
  v_accvgpr_read_b32 v28, a7
  v_mfma_f32_32x32x16_bf16 v[144:159], a[248:251], v[52:55], v[144:159]
  ds_read_b64_tr_b16 a[244:245], v9 offset:16384
  ds_read_b64_tr_b16 a[246:247], v9 offset:16896
  v_accvgpr_read_b32 v29, a15
  v_mul_f32 v26, v26, v27
  v_mul_f32 v28, v28, v29
  v_cvt_pk_bf16_f32 v19, v26, v28
  v_mfma_f32_32x32x16_bf16 v[160:175], a[252:255], v[52:55], v[160:175]
  ds_read_b64_tr_b16 a[248:249], v8 offset:18432
  ds_read_b64_tr_b16 a[250:251], v8 offset:18944
  buffer_store_dwordx4 v[16:19], v24, s[28:31], s71 offen offset:0 sc1
  s_waitcnt lgkmcnt(6)
  v_mfma_f32_32x32x16_bf16 v[144:159], a[224:227], v[56:59], v[144:159]
  ds_read_b64_tr_b16 a[252:253], v9 offset:18432
  ds_read_b64_tr_b16 a[254:255], v9 offset:18944
  buffer_load_dwordx4 v252, s[16:19], s62 offen offset:1024 lds
  v_accvgpr_read_b32 v26, a16
  v_mfma_f32_32x32x16_bf16 v[160:175], a[228:231], v[56:59], v[160:175]
  ds_read_b64_tr_b16 a[224:225], v8 offset:20480
  ds_read_b64_tr_b16 a[226:227], v8 offset:20992
  v_accvgpr_read_b32 v27, a24
  v_accvgpr_read_b32 v28, a17
  v_accvgpr_read_b32 v29, a25
  v_mul_f32 v26, v26, v27
  v_mfma_f32_32x32x16_bf16 v[144:159], a[232:235], v[60:63], v[144:159]
  ds_read_b64_tr_b16 a[228:229], v9 offset:20480
  ds_read_b64_tr_b16 a[230:231], v9 offset:20992
  v_mul_f32 v28, v28, v29
  v_cvt_pk_bf16_f32 v20, v26, v28
  v_accvgpr_read_b32 v26, a18
  v_accvgpr_read_b32 v27, a26
  v_mfma_f32_32x32x16_bf16 v[160:175], a[236:239], v[60:63], v[160:175]
  ds_read_b64_tr_b16 a[232:233], v8 offset:22528
  ds_read_b64_tr_b16 a[234:235], v8 offset:23040
  v_accvgpr_read_b32 v28, a19
  v_accvgpr_read_b32 v29, a27
  v_mul_f32 v26, v26, v27
  s_waitcnt lgkmcnt(6)
  v_mfma_f32_32x32x16_bf16 v[144:159], a[240:243], v[64:67], v[144:159]
  ds_read_b64_tr_b16 a[236:237], v9 offset:22528
  ds_read_b64_tr_b16 a[238:239], v9 offset:23040
  buffer_load_dwordx4 v253, s[16:19], s62 offen offset:2048 lds
  v_mul_f32 v28, v28, v29
  v_mfma_f32_32x32x16_bf16 v[160:175], a[244:247], v[64:67], v[160:175]
  ds_read_b64_tr_b16 a[240:241], v8 offset:24576
  ds_read_b64_tr_b16 a[242:243], v8 offset:25088
  v_cvt_pk_bf16_f32 v21, v26, v28
  v_accvgpr_read_b32 v26, a20
  v_accvgpr_read_b32 v27, a28
  v_accvgpr_read_b32 v28, a21
  v_mfma_f32_32x32x16_bf16 v[144:159], a[248:251], v[68:71], v[144:159]
  ds_read_b64_tr_b16 a[244:245], v9 offset:24576
  ds_read_b64_tr_b16 a[246:247], v9 offset:25088
  v_accvgpr_read_b32 v29, a29
  v_mul_f32 v26, v26, v27
  v_mul_f32 v28, v28, v29
  v_cvt_pk_bf16_f32 v22, v26, v28
  v_mfma_f32_32x32x16_bf16 v[160:175], a[252:255], v[68:71], v[160:175]
  ds_read_b64_tr_b16 a[248:249], v8 offset:26624
  ds_read_b64_tr_b16 a[250:251], v8 offset:27136
  v_accvgpr_read_b32 v26, a22
  v_accvgpr_read_b32 v27, a30
  v_accvgpr_read_b32 v28, a23
  s_waitcnt lgkmcnt(6)
  v_mfma_f32_32x32x16_bf16 v[144:159], a[224:227], v[72:75], v[144:159]
  ds_read_b64_tr_b16 a[252:253], v9 offset:26624
  ds_read_b64_tr_b16 a[254:255], v9 offset:27136
  v_accvgpr_read_b32 v29, a31
  v_mul_f32 v26, v26, v27
  v_mul_f32 v28, v28, v29
  v_cvt_pk_bf16_f32 v23, v26, v28
  v_mfma_f32_32x32x16_bf16 v[160:175], a[228:231], v[72:75], v[160:175]
  s_waitcnt vmcnt(16)
  s_barrier
  ds_read_b64_tr_b16 a[224:225], v8 offset:32768
  ds_read_b64_tr_b16 a[226:227], v8 offset:33280
  s_add_u32 m0, s59, 32768
  v_mfma_f32_32x32x16_bf16 v[144:159], a[232:235], v[76:79], v[144:159]
  ds_read_b64_tr_b16 a[228:229], v9 offset:32768
  ds_read_b64_tr_b16 a[230:231], v9 offset:33280
  s_mov_b32 s64, 0x100
  buffer_store_dwordx4 v[20:23], v24, s[28:31], s71 offen offset:1024 sc1
  v_mfma_f32_32x32x16_bf16 v[160:175], a[236:239], v[76:79], v[160:175]
  ds_read_b64_tr_b16 a[232:233], v8 offset:34816
  ds_read_b64_tr_b16 a[234:235], v8 offset:35328
  v_accvgpr_read_b32 v26, a32
  v_accvgpr_read_b32 v27, a40
  v_accvgpr_read_b32 v28, a33
  s_waitcnt lgkmcnt(6)
  v_mfma_f32_32x32x16_bf16 v[144:159], a[240:243], v[80:83], v[144:159]
  ds_read_b64_tr_b16 a[236:237], v9 offset:34816
  ds_read_b64_tr_b16 a[238:239], v9 offset:35328
  buffer_load_dwordx4 v240, s[16:19], s64 offen offset:0 lds
  v_accvgpr_read_b32 v29, a41
  v_mfma_f32_32x32x16_bf16 v[160:175], a[244:247], v[80:83], v[160:175]
  ds_read_b64_tr_b16 a[240:241], v8 offset:36864
  ds_read_b64_tr_b16 a[242:243], v8 offset:37376
  v_mul_f32 v26, v26, v27
  v_mul_f32 v28, v28, v29
  v_cvt_pk_bf16_f32 v16, v26, v28
  v_accvgpr_read_b32 v26, a34
  v_mfma_f32_32x32x16_bf16 v[144:159], a[248:251], v[84:87], v[144:159]
  ds_read_b64_tr_b16 a[244:245], v9 offset:36864
  ds_read_b64_tr_b16 a[246:247], v9 offset:37376
  buffer_load_dwordx4 v241, s[16:19], s64 offen offset:1024 lds
  v_accvgpr_read_b32 v27, a42
  v_mfma_f32_32x32x16_bf16 v[160:175], a[252:255], v[84:87], v[160:175]
  ds_read_b64_tr_b16 a[248:249], v8 offset:38912
  ds_read_b64_tr_b16 a[250:251], v8 offset:39424
  v_accvgpr_read_b32 v28, a35
  v_accvgpr_read_b32 v29, a43
  v_mul_f32 v26, v26, v27
  s_waitcnt lgkmcnt(6)
  v_mfma_f32_32x32x16_bf16 v[144:159], a[224:227], v[88:91], v[144:159]
  ds_read_b64_tr_b16 a[252:253], v9 offset:38912
  ds_read_b64_tr_b16 a[254:255], v9 offset:39424
  v_mul_f32 v28, v28, v29
  v_cvt_pk_bf16_f32 v17, v26, v28
  v_accvgpr_read_b32 v26, a36
  v_accvgpr_read_b32 v27, a44
  v_mfma_f32_32x32x16_bf16 v[160:175], a[228:231], v[88:91], v[160:175]
  ds_read_b64_tr_b16 a[224:225], v8 offset:40960
  ds_read_b64_tr_b16 a[226:227], v8 offset:41472
  v_accvgpr_read_b32 v28, a37
  v_accvgpr_read_b32 v29, a45
  v_mul_f32 v26, v26, v27
  v_mul_f32 v28, v28, v29
  v_mfma_f32_32x32x16_bf16 v[144:159], a[232:235], v[92:95], v[144:159]
  ds_read_b64_tr_b16 a[228:229], v9 offset:40960
  ds_read_b64_tr_b16 a[230:231], v9 offset:41472
  buffer_load_dwordx4 v242, s[16:19], s64 offen offset:2048 lds
  v_cvt_pk_bf16_f32 v18, v26, v28
  v_mfma_f32_32x32x16_bf16 v[160:175], a[236:239], v[92:95], v[160:175]
  ds_read_b64_tr_b16 a[232:233], v8 offset:43008
  ds_read_b64_tr_b16 a[234:235], v8 offset:43520
  v_accvgpr_read_b32 v26, a38
  v_accvgpr_read_b32 v27, a46
  v_accvgpr_read_b32 v28, a39
  s_waitcnt lgkmcnt(6)
  v_mfma_f32_32x32x16_bf16 v[144:159], a[240:243], v[96:99], v[144:159]
  ds_read_b64_tr_b16 a[236:237], v9 offset:43008
  ds_read_b64_tr_b16 a[238:239], v9 offset:43520
  v_accvgpr_read_b32 v29, a47
  v_mul_f32 v26, v26, v27
  v_mul_f32 v28, v28, v29
  v_cvt_pk_bf16_f32 v19, v26, v28
  v_mfma_f32_32x32x16_bf16 v[160:175], a[244:247], v[96:99], v[160:175]
  ds_read_b64_tr_b16 a[240:241], v8 offset:45056
  ds_read_b64_tr_b16 a[242:243], v8 offset:45568
  buffer_load_dwordx4 v243, s[16:19], s64 offen offset:3072 lds
  v_mfma_f32_32x32x16_bf16 v[144:159], a[248:251], v[100:103], v[144:159]
  ds_read_b64_tr_b16 a[244:245], v9 offset:45056
  ds_read_b64_tr_b16 a[246:247], v9 offset:45568
  s_add_u32 m0, s59, 36864
  buffer_store_dwordx4 v[16:19], v24, s[28:31], s71 offen offset:2048 sc1
  v_mfma_f32_32x32x16_bf16 v[160:175], a[252:255], v[100:103], v[160:175]
  ds_read_b64_tr_b16 a[248:249], v8 offset:47104
  ds_read_b64_tr_b16 a[250:251], v8 offset:47616
  s_waitcnt lgkmcnt(6)
  v_mfma_f32_32x32x16_bf16 v[144:159], a[224:227], v[104:107], v[144:159]
  ds_read_b64_tr_b16 a[252:253], v9 offset:47104
  ds_read_b64_tr_b16 a[254:255], v9 offset:47616
  v_mfma_f32_32x32x16_bf16 v[160:175], a[228:231], v[104:107], v[160:175]
  ds_read_b64_tr_b16 a[224:225], v8 offset:49152
  ds_read_b64_tr_b16 a[226:227], v8 offset:49664
  buffer_load_dwordx4 v244, s[16:19], s64 offen offset:0 lds
  v_mfma_f32_32x32x16_bf16 v[144:159], a[232:235], v[108:111], v[144:159]
  ds_read_b64_tr_b16 a[228:229], v9 offset:49152
  ds_read_b64_tr_b16 a[230:231], v9 offset:49664
  v_accvgpr_read_b32 v5, a133
  buffer_load_dword a200, v5, s[20:23], 0 offen offset:0
  v_mfma_f32_32x32x16_bf16 v[160:175], a[236:239], v[108:111], v[160:175]
  ds_read_b64_tr_b16 a[232:233], v8 offset:51200
  ds_read_b64_tr_b16 a[234:235], v8 offset:51712
  s_waitcnt lgkmcnt(6)
  v_mfma_f32_32x32x16_bf16 v[144:159], a[240:243], v[112:115], v[144:159]
  ds_read_b64_tr_b16 a[236:237], v9 offset:51200
  ds_read_b64_tr_b16 a[238:239], v9 offset:51712
  buffer_load_dwordx4 v245, s[16:19], s64 offen offset:1024 lds
  v_mfma_f32_32x32x16_bf16 v[160:175], a[244:247], v[112:115], v[160:175]
  ds_read_b64_tr_b16 a[240:241], v8 offset:53248
  ds_read_b64_tr_b16 a[242:243], v8 offset:53760
  v_mfma_f32_32x32x16_bf16 v[144:159], a[248:251], v[116:119], v[144:159]
  ds_read_b64_tr_b16 a[244:245], v9 offset:53248
  ds_read_b64_tr_b16 a[246:247], v9 offset:53760
  v_mfma_f32_32x32x16_bf16 v[160:175], a[252:255], v[116:119], v[160:175]
  ds_read_b64_tr_b16 a[248:249], v8 offset:55296
  ds_read_b64_tr_b16 a[250:251], v8 offset:55808
  s_waitcnt lgkmcnt(6)
  v_mfma_f32_32x32x16_bf16 v[144:159], a[224:227], v[120:123], v[144:159]
  ds_read_b64_tr_b16 a[252:253], v9 offset:55296
  ds_read_b64_tr_b16 a[254:255], v9 offset:55808
  buffer_load_dwordx4 v246, s[16:19], s64 offen offset:2048 lds
  v_mfma_f32_32x32x16_bf16 v[160:175], a[228:231], v[120:123], v[160:175]
  ds_read_b64_tr_b16 a[224:225], v8 offset:57344
  ds_read_b64_tr_b16 a[226:227], v8 offset:57856
  v_mfma_f32_32x32x16_bf16 v[144:159], a[232:235], v[124:127], v[144:159]
  ds_read_b64_tr_b16 a[228:229], v9 offset:57344
  ds_read_b64_tr_b16 a[230:231], v9 offset:57856
  v_mfma_f32_32x32x16_bf16 v[160:175], a[236:239], v[124:127], v[160:175]
  ds_read_b64_tr_b16 a[232:233], v8 offset:59392
  ds_read_b64_tr_b16 a[234:235], v8 offset:59904
  s_waitcnt lgkmcnt(6)
  v_mfma_f32_32x32x16_bf16 v[144:159], a[240:243], v[128:131], v[144:159]
  ds_read_b64_tr_b16 a[236:237], v9 offset:59392
  ds_read_b64_tr_b16 a[238:239], v9 offset:59904
  v_mfma_f32_32x32x16_bf16 v[160:175], a[244:247], v[128:131], v[160:175]
  s_waitcnt vmcnt(18)
  s_barrier
  v_add_u32 v8, 0x10000, v8
  ds_read_b64_tr_b16 a[240:241], v8 offset:0
  ds_read_b64_tr_b16 a[242:243], v8 offset:512
  v_mfma_f32_32x32x16_bf16 v[144:159], a[248:251], v[132:135], v[144:159]
  v_add_u32 v9, 0x10000, v9
  ds_read_b64_tr_b16 a[244:245], v9 offset:0
  ds_read_b64_tr_b16 a[246:247], v9 offset:512
  s_add_u32 m0, s59, 65536
  s_mov_b32 s62, 0x100
  v_mfma_f32_32x32x16_bf16 v[160:175], a[252:255], v[132:135], v[160:175]
  ds_read_b64_tr_b16 a[248:249], v8 offset:2048
  ds_read_b64_tr_b16 a[250:251], v8 offset:2560
  s_waitcnt lgkmcnt(6)
  v_mfma_f32_32x32x16_bf16 v[144:159], a[224:227], v[136:139], v[144:159]
  ds_read_b64_tr_b16 a[252:253], v9 offset:2048
  ds_read_b64_tr_b16 a[254:255], v9 offset:2560
  buffer_load_dwordx4 v247, s[16:19], s62 offen offset:0 lds
  v_mfma_f32_32x32x16_bf16 v[160:175], a[228:231], v[136:139], v[160:175]
  ds_read_b64_tr_b16 a[224:225], v8 offset:4096
  ds_read_b64_tr_b16 a[226:227], v8 offset:4608
  v_mfma_f32_32x32x16_bf16 v[144:159], a[232:235], v[140:143], v[144:159]
  ds_read_b64_tr_b16 a[228:229], v9 offset:4096
  ds_read_b64_tr_b16 a[230:231], v9 offset:4608
  buffer_load_dwordx4 v248, s[16:19], s62 offen offset:1024 lds
  v_mfma_f32_32x32x16_bf16 v[160:175], a[236:239], v[140:143], v[160:175]
  ds_read_b64_tr_b16 a[232:233], v8 offset:6144
  ds_read_b64_tr_b16 a[234:235], v8 offset:6656
  s_waitcnt lgkmcnt(6)
  v_mfma_f32_32x32x16_bf16 v[176:191], a[240:243], v[32:35], 0
  ds_read_b64_tr_b16 a[236:237], v9 offset:6144
  ds_read_b64_tr_b16 a[238:239], v9 offset:6656
  v_mfma_f32_32x32x16_bf16 v[192:207], a[244:247], v[32:35], 0
  ds_read_b64_tr_b16 a[240:241], v8 offset:8192
  ds_read_b64_tr_b16 a[242:243], v8 offset:8704
  v_cvt_pk_bf16_f32 v208, v144, v145
  v_cvt_pk_bf16_f32 v209, v146, v147
  v_cvt_pk_bf16_f32 v210, v148, v149
  v_cvt_pk_bf16_f32 v211, v150, v151
  v_mfma_f32_32x32x16_bf16 v[176:191], a[248:251], v[36:39], v[176:191]
  ds_read_b64_tr_b16 a[244:245], v9 offset:8192
  ds_read_b64_tr_b16 a[246:247], v9 offset:8704
  buffer_load_dwordx4 v249, s[16:19], s62 offen offset:2048 lds
  v_cvt_pk_bf16_f32 v212, v152, v153
  v_mfma_f32_32x32x16_bf16 v[192:207], a[252:255], v[36:39], v[192:207]
  ds_read_b64_tr_b16 a[248:249], v8 offset:10240
  ds_read_b64_tr_b16 a[250:251], v8 offset:10752
  v_cvt_pk_bf16_f32 v213, v154, v155
  v_cvt_pk_bf16_f32 v214, v156, v157
  v_cvt_pk_bf16_f32 v215, v158, v159
  s_waitcnt lgkmcnt(6)
  v_mfma_f32_32x32x16_bf16 v[176:191], a[224:227], v[40:43], v[176:191]
  ds_read_b64_tr_b16 a[252:253], v9 offset:10240
  ds_read_b64_tr_b16 a[254:255], v9 offset:10752
  v_cvt_pk_bf16_f32 v216, v160, v161
  v_cvt_pk_bf16_f32 v217, v162, v163
  v_cvt_pk_bf16_f32 v218, v164, v165
  v_cvt_pk_bf16_f32 v219, v166, v167
  v_mfma_f32_32x32x16_bf16 v[192:207], a[228:231], v[40:43], v[192:207]
  ds_read_b64_tr_b16 a[224:225], v8 offset:12288
  ds_read_b64_tr_b16 a[226:227], v8 offset:12800
  buffer_load_dwordx4 v250, s[16:19], s62 offen offset:3072 lds
  v_cvt_pk_bf16_f32 v220, v168, v169
  v_mfma_f32_32x32x16_bf16 v[176:191], a[232:235], v[44:47], v[176:191]
  ds_read_b64_tr_b16 a[228:229], v9 offset:12288
  ds_read_b64_tr_b16 a[230:231], v9 offset:12800
  s_add_u32 m0, s59, 69632
  v_cvt_pk_bf16_f32 v221, v170, v171
  v_cvt_pk_bf16_f32 v222, v172, v173
  v_cvt_pk_bf16_f32 v223, v174, v175
  v_mfma_f32_32x32x16_bf16 v[192:207], a[236:239], v[44:47], v[192:207]
  ds_read_b64_tr_b16 a[232:233], v8 offset:14336
  ds_read_b64_tr_b16 a[234:235], v8 offset:14848
  v_accvgpr_read_b32 v26, a48
  v_accvgpr_read_b32 v27, a56
  v_accvgpr_read_b32 v28, a49
  s_waitcnt lgkmcnt(6)
  v_mfma_f32_32x32x16_bf16 v[176:191], a[240:243], v[48:51], v[176:191]
  ds_read_b64_tr_b16 a[236:237], v9 offset:14336
  ds_read_b64_tr_b16 a[238:239], v9 offset:14848
  v_accvgpr_read_b32 v29, a57
  v_mul_f32 v26, v26, v27
  v_mul_f32 v28, v28, v29
  v_cvt_pk_bf16_f32 v20, v26, v28
  v_mfma_f32_32x32x16_bf16 v[192:207], a[244:247], v[48:51], v[192:207]
  ds_read_b64_tr_b16 a[240:241], v8 offset:16384
  ds_read_b64_tr_b16 a[242:243], v8 offset:16896
  buffer_load_dwordx4 v251, s[16:19], s62 offen offset:0 lds
  v_accvgpr_read_b32 v26, a50
  v_mfma_f32_32x32x16_bf16 v[176:191], a[248:251], v[52:55], v[176:191]
  ds_read_b64_tr_b16 a[244:245], v9 offset:16384
  ds_read_b64_tr_b16 a[246:247], v9 offset:16896
  v_accvgpr_read_b32 v27, a58
  v_accvgpr_read_b32 v28, a51
  v_accvgpr_read_b32 v29, a59
  v_mul_f32 v26, v26, v27
  v_mfma_f32_32x32x16_bf16 v[192:207], a[252:255], v[52:55], v[192:207]
  ds_read_b64_tr_b16 a[248:249], v8 offset:18432
  ds_read_b64_tr_b16 a[250:251], v8 offset:18944
  v_mul_f32 v28, v28, v29
  v_cvt_pk_bf16_f32 v21, v26, v28
  v_accvgpr_read_b32 v26, a52
  s_waitcnt lgkmcnt(6)
  v_mfma_f32_32x32x16_bf16 v[176:191], a[224:227], v[56:59], v[176:191]
  ds_read_b64_tr_b16 a[252:253], v9 offset:18432
  ds_read_b64_tr_b16 a[254:255], v9 offset:18944
  buffer_load_dwordx4 v252, s[16:19], s62 offen offset:1024 lds
  v_accvgpr_read_b32 v27, a60
  v_mfma_f32_32x32x16_bf16 v[192:207], a[228:231], v[56:59], v[192:207]
  ds_read_b64_tr_b16 a[224:225], v8 offset:20480
  ds_read_b64_tr_b16 a[226:227], v8 offset:20992
  v_accvgpr_read_b32 v28, a53
  v_accvgpr_read_b32 v29, a61
  v_mul_f32 v26, v26, v27
  v_mul_f32 v28, v28, v29
  v_mfma_f32_32x32x16_bf16 v[176:191], a[232:235], v[60:63], v[176:191]
  ds_read_b64_tr_b16 a[228:229], v9 offset:20480
  ds_read_b64_tr_b16 a[230:231], v9 offset:20992
  v_cvt_pk_bf16_f32 v22, v26, v28
  v_accvgpr_read_b32 v26, a54
  v_accvgpr_read_b32 v27, a62
  v_accvgpr_read_b32 v28, a55
  v_mfma_f32_32x32x16_bf16 v[192:207], a[236:239], v[60:63], v[192:207]
  ds_read_b64_tr_b16 a[232:233], v8 offset:22528
  ds_read_b64_tr_b16 a[234:235], v8 offset:23040
  v_accvgpr_read_b32 v29, a63
  v_mul_f32 v26, v26, v27
  v_mul_f32 v28, v28, v29
  s_waitcnt lgkmcnt(6)
  v_mfma_f32_32x32x16_bf16 v[176:191], a[240:243], v[64:67], v[176:191]
  ds_read_b64_tr_b16 a[236:237], v9 offset:22528
  ds_read_b64_tr_b16 a[238:239], v9 offset:23040
  buffer_load_dwordx4 v253, s[16:19], s62 offen offset:2048 lds
  v_cvt_pk_bf16_f32 v23, v26, v28
  v_mfma_f32_32x32x16_bf16 v[192:207], a[244:247], v[64:67], v[192:207]
  ds_read_b64_tr_b16 a[240:241], v8 offset:24576
  ds_read_b64_tr_b16 a[242:243], v8 offset:25088
  buffer_store_dwordx4 v[20:23], v24, s[28:31], s71 offen offset:3072 sc1
  v_accvgpr_read_b32 v26, a64
  v_mfma_f32_32x32x16_bf16 v[176:191], a[248:251], v[68:71], v[176:191]
  ds_read_b64_tr_b16 a[244:245], v9 offset:24576
  ds_read_b64_tr_b16 a[246:247], v9 offset:25088
  v_accvgpr_read_b32 v27, a72
  v_accvgpr_read_b32 v28, a65
  v_accvgpr_read_b32 v29, a73
  v_mul_f32 v26, v26, v27
  v_mfma_f32_32x32x16_bf16 v[192:207], a[252:255], v[68:71], v[192:207]
  ds_read_b64_tr_b16 a[248:249], v8 offset:26624
  ds_read_b64_tr_b16 a[250:251], v8 offset:27136
  v_mul_f32 v28, v28, v29
  v_cvt_pk_bf16_f32 v16, v26, v28
  v_accvgpr_read_b32 v26, a66
  s_waitcnt lgkmcnt(6)
  v_mfma_f32_32x32x16_bf16 v[176:191], a[224:227], v[72:75], v[176:191]
  ds_read_b64_tr_b16 a[252:253], v9 offset:26624
  ds_read_b64_tr_b16 a[254:255], v9 offset:27136
  v_accvgpr_read_b32 v27, a74
  v_accvgpr_read_b32 v28, a67
  v_accvgpr_read_b32 v29, a75
  v_mul_f32 v26, v26, v27
  v_mfma_f32_32x32x16_bf16 v[192:207], a[228:231], v[72:75], v[192:207]
  s_waitcnt vmcnt(18)
  s_barrier
  v_add_u32 v8, 0xfffe0000, v8
  ds_read_b64_tr_b16 a[224:225], v8 offset:0
  ds_read_b64_tr_b16 a[226:227], v8 offset:512
  v_mfma_f32_32x32x16_bf16 v[176:191], a[232:235], v[76:79], v[176:191]
  v_add_u32 v9, 0xfffe0000, v9
  ds_read_b64_tr_b16 a[228:229], v9 offset:0
  ds_read_b64_tr_b16 a[230:231], v9 offset:512
  s_add_u32 m0, s59, 98304
  s_mov_b32 s64, 0x180
  v_mul_f32 v28, v28, v29
  v_mfma_f32_32x32x16_bf16 v[192:207], a[236:239], v[76:79], v[192:207]
  ds_read_b64_tr_b16 a[232:233], v8 offset:2048
  ds_read_b64_tr_b16 a[234:235], v8 offset:2560
  v_cvt_pk_bf16_f32 v17, v26, v28
  v_accvgpr_read_b32 v26, a68
  v_accvgpr_read_b32 v27, a76
  s_waitcnt lgkmcnt(6)
  v_mfma_f32_32x32x16_bf16 v[176:191], a[240:243], v[80:83], v[176:191]
  ds_read_b64_tr_b16 a[236:237], v9 offset:2048
  ds_read_b64_tr_b16 a[238:239], v9 offset:2560
  buffer_load_dwordx4 v240, s[16:19], s64 offen offset:0 lds
  v_accvgpr_read_b32 v28, a69
  v_mfma_f32_32x32x16_bf16 v[192:207], a[244:247], v[80:83], v[192:207]
  ds_read_b64_tr_b16 a[240:241], v8 offset:4096
  ds_read_b64_tr_b16 a[242:243], v8 offset:4608
  v_accvgpr_read_b32 v29, a77
  v_mul_f32 v26, v26, v27
  v_mul_f32 v28, v28, v29
  v_cvt_pk_bf16_f32 v18, v26, v28
  v_mfma_f32_32x32x16_bf16 v[176:191], a[248:251], v[84:87], v[176:191]
  ds_read_b64_tr_b16 a[244:245], v9 offset:4096
  ds_read_b64_tr_b16 a[246:247], v9 offset:4608
  buffer_load_dwordx4 v241, s[16:19], s64 offen offset:1024 lds
  v_accvgpr_read_b32 v26, a70
  v_mfma_f32_32x32x16_bf16 v[192:207], a[252:255], v[84:87], v[192:207]
  ds_read_b64_tr_b16 a[248:249], v8 offset:6144
  ds_read_b64_tr_b16 a[250:251], v8 offset:6656
  v_accvgpr_read_b32 v27, a78
  v_accvgpr_read_b32 v28, a71
  v_accvgpr_read_b32 v29, a79
  s_waitcnt lgkmcnt(6)
  v_mfma_f32_32x32x16_bf16 v[176:191], a[224:227], v[88:91], v[176:191]
  ds_read_b64_tr_b16 a[252:253], v9 offset:6144
  ds_read_b64_tr_b16 a[254:255], v9 offset:6656
  v_mul_f32 v26, v26, v27
  v_mul_f32 v28, v28, v29
  v_cvt_pk_bf16_f32 v19, v26, v28
  s_add_u32 s71, s71, 4096
  v_mfma_f32_32x32x16_bf16 v[192:207], a[228:231], v[88:91], v[192:207]
  ds_read_b64_tr_b16 a[224:225], v8 offset:8192
  ds_read_b64_tr_b16 a[226:227], v8 offset:8704
  buffer_store_dwordx4 v[16:19], v24, s[28:31], s71 offen offset:0 sc1
  v_accvgpr_read_b32 v26, a80
  v_mfma_f32_32x32x16_bf16 v[176:191], a[232:235], v[92:95], v[176:191]
  ds_read_b64_tr_b16 a[228:229], v9 offset:8192
  ds_read_b64_tr_b16 a[230:231], v9 offset:8704
  buffer_load_dwordx4 v242, s[16:19], s64 offen offset:2048 lds
  v_accvgpr_read_b32 v27, a88
  v_mfma_f32_32x32x16_bf16 v[192:207], a[236:239], v[92:95], v[192:207]
  ds_read_b64_tr_b16 a[232:233], v8 offset:10240
  ds_read_b64_tr_b16 a[234:235], v8 offset:10752
  v_accvgpr_read_b32 v28, a81
  v_accvgpr_read_b32 v29, a89
  v_mul_f32 v26, v26, v27
  s_waitcnt lgkmcnt(6)
  v_mfma_f32_32x32x16_bf16 v[176:191], a[240:243], v[96:99], v[176:191]
  ds_read_b64_tr_b16 a[236:237], v9 offset:10240
  ds_read_b64_tr_b16 a[238:239], v9 offset:10752
  v_mul_f32 v28, v28, v29
  v_cvt_pk_bf16_f32 v20, v26, v28
  v_accvgpr_read_b32 v26, a82
  v_accvgpr_read_b32 v27, a90
  v_mfma_f32_32x32x16_bf16 v[192:207], a[244:247], v[96:99], v[192:207]
  ds_read_b64_tr_b16 a[240:241], v8 offset:12288
  ds_read_b64_tr_b16 a[242:243], v8 offset:12800
  buffer_load_dwordx4 v243, s[16:19], s64 offen offset:3072 lds
  v_accvgpr_read_b32 v28, a83
  v_mfma_f32_32x32x16_bf16 v[176:191], a[248:251], v[100:103], v[176:191]
  ds_read_b64_tr_b16 a[244:245], v9 offset:12288
  ds_read_b64_tr_b16 a[246:247], v9 offset:12800
  s_add_u32 m0, s59, 102400
  v_accvgpr_read_b32 v29, a91
  v_mul_f32 v26, v26, v27
  v_mul_f32 v28, v28, v29
  v_mfma_f32_32x32x16_bf16 v[192:207], a[252:255], v[100:103], v[192:207]
  ds_read_b64_tr_b16 a[248:249], v8 offset:14336
  ds_read_b64_tr_b16 a[250:251], v8 offset:14848
  v_cvt_pk_bf16_f32 v21, v26, v28
  v_accvgpr_read_b32 v26, a84
  v_accvgpr_read_b32 v27, a92
  s_waitcnt lgkmcnt(6)
  v_mfma_f32_32x32x16_bf16 v[176:191], a[224:227], v[104:107], v[176:191]
  ds_read_b64_tr_b16 a[252:253], v9 offset:14336
  ds_read_b64_tr_b16 a[254:255], v9 offset:14848
  v_accvgpr_read_b32 v28, a85
  v_accvgpr_read_b32 v29, a93
  v_mul_f32 v26, v26, v27
  v_mul_f32 v28, v28, v29
  v_mfma_f32_32x32x16_bf16 v[192:207], a[228:231], v[104:107], v[192:207]
  ds_read_b64_tr_b16 a[224:225], v8 offset:16384
  ds_read_b64_tr_b16 a[226:227], v8 offset:16896
  buffer_load_dwordx4 v244, s[16:19], s64 offen offset:0 lds
  v_cvt_pk_bf16_f32 v22, v26, v28
  v_mfma_f32_32x32x16_bf16 v[176:191], a[232:235], v[108:111], v[176:191]
  ds_read_b64_tr_b16 a[228:229], v9 offset:16384
  ds_read_b64_tr_b16 a[230:231], v9 offset:16896
  v_accvgpr_read_b32 v26, a86
  v_accvgpr_read_b32 v27, a94
  v_accvgpr_read_b32 v28, a87
  v_accvgpr_read_b32 v29, a95
  v_mfma_f32_32x32x16_bf16 v[192:207], a[236:239], v[108:111], v[192:207]
  ds_read_b64_tr_b16 a[232:233], v8 offset:18432
  ds_read_b64_tr_b16 a[234:235], v8 offset:18944
  v_mul_f32 v26, v26, v27
  v_mul_f32 v28, v28, v29
  v_cvt_pk_bf16_f32 v23, v26, v28
  s_waitcnt lgkmcnt(6)
  v_mfma_f32_32x32x16_bf16 v[176:191], a[240:243], v[112:115], v[176:191]
  ds_read_b64_tr_b16 a[236:237], v9 offset:18432
  ds_read_b64_tr_b16 a[238:239], v9 offset:18944
  buffer_load_dwordx4 v245, s[16:19], s64 offen offset:1024 lds
  v_mfma_f32_32x32x16_bf16 v[192:207], a[244:247], v[112:115], v[192:207]
  ds_read_b64_tr_b16 a[240:241], v8 offset:20480
  ds_read_b64_tr_b16 a[242:243], v8 offset:20992
  buffer_store_dwordx4 v[20:23], v24, s[28:31], s71 offen offset:1024 sc1
  v_accvgpr_read_b32 v26, a96
  v_mfma_f32_32x32x16_bf16 v[176:191], a[248:251], v[116:119], v[176:191]
  ds_read_b64_tr_b16 a[244:245], v9 offset:20480
  ds_read_b64_tr_b16 a[246:247], v9 offset:20992
  v_accvgpr_read_b32 v27, a104
  v_accvgpr_read_b32 v28, a97
  v_accvgpr_read_b32 v29, a105
  v_mul_f32 v26, v26, v27
  v_mfma_f32_32x32x16_bf16 v[192:207], a[252:255], v[116:119], v[192:207]
  ds_read_b64_tr_b16 a[248:249], v8 offset:22528
  ds_read_b64_tr_b16 a[250:251], v8 offset:23040
  v_mul_f32 v28, v28, v29
  v_cvt_pk_bf16_f32 v16, v26, v28
  v_accvgpr_read_b32 v26, a98
  s_waitcnt lgkmcnt(6)
  v_mfma_f32_32x32x16_bf16 v[176:191], a[224:227], v[120:123], v[176:191]
  ds_read_b64_tr_b16 a[252:253], v9 offset:22528
  ds_read_b64_tr_b16 a[254:255], v9 offset:23040
  buffer_load_dwordx4 v246, s[16:19], s64 offen offset:2048 lds
  v_accvgpr_read_b32 v27, a106
  v_mfma_f32_32x32x16_bf16 v[192:207], a[228:231], v[120:123], v[192:207]
  ds_read_b64_tr_b16 a[224:225], v8 offset:24576
  ds_read_b64_tr_b16 a[226:227], v8 offset:25088
  v_accvgpr_read_b32 v28, a99
  v_accvgpr_read_b32 v29, a107
  v_mul_f32 v26, v26, v27
  v_mul_f32 v28, v28, v29
  v_mfma_f32_32x32x16_bf16 v[176:191], a[232:235], v[124:127], v[176:191]
  ds_read_b64_tr_b16 a[228:229], v9 offset:24576
  ds_read_b64_tr_b16 a[230:231], v9 offset:25088
  v_cvt_pk_bf16_f32 v17, v26, v28
  v_accvgpr_read_b32 v26, a100
  v_accvgpr_read_b32 v27, a108
  v_accvgpr_read_b32 v28, a101
  v_mfma_f32_32x32x16_bf16 v[192:207], a[236:239], v[124:127], v[192:207]
  ds_read_b64_tr_b16 a[232:233], v8 offset:26624
  ds_read_b64_tr_b16 a[234:235], v8 offset:27136
  v_accvgpr_read_b32 v29, a109
  v_mul_f32 v26, v26, v27
  v_mul_f32 v28, v28, v29
  s_waitcnt lgkmcnt(6)
  v_mfma_f32_32x32x16_bf16 v[176:191], a[240:243], v[128:131], v[176:191]
  ds_read_b64_tr_b16 a[236:237], v9 offset:26624
  ds_read_b64_tr_b16 a[238:239], v9 offset:27136
  v_cvt_pk_bf16_f32 v18, v26, v28
  v_accvgpr_read_b32 v26, a102
  v_accvgpr_read_b32 v27, a110
  v_accvgpr_read_b32 v28, a103
  v_mfma_f32_32x32x16_bf16 v[192:207], a[244:247], v[128:131], v[192:207]
  s_waitcnt vmcnt(17)
  s_barrier
  ds_read_b64_tr_b16 a[240:241], v8 offset:32768
  ds_read_b64_tr_b16 a[242:243], v8 offset:33280
  s_add_u32 m0, s59, 131072
  v_mfma_f32_32x32x16_bf16 v[176:191], a[248:251], v[132:135], v[176:191]
  ds_read_b64_tr_b16 a[244:245], v9 offset:32768
  ds_read_b64_tr_b16 a[246:247], v9 offset:33280
  s_mov_b32 s62, 0x180
  v_accvgpr_read_b32 v29, a111
  v_mul_f32 v26, v26, v27
  v_mul_f32 v28, v28, v29
  v_mfma_f32_32x32x16_bf16 v[192:207], a[252:255], v[132:135], v[192:207]
  ds_read_b64_tr_b16 a[248:249], v8 offset:34816
  ds_read_b64_tr_b16 a[250:251], v8 offset:35328
  v_cvt_pk_bf16_f32 v19, v26, v28
  s_waitcnt lgkmcnt(6)
  v_mfma_f32_32x32x16_bf16 v[176:191], a[224:227], v[136:139], v[176:191]
  ds_read_b64_tr_b16 a[252:253], v9 offset:34816
  ds_read_b64_tr_b16 a[254:255], v9 offset:35328
  buffer_load_dwordx4 v247, s[16:19], s62 offen offset:0 lds
  v_mfma_f32_32x32x16_bf16 v[192:207], a[228:231], v[136:139], v[192:207]
  ds_read_b64_tr_b16 a[224:225], v8 offset:36864
  ds_read_b64_tr_b16 a[226:227], v8 offset:37376
  buffer_store_dwordx4 v[16:19], v24, s[28:31], s71 offen offset:2048 sc1
  v_mfma_f32_32x32x16_bf16 v[176:191], a[232:235], v[140:143], v[176:191]
  ds_read_b64_tr_b16 a[228:229], v9 offset:36864
  ds_read_b64_tr_b16 a[230:231], v9 offset:37376
  buffer_load_dwordx4 v248, s[16:19], s62 offen offset:1024 lds
  v_mfma_f32_32x32x16_bf16 v[192:207], a[236:239], v[140:143], v[192:207]
  ds_read_b64_tr_b16 a[232:233], v8 offset:38912
  ds_read_b64_tr_b16 a[234:235], v8 offset:39424
  s_waitcnt lgkmcnt(6)
  v_mfma_f32_32x32x16_bf16 v[144:159], a[240:243], v[32:35], 0
  ds_read_b64_tr_b16 a[236:237], v9 offset:38912
  ds_read_b64_tr_b16 a[238:239], v9 offset:39424
  v_mfma_f32_32x32x16_bf16 v[160:175], a[244:247], v[32:35], 0
  ds_read_b64_tr_b16 a[240:241], v8 offset:40960
  ds_read_b64_tr_b16 a[242:243], v8 offset:41472
  v_cvt_pk_bf16_f32 v224, v176, v177
  v_cvt_pk_bf16_f32 v225, v178, v179
  v_cvt_pk_bf16_f32 v226, v180, v181
  v_cvt_pk_bf16_f32 v227, v182, v183
  v_mfma_f32_32x32x16_bf16 v[144:159], a[248:251], v[36:39], v[144:159]
  ds_read_b64_tr_b16 a[244:245], v9 offset:40960
  ds_read_b64_tr_b16 a[246:247], v9 offset:41472
  buffer_load_dwordx4 v249, s[16:19], s62 offen offset:2048 lds
  v_accvgpr_read_b32 v5, a133
  v_mfma_f32_32x32x16_bf16 v[160:175], a[252:255], v[36:39], v[160:175]
  ds_read_b64_tr_b16 a[248:249], v8 offset:43008
  ds_read_b64_tr_b16 a[250:251], v8 offset:43520
  buffer_load_dword a200, v5, s[20:23], s66 offen offset:0
  s_waitcnt lgkmcnt(6)
  v_mfma_f32_32x32x16_bf16 v[144:159], a[224:227], v[40:43], v[144:159]
  ds_read_b64_tr_b16 a[252:253], v9 offset:43008
  ds_read_b64_tr_b16 a[254:255], v9 offset:43520
  v_cvt_pk_bf16_f32 v228, v184, v185
  v_cvt_pk_bf16_f32 v229, v186, v187
  v_cvt_pk_bf16_f32 v230, v188, v189
  v_cvt_pk_bf16_f32 v231, v190, v191
  v_mfma_f32_32x32x16_bf16 v[160:175], a[228:231], v[40:43], v[160:175]
  ds_read_b64_tr_b16 a[224:225], v8 offset:45056
  ds_read_b64_tr_b16 a[226:227], v8 offset:45568
  buffer_load_dwordx4 v250, s[16:19], s62 offen offset:3072 lds
  v_cvt_pk_bf16_f32 v232, v192, v193
  v_mfma_f32_32x32x16_bf16 v[144:159], a[232:235], v[44:47], v[144:159]
  ds_read_b64_tr_b16 a[228:229], v9 offset:45056
  ds_read_b64_tr_b16 a[230:231], v9 offset:45568
  s_add_u32 m0, s59, 135168
  v_cvt_pk_bf16_f32 v233, v194, v195
  v_cvt_pk_bf16_f32 v234, v196, v197
  v_cvt_pk_bf16_f32 v235, v198, v199
  v_mfma_f32_32x32x16_bf16 v[160:175], a[236:239], v[44:47], v[160:175]
  ds_read_b64_tr_b16 a[232:233], v8 offset:47104
  ds_read_b64_tr_b16 a[234:235], v8 offset:47616
  v_cvt_pk_bf16_f32 v236, v200, v201
  v_cvt_pk_bf16_f32 v237, v202, v203
  v_cvt_pk_bf16_f32 v238, v204, v205
  s_waitcnt lgkmcnt(6)
  v_mfma_f32_32x32x16_bf16 v[144:159], a[240:243], v[48:51], v[144:159]
  ds_read_b64_tr_b16 a[236:237], v9 offset:47104
  ds_read_b64_tr_b16 a[238:239], v9 offset:47616
  v_cvt_pk_bf16_f32 v239, v206, v207
  v_mfma_f32_32x32x16_bf16 v[160:175], a[244:247], v[48:51], v[160:175]
  ds_read_b64_tr_b16 a[240:241], v8 offset:49152
  ds_read_b64_tr_b16 a[242:243], v8 offset:49664
  buffer_load_dwordx4 v251, s[16:19], s62 offen offset:0 lds
  v_mfma_f32_32x32x16_bf16 v[144:159], a[248:251], v[52:55], v[144:159]
  ds_read_b64_tr_b16 a[244:245], v9 offset:49152
  ds_read_b64_tr_b16 a[246:247], v9 offset:49664
  v_mfma_f32_32x32x16_bf16 v[160:175], a[252:255], v[52:55], v[160:175]
  ds_read_b64_tr_b16 a[248:249], v8 offset:51200
  ds_read_b64_tr_b16 a[250:251], v8 offset:51712
  s_waitcnt lgkmcnt(6)
  v_mfma_f32_32x32x16_bf16 v[144:159], a[224:227], v[56:59], v[144:159]
  ds_read_b64_tr_b16 a[252:253], v9 offset:51200
  ds_read_b64_tr_b16 a[254:255], v9 offset:51712
  buffer_load_dwordx4 v252, s[16:19], s62 offen offset:1024 lds
  v_mfma_f32_32x32x16_bf16 v[160:175], a[228:231], v[56:59], v[160:175]
  ds_read_b64_tr_b16 a[224:225], v8 offset:53248
  ds_read_b64_tr_b16 a[226:227], v8 offset:53760
  v_mfma_f32_32x32x16_bf16 v[144:159], a[232:235], v[60:63], v[144:159]
  ds_read_b64_tr_b16 a[228:229], v9 offset:53248
  ds_read_b64_tr_b16 a[230:231], v9 offset:53760
  v_mfma_f32_32x32x16_bf16 v[160:175], a[236:239], v[60:63], v[160:175]
  ds_read_b64_tr_b16 a[232:233], v8 offset:55296
  ds_read_b64_tr_b16 a[234:235], v8 offset:55808
  s_waitcnt lgkmcnt(6)
  v_mfma_f32_32x32x16_bf16 v[144:159], a[240:243], v[64:67], v[144:159]
  ds_read_b64_tr_b16 a[236:237], v9 offset:55296
  ds_read_b64_tr_b16 a[238:239], v9 offset:55808
  buffer_load_dwordx4 v253, s[16:19], s62 offen offset:2048 lds
  v_mfma_f32_32x32x16_bf16 v[160:175], a[244:247], v[64:67], v[160:175]
  ds_read_b64_tr_b16 a[240:241], v8 offset:57344
  ds_read_b64_tr_b16 a[242:243], v8 offset:57856
  v_mfma_f32_32x32x16_bf16 v[144:159], a[248:251], v[68:71], v[144:159]
  ds_read_b64_tr_b16 a[244:245], v9 offset:57344
  ds_read_b64_tr_b16 a[246:247], v9 offset:57856
  v_mfma_f32_32x32x16_bf16 v[160:175], a[252:255], v[68:71], v[160:175]
  ds_read_b64_tr_b16 a[248:249], v8 offset:59392
  ds_read_b64_tr_b16 a[250:251], v8 offset:59904
  s_waitcnt lgkmcnt(6)
  v_mfma_f32_32x32x16_bf16 v[144:159], a[224:227], v[72:75], v[144:159]
  ds_read_b64_tr_b16 a[252:253], v9 offset:59392
  ds_read_b64_tr_b16 a[254:255], v9 offset:59904
  v_mfma_f32_32x32x16_bf16 v[160:175], a[228:231], v[72:75], v[160:175]
  s_waitcnt vmcnt(19)
  s_barrier
  v_add_u32 v8, 0x10000, v8
  ds_read_b64_tr_b16 a[224:225], v8 offset:0
  ds_read_b64_tr_b16 a[226:227], v8 offset:512
  v_mfma_f32_32x32x16_bf16 v[144:159], a[232:235], v[76:79], v[144:159]
  v_add_u32 v9, 0x10000, v9
  ds_read_b64_tr_b16 a[228:229], v9 offset:0
  ds_read_b64_tr_b16 a[230:231], v9 offset:512
  v_accvgpr_read_b32 v1, a116
  v_accvgpr_read_b32 v2, a117
  v_accvgpr_read_b32 v3, a118
  v_mfma_f32_32x32x16_bf16 v[160:175], a[236:239], v[76:79], v[160:175]
  ds_read_b64_tr_b16 a[232:233], v8 offset:2048
  ds_read_b64_tr_b16 a[234:235], v8 offset:2560
  v_accvgpr_read_b32 v4, a119
  s_add_u32 m0, s60, 0
  s_waitcnt lgkmcnt(6)
  v_mfma_f32_32x32x16_bf16 v[144:159], a[240:243], v[80:83], v[144:159]
  ds_read_b64_tr_b16 a[236:237], v9 offset:2048
  ds_read_b64_tr_b16 a[238:239], v9 offset:2560
  buffer_load_dwordx4 v1, s[20:23], 0 offen offset:0 lds
  v_mfma_f32_32x32x16_bf16 v[160:175], a[244:247], v[80:83], v[160:175]
  ds_read_b64_tr_b16 a[240:241], v8 offset:4096
  ds_read_b64_tr_b16 a[242:243], v8 offset:4608
  v_mfma_f32_32x32x16_bf16 v[144:159], a[248:251], v[84:87], v[144:159]
  ds_read_b64_tr_b16 a[244:245], v9 offset:4096
  ds_read_b64_tr_b16 a[246:247], v9 offset:4608
  v_mfma_f32_32x32x16_bf16 v[160:175], a[252:255], v[84:87], v[160:175]
  ds_read_b64_tr_b16 a[248:249], v8 offset:6144
  ds_read_b64_tr_b16 a[250:251], v8 offset:6656
  s_waitcnt lgkmcnt(6)
  v_mfma_f32_32x32x16_bf16 v[144:159], a[224:227], v[88:91], v[144:159]
  ds_read_b64_tr_b16 a[252:253], v9 offset:6144
  ds_read_b64_tr_b16 a[254:255], v9 offset:6656
  buffer_load_dwordx4 v2, s[20:23], 0 offen offset:1024 lds
  v_mfma_f32_32x32x16_bf16 v[160:175], a[228:231], v[88:91], v[160:175]
  ds_read_b64_tr_b16 a[224:225], v8 offset:8192
  ds_read_b64_tr_b16 a[226:227], v8 offset:8704
  v_mfma_f32_32x32x16_bf16 v[144:159], a[232:235], v[92:95], v[144:159]
  ds_read_b64_tr_b16 a[228:229], v9 offset:8192
  ds_read_b64_tr_b16 a[230:231], v9 offset:8704
  buffer_load_dwordx4 v3, s[20:23], 0 offen offset:2048 lds
  v_mfma_f32_32x32x16_bf16 v[160:175], a[236:239], v[92:95], v[160:175]
  ds_read_b64_tr_b16 a[232:233], v8 offset:10240
  ds_read_b64_tr_b16 a[234:235], v8 offset:10752
  s_waitcnt lgkmcnt(6)
  v_mfma_f32_32x32x16_bf16 v[144:159], a[240:243], v[96:99], v[144:159]
  ds_read_b64_tr_b16 a[236:237], v9 offset:10240
  ds_read_b64_tr_b16 a[238:239], v9 offset:10752
  v_mfma_f32_32x32x16_bf16 v[160:175], a[244:247], v[96:99], v[160:175]
  ds_read_b64_tr_b16 a[240:241], v8 offset:12288
  ds_read_b64_tr_b16 a[242:243], v8 offset:12800
  buffer_load_dwordx4 v4, s[20:23], 0 offen offset:3072 lds
  s_add_u32 m0, s60, 16384
  v_mfma_f32_32x32x16_bf16 v[144:159], a[248:251], v[100:103], v[144:159]
  ds_read_b64_tr_b16 a[244:245], v9 offset:12288
  ds_read_b64_tr_b16 a[246:247], v9 offset:12800
  s_mov_b32 s65, 0x4000
  v_mfma_f32_32x32x16_bf16 v[160:175], a[252:255], v[100:103], v[160:175]
  ds_read_b64_tr_b16 a[248:249], v8 offset:14336
  ds_read_b64_tr_b16 a[250:251], v8 offset:14848
  s_waitcnt lgkmcnt(6)
  v_mfma_f32_32x32x16_bf16 v[144:159], a[224:227], v[104:107], v[144:159]
  ds_read_b64_tr_b16 a[252:253], v9 offset:14336
  ds_read_b64_tr_b16 a[254:255], v9 offset:14848
  buffer_load_dwordx4 v1, s[20:23], s65 offen offset:0 lds
  v_mfma_f32_32x32x16_bf16 v[160:175], a[228:231], v[104:107], v[160:175]
  ds_read_b64_tr_b16 a[224:225], v8 offset:16384
  ds_read_b64_tr_b16 a[226:227], v8 offset:16896
  v_mfma_f32_32x32x16_bf16 v[144:159], a[232:235], v[108:111], v[144:159]
  ds_read_b64_tr_b16 a[228:229], v9 offset:16384
  ds_read_b64_tr_b16 a[230:231], v9 offset:16896
  v_mfma_f32_32x32x16_bf16 v[160:175], a[236:239], v[108:111], v[160:175]
  ds_read_b64_tr_b16 a[232:233], v8 offset:18432
  ds_read_b64_tr_b16 a[234:235], v8 offset:18944
  s_waitcnt lgkmcnt(6)
  v_mfma_f32_32x32x16_bf16 v[144:159], a[240:243], v[112:115], v[144:159]
  ds_read_b64_tr_b16 a[236:237], v9 offset:18432
  ds_read_b64_tr_b16 a[238:239], v9 offset:18944
  buffer_load_dwordx4 v2, s[20:23], s65 offen offset:1024 lds
  v_mfma_f32_32x32x16_bf16 v[160:175], a[244:247], v[112:115], v[160:175]
  ds_read_b64_tr_b16 a[240:241], v8 offset:20480
  ds_read_b64_tr_b16 a[242:243], v8 offset:20992
  v_mfma_f32_32x32x16_bf16 v[144:159], a[248:251], v[116:119], v[144:159]
  ds_read_b64_tr_b16 a[244:245], v9 offset:20480
  ds_read_b64_tr_b16 a[246:247], v9 offset:20992
  buffer_load_dwordx4 v3, s[20:23], s65 offen offset:2048 lds
  v_mfma_f32_32x32x16_bf16 v[160:175], a[252:255], v[116:119], v[160:175]
  ds_read_b64_tr_b16 a[248:249], v8 offset:22528
  ds_read_b64_tr_b16 a[250:251], v8 offset:23040
  s_waitcnt lgkmcnt(6)
  v_mfma_f32_32x32x16_bf16 v[144:159], a[224:227], v[120:123], v[144:159]
  ds_read_b64_tr_b16 a[252:253], v9 offset:22528
  ds_read_b64_tr_b16 a[254:255], v9 offset:23040
  v_mfma_f32_32x32x16_bf16 v[160:175], a[228:231], v[120:123], v[160:175]
  ds_read_b64_tr_b16 a[224:225], v8 offset:24576
  ds_read_b64_tr_b16 a[226:227], v8 offset:25088
  buffer_load_dwordx4 v4, s[20:23], s65 offen offset:3072 lds
  v_mfma_f32_32x32x16_bf16 v[144:159], a[232:235], v[124:127], v[144:159]
  ds_read_b64_tr_b16 a[228:229], v9 offset:24576
  ds_read_b64_tr_b16 a[230:231], v9 offset:25088
  v_mfma_f32_32x32x16_bf16 v[160:175], a[236:239], v[124:127], v[160:175]
  ds_read_b64_tr_b16 a[232:233], v8 offset:26624
  ds_read_b64_tr_b16 a[234:235], v8 offset:27136
  s_waitcnt lgkmcnt(6)
  v_mfma_f32_32x32x16_bf16 v[144:159], a[240:243], v[128:131], v[144:159]
  ds_read_b64_tr_b16 a[236:237], v9 offset:26624
  ds_read_b64_tr_b16 a[238:239], v9 offset:27136
  v_mfma_f32_32x32x16_bf16 v[160:175], a[244:247], v[128:131], v[160:175]
  s_waitcnt vmcnt(17)
  s_barrier
  ds_read_b64_tr_b16 a[240:241], v8 offset:32768
  ds_read_b64_tr_b16 a[242:243], v8 offset:33280
  s_add_u32 m0, s60, 32768
  v_mfma_f32_32x32x16_bf16 v[144:159], a[248:251], v[132:135], v[144:159]
  ds_read_b64_tr_b16 a[244:245], v9 offset:32768
  ds_read_b64_tr_b16 a[246:247], v9 offset:33280
  s_mov_b32 s62, 0x8000
  v_mfma_f32_32x32x16_bf16 v[160:175], a[252:255], v[132:135], v[160:175]
  ds_read_b64_tr_b16 a[248:249], v8 offset:34816
  ds_read_b64_tr_b16 a[250:251], v8 offset:35328
  s_waitcnt lgkmcnt(6)
  v_mfma_f32_32x32x16_bf16 v[144:159], a[224:227], v[136:139], v[144:159]
  ds_read_b64_tr_b16 a[252:253], v9 offset:34816
  ds_read_b64_tr_b16 a[254:255], v9 offset:35328
  buffer_load_dwordx4 v1, s[20:23], s62 offen offset:0 lds
  v_mfma_f32_32x32x16_bf16 v[160:175], a[228:231], v[136:139], v[160:175]
  ds_read_b64_tr_b16 a[224:225], v8 offset:36864
  ds_read_b64_tr_b16 a[226:227], v8 offset:37376
  v_mfma_f32_32x32x16_bf16 v[144:159], a[232:235], v[140:143], v[144:159]
  ds_read_b64_tr_b16 a[228:229], v9 offset:36864
  ds_read_b64_tr_b16 a[230:231], v9 offset:37376
  buffer_load_dwordx4 v2, s[20:23], s62 offen offset:1024 lds
  v_mfma_f32_32x32x16_bf16 v[160:175], a[236:239], v[140:143], v[160:175]
  ds_read_b64_tr_b16 a[232:233], v8 offset:38912
  ds_read_b64_tr_b16 a[234:235], v8 offset:39424
  s_waitcnt lgkmcnt(6)
  v_mfma_f32_32x32x16_bf16 v[176:191], a[240:243], v[32:35], 0
  ds_read_b64_tr_b16 a[236:237], v9 offset:38912
  ds_read_b64_tr_b16 a[238:239], v9 offset:39424
  v_mfma_f32_32x32x16_bf16 v[192:207], a[244:247], v[32:35], 0
  ds_read_b64_tr_b16 a[240:241], v8 offset:40960
  ds_read_b64_tr_b16 a[242:243], v8 offset:41472
  buffer_load_dwordx4 v3, s[20:23], s62 offen offset:2048 lds
  v_cvt_pk_bf16_f32 v144, v144, v145
  v_mfma_f32_32x32x16_bf16 v[176:191], a[248:251], v[36:39], v[176:191]
  ds_read_b64_tr_b16 a[244:245], v9 offset:40960
  ds_read_b64_tr_b16 a[246:247], v9 offset:41472
  v_cvt_pk_bf16_f32 v145, v146, v147
  v_cvt_pk_bf16_f32 v146, v148, v149
  v_cvt_pk_bf16_f32 v147, v150, v151
  v_cvt_pk_bf16_f32 v148, v152, v153
  v_mfma_f32_32x32x16_bf16 v[192:207], a[252:255], v[36:39], v[192:207]
  ds_read_b64_tr_b16 a[248:249], v8 offset:43008
  ds_read_b64_tr_b16 a[250:251], v8 offset:43520
  v_cvt_pk_bf16_f32 v149, v154, v155
  v_cvt_pk_bf16_f32 v150, v156, v157
  v_cvt_pk_bf16_f32 v151, v158, v159
  s_waitcnt lgkmcnt(6)
  v_mfma_f32_32x32x16_bf16 v[176:191], a[224:227], v[40:43], v[176:191]
  ds_read_b64_tr_b16 a[252:253], v9 offset:43008
  ds_read_b64_tr_b16 a[254:255], v9 offset:43520
  buffer_load_dwordx4 v4, s[20:23], s62 offen offset:3072 lds
  v_cvt_pk_bf16_f32 v152, v160, v161
  v_mfma_f32_32x32x16_bf16 v[192:207], a[228:231], v[40:43], v[192:207]
  ds_read_b64_tr_b16 a[224:225], v8 offset:45056
  ds_read_b64_tr_b16 a[226:227], v8 offset:45568
  s_add_u32 m0, s60, 49152
  s_mov_b32 s69, 0xc000
  v_cvt_pk_bf16_f32 v153, v162, v163
  v_cvt_pk_bf16_f32 v154, v164, v165
  v_mfma_f32_32x32x16_bf16 v[176:191], a[232:235], v[44:47], v[176:191]
  ds_read_b64_tr_b16 a[228:229], v9 offset:45056
  ds_read_b64_tr_b16 a[230:231], v9 offset:45568
  v_cvt_pk_bf16_f32 v155, v166, v167
  v_cvt_pk_bf16_f32 v156, v168, v169
  v_cvt_pk_bf16_f32 v157, v170, v171
  v_cvt_pk_bf16_f32 v158, v172, v173
  v_mfma_f32_32x32x16_bf16 v[192:207], a[236:239], v[44:47], v[192:207]
  ds_read_b64_tr_b16 a[232:233], v8 offset:47104
  ds_read_b64_tr_b16 a[234:235], v8 offset:47616
  v_cvt_pk_bf16_f32 v159, v174, v175
  s_waitcnt lgkmcnt(6)
  v_mfma_f32_32x32x16_bf16 v[176:191], a[240:243], v[48:51], v[176:191]
  ds_read_b64_tr_b16 a[236:237], v9 offset:47104
  ds_read_b64_tr_b16 a[238:239], v9 offset:47616
  buffer_load_dwordx4 v1, s[20:23], s69 offen offset:0 lds
  v_mfma_f32_32x32x16_bf16 v[192:207], a[244:247], v[48:51], v[192:207]
  ds_read_b64_tr_b16 a[240:241], v8 offset:49152
  ds_read_b64_tr_b16 a[242:243], v8 offset:49664
  v_mfma_f32_32x32x16_bf16 v[176:191], a[248:251], v[52:55], v[176:191]
  ds_read_b64_tr_b16 a[244:245], v9 offset:49152
  ds_read_b64_tr_b16 a[246:247], v9 offset:49664
  buffer_load_dwordx4 v2, s[20:23], s69 offen offset:1024 lds
  v_mfma_f32_32x32x16_bf16 v[192:207], a[252:255], v[52:55], v[192:207]
  ds_read_b64_tr_b16 a[248:249], v8 offset:51200
  ds_read_b64_tr_b16 a[250:251], v8 offset:51712
  s_waitcnt lgkmcnt(6)
  v_mfma_f32_32x32x16_bf16 v[176:191], a[224:227], v[56:59], v[176:191]
  ds_read_b64_tr_b16 a[252:253], v9 offset:51200
  ds_read_b64_tr_b16 a[254:255], v9 offset:51712
  v_mfma_f32_32x32x16_bf16 v[192:207], a[228:231], v[56:59], v[192:207]
  ds_read_b64_tr_b16 a[224:225], v8 offset:53248
  ds_read_b64_tr_b16 a[226:227], v8 offset:53760
  buffer_load_dwordx4 v3, s[20:23], s69 offen offset:2048 lds
  v_mfma_f32_32x32x16_bf16 v[176:191], a[232:235], v[60:63], v[176:191]
  ds_read_b64_tr_b16 a[228:229], v9 offset:53248
  ds_read_b64_tr_b16 a[230:231], v9 offset:53760
  v_mfma_f32_32x32x16_bf16 v[192:207], a[236:239], v[60:63], v[192:207]
  ds_read_b64_tr_b16 a[232:233], v8 offset:55296
  ds_read_b64_tr_b16 a[234:235], v8 offset:55808
  s_waitcnt lgkmcnt(6)
  v_mfma_f32_32x32x16_bf16 v[176:191], a[240:243], v[64:67], v[176:191]
  ds_read_b64_tr_b16 a[236:237], v9 offset:55296
  ds_read_b64_tr_b16 a[238:239], v9 offset:55808
  buffer_load_dwordx4 v4, s[20:23], s69 offen offset:3072 lds
  v_mfma_f32_32x32x16_bf16 v[192:207], a[244:247], v[64:67], v[192:207]
  ds_read_b64_tr_b16 a[240:241], v8 offset:57344
  ds_read_b64_tr_b16 a[242:243], v8 offset:57856
  v_mfma_f32_32x32x16_bf16 v[176:191], a[248:251], v[68:71], v[176:191]
  ds_read_b64_tr_b16 a[244:245], v9 offset:57344
  ds_read_b64_tr_b16 a[246:247], v9 offset:57856
  v_mfma_f32_32x32x16_bf16 v[192:207], a[252:255], v[68:71], v[192:207]
  ds_read_b64_tr_b16 a[248:249], v8 offset:59392
  ds_read_b64_tr_b16 a[250:251], v8 offset:59904
  s_waitcnt lgkmcnt(6)
  v_mfma_f32_32x32x16_bf16 v[176:191], a[224:227], v[72:75], v[176:191]
  ds_read_b64_tr_b16 a[252:253], v9 offset:59392
  ds_read_b64_tr_b16 a[254:255], v9 offset:59904
  v_mfma_f32_32x32x16_bf16 v[192:207], a[228:231], v[72:75], v[192:207]
  s_waitcnt vmcnt(16)
  s_barrier
  v_add_u32 v8, 0x10000, v8
  ds_read_b64_tr_b16 a[224:225], v8 offset:0
  ds_read_b64_tr_b16 a[226:227], v8 offset:512
  v_mfma_f32_32x32x16_bf16 v[176:191], a[232:235], v[76:79], v[176:191]
  v_add_u32 v9, 0x10000, v9
  ds_read_b64_tr_b16 a[228:229], v9 offset:0
  ds_read_b64_tr_b16 a[230:231], v9 offset:512
  s_add_u32 m0, s60, 65536
  s_mov_b32 s64, 0x10000
  v_mfma_f32_32x32x16_bf16 v[192:207], a[236:239], v[76:79], v[192:207]
  ds_read_b64_tr_b16 a[232:233], v8 offset:2048
  ds_read_b64_tr_b16 a[234:235], v8 offset:2560
  s_waitcnt lgkmcnt(6)
  v_mfma_f32_32x32x16_bf16 v[176:191], a[240:243], v[80:83], v[176:191]
  ds_read_b64_tr_b16 a[236:237], v9 offset:2048
  ds_read_b64_tr_b16 a[238:239], v9 offset:2560
  buffer_load_dwordx4 v1, s[20:23], s64 offen offset:0 lds
  v_mfma_f32_32x32x16_bf16 v[192:207], a[244:247], v[80:83], v[192:207]
  ds_read_b64_tr_b16 a[240:241], v8 offset:4096
  ds_read_b64_tr_b16 a[242:243], v8 offset:4608
  v_mfma_f32_32x32x16_bf16 v[176:191], a[248:251], v[84:87], v[176:191]
  ds_read_b64_tr_b16 a[244:245], v9 offset:4096
  ds_read_b64_tr_b16 a[246:247], v9 offset:4608
  buffer_load_dwordx4 v2, s[20:23], s64 offen offset:1024 lds
  v_accvgpr_read_b32 v5, a134
  v_mfma_f32_32x32x16_bf16 v[192:207], a[252:255], v[84:87], v[192:207]
  ds_read_b64_tr_b16 a[248:249], v8 offset:6144
  ds_read_b64_tr_b16 a[250:251], v8 offset:6656
  buffer_load_dword a200, v5, s[24:27], 0 offen offset:0
  s_waitcnt lgkmcnt(6)
  v_mfma_f32_32x32x16_bf16 v[176:191], a[224:227], v[88:91], v[176:191]
  ds_read_b64_tr_b16 a[252:253], v9 offset:6144
  ds_read_b64_tr_b16 a[254:255], v9 offset:6656
  v_mfma_f32_32x32x16_bf16 v[192:207], a[228:231], v[88:91], v[192:207]
  ds_read_b64_tr_b16 a[224:225], v8 offset:8192
  ds_read_b64_tr_b16 a[226:227], v8 offset:8704
  buffer_load_dwordx4 v3, s[20:23], s64 offen offset:2048 lds
  v_mfma_f32_32x32x16_bf16 v[176:191], a[232:235], v[92:95], v[176:191]
  ds_read_b64_tr_b16 a[228:229], v9 offset:8192
  ds_read_b64_tr_b16 a[230:231], v9 offset:8704
  v_mfma_f32_32x32x16_bf16 v[192:207], a[236:239], v[92:95], v[192:207]
  ds_read_b64_tr_b16 a[232:233], v8 offset:10240
  ds_read_b64_tr_b16 a[234:235], v8 offset:10752
  s_waitcnt lgkmcnt(6)
  v_mfma_f32_32x32x16_bf16 v[176:191], a[240:243], v[96:99], v[176:191]
  ds_read_b64_tr_b16 a[236:237], v9 offset:10240
  ds_read_b64_tr_b16 a[238:239], v9 offset:10752
  buffer_load_dwordx4 v4, s[20:23], s64 offen offset:3072 lds
  v_mfma_f32_32x32x16_bf16 v[192:207], a[244:247], v[96:99], v[192:207]
  ds_read_b64_tr_b16 a[240:241], v8 offset:12288
  ds_read_b64_tr_b16 a[242:243], v8 offset:12800
  s_add_u32 m0, s60, 81920
  s_mov_b32 s65, 0x14000
  v_mfma_f32_32x32x16_bf16 v[176:191], a[248:251], v[100:103], v[176:191]
  ds_read_b64_tr_b16 a[244:245], v9 offset:12288
  ds_read_b64_tr_b16 a[246:247], v9 offset:12800
  v_mfma_f32_32x32x16_bf16 v[192:207], a[252:255], v[100:103], v[192:207]
  ds_read_b64_tr_b16 a[248:249], v8 offset:14336
  ds_read_b64_tr_b16 a[250:251], v8 offset:14848
  s_waitcnt lgkmcnt(6)
  v_mfma_f32_32x32x16_bf16 v[176:191], a[224:227], v[104:107], v[176:191]
  ds_read_b64_tr_b16 a[252:253], v9 offset:14336
  ds_read_b64_tr_b16 a[254:255], v9 offset:14848
  buffer_load_dwordx4 v1, s[20:23], s65 offen offset:0 lds
  v_mfma_f32_32x32x16_bf16 v[192:207], a[228:231], v[104:107], v[192:207]
  ds_read_b64_tr_b16 a[224:225], v8 offset:16384
  ds_read_b64_tr_b16 a[226:227], v8 offset:16896
  v_mfma_f32_32x32x16_bf16 v[176:191], a[232:235], v[108:111], v[176:191]
  ds_read_b64_tr_b16 a[228:229], v9 offset:16384
  ds_read_b64_tr_b16 a[230:231], v9 offset:16896
  buffer_load_dwordx4 v2, s[20:23], s65 offen offset:1024 lds
  v_mfma_f32_32x32x16_bf16 v[192:207], a[236:239], v[108:111], v[192:207]
  ds_read_b64_tr_b16 a[232:233], v8 offset:18432
  ds_read_b64_tr_b16 a[234:235], v8 offset:18944
  s_waitcnt lgkmcnt(6)
  v_mfma_f32_32x32x16_bf16 v[176:191], a[240:243], v[112:115], v[176:191]
  ds_read_b64_tr_b16 a[236:237], v9 offset:18432
  ds_read_b64_tr_b16 a[238:239], v9 offset:18944
  v_mfma_f32_32x32x16_bf16 v[192:207], a[244:247], v[112:115], v[192:207]
  ds_read_b64_tr_b16 a[240:241], v8 offset:20480
  ds_read_b64_tr_b16 a[242:243], v8 offset:20992
  buffer_load_dwordx4 v3, s[20:23], s65 offen offset:2048 lds
  v_mfma_f32_32x32x16_bf16 v[176:191], a[248:251], v[116:119], v[176:191]
  ds_read_b64_tr_b16 a[244:245], v9 offset:20480
  ds_read_b64_tr_b16 a[246:247], v9 offset:20992
  v_mfma_f32_32x32x16_bf16 v[192:207], a[252:255], v[116:119], v[192:207]
  ds_read_b64_tr_b16 a[248:249], v8 offset:22528
  ds_read_b64_tr_b16 a[250:251], v8 offset:23040
  s_waitcnt lgkmcnt(6)
  v_mfma_f32_32x32x16_bf16 v[176:191], a[224:227], v[120:123], v[176:191]
  ds_read_b64_tr_b16 a[252:253], v9 offset:22528
  ds_read_b64_tr_b16 a[254:255], v9 offset:23040
  buffer_load_dwordx4 v4, s[20:23], s65 offen offset:3072 lds
  v_mfma_f32_32x32x16_bf16 v[192:207], a[228:231], v[120:123], v[192:207]
  ds_read_b64_tr_b16 a[224:225], v8 offset:24576
  ds_read_b64_tr_b16 a[226:227], v8 offset:25088
  v_mfma_f32_32x32x16_bf16 v[176:191], a[232:235], v[124:127], v[176:191]
  ds_read_b64_tr_b16 a[228:229], v9 offset:24576
  ds_read_b64_tr_b16 a[230:231], v9 offset:25088
  v_mfma_f32_32x32x16_bf16 v[192:207], a[236:239], v[124:127], v[192:207]
  ds_read_b64_tr_b16 a[232:233], v8 offset:26624
  ds_read_b64_tr_b16 a[234:235], v8 offset:27136
  s_waitcnt lgkmcnt(6)
  v_mfma_f32_32x32x16_bf16 v[176:191], a[240:243], v[128:131], v[176:191]
  ds_read_b64_tr_b16 a[236:237], v9 offset:26624
  ds_read_b64_tr_b16 a[238:239], v9 offset:27136
  v_mfma_f32_32x32x16_bf16 v[192:207], a[244:247], v[128:131], v[192:207]
  v_accvgpr_read_b32 v8, a126
  v_accvgpr_read_b32 v9, a127
  v_accvgpr_read_b32 v10, a128
  v_accvgpr_read_b32 v11, a129
  s_waitcnt vmcnt(17)
  s_barrier
  ds_read_b128 a[240:243], v8 offset:0
  v_mfma_f32_32x32x16_bf16 v[176:191], a[248:251], v[132:135], v[176:191]
  ds_read_b128 a[244:247], v9 offset:0
  s_add_u32 m0, s60, 98304
  s_mov_b32 s62, 0x18000
  v_mfma_f32_32x32x16_bf16 v[192:207], a[252:255], v[132:135], v[192:207]
  ds_read_b128 a[248:251], v10 offset:0
  s_waitcnt lgkmcnt(3)
  v_mfma_f32_32x32x16_bf16 v[176:191], a[224:227], v[136:139], v[176:191]
  ds_read_b128 a[252:255], v11 offset:0
  buffer_load_dwordx4 v1, s[20:23], s62 offen offset:0 lds
  v_mfma_f32_32x32x16_bf16 v[192:207], a[228:231], v[136:139], v[192:207]
  ds_read_b128 a[224:227], v8 offset:4096
  v_mfma_f32_32x32x16_bf16 v[176:191], a[232:235], v[140:143], v[176:191]
  ds_read_b128 a[228:231], v9 offset:4096
  buffer_load_dwordx4 v2, s[20:23], s62 offen offset:1024 lds
  v_mfma_f32_32x32x16_bf16 v[192:207], a[236:239], v[140:143], v[192:207]
  ds_read_b128 a[232:235], v10 offset:4096
  s_waitcnt lgkmcnt(3)
  v_mfma_f32_32x32x16_bf16 v[160:175], a[240:243], v[208:211], 0
  ds_read_b128 a[236:239], v11 offset:4096
  v_mfma_f32_32x32x16_bf16 v[160:175], a[244:247], v[212:215], v[160:175]
  ds_read_b128 a[240:243], v8 offset:8192
  s_nop 2
  v_cvt_pk_bf16_f32 v176, v176, v177
  v_cvt_pk_bf16_f32 v177, v178, v179
  v_cvt_pk_bf16_f32 v178, v180, v181
  v_cvt_pk_bf16_f32 v179, v182, v183
  v_cvt_pk_bf16_f32 v180, v184, v185
  v_mfma_f32_32x32x16_bf16 v[160:175], a[248:251], v[216:219], v[160:175]
  ds_read_b128 a[244:247], v9 offset:8192
  buffer_load_dwordx4 v3, s[20:23], s62 offen offset:2048 lds
  v_cvt_pk_bf16_f32 v181, v186, v187
  v_cvt_pk_bf16_f32 v182, v188, v189
  v_mfma_f32_32x32x16_bf16 v[160:175], a[252:255], v[220:223], v[160:175]
  ds_read_b128 a[248:251], v10 offset:8192
  v_cvt_pk_bf16_f32 v183, v190, v191
  v_cvt_pk_bf16_f32 v184, v192, v193
  v_cvt_pk_bf16_f32 v185, v194, v195
  v_cvt_pk_bf16_f32 v186, v196, v197
  s_waitcnt lgkmcnt(3)
  v_mfma_f32_32x32x16_bf16 v[160:175], a[224:227], v[224:227], v[160:175]
  ds_read_b128 a[252:255], v11 offset:8192
  v_cvt_pk_bf16_f32 v187, v198, v199
  v_cvt_pk_bf16_f32 v188, v200, v201
  v_cvt_pk_bf16_f32 v189, v202, v203
  v_cvt_pk_bf16_f32 v190, v204, v205
  v_cvt_pk_bf16_f32 v191, v206, v207
  v_mfma_f32_32x32x16_bf16 v[160:175], a[228:231], v[228:231], v[160:175]
  ds_read_b128 a[224:227], v8 offset:12288
  buffer_load_dwordx4 v4, s[20:23], s62 offen offset:3072 lds
  v_mfma_f32_32x32x16_bf16 v[160:175], a[232:235], v[232:235], v[160:175]
  ds_read_b128 a[228:231], v9 offset:12288
  s_add_u32 m0, s60, 114688
  s_mov_b32 s69, 0x1c000
  v_mfma_f32_32x32x16_bf16 v[160:175], a[236:239], v[236:239], v[160:175]
  ds_read_b128 a[232:235], v10 offset:12288
  s_waitcnt lgkmcnt(3)
  v_mfma_f32_32x32x16_bf16 v[160:175], a[240:243], v[144:147], v[160:175]
  ds_read_b128 a[236:239], v11 offset:12288
  v_mfma_f32_32x32x16_bf16 v[160:175], a[244:247], v[148:151], v[160:175]
  ds_read_b128 a[240:243], v8 offset:16384
  buffer_load_dwordx4 v1, s[20:23], s69 offen offset:0 lds
  v_mfma_f32_32x32x16_bf16 v[160:175], a[248:251], v[152:155], v[160:175]
  ds_read_b128 a[244:247], v9 offset:16384
  v_mfma_f32_32x32x16_bf16 v[160:175], a[252:255], v[156:159], v[160:175]
  ds_read_b128 a[248:251], v10 offset:16384
  s_waitcnt lgkmcnt(3)
  v_mfma_f32_32x32x16_bf16 v[160:175], a[224:227], v[176:179], v[160:175]
  ds_read_b128 a[252:255], v11 offset:16384
  v_mfma_f32_32x32x16_bf16 v[160:175], a[228:231], v[180:183], v[160:175]
  ds_read_b128 a[224:227], v8 offset:20480
  buffer_load_dwordx4 v2, s[20:23], s69 offen offset:1024 lds
  v_mfma_f32_32x32x16_bf16 v[160:175], a[232:235], v[184:187], v[160:175]
  ds_read_b128 a[228:231], v9 offset:20480
  v_mfma_f32_32x32x16_bf16 v[160:175], a[236:239], v[188:191], v[160:175]
  ds_read_b128 a[232:235], v10 offset:20480
  s_waitcnt lgkmcnt(3)
  v_mfma_f32_32x32x16_bf16 v[192:207], a[240:243], v[208:211], 0
  ds_read_b128 a[236:239], v11 offset:20480
  buffer_load_dwordx4 v3, s[20:23], s69 offen offset:2048 lds
  v_mfma_f32_32x32x16_bf16 v[192:207], a[244:247], v[212:215], v[192:207]
  ds_read_b128 a[240:243], v8 offset:24576
  s_nop 4
  v_max3_f32 v30, v160, v161, v162
  v_max3_f32 v30, v30, v163, v164
  v_max3_f32 v30, v30, v165, v166
  v_max3_f32 v30, v30, v167, v168
  v_max3_f32 v30, v30, v169, v170
  v_mfma_f32_32x32x16_bf16 v[192:207], a[248:251], v[216:219], v[192:207]
  ds_read_b128 a[244:247], v9 offset:24576
  v_max3_f32 v30, v30, v171, v172
  v_max3_f32 v30, v30, v173, v174
  v_max_f32 v30, v30, v175
  v_mov_b32 v31, v30
  v_mfma_f32_32x32x16_bf16 v[192:207], a[252:255], v[220:223], v[192:207]
  ds_read_b128 a[248:251], v10 offset:24576
  s_nop 1
  v_permlane32_swap_b32 v30, v31
  v_max_f32 v30, v30, v31
  s_waitcnt lgkmcnt(3)
  v_mfma_f32_32x32x16_bf16 v[192:207], a[224:227], v[224:227], v[192:207]
  ds_read_b128 a[252:255], v11 offset:24576
  buffer_load_dwordx4 v4, s[20:23], s69 offen offset:3072 lds
  v_sub_f32 v240, 0, v30
  v_sub_f32 v241, 0, v30
  v_mfma_f32_32x32x16_bf16 v[192:207], a[228:231], v[228:231], v[192:207]
  ds_read_b128 a[224:227], v8 offset:28672
  v_sub_f32 v242, 0, v30
  v_sub_f32 v243, 0, v30
  v_sub_f32 v244, 0, v30
  v_sub_f32 v245, 0, v30
  v_sub_f32 v246, 0, v30
  v_mfma_f32_32x32x16_bf16 v[192:207], a[232:235], v[232:235], v[192:207]
  ds_read_b128 a[228:231], v9 offset:28672
  v_sub_f32 v247, 0, v30
  v_sub_f32 v248, 0, v30
  v_sub_f32 v249, 0, v30
  v_sub_f32 v250, 0, v30
  v_sub_f32 v251, 0, v30
  v_mfma_f32_32x32x16_bf16 v[192:207], a[236:239], v[236:239], v[192:207]
  ds_read_b128 a[232:235], v10 offset:28672
  v_sub_f32 v252, 0, v30
  v_sub_f32 v253, 0, v30
  v_sub_f32 v254, 0, v30
  v_sub_f32 v255, 0, v30
  s_waitcnt lgkmcnt(3)
  v_mfma_f32_32x32x16_bf16 v[192:207], a[240:243], v[144:147], v[192:207]
  ds_read_b128 a[236:239], v11 offset:28672
  v_sub_f32 v160, v160, v30
  v_exp_f32 v160, v160
  v_sub_f32 v161, v161, v30
  v_mfma_f32_32x32x16_bf16 v[192:207], a[244:247], v[148:151], v[192:207]
  s_waitcnt vmcnt(17)
  s_barrier
  ds_read_b128 a[240:243], v8 offset:32768
  s_add_u32 m0, s60, 131072
  s_mov_b32 s64, 0x20000
  v_mfma_f32_32x32x16_bf16 v[192:207], a[248:251], v[152:155], v[192:207]
  ds_read_b128 a[244:247], v9 offset:32768
  v_exp_f32 v161, v161
  v_sub_f32 v162, v162, v30
  v_exp_f32 v162, v162
  v_mfma_f32_32x32x16_bf16 v[192:207], a[252:255], v[156:159], v[192:207]
  ds_read_b128 a[248:251], v10 offset:32768
  v_sub_f32 v163, v163, v30
  v_exp_f32 v163, v163
  v_sub_f32 v164, v164, v30
  s_waitcnt lgkmcnt(3)
  v_mfma_f32_32x32x16_bf16 v[192:207], a[224:227], v[176:179], v[192:207]
  ds_read_b128 a[252:255], v11 offset:32768
  buffer_load_dwordx4 v1, s[20:23], s64 offen offset:0 lds
  v_exp_f32 v164, v164
  v_mfma_f32_32x32x16_bf16 v[192:207], a[228:231], v[180:183], v[192:207]
  ds_read_b128 a[224:227], v8 offset:36864
  v_sub_f32 v165, v165, v30
  v_exp_f32 v165, v165
  v_sub_f32 v166, v166, v30
  v_add_f32 v14, v14, v160
  v_mfma_f32_32x32x16_bf16 v[192:207], a[232:235], v[184:187], v[192:207]
  ds_read_b128 a[228:231], v9 offset:36864
  buffer_load_dwordx4 v2, s[20:23], s64 offen offset:1024 lds
  v_exp_f32 v166, v166
  v_mfma_f32_32x32x16_bf16 v[192:207], a[236:239], v[188:191], v[192:207]
  ds_read_b128 a[232:235], v10 offset:36864
  v_sub_f32 v167, v167, v30
  v_exp_f32 v167, v167
  v_sub_f32 v168, v168, v30
  s_waitcnt lgkmcnt(3)
  v_mfma_f32_32x32x16_bf16 v[128:143], a[240:243], v[208:211], v[240:255]
  ds_read_b128 a[236:239], v11 offset:36864
  v_exp_f32 v168, v168
  v_sub_f32 v169, v169, v30
  v_exp_f32 v169, v169
  v_mfma_f32_32x32x16_bf16 v[128:143], a[244:247], v[212:215], v[128:143]
  ds_read_b128 a[240:243], v8 offset:40960
  v_sub_f32 v170, v170, v30
  v_exp_f32 v170, v170
  v_sub_f32 v171, v171, v30
  v_add_f32 v15, v15, v161
  v_mfma_f32_32x32x16_bf16 v[128:143], a[248:251], v[216:219], v[128:143]
  ds_read_b128 a[244:247], v9 offset:40960
  buffer_load_dwordx4 v3, s[20:23], s64 offen offset:2048 lds
  v_exp_f32 v171, v171
  v_mfma_f32_32x32x16_bf16 v[128:143], a[252:255], v[220:223], v[128:143]
  ds_read_b128 a[248:251], v10 offset:40960
  v_sub_f32 v172, v172, v30
  v_exp_f32 v172, v172
  v_sub_f32 v173, v173, v30
  s_waitcnt lgkmcnt(3)
  v_mfma_f32_32x32x16_bf16 v[128:143], a[224:227], v[224:227], v[128:143]
  ds_read_b128 a[252:255], v11 offset:40960
  v_exp_f32 v173, v173
  v_sub_f32 v174, v174, v30
  v_exp_f32 v174, v174
  v_mfma_f32_32x32x16_bf16 v[128:143], a[228:231], v[228:231], v[128:143]
  ds_read_b128 a[224:227], v8 offset:45056
  buffer_load_dwordx4 v4, s[20:23], s64 offen offset:3072 lds
  v_sub_f32 v175, v175, v30
  v_cvt_pk_bf16_f32 v32, v160, v161
  v_mfma_f32_32x32x16_bf16 v[128:143], a[232:235], v[232:235], v[128:143]
  ds_read_b128 a[228:231], v9 offset:45056
  s_add_u32 m0, s60, 147456
  s_mov_b32 s65, 0x24000
  v_exp_f32 v175, v175
  v_add_f32 v14, v14, v162
  v_mfma_f32_32x32x16_bf16 v[128:143], a[236:239], v[236:239], v[128:143]
  ds_read_b128 a[232:235], v10 offset:45056
  v_add_f32 v15, v15, v163
  v_cvt_pk_bf16_f32 v33, v162, v163
  v_add_f32 v14, v14, v164
  v_add_f32 v15, v15, v165
  s_waitcnt lgkmcnt(3)
  v_mfma_f32_32x32x16_bf16 v[128:143], a[240:243], v[144:147], v[128:143]
  ds_read_b128 a[236:239], v11 offset:45056
  v_cvt_pk_bf16_f32 v34, v164, v165
  v_add_f32 v14, v14, v166
  v_add_f32 v15, v15, v167
  v_cvt_pk_bf16_f32 v35, v166, v167
  v_add_f32 v14, v14, v168
  v_mfma_f32_32x32x16_bf16 v[128:143], a[244:247], v[148:151], v[128:143]
  ds_read_b128 a[240:243], v8 offset:49152
  buffer_load_dwordx4 v1, s[20:23], s65 offen offset:0 lds
  v_add_f32 v15, v15, v169
  v_cvt_pk_bf16_f32 v36, v168, v169
  v_mfma_f32_32x32x16_bf16 v[128:143], a[248:251], v[152:155], v[128:143]
  ds_read_b128 a[244:247], v9 offset:49152
  v_add_f32 v14, v14, v170
  v_add_f32 v15, v15, v171
  v_cvt_pk_bf16_f32 v37, v170, v171
  v_add_f32 v14, v14, v172
  v_add_f32 v15, v15, v173
  v_mfma_f32_32x32x16_bf16 v[128:143], a[252:255], v[156:159], v[128:143]
  ds_read_b128 a[248:251], v10 offset:49152
  v_cvt_pk_bf16_f32 v38, v172, v173
  v_add_f32 v14, v14, v174
  v_add_f32 v15, v15, v175
  v_cvt_pk_bf16_f32 v39, v174, v175
  s_waitcnt lgkmcnt(3)
  v_mfma_f32_32x32x16_bf16 v[128:143], a[224:227], v[176:179], v[128:143]
  ds_read_b128 a[252:255], v11 offset:49152
  v_sub_f32 v192, v192, v30
  v_exp_f32 v192, v192
  v_sub_f32 v193, v193, v30
  v_mfma_f32_32x32x16_bf16 v[128:143], a[228:231], v[180:183], v[128:143]
  ds_read_b128 a[224:227], v8 offset:53248
  buffer_load_dwordx4 v2, s[20:23], s65 offen offset:1024 lds
  v_exp_f32 v193, v193
  v_mfma_f32_32x32x16_bf16 v[128:143], a[232:235], v[184:187], v[128:143]
  ds_read_b128 a[228:231], v9 offset:53248
  v_sub_f32 v194, v194, v30
  v_exp_f32 v194, v194
  v_sub_f32 v195, v195, v30
  v_add_f32 v14, v14, v192
  v_mfma_f32_32x32x16_bf16 v[128:143], a[236:239], v[188:191], v[128:143]
  ds_read_b128 a[232:235], v10 offset:53248
  v_exp_f32 v195, v195
  v_sub_f32 v196, v196, v30
  v_add_f32 v15, v15, v193
  s_waitcnt lgkmcnt(3)
  v_mfma_f32_32x32x16_bf16 v[160:175], a[240:243], v[208:211], v[240:255]
  ds_read_b128 a[236:239], v11 offset:53248
  buffer_load_dwordx4 v3, s[20:23], s65 offen offset:2048 lds
  v_exp_f32 v196, v196
  v_mfma_f32_32x32x16_bf16 v[160:175], a[244:247], v[212:215], v[160:175]
  ds_read_b128 a[240:243], v8 offset:57344
  v_sub_f32 v197, v197, v30
  v_exp_f32 v197, v197
  v_sub_f32 v198, v198, v30
  v_cvt_pk_bf16_f32 v40, v192, v193
  v_mfma_f32_32x32x16_bf16 v[160:175], a[248:251], v[216:219], v[160:175]
  ds_read_b128 a[244:247], v9 offset:57344
  v_exp_f32 v198, v198
  v_sub_f32 v199, v199, v30
  v_exp_f32 v199, v199
  v_mfma_f32_32x32x16_bf16 v[160:175], a[252:255], v[220:223], v[160:175]
  ds_read_b128 a[248:251], v10 offset:57344
  v_sub_f32 v200, v200, v30
  v_exp_f32 v200, v200
  v_sub_f32 v201, v201, v30
  s_waitcnt lgkmcnt(3)
  v_mfma_f32_32x32x16_bf16 v[160:175], a[224:227], v[224:227], v[160:175]
  ds_read_b128 a[252:255], v11 offset:57344
  buffer_load_dwordx4 v4, s[20:23], s65 offen offset:3072 lds
  v_exp_f32 v201, v201
  v_mfma_f32_32x32x16_bf16 v[160:175], a[228:231], v[228:231], v[160:175]
  ds_read_b128 a[224:227], v8 offset:61440
  v_sub_f32 v202, v202, v30
  v_exp_f32 v202, v202
  v_sub_f32 v203, v203, v30
  v_add_f32 v14, v14, v194
  v_mfma_f32_32x32x16_bf16 v[160:175], a[232:235], v[232:235], v[160:175]
  ds_read_b128 a[228:231], v9 offset:61440
  v_exp_f32 v203, v203
  v_sub_f32 v204, v204, v30
  v_exp_f32 v204, v204
  v_mfma_f32_32x32x16_bf16 v[160:175], a[236:239], v[236:239], v[160:175]
  ds_read_b128 a[232:235], v10 offset:61440
  v_sub_f32 v205, v205, v30
  v_exp_f32 v205, v205
  v_sub_f32 v206, v206, v30
  s_waitcnt lgkmcnt(3)
  v_mfma_f32_32x32x16_bf16 v[160:175], a[240:243], v[144:147], v[160:175]
  ds_read_b128 a[236:239], v11 offset:61440
  v_exp_f32 v206, v206
  v_sub_f32 v207, v207, v30
  v_exp_f32 v207, v207
  v_mfma_f32_32x32x16_bf16 v[160:175], a[244:247], v[148:151], v[160:175]
  s_waitcnt vmcnt(16)
  s_barrier
  v_add_u32 v8, 0x10000, v8
  ds_read_b128 a[240:243], v8 offset:0
  s_add_u32 m0, s60, 0
  v_mfma_f32_32x32x16_bf16 v[160:175], a[248:251], v[152:155], v[160:175]
  v_add_u32 v9, 0x10000, v9
  ds_read_b128 a[244:247], v9 offset:0
  s_mov_b32 s62, 0x28000
  v_add_f32 v15, v15, v195
  v_cvt_pk_bf16_f32 v41, v194, v195
  v_add_f32 v14, v14, v196
  v_mfma_f32_32x32x16_bf16 v[160:175], a[252:255], v[156:159], v[160:175]
  v_add_u32 v10, 0x10000, v10
  ds_read_b128 a[248:251], v10 offset:0
  v_add_f32 v15, v15, v197
  v_cvt_pk_bf16_f32 v42, v196, v197
  v_add_f32 v14, v14, v198
  s_waitcnt lgkmcnt(3)
  v_mfma_f32_32x32x16_bf16 v[160:175], a[224:227], v[176:179], v[160:175]
  v_add_u32 v11, 0x10000, v11
  ds_read_b128 a[252:255], v11 offset:0
  buffer_load_dwordx4 v1, s[20:23], s62 offen offset:0 lds
  v_add_f32 v15, v15, v199
  v_mfma_f32_32x32x16_bf16 v[160:175], a[228:231], v[180:183], v[160:175]
  ds_read_b128 a[224:227], v8 offset:4096
  v_cvt_pk_bf16_f32 v43, v198, v199
  v_add_f32 v14, v14, v200
  v_add_f32 v15, v15, v201
  v_cvt_pk_bf16_f32 v44, v200, v201
  v_add_f32 v14, v14, v202
  v_mfma_f32_32x32x16_bf16 v[160:175], a[232:235], v[184:187], v[160:175]
  ds_read_b128 a[228:231], v9 offset:4096
  buffer_load_dwordx4 v2, s[20:23], s62 offen offset:1024 lds
  v_add_f32 v15, v15, v203
  v_cvt_pk_bf16_f32 v45, v202, v203
  v_mfma_f32_32x32x16_bf16 v[160:175], a[236:239], v[188:191], v[160:175]
  ds_read_b128 a[232:235], v10 offset:4096
  v_add_f32 v14, v14, v204
  v_add_f32 v15, v15, v205
  v_cvt_pk_bf16_f32 v46, v204, v205
  v_add_f32 v14, v14, v206
  v_add_f32 v15, v15, v207
  v_cvt_pk_bf16_f32 v47, v206, v207
  s_waitcnt lgkmcnt(3)
  v_mfma_f32_32x32x16_bf16 v[192:207], a[240:243], v[208:211], v[240:255]
  ds_read_b128 a[236:239], v11 offset:4096
  v_exp_f32 v128, v128
  v_exp_f32 v129, v129
  v_mfma_f32_32x32x16_bf16 v[192:207], a[244:247], v[212:215], v[192:207]
  ds_read_b128 a[240:243], v8 offset:8192
  v_exp_f32 v130, v130
  v_exp_f32 v131, v131
  v_add_f32 v14, v14, v128
  v_mfma_f32_32x32x16_bf16 v[192:207], a[248:251], v[216:219], v[192:207]
  ds_read_b128 a[244:247], v9 offset:8192
  buffer_load_dwordx4 v3, s[20:23], s62 offen offset:2048 lds
  v_exp_f32 v132, v132
  v_mfma_f32_32x32x16_bf16 v[192:207], a[252:255], v[220:223], v[192:207]
  ds_read_b128 a[248:251], v10 offset:8192
  v_exp_f32 v133, v133
  v_exp_f32 v134, v134
  s_waitcnt lgkmcnt(3)
  v_mfma_f32_32x32x16_bf16 v[192:207], a[224:227], v[224:227], v[192:207]
  ds_read_b128 a[252:255], v11 offset:8192
  v_exp_f32 v135, v135
  v_exp_f32 v136, v136
  v_add_f32 v15, v15, v129
  v_mfma_f32_32x32x16_bf16 v[192:207], a[228:231], v[228:231], v[192:207]
  ds_read_b128 a[224:227], v8 offset:12288
  buffer_load_dwordx4 v4, s[20:23], s62 offen offset:3072 lds
  v_exp_f32 v137, v137
  v_mfma_f32_32x32x16_bf16 v[192:207], a[232:235], v[232:235], v[192:207]
  ds_read_b128 a[228:231], v9 offset:12288
  s_add_u32 m0, s60, 16384
  s_mov_b32 s69, 0x2c000
  v_exp_f32 v138, v138
  v_cvt_pk_bf16_f32 v48, v128, v129
  v_mfma_f32_32x32x16_bf16 v[192:207], a[236:239], v[236:239], v[192:207]
  ds_read_b128 a[232:235], v10 offset:12288
  v_exp_f32 v139, v139
  v_exp_f32 v140, v140
  s_waitcnt lgkmcnt(3)
  v_mfma_f32_32x32x16_bf16 v[192:207], a[240:243], v[144:147], v[192:207]
  ds_read_b128 a[236:239], v11 offset:12288
  v_exp_f32 v141, v141
  v_exp_f32 v142, v142
  v_add_f32 v14, v14, v130
  v_mfma_f32_32x32x16_bf16 v[192:207], a[244:247], v[148:151], v[192:207]
  ds_read_b128 a[240:243], v8 offset:16384
  buffer_load_dwordx4 v1, s[20:23], s69 offen offset:0 lds
  v_exp_f32 v143, v143
  v_mfma_f32_32x32x16_bf16 v[192:207], a[248:251], v[152:155], v[192:207]
  ds_read_b128 a[244:247], v9 offset:16384
  v_add_f32 v15, v15, v131
  v_cvt_pk_bf16_f32 v49, v130, v131
  v_add_f32 v14, v14, v132
  v_add_f32 v15, v15, v133
  v_cvt_pk_bf16_f32 v50, v132, v133
  v_mfma_f32_32x32x16_bf16 v[192:207], a[252:255], v[156:159], v[192:207]
  ds_read_b128 a[248:251], v10 offset:16384
  v_add_f32 v14, v14, v134
  v_add_f32 v15, v15, v135
  v_cvt_pk_bf16_f32 v51, v134, v135
  v_add_f32 v14, v14, v136
  s_waitcnt lgkmcnt(3)
  v_mfma_f32_32x32x16_bf16 v[192:207], a[224:227], v[176:179], v[192:207]
  ds_read_b128 a[252:255], v11 offset:16384
  v_add_f32 v15, v15, v137
  v_cvt_pk_bf16_f32 v52, v136, v137
  v_add_f32 v14, v14, v138
  v_add_f32 v15, v15, v139
  v_cvt_pk_bf16_f32 v53, v138, v139
  v_mfma_f32_32x32x16_bf16 v[192:207], a[228:231], v[180:183], v[192:207]
  ds_read_b128 a[224:227], v8 offset:20480
  buffer_load_dwordx4 v2, s[20:23], s69 offen offset:1024 lds
  v_add_f32 v14, v14, v140
  v_add_f32 v15, v15, v141
  v_mfma_f32_32x32x16_bf16 v[192:207], a[232:235], v[184:187], v[192:207]
  ds_read_b128 a[228:231], v9 offset:20480
  v_cvt_pk_bf16_f32 v54, v140, v141
  v_add_f32 v14, v14, v142
  v_add_f32 v15, v15, v143
  v_cvt_pk_bf16_f32 v55, v142, v143
  v_mfma_f32_32x32x16_bf16 v[192:207], a[236:239], v[188:191], v[192:207]
  ds_read_b128 a[232:235], v10 offset:20480
  v_exp_f32 v160, v160
  v_exp_f32 v161, v161
  s_waitcnt lgkmcnt(3)
  v_mfma_f32_32x32x16_bf16 v[128:143], a[240:243], v[208:211], v[240:255]
  ds_read_b128 a[236:239], v11 offset:20480
  buffer_load_dwordx4 v3, s[20:23], s69 offen offset:2048 lds
  v_exp_f32 v162, v162
  v_mfma_f32_32x32x16_bf16 v[128:143], a[244:247], v[212:215], v[128:143]
  ds_read_b128 a[240:243], v8 offset:24576
  v_exp_f32 v163, v163
  v_exp_f32 v164, v164
  v_add_f32 v14, v14, v160
  v_mfma_f32_32x32x16_bf16 v[128:143], a[248:251], v[216:219], v[128:143]
  ds_read_b128 a[244:247], v9 offset:24576
  v_exp_f32 v165, v165
  v_exp_f32 v166, v166
  v_add_f32 v15, v15, v161
  v_mfma_f32_32x32x16_bf16 v[128:143], a[252:255], v[220:223], v[128:143]
  ds_read_b128 a[248:251], v10 offset:24576
  v_exp_f32 v167, v167
  v_exp_f32 v168, v168
  s_waitcnt lgkmcnt(3)
  v_mfma_f32_32x32x16_bf16 v[128:143], a[224:227], v[224:227], v[128:143]
  ds_read_b128 a[252:255], v11 offset:24576
  buffer_load_dwordx4 v4, s[20:23], s69 offen offset:3072 lds
  v_exp_f32 v169, v169
  v_mfma_f32_32x32x16_bf16 v[128:143], a[228:231], v[228:231], v[128:143]
  ds_read_b128 a[224:227], v8 offset:28672
  v_exp_f32 v170, v170
  v_exp_f32 v171, v171
  v_cvt_pk_bf16_f32 v56, v160, v161
  v_mfma_f32_32x32x16_bf16 v[128:143], a[232:235], v[232:235], v[128:143]
  ds_read_b128 a[228:231], v9 offset:28672
  v_exp_f32 v172, v172
  v_exp_f32 v173, v173
  v_add_f32 v14, v14, v162
  v_mfma_f32_32x32x16_bf16 v[128:143], a[236:239], v[236:239], v[128:143]
  ds_read_b128 a[232:235], v10 offset:28672
  v_exp_f32 v174, v174
  v_exp_f32 v175, v175
  s_waitcnt lgkmcnt(3)
  v_mfma_f32_32x32x16_bf16 v[128:143], a[240:243], v[144:147], v[128:143]
  ds_read_b128 a[236:239], v11 offset:28672
  v_add_f32 v15, v15, v163
  v_cvt_pk_bf16_f32 v57, v162, v163
  v_add_f32 v14, v14, v164
  v_add_f32 v15, v15, v165
  v_cvt_pk_bf16_f32 v58, v164, v165
  v_mfma_f32_32x32x16_bf16 v[128:143], a[244:247], v[148:151], v[128:143]
  s_waitcnt vmcnt(16)
  s_barrier
  ds_read_b128 a[240:243], v8 offset:32768
  s_add_u32 m0, s60, 32768
  s_mov_b32 s64, 0x30000
  v_mfma_f32_32x32x16_bf16 v[128:143], a[248:251], v[152:155], v[128:143]
  ds_read_b128 a[244:247], v9 offset:32768
  v_add_f32 v14, v14, v166
  v_add_f32 v15, v15, v167
  v_cvt_pk_bf16_f32 v59, v166, v167
  v_add_f32 v14, v14, v168
  v_add_f32 v15, v15, v169
  v_mfma_f32_32x32x16_bf16 v[128:143], a[252:255], v[156:159], v[128:143]
  ds_read_b128 a[248:251], v10 offset:32768
  v_cvt_pk_bf16_f32 v60, v168, v169
  v_add_f32 v14, v14, v170
  v_add_f32 v15, v15, v171
  v_cvt_pk_bf16_f32 v61, v170, v171
  s_waitcnt lgkmcnt(3)
  v_mfma_f32_32x32x16_bf16 v[128:143], a[224:227], v[176:179], v[128:143]
  ds_read_b128 a[252:255], v11 offset:32768
  buffer_load_dwordx4 v1, s[20:23], s64 offen offset:0 lds
  v_add_f32 v14, v14, v172
  v_add_f32 v15, v15, v173
  v_mfma_f32_32x32x16_bf16 v[128:143], a[228:231], v[180:183], v[128:143]
  ds_read_b128 a[224:227], v8 offset:36864
  v_cvt_pk_bf16_f32 v62, v172, v173
  v_add_f32 v14, v14, v174
  v_add_f32 v15, v15, v175
  v_cvt_pk_bf16_f32 v63, v174, v175
  v_mfma_f32_32x32x16_bf16 v[128:143], a[232:235], v[184:187], v[128:143]
  ds_read_b128 a[228:231], v9 offset:36864
  buffer_load_dwordx4 v2, s[20:23], s64 offen offset:1024 lds
  v_exp_f32 v192, v192
  v_mfma_f32_32x32x16_bf16 v[128:143], a[236:239], v[188:191], v[128:143]
  ds_read_b128 a[232:235], v10 offset:36864
  v_exp_f32 v193, v193
  v_exp_f32 v194, v194
  s_waitcnt lgkmcnt(3)
  v_mfma_f32_32x32x16_bf16 v[160:175], a[240:243], v[208:211], v[240:255]
  ds_read_b128 a[236:239], v11 offset:36864
  v_exp_f32 v195, v195
  v_exp_f32 v196, v196
  v_add_f32 v14, v14, v192
  v_mfma_f32_32x32x16_bf16 v[160:175], a[244:247], v[212:215], v[160:175]
  ds_read_b128 a[240:243], v8 offset:40960
  v_exp_f32 v197, v197
  v_exp_f32 v198, v198
  v_add_f32 v15, v15, v193
  v_mfma_f32_32x32x16_bf16 v[160:175], a[248:251], v[216:219], v[160:175]
  ds_read_b128 a[244:247], v9 offset:40960
  buffer_load_dwordx4 v3, s[20:23], s64 offen offset:2048 lds
  v_exp_f32 v199, v199
  v_mfma_f32_32x32x16_bf16 v[160:175], a[252:255], v[220:223], v[160:175]
  ds_read_b128 a[248:251], v10 offset:40960
  v_exp_f32 v200, v200
  v_exp_f32 v201, v201
  s_waitcnt lgkmcnt(3)
  v_mfma_f32_32x32x16_bf16 v[160:175], a[224:227], v[224:227], v[160:175]
  ds_read_b128 a[252:255], v11 offset:40960
  v_exp_f32 v202, v202
  v_exp_f32 v203, v203
  v_cvt_pk_bf16_f32 v64, v192, v193
  v_mfma_f32_32x32x16_bf16 v[160:175], a[228:231], v[228:231], v[160:175]
  ds_read_b128 a[224:227], v8 offset:45056
  buffer_load_dwordx4 v4, s[20:23], s64 offen offset:3072 lds
  v_exp_f32 v204, v204
  v_mfma_f32_32x32x16_bf16 v[160:175], a[232:235], v[232:235], v[160:175]
  ds_read_b128 a[228:231], v9 offset:45056
  s_add_u32 m0, s60, 49152
  s_mov_b32 s65, 0x34000
  v_exp_f32 v205, v205
  v_add_f32 v14, v14, v194
  v_mfma_f32_32x32x16_bf16 v[160:175], a[236:239], v[236:239], v[160:175]
  ds_read_b128 a[232:235], v10 offset:45056
  v_exp_f32 v206, v206
  v_exp_f32 v207, v207
  s_waitcnt lgkmcnt(3)
  v_mfma_f32_32x32x16_bf16 v[160:175], a[240:243], v[144:147], v[160:175]
  ds_read_b128 a[236:239], v11 offset:45056
  v_add_f32 v15, v15, v195
  v_cvt_pk_bf16_f32 v65, v194, v195
  v_add_f32 v14, v14, v196
  v_add_f32 v15, v15, v197
  v_cvt_pk_bf16_f32 v66, v196, v197
  v_mfma_f32_32x32x16_bf16 v[160:175], a[244:247], v[148:151], v[160:175]
  ds_read_b128 a[240:243], v8 offset:49152
  buffer_load_dwordx4 v1, s[20:23], s65 offen offset:0 lds
  v_add_f32 v14, v14, v198
  v_add_f32 v15, v15, v199
  v_mfma_f32_32x32x16_bf16 v[160:175], a[248:251], v[152:155], v[160:175]
  ds_read_b128 a[244:247], v9 offset:49152
  v_cvt_pk_bf16_f32 v67, v198, v199
  v_add_f32 v14, v14, v200
  v_add_f32 v15, v15, v201
  v_cvt_pk_bf16_f32 v68, v200, v201
  v_add_f32 v14, v14, v202
  v_mfma_f32_32x32x16_bf16 v[160:175], a[252:255], v[156:159], v[160:175]
  ds_read_b128 a[248:251], v10 offset:49152
  v_add_f32 v15, v15, v203
  v_cvt_pk_bf16_f32 v69, v202, v203
  v_add_f32 v14, v14, v204
  v_add_f32 v15, v15, v205
  s_waitcnt lgkmcnt(3)
  v_mfma_f32_32x32x16_bf16 v[160:175], a[224:227], v[176:179], v[160:175]
  ds_read_b128 a[252:255], v11 offset:49152
  v_cvt_pk_bf16_f32 v70, v204, v205
  v_add_f32 v14, v14, v206
  v_add_f32 v15, v15, v207
  v_cvt_pk_bf16_f32 v71, v206, v207
  v_mfma_f32_32x32x16_bf16 v[160:175], a[228:231], v[180:183], v[160:175]
  ds_read_b128 a[224:227], v8 offset:53248
  buffer_load_dwordx4 v2, s[20:23], s65 offen offset:1024 lds
  v_exp_f32 v128, v128
  v_mfma_f32_32x32x16_bf16 v[160:175], a[232:235], v[184:187], v[160:175]
  ds_read_b128 a[228:231], v9 offset:53248
  v_exp_f32 v129, v129
  v_exp_f32 v130, v130
  v_add_f32 v14, v14, v128
  v_mfma_f32_32x32x16_bf16 v[160:175], a[236:239], v[188:191], v[160:175]
  ds_read_b128 a[232:235], v10 offset:53248
  v_exp_f32 v131, v131
  v_exp_f32 v132, v132
  s_waitcnt lgkmcnt(3)
  v_mfma_f32_32x32x16_bf16 v[192:207], a[240:243], v[208:211], v[240:255]
  ds_read_b128 a[236:239], v11 offset:53248
  buffer_load_dwordx4 v3, s[20:23], s65 offen offset:2048 lds
  v_exp_f32 v133, v133
  v_mfma_f32_32x32x16_bf16 v[192:207], a[244:247], v[212:215], v[192:207]
  ds_read_b128 a[240:243], v8 offset:57344
  v_exp_f32 v134, v134
  v_exp_f32 v135, v135
  v_add_f32 v15, v15, v129
  v_mfma_f32_32x32x16_bf16 v[192:207], a[248:251], v[216:219], v[192:207]
  ds_read_b128 a[244:247], v9 offset:57344
  v_exp_f32 v136, v136
  v_exp_f32 v137, v137
  v_cvt_pk_bf16_f32 v72, v128, v129
  v_mfma_f32_32x32x16_bf16 v[192:207], a[252:255], v[220:223], v[192:207]
  ds_read_b128 a[248:251], v10 offset:57344
  v_exp_f32 v138, v138
  v_exp_f32 v139, v139
  s_waitcnt lgkmcnt(3)
  v_mfma_f32_32x32x16_bf16 v[192:207], a[224:227], v[224:227], v[192:207]
  ds_read_b128 a[252:255], v11 offset:57344
  buffer_load_dwordx4 v4, s[20:23], s65 offen offset:3072 lds
  v_exp_f32 v140, v140
  v_mfma_f32_32x32x16_bf16 v[192:207], a[228:231], v[228:231], v[192:207]
  ds_read_b128 a[224:227], v8 offset:61440
  v_exp_f32 v141, v141
  v_exp_f32 v142, v142
  v_add_f32 v14, v14, v130
  v_mfma_f32_32x32x16_bf16 v[192:207], a[232:235], v[232:235], v[192:207]
  ds_read_b128 a[228:231], v9 offset:61440
  v_exp_f32 v143, v143
  v_add_f32 v15, v15, v131
  v_cvt_pk_bf16_f32 v73, v130, v131
  v_add_f32 v14, v14, v132
  v_mfma_f32_32x32x16_bf16 v[192:207], a[236:239], v[236:239], v[192:207]
  ds_read_b128 a[232:235], v10 offset:61440
  v_add_f32 v15, v15, v133
  v_cvt_pk_bf16_f32 v74, v132, v133
  v_add_f32 v14, v14, v134
  v_add_f32 v15, v15, v135
  s_waitcnt lgkmcnt(3)
  v_mfma_f32_32x32x16_bf16 v[192:207], a[240:243], v[144:147], v[192:207]
  ds_read_b128 a[236:239], v11 offset:61440
  v_cvt_pk_bf16_f32 v75, v134, v135
  v_add_f32 v14, v14, v136
  v_add_f32 v15, v15, v137
  v_cvt_pk_bf16_f32 v76, v136, v137
  v_add_f32 v14, v14, v138
  v_mfma_f32_32x32x16_bf16 v[192:207], a[244:247], v[148:151], v[192:207]
  s_waitcnt vmcnt(16)
  s_barrier
  v_add_u32 v8, 0x10000, v8
  ds_read_b128 a[240:243], v8 offset:0
  s_add_u32 m0, s60, 65536
  v_mfma_f32_32x32x16_bf16 v[192:207], a[248:251], v[152:155], v[192:207]
  v_add_u32 v9, 0x10000, v9
  ds_read_b128 a[244:247], v9 offset:0
  s_mov_b32 s62, 0x38000
  v_add_f32 v15, v15, v139
  v_cvt_pk_bf16_f32 v77, v138, v139
  v_add_f32 v14, v14, v140
  v_mfma_f32_32x32x16_bf16 v[192:207], a[252:255], v[156:159], v[192:207]
  v_add_u32 v10, 0x10000, v10
  ds_read_b128 a[248:251], v10 offset:0
  v_add_f32 v15, v15, v141
  v_cvt_pk_bf16_f32 v78, v140, v141
  v_add_f32 v14, v14, v142
  s_waitcnt lgkmcnt(3)
  v_mfma_f32_32x32x16_bf16 v[192:207], a[224:227], v[176:179], v[192:207]
  v_add_u32 v11, 0x10000, v11
  ds_read_b128 a[252:255], v11 offset:0
  buffer_load_dwordx4 v1, s[20:23], s62 offen offset:0 lds
  v_add_f32 v15, v15, v143
  v_mfma_f32_32x32x16_bf16 v[192:207], a[228:231], v[180:183], v[192:207]
  ds_read_b128 a[224:227], v8 offset:4096
  v_cvt_pk_bf16_f32 v79, v142, v143
  v_exp_f32 v160, v160
  v_exp_f32 v161, v161
  v_mfma_f32_32x32x16_bf16 v[192:207], a[232:235], v[184:187], v[192:207]
  ds_read_b128 a[228:231], v9 offset:4096
  buffer_load_dwordx4 v2, s[20:23], s62 offen offset:1024 lds
  v_exp_f32 v162, v162
  v_mfma_f32_32x32x16_bf16 v[192:207], a[236:239], v[188:191], v[192:207]
  ds_read_b128 a[232:235], v10 offset:4096
  v_exp_f32 v163, v163
  v_exp_f32 v164, v164
  s_waitcnt lgkmcnt(3)
  v_mfma_f32_32x32x16_bf16 v[128:143], a[240:243], v[208:211], v[240:255]
  ds_read_b128 a[236:239], v11 offset:4096
  v_exp_f32 v165, v165
  v_exp_f32 v166, v166
  v_add_f32 v14, v14, v160
  v_mfma_f32_32x32x16_bf16 v[128:143], a[244:247], v[212:215], v[128:143]
  ds_read_b128 a[240:243], v8 offset:8192
  v_exp_f32 v167, v167
  v_exp_f32 v168, v168
  v_add_f32 v15, v15, v161
  v_mfma_f32_32x32x16_bf16 v[128:143], a[248:251], v[216:219], v[128:143]
  ds_read_b128 a[244:247], v9 offset:8192
  buffer_load_dwordx4 v3, s[20:23], s62 offen offset:2048 lds
  v_exp_f32 v169, v169
  v_mfma_f32_32x32x16_bf16 v[128:143], a[252:255], v[220:223], v[128:143]
  ds_read_b128 a[248:251], v10 offset:8192
  v_exp_f32 v170, v170
  v_exp_f32 v171, v171
  s_waitcnt lgkmcnt(3)
  v_mfma_f32_32x32x16_bf16 v[128:143], a[224:227], v[224:227], v[128:143]
  ds_read_b128 a[252:255], v11 offset:8192
  v_exp_f32 v172, v172
  v_exp_f32 v173, v173
  v_cvt_pk_bf16_f32 v80, v160, v161
  v_mfma_f32_32x32x16_bf16 v[128:143], a[228:231], v[228:231], v[128:143]
  ds_read_b128 a[224:227], v8 offset:12288
  buffer_load_dwordx4 v4, s[20:23], s62 offen offset:3072 lds
  v_exp_f32 v174, v174
  v_mfma_f32_32x32x16_bf16 v[128:143], a[232:235], v[232:235], v[128:143]
  ds_read_b128 a[228:231], v9 offset:12288
  s_add_u32 m0, s60, 81920
  s_mov_b32 s69, 0x3c000
  v_exp_f32 v175, v175
  v_add_f32 v14, v14, v162
  v_mfma_f32_32x32x16_bf16 v[128:143], a[236:239], v[236:239], v[128:143]
  ds_read_b128 a[232:235], v10 offset:12288
  v_add_f32 v15, v15, v163
  v_cvt_pk_bf16_f32 v81, v162, v163
  v_add_f32 v14, v14, v164
  v_add_f32 v15, v15, v165
  s_waitcnt lgkmcnt(3)
  v_mfma_f32_32x32x16_bf16 v[128:143], a[240:243], v[144:147], v[128:143]
  ds_read_b128 a[236:239], v11 offset:12288
  v_cvt_pk_bf16_f32 v82, v164, v165
  v_add_f32 v14, v14, v166
  v_add_f32 v15, v15, v167
  v_cvt_pk_bf16_f32 v83, v166, v167
  v_add_f32 v14, v14, v168
  v_mfma_f32_32x32x16_bf16 v[128:143], a[244:247], v[148:151], v[128:143]
  ds_read_b128 a[240:243], v8 offset:16384
  buffer_load_dwordx4 v1, s[20:23], s69 offen offset:0 lds
  v_add_f32 v15, v15, v169
  v_cvt_pk_bf16_f32 v84, v168, v169
  v_mfma_f32_32x32x16_bf16 v[128:143], a[248:251], v[152:155], v[128:143]
  ds_read_b128 a[244:247], v9 offset:16384
  v_add_f32 v14, v14, v170
  v_add_f32 v15, v15, v171
  v_cvt_pk_bf16_f32 v85, v170, v171
  v_add_f32 v14, v14, v172
  v_add_f32 v15, v15, v173
  v_mfma_f32_32x32x16_bf16 v[128:143], a[252:255], v[156:159], v[128:143]
  ds_read_b128 a[248:251], v10 offset:16384
  v_cvt_pk_bf16_f32 v86, v172, v173
  v_add_f32 v14, v14, v174
  v_add_f32 v15, v15, v175
  v_cvt_pk_bf16_f32 v87, v174, v175
  s_waitcnt lgkmcnt(3)
  v_mfma_f32_32x32x16_bf16 v[128:143], a[224:227], v[176:179], v[128:143]
  ds_read_b128 a[252:255], v11 offset:16384
  v_accvgpr_read_b32 v5, a134
  buffer_load_dword a200, v5, s[24:27], 0 offen offset:256
  v_mfma_f32_32x32x16_bf16 v[128:143], a[228:231], v[180:183], v[128:143]
  ds_read_b128 a[224:227], v8 offset:20480
  buffer_load_dwordx4 v2, s[20:23], s69 offen offset:1024 lds
  v_exp_f32 v192, v192
  v_mfma_f32_32x32x16_bf16 v[128:143], a[232:235], v[184:187], v[128:143]
  ds_read_b128 a[228:231], v9 offset:20480
  v_exp_f32 v193, v193
  v_exp_f32 v194, v194
  v_add_f32 v14, v14, v192
  v_mfma_f32_32x32x16_bf16 v[128:143], a[236:239], v[188:191], v[128:143]
  ds_read_b128 a[232:235], v10 offset:20480
  v_exp_f32 v195, v195
  v_exp_f32 v196, v196
  s_waitcnt lgkmcnt(3)
  v_mfma_f32_32x32x16_bf16 v[160:175], a[240:243], v[208:211], v[240:255]
  ds_read_b128 a[236:239], v11 offset:20480
  buffer_load_dwordx4 v3, s[20:23], s69 offen offset:2048 lds
  v_exp_f32 v197, v197
  v_mfma_f32_32x32x16_bf16 v[160:175], a[244:247], v[212:215], v[160:175]
  ds_read_b128 a[240:243], v8 offset:24576
  v_exp_f32 v198, v198
  v_exp_f32 v199, v199
  v_add_f32 v15, v15, v193
  v_mfma_f32_32x32x16_bf16 v[160:175], a[248:251], v[216:219], v[160:175]
  ds_read_b128 a[244:247], v9 offset:24576
  v_exp_f32 v200, v200
  v_exp_f32 v201, v201
  v_cvt_pk_bf16_f32 v88, v192, v193
  v_mfma_f32_32x32x16_bf16 v[160:175], a[252:255], v[220:223], v[160:175]
  ds_read_b128 a[248:251], v10 offset:24576
  v_exp_f32 v202, v202
  v_exp_f32 v203, v203
  s_waitcnt lgkmcnt(3)
  v_mfma_f32_32x32x16_bf16 v[160:175], a[224:227], v[224:227], v[160:175]
  ds_read_b128 a[252:255], v11 offset:24576
  buffer_load_dwordx4 v4, s[20:23], s69 offen offset:3072 lds
  v_exp_f32 v204, v204
  v_mfma_f32_32x32x16_bf16 v[160:175], a[228:231], v[228:231], v[160:175]
  ds_read_b128 a[224:227], v8 offset:28672
  v_exp_f32 v205, v205
  v_exp_f32 v206, v206
  v_add_f32 v14, v14, v194
  v_mfma_f32_32x32x16_bf16 v[160:175], a[232:235], v[232:235], v[160:175]
  ds_read_b128 a[228:231], v9 offset:28672
  v_exp_f32 v207, v207
  v_add_f32 v15, v15, v195
  v_cvt_pk_bf16_f32 v89, v194, v195
  v_add_f32 v14, v14, v196
  v_mfma_f32_32x32x16_bf16 v[160:175], a[236:239], v[236:239], v[160:175]
  ds_read_b128 a[232:235], v10 offset:28672
  v_add_f32 v15, v15, v197
  v_cvt_pk_bf16_f32 v90, v196, v197
  v_add_f32 v14, v14, v198
  v_add_f32 v15, v15, v199
  s_waitcnt lgkmcnt(3)
  v_mfma_f32_32x32x16_bf16 v[160:175], a[240:243], v[144:147], v[160:175]
  ds_read_b128 a[236:239], v11 offset:28672
  v_cvt_pk_bf16_f32 v91, v198, v199
  v_add_f32 v14, v14, v200
  v_add_f32 v15, v15, v201
  v_cvt_pk_bf16_f32 v92, v200, v201
  v_add_f32 v14, v14, v202
  v_mfma_f32_32x32x16_bf16 v[160:175], a[244:247], v[148:151], v[160:175]
  s_waitcnt vmcnt(17)
  s_barrier
  v_add_u32 v8, 0xfffe0000, v8
  ds_read_b128 a[240:243], v8 offset:0
  v_accvgpr_read_b32 v1, a120
  v_mfma_f32_32x32x16_bf16 v[160:175], a[248:251], v[152:155], v[160:175]
  v_add_u32 v9, 0xfffe0000, v9
  ds_read_b128 a[244:247], v9 offset:0
  v_accvgpr_read_b32 v2, a121
  v_accvgpr_read_b32 v3, a122
  v_accvgpr_read_b32 v4, a123
  s_add_u32 m0, s57, 98304
  v_mfma_f32_32x32x16_bf16 v[160:175], a[252:255], v[156:159], v[160:175]
  v_add_u32 v10, 0xfffe0000, v10
  ds_read_b128 a[248:251], v10 offset:0
  v_add_f32 v15, v15, v203
  v_cvt_pk_bf16_f32 v93, v202, v203
  v_add_f32 v14, v14, v204
  s_waitcnt lgkmcnt(3)
  v_mfma_f32_32x32x16_bf16 v[160:175], a[224:227], v[176:179], v[160:175]
  v_add_u32 v11, 0xfffe0000, v11
  ds_read_b128 a[252:255], v11 offset:0
  buffer_load_dwordx4 v1, s[24:27], 0 offen offset:0 lds
  v_add_f32 v15, v15, v205
  v_mfma_f32_32x32x16_bf16 v[160:175], a[228:231], v[180:183], v[160:175]
  ds_read_b128 a[224:227], v8 offset:4096
  v_cvt_pk_bf16_f32 v94, v204, v205
  v_add_f32 v14, v14, v206
  v_add_f32 v15, v15, v207
  v_cvt_pk_bf16_f32 v95, v206, v207
  v_mfma_f32_32x32x16_bf16 v[160:175], a[232:235], v[184:187], v[160:175]
  ds_read_b128 a[228:231], v9 offset:4096
  v_exp_f32 v128, v128
  v_exp_f32 v129, v129
  v_mfma_f32_32x32x16_bf16 v[160:175], a[236:239], v[188:191], v[160:175]
  ds_read_b128 a[232:235], v10 offset:4096
  v_exp_f32 v130, v130
  v_exp_f32 v131, v131
  s_waitcnt lgkmcnt(3)
  v_mfma_f32_32x32x16_bf16 v[192:207], a[240:243], v[208:211], v[240:255]
  ds_read_b128 a[236:239], v11 offset:4096
  buffer_load_dwordx4 v2, s[24:27], 0 offen offset:1024 lds
  v_exp_f32 v132, v132
  v_mfma_f32_32x32x16_bf16 v[192:207], a[244:247], v[212:215], v[192:207]
  ds_read_b128 a[240:243], v8 offset:8192
  v_exp_f32 v133, v133
  v_exp_f32 v134, v134
  v_add_f32 v14, v14, v128
  v_mfma_f32_32x32x16_bf16 v[192:207], a[248:251], v[216:219], v[192:207]
  ds_read_b128 a[244:247], v9 offset:8192
  v_exp_f32 v135, v135
  v_exp_f32 v136, v136
  v_add_f32 v15, v15, v129
  v_mfma_f32_32x32x16_bf16 v[192:207], a[252:255], v[220:223], v[192:207]
  ds_read_b128 a[248:251], v10 offset:8192
  v_exp_f32 v137, v137
  v_exp_f32 v138, v138
  s_waitcnt lgkmcnt(3)
  v_mfma_f32_32x32x16_bf16 v[192:207], a[224:227], v[224:227], v[192:207]
  ds_read_b128 a[252:255], v11 offset:8192
  buffer_load_dwordx4 v3, s[24:27], 0 offen offset:2048 lds
  v_exp_f32 v139, v139
  v_mfma_f32_32x32x16_bf16 v[192:207], a[228:231], v[228:231], v[192:207]
  ds_read_b128 a[224:227], v8 offset:12288
  v_exp_f32 v140, v140
  v_exp_f32 v141, v141
  v_cvt_pk_bf16_f32 v96, v128, v129
  v_mfma_f32_32x32x16_bf16 v[192:207], a[232:235], v[232:235], v[192:207]
  ds_read_b128 a[228:231], v9 offset:12288
  buffer_load_dwordx4 v4, s[24:27], 0 offen offset:3072 lds
  v_exp_f32 v142, v142
  v_mfma_f32_32x32x16_bf16 v[192:207], a[236:239], v[236:239], v[192:207]
  ds_read_b128 a[232:235], v10 offset:12288
  s_add_u32 m0, s57, 102400
  s_mov_b32 s65, 0x4000
  v_exp_f32 v143, v143
  s_waitcnt lgkmcnt(3)
  v_mfma_f32_32x32x16_bf16 v[192:207], a[240:243], v[144:147], v[192:207]
  ds_read_b128 a[236:239], v11 offset:12288
  v_add_f32 v14, v14, v130
  v_add_f32 v15, v15, v131
  v_cvt_pk_bf16_f32 v97, v130, v131
  v_add_f32 v14, v14, v132
  v_add_f32 v15, v15, v133
  v_mfma_f32_32x32x16_bf16 v[192:207], a[244:247], v[148:151], v[192:207]
  ds_read_b128 a[240:243], v8 offset:16384
  v_cvt_pk_bf16_f32 v98, v132, v133
  v_add_f32 v14, v14, v134
  v_add_f32 v15, v15, v135
  v_cvt_pk_bf16_f32 v99, v134, v135
  v_add_f32 v14, v14, v136
  v_mfma_f32_32x32x16_bf16 v[192:207], a[248:251], v[152:155], v[192:207]
  ds_read_b128 a[244:247], v9 offset:16384
  buffer_load_dwordx4 v1, s[24:27], s65 offen offset:0 lds
  v_add_f32 v15, v15, v137
  v_cvt_pk_bf16_f32 v100, v136, v137
  v_mfma_f32_32x32x16_bf16 v[192:207], a[252:255], v[156:159], v[192:207]
  ds_read_b128 a[248:251], v10 offset:16384
  v_add_f32 v14, v14, v138
  v_add_f32 v15, v15, v139
  v_cvt_pk_bf16_f32 v101, v138, v139
  v_add_f32 v14, v14, v140
  s_waitcnt lgkmcnt(3)
  v_mfma_f32_32x32x16_bf16 v[192:207], a[224:227], v[176:179], v[192:207]
  ds_read_b128 a[252:255], v11 offset:16384
  v_add_f32 v15, v15, v141
  v_cvt_pk_bf16_f32 v102, v140, v141
  v_add_f32 v14, v14, v142
  v_add_f32 v15, v15, v143
  v_cvt_pk_bf16_f32 v103, v142, v143
  v_mfma_f32_32x32x16_bf16 v[192:207], a[228:231], v[180:183], v[192:207]
  ds_read_b128 a[224:227], v8 offset:20480
  buffer_load_dwordx4 v2, s[24:27], s65 offen offset:1024 lds
  v_exp_f32 v160, v160
  v_mfma_f32_32x32x16_bf16 v[192:207], a[232:235], v[184:187], v[192:207]
  ds_read_b128 a[228:231], v9 offset:20480
  v_exp_f32 v161, v161
  v_exp_f32 v162, v162
  v_add_f32 v14, v14, v160
  v_mfma_f32_32x32x16_bf16 v[192:207], a[236:239], v[188:191], v[192:207]
  ds_read_b128 a[232:235], v10 offset:20480
  v_exp_f32 v163, v163
  v_exp_f32 v164, v164
  s_waitcnt lgkmcnt(3)
  v_mfma_f32_32x32x16_bf16 v[128:143], a[240:243], v[208:211], v[240:255]
  ds_read_b128 a[236:239], v11 offset:20480
  v_exp_f32 v165, v165
  v_exp_f32 v166, v166
  v_add_f32 v15, v15, v161
  v_mfma_f32_32x32x16_bf16 v[128:143], a[244:247], v[212:215], v[128:143]
  ds_read_b128 a[240:243], v8 offset:24576
  buffer_load_dwordx4 v3, s[24:27], s65 offen offset:2048 lds
  v_exp_f32 v167, v167
  v_mfma_f32_32x32x16_bf16 v[128:143], a[248:251], v[216:219], v[128:143]
  ds_read_b128 a[244:247], v9 offset:24576
  v_exp_f32 v168, v168
  v_exp_f32 v169, v169
  v_cvt_pk_bf16_f32 v104, v160, v161
  v_mfma_f32_32x32x16_bf16 v[128:143], a[252:255], v[220:223], v[128:143]
  ds_read_b128 a[248:251], v10 offset:24576
  v_exp_f32 v170, v170
  v_exp_f32 v171, v171
  s_waitcnt lgkmcnt(3)
  v_mfma_f32_32x32x16_bf16 v[128:143], a[224:227], v[224:227], v[128:143]
  ds_read_b128 a[252:255], v11 offset:24576
  buffer_load_dwordx4 v4, s[24:27], s65 offen offset:3072 lds
  v_accvgpr_read_b32 v5, a135
  v_add_f32 v14, v14, v162
  v_mfma_f32_32x32x16_bf16 v[128:143], a[228:231], v[228:231], v[128:143]
  ds_read_b128 a[224:227], v8 offset:28672
  buffer_load_dword a200, v5, s[96:99], 0 offen offset:0
  v_exp_f32 v172, v172
  v_mfma_f32_32x32x16_bf16 v[128:143], a[232:235], v[232:235], v[128:143]
  ds_read_b128 a[228:231], v9 offset:28672
  v_exp_f32 v173, v173
  v_exp_f32 v174, v174
  v_add_f32 v15, v15, v163
  v_mfma_f32_32x32x16_bf16 v[128:143], a[236:239], v[236:239], v[128:143]
  ds_read_b128 a[232:235], v10 offset:28672
  v_exp_f32 v175, v175
  v_cvt_pk_bf16_f32 v105, v162, v163
  v_add_f32 v14, v14, v164
  s_waitcnt lgkmcnt(3)
  v_mfma_f32_32x32x16_bf16 v[128:143], a[240:243], v[144:147], v[128:143]
  ds_read_b128 a[236:239], v11 offset:28672
  v_add_f32 v15, v15, v165
  v_cvt_pk_bf16_f32 v106, v164, v165
  v_add_f32 v14, v14, v166
  v_add_f32 v15, v15, v167
  v_cvt_pk_bf16_f32 v107, v166, v167
  v_mfma_f32_32x32x16_bf16 v[128:143], a[244:247], v[148:151], v[128:143]
  s_waitcnt vmcnt(18)
  s_barrier
  ds_read_b128 a[240:243], v8 offset:32768
  s_add_u32 m0, s57, 131072
  s_mov_b32 s62, 0x20000
  v_mfma_f32_32x32x16_bf16 v[128:143], a[248:251], v[152:155], v[128:143]
  ds_read_b128 a[244:247], v9 offset:32768
  v_add_f32 v14, v14, v168
  v_add_f32 v15, v15, v169
  v_cvt_pk_bf16_f32 v108, v168, v169
  v_add_f32 v14, v14, v170
  v_add_f32 v15, v15, v171
  v_mfma_f32_32x32x16_bf16 v[128:143], a[252:255], v[156:159], v[128:143]
  ds_read_b128 a[248:251], v10 offset:32768
  v_cvt_pk_bf16_f32 v109, v170, v171
  v_add_f32 v14, v14, v172
  v_add_f32 v15, v15, v173
  v_cvt_pk_bf16_f32 v110, v172, v173
  s_waitcnt lgkmcnt(3)
  v_mfma_f32_32x32x16_bf16 v[128:143], a[224:227], v[176:179], v[128:143]
  ds_read_b128 a[252:255], v11 offset:32768
  buffer_load_dwordx4 v1, s[24:27], s62 offen offset:0 lds
  v_add_f32 v14, v14, v174
  v_add_f32 v15, v15, v175
  v_mfma_f32_32x32x16_bf16 v[128:143], a[228:231], v[180:183], v[128:143]
  ds_read_b128 a[224:227], v8 offset:36864
  v_cvt_pk_bf16_f32 v111, v174, v175
  v_exp_f32 v192, v192
  v_exp_f32 v193, v193
  v_mfma_f32_32x32x16_bf16 v[128:143], a[232:235], v[184:187], v[128:143]
  ds_read_b128 a[228:231], v9 offset:36864
  buffer_load_dwordx4 v2, s[24:27], s62 offen offset:1024 lds
  v_exp_f32 v194, v194
  v_mfma_f32_32x32x16_bf16 v[128:143], a[236:239], v[188:191], v[128:143]
  ds_read_b128 a[232:235], v10 offset:36864
  v_exp_f32 v195, v195
  v_exp_f32 v196, v196
  s_waitcnt lgkmcnt(3)
  v_mfma_f32_32x32x16_bf16 v[160:175], a[240:243], v[208:211], v[240:255]
  ds_read_b128 a[236:239], v11 offset:36864
  v_exp_f32 v197, v197
  v_exp_f32 v198, v198
  v_add_f32 v14, v14, v192
  v_mfma_f32_32x32x16_bf16 v[160:175], a[244:247], v[212:215], v[160:175]
  ds_read_b128 a[240:243], v8 offset:40960
  v_exp_f32 v199, v199
  v_exp_f32 v200, v200
  v_add_f32 v15, v15, v193
  v_mfma_f32_32x32x16_bf16 v[160:175], a[248:251], v[216:219], v[160:175]
  ds_read_b128 a[244:247], v9 offset:40960
  buffer_load_dwordx4 v3, s[24:27], s62 offen offset:2048 lds
  v_exp_f32 v201, v201
  v_mfma_f32_32x32x16_bf16 v[160:175], a[252:255], v[220:223], v[160:175]
  ds_read_b128 a[248:251], v10 offset:40960
  v_exp_f32 v202, v202
  v_exp_f32 v203, v203
  s_waitcnt lgkmcnt(3)
  v_mfma_f32_32x32x16_bf16 v[160:175], a[224:227], v[224:227], v[160:175]
  ds_read_b128 a[252:255], v11 offset:40960
  v_exp_f32 v204, v204
  v_exp_f32 v205, v205
  v_cvt_pk_bf16_f32 v112, v192, v193
  v_mfma_f32_32x32x16_bf16 v[160:175], a[228:231], v[228:231], v[160:175]
  ds_read_b128 a[224:227], v8 offset:45056
  buffer_load_dwordx4 v4, s[24:27], s62 offen offset:3072 lds
  v_exp_f32 v206, v206
  v_mfma_f32_32x32x16_bf16 v[160:175], a[232:235], v[232:235], v[160:175]
  ds_read_b128 a[228:231], v9 offset:45056
  s_add_u32 m0, s57, 135168
  s_mov_b32 s69, 0x24000
  v_exp_f32 v207, v207
  v_add_f32 v14, v14, v194
  v_mfma_f32_32x32x16_bf16 v[160:175], a[236:239], v[236:239], v[160:175]
  ds_read_b128 a[232:235], v10 offset:45056
  v_add_f32 v15, v15, v195
  v_cvt_pk_bf16_f32 v113, v194, v195
  v_add_f32 v14, v14, v196
  v_add_f32 v15, v15, v197
  s_waitcnt lgkmcnt(3)
  v_mfma_f32_32x32x16_bf16 v[160:175], a[240:243], v[144:147], v[160:175]
  ds_read_b128 a[236:239], v11 offset:45056
  v_cvt_pk_bf16_f32 v114, v196, v197
  v_add_f32 v14, v14, v198
  v_add_f32 v15, v15, v199
  v_cvt_pk_bf16_f32 v115, v198, v199
  v_add_f32 v14, v14, v200
  v_mfma_f32_32x32x16_bf16 v[160:175], a[244:247], v[148:151], v[160:175]
  ds_read_b128 a[240:243], v8 offset:49152
  buffer_load_dwordx4 v1, s[24:27], s69 offen offset:0 lds
  v_add_f32 v15, v15, v201
  v_cvt_pk_bf16_f32 v116, v200, v201
  v_mfma_f32_32x32x16_bf16 v[160:175], a[248:251], v[152:155], v[160:175]
  ds_read_b128 a[244:247], v9 offset:49152
  v_add_f32 v14, v14, v202
  v_add_f32 v15, v15, v203
  v_cvt_pk_bf16_f32 v117, v202, v203
  v_add_f32 v14, v14, v204
  v_add_f32 v15, v15, v205
  v_mfma_f32_32x32x16_bf16 v[160:175], a[252:255], v[156:159], v[160:175]
  ds_read_b128 a[248:251], v10 offset:49152
  v_cvt_pk_bf16_f32 v118, v204, v205
  v_add_f32 v14, v14, v206
  v_add_f32 v15, v15, v207
  v_cvt_pk_bf16_f32 v119, v206, v207
  s_waitcnt lgkmcnt(3)
  v_mfma_f32_32x32x16_bf16 v[160:175], a[224:227], v[176:179], v[160:175]
  ds_read_b128 a[252:255], v11 offset:49152
  v_exp_f32 v128, v128
  v_exp_f32 v129, v129
  v_mfma_f32_32x32x16_bf16 v[160:175], a[228:231], v[180:183], v[160:175]
  ds_read_b128 a[224:227], v8 offset:53248
  buffer_load_dwordx4 v2, s[24:27], s69 offen offset:1024 lds
  v_exp_f32 v130, v130
  v_mfma_f32_32x32x16_bf16 v[160:175], a[232:235], v[184:187], v[160:175]
  ds_read_b128 a[228:231], v9 offset:53248
  v_exp_f32 v131, v131
  v_exp_f32 v132, v132
  v_add_f32 v14, v14, v128
  v_mfma_f32_32x32x16_bf16 v[160:175], a[236:239], v[188:191], v[160:175]
  ds_read_b128 a[232:235], v10 offset:53248
  v_exp_f32 v133, v133
  v_exp_f32 v134, v134
  s_waitcnt lgkmcnt(3)
  v_mfma_f32_32x32x16_bf16 v[192:207], a[240:243], v[208:211], v[240:255]
  ds_read_b128 a[236:239], v11 offset:53248
  buffer_load_dwordx4 v3, s[24:27], s69 offen offset:2048 lds
  v_exp_f32 v135, v135
  v_mfma_f32_32x32x16_bf16 v[192:207], a[244:247], v[212:215], v[192:207]
  ds_read_b128 a[240:243], v8 offset:57344
  v_exp_f32 v136, v136
  v_exp_f32 v137, v137
  v_add_f32 v15, v15, v129
  v_mfma_f32_32x32x16_bf16 v[192:207], a[248:251], v[216:219], v[192:207]
  ds_read_b128 a[244:247], v9 offset:57344
  v_exp_f32 v138, v138
  v_exp_f32 v139, v139
  v_cvt_pk_bf16_f32 v120, v128, v129
  v_mfma_f32_32x32x16_bf16 v[192:207], a[252:255], v[220:223], v[192:207]
  ds_read_b128 a[248:251], v10 offset:57344
  v_exp_f32 v140, v140
  v_exp_f32 v141, v141
  s_waitcnt lgkmcnt(3)
  v_mfma_f32_32x32x16_bf16 v[192:207], a[224:227], v[224:227], v[192:207]
  ds_read_b128 a[252:255], v11 offset:57344
  buffer_load_dwordx4 v4, s[24:27], s69 offen offset:3072 lds
  v_exp_f32 v142, v142
  v_mfma_f32_32x32x16_bf16 v[192:207], a[228:231], v[228:231], v[192:207]
  ds_read_b128 a[224:227], v8 offset:61440
  v_exp_f32 v143, v143
  v_exp_f32 v160, v160
  v_add_f32 v14, v14, v130
  v_mfma_f32_32x32x16_bf16 v[192:207], a[232:235], v[232:235], v[192:207]
  ds_read_b128 a[228:231], v9 offset:61440
  v_exp_f32 v161, v161
  v_exp_f32 v162, v162
  v_add_f32 v15, v15, v131
  v_mfma_f32_32x32x16_bf16 v[192:207], a[236:239], v[236:239], v[192:207]
  ds_read_b128 a[232:235], v10 offset:61440
  v_exp_f32 v163, v163
  v_exp_f32 v164, v164
  s_waitcnt lgkmcnt(3)
  v_mfma_f32_32x32x16_bf16 v[192:207], a[240:243], v[144:147], v[192:207]
  ds_read_b128 a[236:239], v11 offset:61440
  v_exp_f32 v165, v165
  v_exp_f32 v166, v166
  v_cvt_pk_bf16_f32 v121, v130, v131
  v_mfma_f32_32x32x16_bf16 v[192:207], a[244:247], v[148:151], v[192:207]
  s_waitcnt vmcnt(17)
  s_barrier
  v_add_u32 v8, 0x10000, v8
  ds_read_b128 a[240:243], v8 offset:0
  s_add_u32 m0, s57, 0
  v_mfma_f32_32x32x16_bf16 v[192:207], a[248:251], v[152:155], v[192:207]
  v_add_u32 v9, 0x10000, v9
  ds_read_b128 a[244:247], v9 offset:0
  s_mov_b32 s64, 0x80
  v_exp_f32 v167, v167
  v_add_f32 v14, v14, v132
  v_mfma_f32_32x32x16_bf16 v[192:207], a[252:255], v[156:159], v[192:207]
  v_add_u32 v10, 0x10000, v10
  ds_read_b128 a[248:251], v10 offset:0
  v_exp_f32 v168, v168
  v_add_f32 v15, v15, v133
  s_waitcnt lgkmcnt(3)
  v_mfma_f32_32x32x16_bf16 v[192:207], a[224:227], v[176:179], v[192:207]
  v_add_u32 v11, 0x10000, v11
  ds_read_b128 a[252:255], v11 offset:0
  buffer_load_dwordx4 v1, s[24:27], s64 offen offset:0 lds
  v_cvt_pk_bf16_f32 v122, v132, v133
  v_mfma_f32_32x32x16_bf16 v[192:207], a[228:231], v[180:183], v[192:207]
  ds_read_b128 a[224:227], v8 offset:4096
  v_exp_f32 v169, v169
  v_exp_f32 v170, v170
  v_add_f32 v14, v14, v134
  v_mfma_f32_32x32x16_bf16 v[192:207], a[232:235], v[184:187], v[192:207]
  ds_read_b128 a[228:231], v9 offset:4096
  buffer_load_dwordx4 v2, s[24:27], s64 offen offset:1024 lds
  v_exp_f32 v171, v171
  v_exp_f32 v172, v172
  v_exp_f32 v173, v173
  v_exp_f32 v174, v174
  v_exp_f32 v175, v175
  v_mfma_f32_32x32x16_bf16 v[192:207], a[236:239], v[188:191], v[192:207]
  ds_read_b128 a[232:235], v10 offset:4096
  v_add_f32 v15, v15, v135
  v_cvt_pk_bf16_f32 v123, v134, v135
  v_add_f32 v14, v14, v136
  v_add_f32 v15, v15, v137
  v_cvt_pk_bf16_f32 v124, v136, v137
  v_add_f32 v14, v14, v138
  v_add_f32 v15, v15, v139
  v_cvt_pk_bf16_f32 v125, v138, v139
  v_add_f32 v14, v14, v140
  v_add_f32 v15, v15, v141
  v_cvt_pk_bf16_f32 v126, v140, v141
  v_add_f32 v14, v14, v142
  v_add_f32 v15, v15, v143
  v_cvt_pk_bf16_f32 v127, v142, v143
  v_add_f32 v14, v14, v160
  v_add_f32 v15, v15, v161
  v_cvt_pk_bf16_f32 v128, v160, v161
  v_add_f32 v14, v14, v162
  v_add_f32 v15, v15, v163
  v_cvt_pk_bf16_f32 v129, v162, v163
  v_add_f32 v14, v14, v164
  v_add_f32 v15, v15, v165
  v_cvt_pk_bf16_f32 v130, v164, v165
  v_add_f32 v14, v14, v166
  v_add_f32 v15, v15, v167
  v_cvt_pk_bf16_f32 v131, v166, v167
  v_add_f32 v14, v14, v168
  v_add_f32 v15, v15, v169
  v_cvt_pk_bf16_f32 v132, v168, v169
  v_add_f32 v14, v14, v170
  v_add_f32 v15, v15, v171
  v_cvt_pk_bf16_f32 v133, v170, v171
  v_add_f32 v14, v14, v172
  v_add_f32 v15, v15, v173
  v_cvt_pk_bf16_f32 v134, v172, v173
  v_add_f32 v14, v14, v174
  v_add_f32 v15, v15, v175
  v_cvt_pk_bf16_f32 v135, v174, v175
  s_waitcnt lgkmcnt(3)
  v_mfma_f32_32x32x16_bf16 v[160:175], a[240:243], v[208:211], v[240:255]
  ds_read_b128 a[236:239], v11 offset:4096
  v_mfma_f32_32x32x16_bf16 v[160:175], a[244:247], v[212:215], v[160:175]
  ds_read_b128 a[240:243], v8 offset:8192
  v_exp_f32 v192, v192
  v_exp_f32 v193, v193
  v_mfma_f32_32x32x16_bf16 v[160:175], a[248:251], v[216:219], v[160:175]
  ds_read_b128 a[244:247], v9 offset:8192
  buffer_load_dwordx4 v3, s[24:27], s64 offen offset:2048 lds
  v_exp_f32 v194, v194
  v_mfma_f32_32x32x16_bf16 v[160:175], a[252:255], v[220:223], v[160:175]
  ds_read_b128 a[248:251], v10 offset:8192
  v_exp_f32 v195, v195
  v_exp_f32 v196, v196
  s_waitcnt lgkmcnt(3)
  v_mfma_f32_32x32x16_bf16 v[160:175], a[224:227], v[224:227], v[160:175]
  ds_read_b128 a[252:255], v11 offset:8192
  v_exp_f32 v197, v197
  v_exp_f32 v198, v198
  v_add_f32 v14, v14, v192
  v_mfma_f32_32x32x16_bf16 v[160:175], a[228:231], v[228:231], v[160:175]
  ds_read_b128 a[224:227], v8 offset:12288
  buffer_load_dwordx4 v4, s[24:27], s64 offen offset:3072 lds
  v_exp_f32 v199, v199
  v_mfma_f32_32x32x16_bf16 v[160:175], a[232:235], v[232:235], v[160:175]
  ds_read_b128 a[228:231], v9 offset:12288
  s_add_u32 m0, s57, 4096
  s_mov_b32 s65, 0x4080
  v_exp_f32 v200, v200
  v_add_f32 v15, v15, v193
  v_mfma_f32_32x32x16_bf16 v[160:175], a[236:239], v[236:239], v[160:175]
  ds_read_b128 a[232:235], v10 offset:12288
  v_exp_f32 v201, v201
  v_exp_f32 v202, v202
  s_waitcnt lgkmcnt(3)
  v_mfma_f32_32x32x16_bf16 v[160:175], a[240:243], v[144:147], v[160:175]
  ds_read_b128 a[236:239], v11 offset:12288
  v_exp_f32 v203, v203
  v_exp_f32 v204, v204
  v_cvt_pk_bf16_f32 v136, v192, v193
  v_mfma_f32_32x32x16_bf16 v[160:175], a[244:247], v[148:151], v[160:175]
  ds_read_b128 a[240:243], v8 offset:16384
  buffer_load_dwordx4 v1, s[24:27], s65 offen offset:0 lds
  v_exp_f32 v205, v205
  v_mfma_f32_32x32x16_bf16 v[160:175], a[248:251], v[152:155], v[160:175]
  ds_read_b128 a[244:247], v9 offset:16384
  v_exp_f32 v206, v206
  v_exp_f32 v207, v207
  v_add_f32 v14, v14, v194
  v_mfma_f32_32x32x16_bf16 v[160:175], a[252:255], v[156:159], v[160:175]
  ds_read_b128 a[248:251], v10 offset:16384
  v_add_f32 v15, v15, v195
  v_cvt_pk_bf16_f32 v137, v194, v195
  v_add_f32 v14, v14, v196
  v_add_f32 v15, v15, v197
  s_waitcnt lgkmcnt(3)
  v_mfma_f32_32x32x16_bf16 v[160:175], a[224:227], v[176:179], v[160:175]
  ds_read_b128 a[252:255], v11 offset:16384
  v_cvt_pk_bf16_f32 v138, v196, v197
  v_add_f32 v14, v14, v198
  v_add_f32 v15, v15, v199
  v_cvt_pk_bf16_f32 v139, v198, v199
  v_add_f32 v14, v14, v200
  v_mfma_f32_32x32x16_bf16 v[160:175], a[228:231], v[180:183], v[160:175]
  ds_read_b128 a[224:227], v8 offset:20480
  buffer_load_dwordx4 v2, s[24:27], s65 offen offset:1024 lds
  v_add_f32 v15, v15, v201
  v_cvt_pk_bf16_f32 v140, v200, v201
  v_mfma_f32_32x32x16_bf16 v[160:175], a[232:235], v[184:187], v[160:175]
  ds_read_b128 a[228:231], v9 offset:20480
  v_add_f32 v14, v14, v202
  v_add_f32 v15, v15, v203
  v_cvt_pk_bf16_f32 v141, v202, v203
  v_add_f32 v14, v14, v204
  v_add_f32 v15, v15, v205
  v_mfma_f32_32x32x16_bf16 v[160:175], a[236:239], v[188:191], v[160:175]
  ds_read_b128 a[232:235], v10 offset:20480
  v_cvt_pk_bf16_f32 v142, v204, v205
  v_add_f32 v14, v14, v206
  v_add_f32 v15, v15, v207
  v_cvt_pk_bf16_f32 v143, v206, v207
  s_waitcnt lgkmcnt(3)
  v_mfma_f32_32x32x16_bf16 v[192:207], a[240:243], v[208:211], v[240:255]
  ds_read_b128 a[236:239], v11 offset:20480
  buffer_load_dwordx4 v3, s[24:27], s65 offen offset:2048 lds
  v_mfma_f32_32x32x16_bf16 v[192:207], a[244:247], v[212:215], v[192:207]
  ds_read_b128 a[240:243], v8 offset:24576
  s_nop 0
  v_exp_f32 v160, v160
  v_exp_f32 v161, v161
  v_mfma_f32_32x32x16_bf16 v[192:207], a[248:251], v[216:219], v[192:207]
  ds_read_b128 a[244:247], v9 offset:24576
  v_exp_f32 v162, v162
  v_exp_f32 v163, v163
  v_add_f32 v14, v14, v160
  v_mfma_f32_32x32x16_bf16 v[192:207], a[252:255], v[220:223], v[192:207]
  ds_read_b128 a[248:251], v10 offset:24576
  v_exp_f32 v164, v164
  v_exp_f32 v165, v165
  s_waitcnt lgkmcnt(3)
  v_mfma_f32_32x32x16_bf16 v[192:207], a[224:227], v[224:227], v[192:207]
  ds_read_b128 a[252:255], v11 offset:24576
  buffer_load_dwordx4 v4, s[24:27], s65 offen offset:3072 lds
  v_exp_f32 v166, v166
  v_mfma_f32_32x32x16_bf16 v[192:207], a[228:231], v[228:231], v[192:207]
  ds_read_b128 a[224:227], v8 offset:28672
  v_exp_f32 v167, v167
  v_exp_f32 v168, v168
  v_add_f32 v15, v15, v161
  v_mfma_f32_32x32x16_bf16 v[192:207], a[232:235], v[232:235], v[192:207]
  ds_read_b128 a[228:231], v9 offset:28672
  v_exp_f32 v169, v169
  v_exp_f32 v170, v170
  v_cvt_pk_bf16_f32 v160, v160, v161
  v_mfma_f32_32x32x16_bf16 v[192:207], a[236:239], v[236:239], v[192:207]
  ds_read_b128 a[232:235], v10 offset:28672
  v_exp_f32 v171, v171
  v_exp_f32 v172, v172
  s_waitcnt lgkmcnt(3)
  v_mfma_f32_32x32x16_bf16 v[192:207], a[240:243], v[144:147], v[192:207]
  ds_read_b128 a[236:239], v11 offset:28672
  v_exp_f32 v173, v173
  v_exp_f32 v174, v174
  v_add_f32 v14, v14, v162
  v_mfma_f32_32x32x16_bf16 v[192:207], a[244:247], v[148:151], v[192:207]
  v_accvgpr_read_b32 v8, a130
  v_accvgpr_read_b32 v9, a131
  s_waitcnt vmcnt(17)
  s_barrier
  v_add_u32 v8, 0x10000, v8
  ds_read_b64_tr_b16 a[240:241], v8 offset:32768
  ds_read_b64_tr_b16 a[242:243], v8 offset:33792
  v_mfma_f32_32x32x16_bf16 v[192:207], a[248:251], v[152:155], v[192:207]
  v_add_u32 v9, 0x10000, v9
  ds_read_b64_tr_b16 a[244:245], v9 offset:32768
  ds_read_b64_tr_b16 a[246:247], v9 offset:33792
  s_add_u32 m0, s57, 32768
  s_mov_b32 s62, 0x20080
  v_add_f32 v15, v15, v163
  v_mfma_f32_32x32x16_bf16 v[192:207], a[252:255], v[156:159], v[192:207]
  ds_read_b64_tr_b16 a[248:249], v8 offset:34816
  ds_read_b64_tr_b16 a[250:251], v8 offset:35840
  v_exp_f32 v175, v175
  v_cvt_pk_bf16_f32 v161, v162, v163
  s_waitcnt lgkmcnt(6)
  v_mfma_f32_32x32x16_bf16 v[192:207], a[224:227], v[176:179], v[192:207]
  ds_read_b64_tr_b16 a[252:253], v9 offset:34816
  ds_read_b64_tr_b16 a[254:255], v9 offset:35840
  buffer_load_dwordx4 v1, s[24:27], s62 offen offset:0 lds
  v_add_f32 v14, v14, v164
  v_mfma_f32_32x32x16_bf16 v[192:207], a[228:231], v[180:183], v[192:207]
  ds_read_b64_tr_b16 a[224:225], v8 offset:36864
  ds_read_b64_tr_b16 a[226:227], v8 offset:37888
  v_add_f32 v15, v15, v165
  v_cvt_pk_bf16_f32 v162, v164, v165
  v_add_f32 v14, v14, v166
  v_add_f32 v15, v15, v167
  v_mfma_f32_32x32x16_bf16 v[192:207], a[232:235], v[184:187], v[192:207]
  ds_read_b64_tr_b16 a[228:229], v9 offset:36864
  ds_read_b64_tr_b16 a[230:231], v9 offset:37888
  buffer_load_dwordx4 v2, s[24:27], s62 offen offset:1024 lds
  v_cvt_pk_bf16_f32 v163, v166, v167
  v_mfma_f32_32x32x16_bf16 v[192:207], a[236:239], v[188:191], v[192:207]
  ds_read_b64_tr_b16 a[232:233], v8 offset:38912
  ds_read_b64_tr_b16 a[234:235], v8 offset:39936
  v_add_f32 v14, v14, v168
  v_add_f32 v15, v15, v169
  v_cvt_pk_bf16_f32 v164, v168, v169
  s_waitcnt lgkmcnt(6)
  v_mfma_f32_32x32x16_bf16 a[0:15], a[240:243], v[32:35], 0
  ds_read_b64_tr_b16 a[236:237], v9 offset:38912
  ds_read_b64_tr_b16 a[238:239], v9 offset:39936
  v_add_f32 v14, v14, v170
  v_add_f32 v15, v15, v171
  v_cvt_pk_bf16_f32 v165, v170, v171
  v_add_f32 v14, v14, v172
  v_mfma_f32_32x32x16_bf16 a[16:31], a[244:247], v[32:35], 0
  ds_read_b64_tr_b16 a[240:241], v8 offset:40960
  ds_read_b64_tr_b16 a[242:243], v8 offset:41984
  v_add_f32 v15, v15, v173
  v_cvt_pk_bf16_f32 v166, v172, v173
  v_add_f32 v14, v14, v174
  v_add_f32 v15, v15, v175
  v_mfma_f32_32x32x16_bf16 a[0:15], a[248:251], v[36:39], a[0:15]
  ds_read_b64_tr_b16 a[244:245], v9 offset:40960
  ds_read_b64_tr_b16 a[246:247], v9 offset:41984
  buffer_load_dwordx4 v3, s[24:27], s62 offen offset:2048 lds
  v_cvt_pk_bf16_f32 v167, v174, v175
  v_mfma_f32_32x32x16_bf16 a[16:31], a[252:255], v[36:39], a[16:31]
  ds_read_b64_tr_b16 a[248:249], v8 offset:43008
  ds_read_b64_tr_b16 a[250:251], v8 offset:44032
  v_exp_f32 v192, v192
  s_waitcnt lgkmcnt(6)
  v_mfma_f32_32x32x16_bf16 a[0:15], a[224:227], v[40:43], a[0:15]
  ds_read_b64_tr_b16 a[252:253], v9 offset:43008
  ds_read_b64_tr_b16 a[254:255], v9 offset:44032
  v_exp_f32 v193, v193
  v_exp_f32 v194, v194
  v_mfma_f32_32x32x16_bf16 a[16:31], a[228:231], v[40:43], a[16:31]
  ds_read_b64_tr_b16 a[224:225], v8 offset:45056
  ds_read_b64_tr_b16 a[226:227], v8 offset:46080
  buffer_load_dwordx4 v4, s[24:27], s62 offen offset:3072 lds
  v_add_f32 v14, v14, v192
  v_mfma_f32_32x32x16_bf16 a[0:15], a[232:235], v[44:47], a[0:15]
  ds_read_b64_tr_b16 a[228:229], v9 offset:45056
  ds_read_b64_tr_b16 a[230:231], v9 offset:46080
  s_add_u32 m0, s57, 36864
  s_mov_b32 s69, 0x24080
  v_exp_f32 v195, v195
  v_mfma_f32_32x32x16_bf16 a[16:31], a[236:239], v[44:47], a[16:31]
  ds_read_b64_tr_b16 a[232:233], v8 offset:47104
  ds_read_b64_tr_b16 a[234:235], v8 offset:48128
  v_exp_f32 v196, v196
  v_add_f32 v15, v15, v193
  s_waitcnt lgkmcnt(6)
  v_mfma_f32_32x32x16_bf16 a[0:15], a[240:243], v[48:51], a[0:15]
  ds_read_b64_tr_b16 a[236:237], v9 offset:47104
  ds_read_b64_tr_b16 a[238:239], v9 offset:48128
  v_exp_f32 v197, v197
  v_exp_f32 v198, v198
  v_mfma_f32_32x32x16_bf16 a[16:31], a[244:247], v[48:51], a[16:31]
  ds_read_b64_tr_b16 a[240:241], v8 offset:49152
  ds_read_b64_tr_b16 a[242:243], v8 offset:50176
  buffer_load_dwordx4 v1, s[24:27], s69 offen offset:0 lds
  v_cvt_pk_bf16_f32 v168, v192, v193
  v_mfma_f32_32x32x16_bf16 a[0:15], a[248:251], v[52:55], a[0:15]
  ds_read_b64_tr_b16 a[244:245], v9 offset:49152
  ds_read_b64_tr_b16 a[246:247], v9 offset:50176
  v_exp_f32 v199, v199
  v_exp_f32 v200, v200
  v_mfma_f32_32x32x16_bf16 a[16:31], a[252:255], v[52:55], a[16:31]
  ds_read_b64_tr_b16 a[248:249], v8 offset:51200
  ds_read_b64_tr_b16 a[250:251], v8 offset:52224
  v_exp_f32 v201, v201
  v_add_f32 v14, v14, v194
  s_waitcnt lgkmcnt(6)
  v_mfma_f32_32x32x16_bf16 a[0:15], a[224:227], v[56:59], a[0:15]
  ds_read_b64_tr_b16 a[252:253], v9 offset:51200
  ds_read_b64_tr_b16 a[254:255], v9 offset:52224
  v_exp_f32 v202, v202
  v_exp_f32 v203, v203
  v_mfma_f32_32x32x16_bf16 a[16:31], a[228:231], v[56:59], a[16:31]
  ds_read_b64_tr_b16 a[224:225], v8 offset:53248
  ds_read_b64_tr_b16 a[226:227], v8 offset:54272
  buffer_load_dwordx4 v2, s[24:27], s69 offen offset:1024 lds
  v_add_f32 v15, v15, v195
  v_mfma_f32_32x32x16_bf16 a[0:15], a[232:235], v[60:63], a[0:15]
  ds_read_b64_tr_b16 a[228:229], v9 offset:53248
  ds_read_b64_tr_b16 a[230:231], v9 offset:54272
  v_accvgpr_read_b32 v5, a135
  buffer_load_dword a200, v5, s[92:95], 0 offen offset:0
  v_mfma_f32_32x32x16_bf16 a[16:31], a[236:239], v[60:63], a[16:31]
  ds_read_b64_tr_b16 a[232:233], v8 offset:55296
  ds_read_b64_tr_b16 a[234:235], v8 offset:56320
  v_exp_f32 v204, v204
  v_cvt_pk_bf16_f32 v169, v194, v195
  s_waitcnt lgkmcnt(6)
  v_mfma_f32_32x32x16_bf16 a[0:15], a[240:243], v[64:67], a[0:15]
  ds_read_b64_tr_b16 a[236:237], v9 offset:55296
  ds_read_b64_tr_b16 a[238:239], v9 offset:56320
  buffer_load_dwordx4 v3, s[24:27], s69 offen offset:2048 lds
  v_add_f32 v14, v14, v196
  v_mfma_f32_32x32x16_bf16 a[16:31], a[244:247], v[64:67], a[16:31]
  ds_read_b64_tr_b16 a[240:241], v8 offset:57344
  ds_read_b64_tr_b16 a[242:243], v8 offset:58368
  v_exp_f32 v205, v205
  v_exp_f32 v206, v206
  v_mfma_f32_32x32x16_bf16 a[0:15], a[248:251], v[68:71], a[0:15]
  ds_read_b64_tr_b16 a[244:245], v9 offset:57344
  ds_read_b64_tr_b16 a[246:247], v9 offset:58368
  v_exp_f32 v207, v207
  v_add_f32 v15, v15, v197
  v_cvt_pk_bf16_f32 v170, v196, v197
  v_mfma_f32_32x32x16_bf16 a[16:31], a[252:255], v[68:71], a[16:31]
  ds_read_b64_tr_b16 a[248:249], v8 offset:59392
  ds_read_b64_tr_b16 a[250:251], v8 offset:60416
  v_add_f32 v14, v14, v198
  v_add_f32 v15, v15, v199
  v_cvt_pk_bf16_f32 v171, v198, v199
  s_waitcnt lgkmcnt(6)
  v_mfma_f32_32x32x16_bf16 a[0:15], a[224:227], v[72:75], a[0:15]
  ds_read_b64_tr_b16 a[252:253], v9 offset:59392
  ds_read_b64_tr_b16 a[254:255], v9 offset:60416
  buffer_load_dwordx4 v4, s[24:27], s69 offen offset:3072 lds
  v_add_f32 v14, v14, v200
  v_mfma_f32_32x32x16_bf16 a[16:31], a[228:231], v[72:75], a[16:31]
  ds_read_b64_tr_b16 a[224:225], v8 offset:61440
  ds_read_b64_tr_b16 a[226:227], v8 offset:62464
  v_add_f32 v15, v15, v201
  v_cvt_pk_bf16_f32 v172, v200, v201
  v_add_f32 v14, v14, v202
  v_add_f32 v15, v15, v203
  v_mfma_f32_32x32x16_bf16 a[0:15], a[232:235], v[76:79], a[0:15]
  ds_read_b64_tr_b16 a[228:229], v9 offset:61440
  ds_read_b64_tr_b16 a[230:231], v9 offset:62464
  v_cvt_pk_bf16_f32 v173, v202, v203
  v_add_f32 v14, v14, v204
  v_add_f32 v15, v15, v205
  v_cvt_pk_bf16_f32 v174, v204, v205
  v_mfma_f32_32x32x16_bf16 a[16:31], a[236:239], v[76:79], a[16:31]
  ds_read_b64_tr_b16 a[232:233], v8 offset:63488
  ds_read_b64_tr_b16 a[234:235], v8 offset:64512
  v_add_f32 v14, v14, v206
  v_add_f32 v15, v15, v207
  v_cvt_pk_bf16_f32 v175, v206, v207
  s_waitcnt lgkmcnt(6)
  v_mfma_f32_32x32x16_bf16 a[0:15], a[240:243], v[80:83], a[0:15]
  ds_read_b64_tr_b16 a[236:237], v9 offset:63488
  ds_read_b64_tr_b16 a[238:239], v9 offset:64512
  v_add_f32 v14, v14, v15
  v_mov_b32 v15, v14
  s_nop 1
  v_mfma_f32_32x32x16_bf16 a[16:31], a[244:247], v[80:83], a[16:31]
  s_waitcnt vmcnt(17)
  s_barrier
  v_add_u32 v8, 0x10000, v8
  ds_read_b64_tr_b16 a[240:241], v8 offset:0
  ds_read_b64_tr_b16 a[242:243], v8 offset:1024
  v_mfma_f32_32x32x16_bf16 a[0:15], a[248:251], v[84:87], a[0:15]
  v_add_u32 v9, 0x10000, v9
  ds_read_b64_tr_b16 a[244:245], v9 offset:0
  ds_read_b64_tr_b16 a[246:247], v9 offset:1024
  s_add_u32 m0, s57, 65536
  s_mov_b32 s64, 0x100
  v_permlane32_swap_b32 v14, v15
  v_mfma_f32_32x32x16_bf16 a[16:31], a[252:255], v[84:87], a[16:31]
  ds_read_b64_tr_b16 a[248:249], v8 offset:2048
  ds_read_b64_tr_b16 a[250:251], v8 offset:3072
  v_add_f32 v14, v14, v15
  v_rcp_f32 v25, v14
  s_waitcnt lgkmcnt(6)
  v_mfma_f32_32x32x16_bf16 a[0:15], a[224:227], v[88:91], a[0:15]
  ds_read_b64_tr_b16 a[252:253], v9 offset:2048
  ds_read_b64_tr_b16 a[254:255], v9 offset:3072
  buffer_load_dwordx4 v1, s[24:27], s64 offen offset:0 lds
  v_cmp_ngt_f32 vcc, 0x4e800000, v14
  v_mfma_f32_32x32x16_bf16 a[16:31], a[228:231], v[88:91], a[16:31]
  ds_read_b64_tr_b16 a[224:225], v8 offset:4096
  ds_read_b64_tr_b16 a[226:227], v8 offset:5120
  s_mov_b32 s8, s52
  s_mov_b32 s9, s53
  s_cmp_eq_u32 s56, 0
  s_cselect_b32 s10, 256, 0
  v_mfma_f32_32x32x16_bf16 a[0:15], a[232:235], v[92:95], a[0:15]
  ds_read_b64_tr_b16 a[228:229], v9 offset:4096
  ds_read_b64_tr_b16 a[230:231], v9 offset:5120
  buffer_load_dwordx4 v2, s[24:27], s64 offen offset:1024 lds
  v_mov_b32 v26, 1
  v_mfma_f32_32x32x16_bf16 a[16:31], a[236:239], v[92:95], a[16:31]
  ds_read_b64_tr_b16 a[232:233], v8 offset:6144
  ds_read_b64_tr_b16 a[234:235], v8 offset:7168
  v_lshl_add_u32 v27, v0, 8, s5
  s_waitcnt lgkmcnt(6)
  v_mfma_f32_32x32x16_bf16 a[0:15], a[240:243], v[96:99], a[0:15]
  ds_read_b64_tr_b16 a[236:237], v9 offset:6144
  ds_read_b64_tr_b16 a[238:239], v9 offset:7168
  buffer_store_byte v26, v27, s[8:11], 0 offen sc1
  v_mfma_f32_32x32x16_bf16 a[16:31], a[244:247], v[96:99], a[16:31]
  ds_read_b64_tr_b16 a[240:241], v8 offset:8192
  ds_read_b64_tr_b16 a[242:243], v8 offset:9216
  v_mfma_f32_32x32x16_bf16 a[0:15], a[248:251], v[100:103], a[0:15]
  ds_read_b64_tr_b16 a[244:245], v9 offset:8192
  ds_read_b64_tr_b16 a[246:247], v9 offset:9216
  buffer_load_dwordx4 v3, s[24:27], s64 offen offset:2048 lds
  v_mfma_f32_32x32x16_bf16 a[16:31], a[252:255], v[100:103], a[16:31]
  ds_read_b64_tr_b16 a[248:249], v8 offset:10240
  ds_read_b64_tr_b16 a[250:251], v8 offset:11264
  s_waitcnt lgkmcnt(6)
  v_mfma_f32_32x32x16_bf16 a[0:15], a[224:227], v[104:107], a[0:15]
  ds_read_b64_tr_b16 a[252:253], v9 offset:10240
  ds_read_b64_tr_b16 a[254:255], v9 offset:11264
  v_mfma_f32_32x32x16_bf16 a[16:31], a[228:231], v[104:107], a[16:31]
  ds_read_b64_tr_b16 a[224:225], v8 offset:12288
  ds_read_b64_tr_b16 a[226:227], v8 offset:13312
  buffer_load_dwordx4 v4, s[24:27], s64 offen offset:3072 lds
  v_mfma_f32_32x32x16_bf16 a[0:15], a[232:235], v[108:111], a[0:15]
  ds_read_b64_tr_b16 a[228:229], v9 offset:12288
  ds_read_b64_tr_b16 a[230:231], v9 offset:13312
  s_add_u32 m0, s57, 69632
  s_mov_b32 s65, 0x4100
  v_mfma_f32_32x32x16_bf16 a[16:31], a[236:239], v[108:111], a[16:31]
  ds_read_b64_tr_b16 a[232:233], v8 offset:14336
  ds_read_b64_tr_b16 a[234:235], v8 offset:15360
  s_waitcnt lgkmcnt(6)
  v_mfma_f32_32x32x16_bf16 a[0:15], a[240:243], v[112:115], a[0:15]
  ds_read_b64_tr_b16 a[236:237], v9 offset:14336
  ds_read_b64_tr_b16 a[238:239], v9 offset:15360
  v_mfma_f32_32x32x16_bf16 a[16:31], a[244:247], v[112:115], a[16:31]
  ds_read_b64_tr_b16 a[240:241], v8 offset:16384
  ds_read_b64_tr_b16 a[242:243], v8 offset:17408
  buffer_load_dwordx4 v1, s[24:27], s65 offen offset:0 lds
  v_mfma_f32_32x32x16_bf16 a[0:15], a[248:251], v[116:119], a[0:15]
  ds_read_b64_tr_b16 a[244:245], v9 offset:16384
  ds_read_b64_tr_b16 a[246:247], v9 offset:17408
  v_mfma_f32_32x32x16_bf16 a[16:31], a[252:255], v[116:119], a[16:31]
  ds_read_b64_tr_b16 a[248:249], v8 offset:18432
  ds_read_b64_tr_b16 a[250:251], v8 offset:19456
  s_waitcnt lgkmcnt(6)
  v_mfma_f32_32x32x16_bf16 a[0:15], a[224:227], v[120:123], a[0:15]
  ds_read_b64_tr_b16 a[252:253], v9 offset:18432
  ds_read_b64_tr_b16 a[254:255], v9 offset:19456
  v_mfma_f32_32x32x16_bf16 a[16:31], a[228:231], v[120:123], a[16:31]
  ds_read_b64_tr_b16 a[224:225], v8 offset:20480
  ds_read_b64_tr_b16 a[226:227], v8 offset:21504
  buffer_load_dwordx4 v2, s[24:27], s65 offen offset:1024 lds
  v_mfma_f32_32x32x16_bf16 a[0:15], a[232:235], v[124:127], a[0:15]
  ds_read_b64_tr_b16 a[228:229], v9 offset:20480
  ds_read_b64_tr_b16 a[230:231], v9 offset:21504
  v_mfma_f32_32x32x16_bf16 a[16:31], a[236:239], v[124:127], a[16:31]
  ds_read_b64_tr_b16 a[232:233], v8 offset:22528
  ds_read_b64_tr_b16 a[234:235], v8 offset:23552
  s_waitcnt lgkmcnt(6)
  v_mfma_f32_32x32x16_bf16 a[0:15], a[240:243], v[128:131], a[0:15]
  ds_read_b64_tr_b16 a[236:237], v9 offset:22528
  ds_read_b64_tr_b16 a[238:239], v9 offset:23552
  buffer_load_dwordx4 v3, s[24:27], s65 offen offset:2048 lds
  v_mfma_f32_32x32x16_bf16 a[16:31], a[244:247], v[128:131], a[16:31]
  ds_read_b64_tr_b16 a[240:241], v8 offset:24576
  ds_read_b64_tr_b16 a[242:243], v8 offset:25600
  v_mfma_f32_32x32x16_bf16 a[0:15], a[248:251], v[132:135], a[0:15]
  ds_read_b64_tr_b16 a[244:245], v9 offset:24576
  ds_read_b64_tr_b16 a[246:247], v9 offset:25600
  v_mfma_f32_32x32x16_bf16 a[16:31], a[252:255], v[132:135], a[16:31]
  ds_read_b64_tr_b16 a[248:249], v8 offset:26624
  ds_read_b64_tr_b16 a[250:251], v8 offset:27648
  s_waitcnt lgkmcnt(6)
  v_mfma_f32_32x32x16_bf16 a[0:15], a[224:227], v[136:139], a[0:15]
  ds_read_b64_tr_b16 a[252:253], v9 offset:26624
  ds_read_b64_tr_b16 a[254:255], v9 offset:27648
  buffer_load_dwordx4 v4, s[24:27], s65 offen offset:3072 lds
  v_mfma_f32_32x32x16_bf16 a[16:31], a[228:231], v[136:139], a[16:31]
  ds_read_b64_tr_b16 a[224:225], v8 offset:28672
  ds_read_b64_tr_b16 a[226:227], v8 offset:29696
  v_mfma_f32_32x32x16_bf16 a[0:15], a[232:235], v[140:143], a[0:15]
  ds_read_b64_tr_b16 a[228:229], v9 offset:28672
  ds_read_b64_tr_b16 a[230:231], v9 offset:29696
  v_mfma_f32_32x32x16_bf16 a[16:31], a[236:239], v[140:143], a[16:31]
  ds_read_b64_tr_b16 a[232:233], v8 offset:30720
  ds_read_b64_tr_b16 a[234:235], v8 offset:31744
  s_waitcnt lgkmcnt(6)
  v_mfma_f32_32x32x16_bf16 a[0:15], a[240:243], v[160:163], a[0:15]
  ds_read_b64_tr_b16 a[236:237], v9 offset:30720
  ds_read_b64_tr_b16 a[238:239], v9 offset:31744
  v_mfma_f32_32x32x16_bf16 a[16:31], a[244:247], v[160:163], a[16:31]
  s_waitcnt vmcnt(18)
  s_barrier
  v_add_u32 v8, 0xfffe0000, v8
  ds_read_b64_tr_b16 a[240:241], v8 offset:0
  ds_read_b64_tr_b16 a[242:243], v8 offset:1024
  v_mfma_f32_32x32x16_bf16 a[0:15], a[248:251], v[164:167], a[0:15]
  v_add_u32 v9, 0xfffe0000, v9
  ds_read_b64_tr_b16 a[244:245], v9 offset:0
  ds_read_b64_tr_b16 a[246:247], v9 offset:1024
  s_add_u32 m0, s57, 98304
  s_mov_b32 s62, 0x20100
  v_mfma_f32_32x32x16_bf16 a[16:31], a[252:255], v[164:167], a[16:31]
  ds_read_b64_tr_b16 a[248:249], v8 offset:2048
  ds_read_b64_tr_b16 a[250:251], v8 offset:3072
  s_waitcnt lgkmcnt(6)
  v_mfma_f32_32x32x16_bf16 a[0:15], a[224:227], v[168:171], a[0:15]
  ds_read_b64_tr_b16 a[252:253], v9 offset:2048
  ds_read_b64_tr_b16 a[254:255], v9 offset:3072
  buffer_load_dwordx4 v1, s[24:27], s62 offen offset:0 lds
  v_mfma_f32_32x32x16_bf16 a[16:31], a[228:231], v[168:171], a[16:31]
  ds_read_b64_tr_b16 a[224:225], v8 offset:4096
  ds_read_b64_tr_b16 a[226:227], v8 offset:5120
  v_mfma_f32_32x32x16_bf16 a[0:15], a[232:235], v[172:175], a[0:15]
  ds_read_b64_tr_b16 a[228:229], v9 offset:4096
  ds_read_b64_tr_b16 a[230:231], v9 offset:5120
  buffer_load_dwordx4 v2, s[24:27], s62 offen offset:1024 lds
  v_mfma_f32_32x32x16_bf16 a[16:31], a[236:239], v[172:175], a[16:31]
  ds_read_b64_tr_b16 a[232:233], v8 offset:6144
  ds_read_b64_tr_b16 a[234:235], v8 offset:7168
  s_waitcnt lgkmcnt(6)
  v_mfma_f32_32x32x16_bf16 a[32:47], a[240:243], v[32:35], 0
  ds_read_b64_tr_b16 a[236:237], v9 offset:6144
  ds_read_b64_tr_b16 a[238:239], v9 offset:7168
  v_accvgpr_read_b32 v5, a136
  buffer_load_dword a200, v5, s[92:95], 0 offen offset:0
  v_mfma_f32_32x32x16_bf16 a[48:63], a[244:247], v[32:35], 0
  ds_read_b64_tr_b16 a[240:241], v8 offset:8192
  ds_read_b64_tr_b16 a[242:243], v8 offset:9216
  v_accvgpr_read_b32 v28, a0
  v_accvgpr_read_b32 v29, a1
  v_mul_f32 v28, v28, v25
  v_mul_f32 v29, v29, v25
  v_mfma_f32_32x32x16_bf16 a[32:47], a[248:251], v[36:39], a[32:47]
  ds_read_b64_tr_b16 a[244:245], v9 offset:8192
  ds_read_b64_tr_b16 a[246:247], v9 offset:9216
  buffer_load_dwordx4 v3, s[24:27], s62 offen offset:2048 lds
  v_cvt_pk_bf16_f32 v16, v28, v29
  v_mfma_f32_32x32x16_bf16 a[48:63], a[252:255], v[36:39], a[48:63]
  ds_read_b64_tr_b16 a[248:249], v8 offset:10240
  ds_read_b64_tr_b16 a[250:251], v8 offset:11264
  v_accvgpr_read_b32 v26, a2
  v_accvgpr_read_b32 v27, a3
  v_mul_f32 v26, v26, v25
  s_waitcnt lgkmcnt(6)
  v_mfma_f32_32x32x16_bf16 a[32:47], a[224:227], v[40:43], a[32:47]
  ds_read_b64_tr_b16 a[252:253], v9 offset:10240
  ds_read_b64_tr_b16 a[254:255], v9 offset:11264
  v_mul_f32 v27, v27, v25
  v_cvt_pk_bf16_f32 v17, v26, v27
  v_accvgpr_read_b32 v28, a4
  v_accvgpr_read_b32 v29, a5
  v_mfma_f32_32x32x16_bf16 a[48:63], a[228:231], v[40:43], a[48:63]
  ds_read_b64_tr_b16 a[224:225], v8 offset:12288
  ds_read_b64_tr_b16 a[226:227], v8 offset:13312
  buffer_load_dwordx4 v4, s[24:27], s62 offen offset:3072 lds
  v_mul_f32 v28, v28, v25
  v_mfma_f32_32x32x16_bf16 a[32:47], a[232:235], v[44:47], a[32:47]
  ds_read_b64_tr_b16 a[228:229], v9 offset:12288
  ds_read_b64_tr_b16 a[230:231], v9 offset:13312
  s_add_u32 m0, s57, 102400
  s_mov_b32 s69, 0x24100
  v_mul_f32 v29, v29, v25
  v_cvt_pk_bf16_f32 v18, v28, v29
  v_mfma_f32_32x32x16_bf16 a[48:63], a[236:239], v[44:47], a[48:63]
  ds_read_b64_tr_b16 a[232:233], v8 offset:14336
  ds_read_b64_tr_b16 a[234:235], v8 offset:15360
  v_accvgpr_read_b32 v26, a6
  v_accvgpr_read_b32 v27, a7
  v_mul_f32 v26, v26, v25
  s_waitcnt lgkmcnt(6)
  v_mfma_f32_32x32x16_bf16 a[32:47], a[240:243], v[48:51], a[32:47]
  ds_read_b64_tr_b16 a[236:237], v9 offset:14336
  ds_read_b64_tr_b16 a[238:239], v9 offset:15360
  v_mul_f32 v27, v27, v25
  v_cvt_pk_bf16_f32 v19, v26, v27
  v_mfma_f32_32x32x16_bf16 a[48:63], a[244:247], v[48:51], a[48:63]
  ds_read_b64_tr_b16 a[240:241], v8 offset:16384
  ds_read_b64_tr_b16 a[242:243], v8 offset:17408
  buffer_load_dwordx4 v1, s[24:27], s69 offen offset:0 lds
  v_mfma_f32_32x32x16_bf16 a[32:47], a[248:251], v[52:55], a[32:47]
  ds_read_b64_tr_b16 a[244:245], v9 offset:16384
  ds_read_b64_tr_b16 a[246:247], v9 offset:17408
  buffer_store_dwordx4 v[16:19], v24, s[28:31], s70 offen offset:0 sc1
  v_accvgpr_read_b32 v28, a8
  v_mfma_f32_32x32x16_bf16 a[48:63], a[252:255], v[52:55], a[48:63]
  ds_read_b64_tr_b16 a[248:249], v8 offset:18432
  ds_read_b64_tr_b16 a[250:251], v8 offset:19456
  v_accvgpr_read_b32 v29, a9
  v_mul_f32 v28, v28, v25
  v_mul_f32 v29, v29, v25
  s_waitcnt lgkmcnt(6)
  v_mfma_f32_32x32x16_bf16 a[32:47], a[224:227], v[56:59], a[32:47]
  ds_read_b64_tr_b16 a[252:253], v9 offset:18432
  ds_read_b64_tr_b16 a[254:255], v9 offset:19456
  v_cvt_pk_bf16_f32 v20, v28, v29
  v_accvgpr_read_b32 v26, a10
  v_accvgpr_read_b32 v27, a11
  v_mul_f32 v26, v26, v25
  v_mfma_f32_32x32x16_bf16 a[48:63], a[228:231], v[56:59], a[48:63]
  ds_read_b64_tr_b16 a[224:225], v8 offset:20480
  ds_read_b64_tr_b16 a[226:227], v8 offset:21504
  buffer_load_dwordx4 v2, s[24:27], s69 offen offset:1024 lds
  v_mul_f32 v27, v27, v25
  v_mfma_f32_32x32x16_bf16 a[32:47], a[232:235], v[60:63], a[32:47]
  ds_read_b64_tr_b16 a[228:229], v9 offset:20480
  ds_read_b64_tr_b16 a[230:231], v9 offset:21504
  v_cvt_pk_bf16_f32 v21, v26, v27
  v_accvgpr_read_b32 v28, a12
  v_accvgpr_read_b32 v29, a13
  v_mul_f32 v28, v28, v25
  v_mfma_f32_32x32x16_bf16 a[48:63], a[236:239], v[60:63], a[48:63]
  ds_read_b64_tr_b16 a[232:233], v8 offset:22528
  ds_read_b64_tr_b16 a[234:235], v8 offset:23552
  v_mul_f32 v29, v29, v25
  v_cvt_pk_bf16_f32 v22, v28, v29
  v_accvgpr_read_b32 v26, a14
  s_waitcnt lgkmcnt(6)
  v_mfma_f32_32x32x16_bf16 a[32:47], a[240:243], v[64:67], a[32:47]
  ds_read_b64_tr_b16 a[236:237], v9 offset:22528
  ds_read_b64_tr_b16 a[238:239], v9 offset:23552
  buffer_load_dwordx4 v3, s[24:27], s69 offen offset:2048 lds
  v_accvgpr_read_b32 v27, a15
  v_mfma_f32_32x32x16_bf16 a[48:63], a[244:247], v[64:67], a[48:63]
  ds_read_b64_tr_b16 a[240:241], v8 offset:24576
  ds_read_b64_tr_b16 a[242:243], v8 offset:25600
  v_mul_f32 v26, v26, v25
  v_mul_f32 v27, v27, v25
  v_cvt_pk_bf16_f32 v23, v26, v27
  v_mfma_f32_32x32x16_bf16 a[32:47], a[248:251], v[68:71], a[32:47]
  ds_read_b64_tr_b16 a[244:245], v9 offset:24576
  ds_read_b64_tr_b16 a[246:247], v9 offset:25600
  buffer_store_dwordx4 v[20:23], v24, s[28:31], s70 offen offset:1024 sc1
  v_accvgpr_read_b32 v28, a16
  v_mfma_f32_32x32x16_bf16 a[48:63], a[252:255], v[68:71], a[48:63]
  ds_read_b64_tr_b16 a[248:249], v8 offset:26624
  ds_read_b64_tr_b16 a[250:251], v8 offset:27648
  v_accvgpr_read_b32 v29, a17
  v_mul_f32 v28, v28, v25
  v_mul_f32 v29, v29, v25
  s_waitcnt lgkmcnt(6)
  v_mfma_f32_32x32x16_bf16 a[32:47], a[224:227], v[72:75], a[32:47]
  ds_read_b64_tr_b16 a[252:253], v9 offset:26624
  ds_read_b64_tr_b16 a[254:255], v9 offset:27648
  buffer_load_dwordx4 v4, s[24:27], s69 offen offset:3072 lds
  v_cvt_pk_bf16_f32 v16, v28, v29
  v_mfma_f32_32x32x16_bf16 a[48:63], a[228:231], v[72:75], a[48:63]
  ds_read_b64_tr_b16 a[224:225], v8 offset:28672
  ds_read_b64_tr_b16 a[226:227], v8 offset:29696
  v_accvgpr_read_b32 v26, a18
  v_accvgpr_read_b32 v27, a19
  v_mul_f32 v26, v26, v25
  v_mul_f32 v27, v27, v25
  v_mfma_f32_32x32x16_bf16 a[32:47], a[232:235], v[76:79], a[32:47]
  ds_read_b64_tr_b16 a[228:229], v9 offset:28672
  ds_read_b64_tr_b16 a[230:231], v9 offset:29696
  v_cvt_pk_bf16_f32 v17, v26, v27
  v_accvgpr_read_b32 v28, a20
  v_accvgpr_read_b32 v29, a21
  v_mul_f32 v28, v28, v25
  v_mfma_f32_32x32x16_bf16 a[48:63], a[236:239], v[76:79], a[48:63]
  ds_read_b64_tr_b16 a[232:233], v8 offset:30720
  ds_read_b64_tr_b16 a[234:235], v8 offset:31744
  v_mul_f32 v29, v29, v25
  v_cvt_pk_bf16_f32 v18, v28, v29
  v_accvgpr_read_b32 v26, a22
  s_waitcnt lgkmcnt(6)
  v_mfma_f32_32x32x16_bf16 a[32:47], a[240:243], v[80:83], a[32:47]
  ds_read_b64_tr_b16 a[236:237], v9 offset:30720
  ds_read_b64_tr_b16 a[238:239], v9 offset:31744
  v_accvgpr_read_b32 v27, a23
  v_mul_f32 v26, v26, v25
  v_mul_f32 v27, v27, v25
  v_cvt_pk_bf16_f32 v19, v26, v27
  v_mfma_f32_32x32x16_bf16 a[48:63], a[244:247], v[80:83], a[48:63]
  s_waitcnt vmcnt(20)
  s_barrier
  ds_read_b64_tr_b16 a[240:241], v8 offset:32768
  ds_read_b64_tr_b16 a[242:243], v8 offset:33792
  s_add_u32 m0, s57, 131072
  v_mfma_f32_32x32x16_bf16 a[32:47], a[248:251], v[84:87], a[32:47]
  ds_read_b64_tr_b16 a[244:245], v9 offset:32768
  ds_read_b64_tr_b16 a[246:247], v9 offset:33792
  s_mov_b32 s64, 0x180
  buffer_store_dwordx4 v[16:19], v24, s[28:31], s70 offen offset:2048 sc1
  v_mfma_f32_32x32x16_bf16 a[48:63], a[252:255], v[84:87], a[48:63]
  ds_read_b64_tr_b16 a[248:249], v8 offset:34816
  ds_read_b64_tr_b16 a[250:251], v8 offset:35840
  v_accvgpr_read_b32 v28, a24
  v_accvgpr_read_b32 v29, a25
  v_mul_f32 v28, v28, v25
  s_waitcnt lgkmcnt(6)
  v_mfma_f32_32x32x16_bf16 a[32:47], a[224:227], v[88:91], a[32:47]
  ds_read_b64_tr_b16 a[252:253], v9 offset:34816
  ds_read_b64_tr_b16 a[254:255], v9 offset:35840
  buffer_load_dwordx4 v1, s[24:27], s64 offen offset:0 lds
  v_mul_f32 v29, v29, v25
  v_mfma_f32_32x32x16_bf16 a[48:63], a[228:231], v[88:91], a[48:63]
  ds_read_b64_tr_b16 a[224:225], v8 offset:36864
  ds_read_b64_tr_b16 a[226:227], v8 offset:37888
  v_cvt_pk_bf16_f32 v20, v28, v29
  v_accvgpr_read_b32 v26, a26
  v_accvgpr_read_b32 v27, a27
  v_mul_f32 v26, v26, v25
  v_mfma_f32_32x32x16_bf16 a[32:47], a[232:235], v[92:95], a[32:47]
  ds_read_b64_tr_b16 a[228:229], v9 offset:36864
  ds_read_b64_tr_b16 a[230:231], v9 offset:37888
  buffer_load_dwordx4 v2, s[24:27], s64 offen offset:1024 lds
  v_mul_f32 v27, v27, v25
  v_mfma_f32_32x32x16_bf16 a[48:63], a[236:239], v[92:95], a[48:63]
  ds_read_b64_tr_b16 a[232:233], v8 offset:38912
  ds_read_b64_tr_b16 a[234:235], v8 offset:39936
  v_cvt_pk_bf16_f32 v21, v26, v27
  v_accvgpr_read_b32 v28, a28
  v_accvgpr_read_b32 v29, a29
  s_waitcnt lgkmcnt(6)
  v_mfma_f32_32x32x16_bf16 a[32:47], a[240:243], v[96:99], a[32:47]
  ds_read_b64_tr_b16 a[236:237], v9 offset:38912
  ds_read_b64_tr_b16 a[238:239], v9 offset:39936
  v_mul_f32 v28, v28, v25
  v_mul_f32 v29, v29, v25
  v_cvt_pk_bf16_f32 v22, v28, v29
  v_accvgpr_read_b32 v26, a30
  v_mfma_f32_32x32x16_bf16 a[48:63], a[244:247], v[96:99], a[48:63]
  ds_read_b64_tr_b16 a[240:241], v8 offset:40960
  ds_read_b64_tr_b16 a[242:243], v8 offset:41984
  v_accvgpr_read_b32 v27, a31
  v_mul_f32 v26, v26, v25
  v_mul_f32 v27, v27, v25
  v_cvt_pk_bf16_f32 v23, v26, v27
  v_mfma_f32_32x32x16_bf16 a[32:47], a[248:251], v[100:103], a[32:47]
  ds_read_b64_tr_b16 a[244:245], v9 offset:40960
  ds_read_b64_tr_b16 a[246:247], v9 offset:41984
  buffer_load_dwordx4 v3, s[24:27], s64 offen offset:2048 lds
  v_mfma_f32_32x32x16_bf16 a[48:63], a[252:255], v[100:103], a[48:63]
  ds_read_b64_tr_b16 a[248:249], v8 offset:43008
  ds_read_b64_tr_b16 a[250:251], v8 offset:44032
  buffer_store_dwordx4 v[20:23], v24, s[28:31], s70 offen offset:3072 sc1
  s_waitcnt lgkmcnt(6)
  v_mfma_f32_32x32x16_bf16 a[32:47], a[224:227], v[104:107], a[32:47]
  ds_read_b64_tr_b16 a[252:253], v9 offset:43008
  ds_read_b64_tr_b16 a[254:255], v9 offset:44032
  v_mfma_f32_32x32x16_bf16 a[48:63], a[228:231], v[104:107], a[48:63]
  ds_read_b64_tr_b16 a[224:225], v8 offset:45056
  ds_read_b64_tr_b16 a[226:227], v8 offset:46080
  buffer_load_dwordx4 v4, s[24:27], s64 offen offset:3072 lds
  v_mfma_f32_32x32x16_bf16 a[32:47], a[232:235], v[108:111], a[32:47]
  ds_read_b64_tr_b16 a[228:229], v9 offset:45056
  ds_read_b64_tr_b16 a[230:231], v9 offset:46080
  s_add_u32 m0, s57, 135168
  s_mov_b32 s65, 0x4180
  v_mfma_f32_32x32x16_bf16 a[48:63], a[236:239], v[108:111], a[48:63]
  ds_read_b64_tr_b16 a[232:233], v8 offset:47104
  ds_read_b64_tr_b16 a[234:235], v8 offset:48128
  s_waitcnt lgkmcnt(6)
  v_mfma_f32_32x32x16_bf16 a[32:47], a[240:243], v[112:115], a[32:47]
  ds_read_b64_tr_b16 a[236:237], v9 offset:47104
  ds_read_b64_tr_b16 a[238:239], v9 offset:48128
  v_mfma_f32_32x32x16_bf16 a[48:63], a[244:247], v[112:115], a[48:63]
  ds_read_b64_tr_b16 a[240:241], v8 offset:49152
  ds_read_b64_tr_b16 a[242:243], v8 offset:50176
  buffer_load_dwordx4 v1, s[24:27], s65 offen offset:0 lds
  v_mfma_f32_32x32x16_bf16 a[32:47], a[248:251], v[116:119], a[32:47]
  ds_read_b64_tr_b16 a[244:245], v9 offset:49152
  ds_read_b64_tr_b16 a[246:247], v9 offset:50176
  v_mfma_f32_32x32x16_bf16 a[48:63], a[252:255], v[116:119], a[48:63]
  ds_read_b64_tr_b16 a[248:249], v8 offset:51200
  ds_read_b64_tr_b16 a[250:251], v8 offset:52224
  s_waitcnt lgkmcnt(6)
  v_mfma_f32_32x32x16_bf16 a[32:47], a[224:227], v[120:123], a[32:47]
  ds_read_b64_tr_b16 a[252:253], v9 offset:51200
  ds_read_b64_tr_b16 a[254:255], v9 offset:52224
  v_mfma_f32_32x32x16_bf16 a[48:63], a[228:231], v[120:123], a[48:63]
  ds_read_b64_tr_b16 a[224:225], v8 offset:53248
  ds_read_b64_tr_b16 a[226:227], v8 offset:54272
  buffer_load_dwordx4 v2, s[24:27], s65 offen offset:1024 lds
  v_mfma_f32_32x32x16_bf16 a[32:47], a[232:235], v[124:127], a[32:47]
  ds_read_b64_tr_b16 a[228:229], v9 offset:53248
  ds_read_b64_tr_b16 a[230:231], v9 offset:54272
  v_mfma_f32_32x32x16_bf16 a[48:63], a[236:239], v[124:127], a[48:63]
  ds_read_b64_tr_b16 a[232:233], v8 offset:55296
  ds_read_b64_tr_b16 a[234:235], v8 offset:56320
  s_waitcnt lgkmcnt(6)
  v_mfma_f32_32x32x16_bf16 a[32:47], a[240:243], v[128:131], a[32:47]
  ds_read_b64_tr_b16 a[236:237], v9 offset:55296
  ds_read_b64_tr_b16 a[238:239], v9 offset:56320
  buffer_load_dwordx4 v3, s[24:27], s65 offen offset:2048 lds
  v_mfma_f32_32x32x16_bf16 a[48:63], a[244:247], v[128:131], a[48:63]
  ds_read_b64_tr_b16 a[240:241], v8 offset:57344
  ds_read_b64_tr_b16 a[242:243], v8 offset:58368
  v_mfma_f32_32x32x16_bf16 a[32:47], a[248:251], v[132:135], a[32:47]
  ds_read_b64_tr_b16 a[244:245], v9 offset:57344
  ds_read_b64_tr_b16 a[246:247], v9 offset:58368
  v_mfma_f32_32x32x16_bf16 a[48:63], a[252:255], v[132:135], a[48:63]
  ds_read_b64_tr_b16 a[248:249], v8 offset:59392
  ds_read_b64_tr_b16 a[250:251], v8 offset:60416
  s_waitcnt lgkmcnt(6)
  v_mfma_f32_32x32x16_bf16 a[32:47], a[224:227], v[136:139], a[32:47]
  ds_read_b64_tr_b16 a[252:253], v9 offset:59392
  ds_read_b64_tr_b16 a[254:255], v9 offset:60416
  buffer_load_dwordx4 v4, s[24:27], s65 offen offset:3072 lds
  v_mfma_f32_32x32x16_bf16 a[48:63], a[228:231], v[136:139], a[48:63]
  ds_read_b64_tr_b16 a[224:225], v8 offset:61440
  ds_read_b64_tr_b16 a[226:227], v8 offset:62464
  v_mfma_f32_32x32x16_bf16 a[32:47], a[232:235], v[140:143], a[32:47]
  ds_read_b64_tr_b16 a[228:229], v9 offset:61440
  ds_read_b64_tr_b16 a[230:231], v9 offset:62464
  v_mfma_f32_32x32x16_bf16 a[48:63], a[236:239], v[140:143], a[48:63]
  ds_read_b64_tr_b16 a[232:233], v8 offset:63488
  ds_read_b64_tr_b16 a[234:235], v8 offset:64512
  s_waitcnt lgkmcnt(6)
  v_mfma_f32_32x32x16_bf16 a[32:47], a[240:243], v[160:163], a[32:47]
  ds_read_b64_tr_b16 a[236:237], v9 offset:63488
  ds_read_b64_tr_b16 a[238:239], v9 offset:64512
  v_mfma_f32_32x32x16_bf16 a[48:63], a[244:247], v[160:163], a[48:63]
  s_waitcnt vmcnt(21)
  s_barrier
  v_add_u32 v8, 0x10000, v8
  ds_read_b64_tr_b16 a[240:241], v8 offset:0
  ds_read_b64_tr_b16 a[242:243], v8 offset:1024
  v_mfma_f32_32x32x16_bf16 a[32:47], a[248:251], v[164:167], a[32:47]
  v_add_u32 v9, 0x10000, v9
  ds_read_b64_tr_b16 a[244:245], v9 offset:0
  ds_read_b64_tr_b16 a[246:247], v9 offset:1024
  s_add_u32 m0, s57, 0
  s_mov_b32 s62, 0x20180
  v_mfma_f32_32x32x16_bf16 a[48:63], a[252:255], v[164:167], a[48:63]
  ds_read_b64_tr_b16 a[248:249], v8 offset:2048
  ds_read_b64_tr_b16 a[250:251], v8 offset:3072
  s_waitcnt lgkmcnt(6)
  v_mfma_f32_32x32x16_bf16 a[32:47], a[224:227], v[168:171], a[32:47]
  ds_read_b64_tr_b16 a[252:253], v9 offset:2048
  ds_read_b64_tr_b16 a[254:255], v9 offset:3072
  buffer_load_dwordx4 v1, s[24:27], s62 offen offset:0 lds
  v_mfma_f32_32x32x16_bf16 a[48:63], a[228:231], v[168:171], a[48:63]
  ds_read_b64_tr_b16 a[224:225], v8 offset:4096
  ds_read_b64_tr_b16 a[226:227], v8 offset:5120
  v_mfma_f32_32x32x16_bf16 a[32:47], a[232:235], v[172:175], a[32:47]
  ds_read_b64_tr_b16 a[228:229], v9 offset:4096
  ds_read_b64_tr_b16 a[230:231], v9 offset:5120
  buffer_load_dwordx4 v2, s[24:27], s62 offen offset:1024 lds
  v_mfma_f32_32x32x16_bf16 a[48:63], a[236:239], v[172:175], a[48:63]
  ds_read_b64_tr_b16 a[232:233], v8 offset:6144
  ds_read_b64_tr_b16 a[234:235], v8 offset:7168
  s_waitcnt lgkmcnt(6)
  v_mfma_f32_32x32x16_bf16 a[0:15], a[240:243], v[32:35], 0
  ds_read_b64_tr_b16 a[236:237], v9 offset:6144
  ds_read_b64_tr_b16 a[238:239], v9 offset:7168
  s_nop 1
  v_accvgpr_read_b32 v28, a32
  v_accvgpr_read_b32 v29, a33
  v_mul_f32 v28, v28, v25
  v_mul_f32 v29, v29, v25
  v_mfma_f32_32x32x16_bf16 a[16:31], a[244:247], v[32:35], 0
  ds_read_b64_tr_b16 a[240:241], v8 offset:8192
  ds_read_b64_tr_b16 a[242:243], v8 offset:9216
  v_cvt_pk_bf16_f32 v16, v28, v29
  v_accvgpr_read_b32 v26, a34
  v_accvgpr_read_b32 v27, a35
  v_mul_f32 v26, v26, v25
  v_mfma_f32_32x32x16_bf16 a[0:15], a[248:251], v[36:39], a[0:15]
  ds_read_b64_tr_b16 a[244:245], v9 offset:8192
  ds_read_b64_tr_b16 a[246:247], v9 offset:9216
  buffer_load_dwordx4 v3, s[24:27], s62 offen offset:2048 lds
  v_mul_f32 v27, v27, v25
  v_mfma_f32_32x32x16_bf16 a[16:31], a[252:255], v[36:39], a[16:31]
  ds_read_b64_tr_b16 a[248:249], v8 offset:10240
  ds_read_b64_tr_b16 a[250:251], v8 offset:11264
  v_cvt_pk_bf16_f32 v17, v26, v27
  v_accvgpr_read_b32 v28, a36
  v_accvgpr_read_b32 v29, a37
  s_waitcnt lgkmcnt(6)
  v_mfma_f32_32x32x16_bf16 a[0:15], a[224:227], v[40:43], a[0:15]
  ds_read_b64_tr_b16 a[252:253], v9 offset:10240
  ds_read_b64_tr_b16 a[254:255], v9 offset:11264
  v_mul_f32 v28, v28, v25
  v_mul_f32 v29, v29, v25
  v_cvt_pk_bf16_f32 v18, v28, v29
  v_accvgpr_read_b32 v26, a38
  v_mfma_f32_32x32x16_bf16 a[16:31], a[228:231], v[40:43], a[16:31]
  ds_read_b64_tr_b16 a[224:225], v8 offset:12288
  ds_read_b64_tr_b16 a[226:227], v8 offset:13312
  buffer_load_dwordx4 v4, s[24:27], s62 offen offset:3072 lds
  v_accvgpr_read_b32 v27, a39
  v_mfma_f32_32x32x16_bf16 a[0:15], a[232:235], v[44:47], a[0:15]
  ds_read_b64_tr_b16 a[228:229], v9 offset:12288
  ds_read_b64_tr_b16 a[230:231], v9 offset:13312
  s_add_u32 m0, s57, 4096
  s_mov_b32 s69, 0x24180
  v_mul_f32 v26, v26, v25
  v_mul_f32 v27, v27, v25
  v_mfma_f32_32x32x16_bf16 a[16:31], a[236:239], v[44:47], a[16:31]
  ds_read_b64_tr_b16 a[232:233], v8 offset:14336
  ds_read_b64_tr_b16 a[234:235], v8 offset:15360
  v_cvt_pk_bf16_f32 v19, v26, v27
  s_add_u32 s70, s70, 4096
  s_waitcnt lgkmcnt(6)
  v_mfma_f32_32x32x16_bf16 a[0:15], a[240:243], v[48:51], a[0:15]
  ds_read_b64_tr_b16 a[236:237], v9 offset:14336
  ds_read_b64_tr_b16 a[238:239], v9 offset:15360
  buffer_store_dwordx4 v[16:19], v24, s[28:31], s70 offen offset:0 sc1
  v_accvgpr_read_b32 v28, a40
  v_mfma_f32_32x32x16_bf16 a[16:31], a[244:247], v[48:51], a[16:31]
  ds_read_b64_tr_b16 a[240:241], v8 offset:16384
  ds_read_b64_tr_b16 a[242:243], v8 offset:17408
  buffer_load_dwordx4 v1, s[24:27], s69 offen offset:0 lds
  v_accvgpr_read_b32 v29, a41
  v_mfma_f32_32x32x16_bf16 a[0:15], a[248:251], v[52:55], a[0:15]
  ds_read_b64_tr_b16 a[244:245], v9 offset:16384
  ds_read_b64_tr_b16 a[246:247], v9 offset:17408
  v_mul_f32 v28, v28, v25
  v_mul_f32 v29, v29, v25
  v_cvt_pk_bf16_f32 v20, v28, v29
  v_accvgpr_read_b32 v26, a42
  v_mfma_f32_32x32x16_bf16 a[16:31], a[252:255], v[52:55], a[16:31]
  ds_read_b64_tr_b16 a[248:249], v8 offset:18432
  ds_read_b64_tr_b16 a[250:251], v8 offset:19456
  v_accvgpr_read_b32 v27, a43
  v_mul_f32 v26, v26, v25
  v_mul_f32 v27, v27, v25
  s_waitcnt lgkmcnt(6)
  v_mfma_f32_32x32x16_bf16 a[0:15], a[224:227], v[56:59], a[0:15]
  ds_read_b64_tr_b16 a[252:253], v9 offset:18432
  ds_read_b64_tr_b16 a[254:255], v9 offset:19456
  v_cvt_pk_bf16_f32 v21, v26, v27
  v_accvgpr_read_b32 v28, a44
  v_accvgpr_read_b32 v29, a45
  v_mul_f32 v28, v28, v25
  v_mfma_f32_32x32x16_bf16 a[16:31], a[228:231], v[56:59], a[16:31]
  ds_read_b64_tr_b16 a[224:225], v8 offset:20480
  ds_read_b64_tr_b16 a[226:227], v8 offset:21504
  buffer_load_dwordx4 v2, s[24:27], s69 offen offset:1024 lds
  v_mul_f32 v29, v29, v25
  v_mfma_f32_32x32x16_bf16 a[0:15], a[232:235], v[60:63], a[0:15]
  ds_read_b64_tr_b16 a[228:229], v9 offset:20480
  ds_read_b64_tr_b16 a[230:231], v9 offset:21504
  v_cvt_pk_bf16_f32 v22, v28, v29
  v_accvgpr_read_b32 v26, a46
  v_accvgpr_read_b32 v27, a47
  v_mul_f32 v26, v26, v25
  v_mfma_f32_32x32x16_bf16 a[16:31], a[236:239], v[60:63], a[16:31]
  ds_read_b64_tr_b16 a[232:233], v8 offset:22528
  ds_read_b64_tr_b16 a[234:235], v8 offset:23552
  v_mul_f32 v27, v27, v25
  v_cvt_pk_bf16_f32 v23, v26, v27
  s_waitcnt lgkmcnt(6)
  v_mfma_f32_32x32x16_bf16 a[0:15], a[240:243], v[64:67], a[0:15]
  ds_read_b64_tr_b16 a[236:237], v9 offset:22528
  ds_read_b64_tr_b16 a[238:239], v9 offset:23552
  buffer_load_dwordx4 v3, s[24:27], s69 offen offset:2048 lds
  v_mfma_f32_32x32x16_bf16 a[16:31], a[244:247], v[64:67], a[16:31]
  ds_read_b64_tr_b16 a[240:241], v8 offset:24576
  ds_read_b64_tr_b16 a[242:243], v8 offset:25600
  buffer_store_dwordx4 v[20:23], v24, s[28:31], s70 offen offset:1024 sc1
  v_accvgpr_read_b32 v28, a48
  v_mfma_f32_32x32x16_bf16 a[0:15], a[248:251], v[68:71], a[0:15]
  ds_read_b64_tr_b16 a[244:245], v9 offset:24576
  ds_read_b64_tr_b16 a[246:247], v9 offset:25600
  v_accvgpr_read_b32 v29, a49
  v_mul_f32 v28, v28, v25
  v_mul_f32 v29, v29, v25
  v_cvt_pk_bf16_f32 v16, v28, v29
  v_mfma_f32_32x32x16_bf16 a[16:31], a[252:255], v[68:71], a[16:31]
  ds_read_b64_tr_b16 a[248:249], v8 offset:26624
  ds_read_b64_tr_b16 a[250:251], v8 offset:27648
  v_accvgpr_read_b32 v26, a50
  v_accvgpr_read_b32 v27, a51
  v_mul_f32 v26, v26, v25
  s_waitcnt lgkmcnt(6)
  v_mfma_f32_32x32x16_bf16 a[0:15], a[224:227], v[72:75], a[0:15]
  ds_read_b64_tr_b16 a[252:253], v9 offset:26624
  ds_read_b64_tr_b16 a[254:255], v9 offset:27648
  buffer_load_dwordx4 v4, s[24:27], s69 offen offset:3072 lds
  v_mul_f32 v27, v27, v25
  v_mfma_f32_32x32x16_bf16 a[16:31], a[228:231], v[72:75], a[16:31]
  ds_read_b64_tr_b16 a[224:225], v8 offset:28672
  ds_read_b64_tr_b16 a[226:227], v8 offset:29696
  v_cvt_pk_bf16_f32 v17, v26, v27
  v_accvgpr_read_b32 v28, a52
  v_accvgpr_read_b32 v29, a53
  v_mul_f32 v28, v28, v25
  v_mfma_f32_32x32x16_bf16 a[0:15], a[232:235], v[76:79], a[0:15]
  ds_read_b64_tr_b16 a[228:229], v9 offset:28672
  ds_read_b64_tr_b16 a[230:231], v9 offset:29696
  v_mul_f32 v29, v29, v25
  v_cvt_pk_bf16_f32 v18, v28, v29
  v_accvgpr_read_b32 v26, a54
  v_accvgpr_read_b32 v27, a55
  v_mfma_f32_32x32x16_bf16 a[16:31], a[236:239], v[76:79], a[16:31]
  ds_read_b64_tr_b16 a[232:233], v8 offset:30720
  ds_read_b64_tr_b16 a[234:235], v8 offset:31744
  v_mul_f32 v26, v26, v25
  v_mul_f32 v27, v27, v25
  v_cvt_pk_bf16_f32 v19, v26, v27
  s_waitcnt lgkmcnt(6)
  v_mfma_f32_32x32x16_bf16 a[0:15], a[240:243], v[80:83], a[0:15]
  ds_read_b64_tr_b16 a[236:237], v9 offset:30720
  ds_read_b64_tr_b16 a[238:239], v9 offset:31744
  buffer_store_dwordx4 v[16:19], v24, s[28:31], s70 offen offset:2048 sc1
  v_accvgpr_read_b32 v28, a56
  v_mfma_f32_32x32x16_bf16 a[16:31], a[244:247], v[80:83], a[16:31]
  s_waitcnt vmcnt(21)
  s_barrier
  ds_read_b64_tr_b16 a[240:241], v8 offset:32768
  ds_read_b64_tr_b16 a[242:243], v8 offset:33792
  v_accvgpr_read_b32 v29, a57
  v_mfma_f32_32x32x16_bf16 a[0:15], a[248:251], v[84:87], a[0:15]
  ds_read_b64_tr_b16 a[244:245], v9 offset:32768
  ds_read_b64_tr_b16 a[246:247], v9 offset:33792
  v_mul_f32 v28, v28, v25
  v_mul_f32 v29, v29, v25
  v_cvt_pk_bf16_f32 v20, v28, v29
  v_accvgpr_read_b32 v26, a58
  v_mfma_f32_32x32x16_bf16 a[16:31], a[252:255], v[84:87], a[16:31]
  ds_read_b64_tr_b16 a[248:249], v8 offset:34816
  ds_read_b64_tr_b16 a[250:251], v8 offset:35840
  v_accvgpr_read_b32 v27, a59
  v_mul_f32 v26, v26, v25
  v_mul_f32 v27, v27, v25
  s_waitcnt lgkmcnt(6)
  v_mfma_f32_32x32x16_bf16 a[0:15], a[224:227], v[88:91], a[0:15]
  ds_read_b64_tr_b16 a[252:253], v9 offset:34816
  ds_read_b64_tr_b16 a[254:255], v9 offset:35840
  v_cvt_pk_bf16_f32 v21, v26, v27
  v_accvgpr_read_b32 v28, a60
  v_accvgpr_read_b32 v29, a61
  v_mul_f32 v28, v28, v25
  v_mfma_f32_32x32x16_bf16 a[16:31], a[228:231], v[88:91], a[16:31]
  ds_read_b64_tr_b16 a[224:225], v8 offset:36864
  ds_read_b64_tr_b16 a[226:227], v8 offset:37888
  v_mul_f32 v29, v29, v25
  v_cvt_pk_bf16_f32 v22, v28, v29
  v_accvgpr_read_b32 v26, a62
  v_accvgpr_read_b32 v27, a63
  v_mfma_f32_32x32x16_bf16 a[0:15], a[232:235], v[92:95], a[0:15]
  ds_read_b64_tr_b16 a[228:229], v9 offset:36864
  ds_read_b64_tr_b16 a[230:231], v9 offset:37888
  v_mul_f32 v26, v26, v25
  v_mul_f32 v27, v27, v25
  v_cvt_pk_bf16_f32 v23, v26, v27
  v_mfma_f32_32x32x16_bf16 a[16:31], a[236:239], v[92:95], a[16:31]
  ds_read_b64_tr_b16 a[232:233], v8 offset:38912
  ds_read_b64_tr_b16 a[234:235], v8 offset:39936
  buffer_store_dwordx4 v[20:23], v24, s[28:31], s70 offen offset:3072 sc1
  s_waitcnt lgkmcnt(6)
  v_mfma_f32_32x32x16_bf16 a[0:15], a[240:243], v[96:99], a[0:15]
  ds_read_b64_tr_b16 a[236:237], v9 offset:38912
  ds_read_b64_tr_b16 a[238:239], v9 offset:39936
  v_mfma_f32_32x32x16_bf16 a[16:31], a[244:247], v[96:99], a[16:31]
  ds_read_b64_tr_b16 a[240:241], v8 offset:40960
  ds_read_b64_tr_b16 a[242:243], v8 offset:41984
  v_mfma_f32_32x32x16_bf16 a[0:15], a[248:251], v[100:103], a[0:15]
  ds_read_b64_tr_b16 a[244:245], v9 offset:40960
  ds_read_b64_tr_b16 a[246:247], v9 offset:41984
  v_mfma_f32_32x32x16_bf16 a[16:31], a[252:255], v[100:103], a[16:31]
  ds_read_b64_tr_b16 a[248:249], v8 offset:43008
  ds_read_b64_tr_b16 a[250:251], v8 offset:44032
  s_waitcnt lgkmcnt(6)
  v_mfma_f32_32x32x16_bf16 a[0:15], a[224:227], v[104:107], a[0:15]
  ds_read_b64_tr_b16 a[252:253], v9 offset:43008
  ds_read_b64_tr_b16 a[254:255], v9 offset:44032
  v_mfma_f32_32x32x16_bf16 a[16:31], a[228:231], v[104:107], a[16:31]
  ds_read_b64_tr_b16 a[224:225], v8 offset:45056
  ds_read_b64_tr_b16 a[226:227], v8 offset:46080
  v_mfma_f32_32x32x16_bf16 a[0:15], a[232:235], v[108:111], a[0:15]
  ds_read_b64_tr_b16 a[228:229], v9 offset:45056
  ds_read_b64_tr_b16 a[230:231], v9 offset:46080
  v_mfma_f32_32x32x16_bf16 a[16:31], a[236:239], v[108:111], a[16:31]
  ds_read_b64_tr_b16 a[232:233], v8 offset:47104
  ds_read_b64_tr_b16 a[234:235], v8 offset:48128
  s_waitcnt lgkmcnt(6)
  v_mfma_f32_32x32x16_bf16 a[0:15], a[240:243], v[112:115], a[0:15]
  ds_read_b64_tr_b16 a[236:237], v9 offset:47104
  ds_read_b64_tr_b16 a[238:239], v9 offset:48128
  v_mfma_f32_32x32x16_bf16 a[16:31], a[244:247], v[112:115], a[16:31]
  ds_read_b64_tr_b16 a[240:241], v8 offset:49152
  ds_read_b64_tr_b16 a[242:243], v8 offset:50176
  v_mfma_f32_32x32x16_bf16 a[0:15], a[248:251], v[116:119], a[0:15]
  ds_read_b64_tr_b16 a[244:245], v9 offset:49152
  ds_read_b64_tr_b16 a[246:247], v9 offset:50176
  v_mfma_f32_32x32x16_bf16 a[16:31], a[252:255], v[116:119], a[16:31]
  ds_read_b64_tr_b16 a[248:249], v8 offset:51200
  ds_read_b64_tr_b16 a[250:251], v8 offset:52224
  s_waitcnt lgkmcnt(6)
  v_mfma_f32_32x32x16_bf16 a[0:15], a[224:227], v[120:123], a[0:15]
  ds_read_b64_tr_b16 a[252:253], v9 offset:51200
  ds_read_b64_tr_b16 a[254:255], v9 offset:52224
  v_mfma_f32_32x32x16_bf16 a[16:31], a[228:231], v[120:123], a[16:31]
  ds_read_b64_tr_b16 a[224:225], v8 offset:53248
  ds_read_b64_tr_b16 a[226:227], v8 offset:54272
  v_mfma_f32_32x32x16_bf16 a[0:15], a[232:235], v[124:127], a[0:15]
  ds_read_b64_tr_b16 a[228:229], v9 offset:53248
  ds_read_b64_tr_b16 a[230:231], v9 offset:54272
  v_mfma_f32_32x32x16_bf16 a[16:31], a[236:239], v[124:127], a[16:31]
  ds_read_b64_tr_b16 a[232:233], v8 offset:55296
  ds_read_b64_tr_b16 a[234:235], v8 offset:56320
  s_waitcnt lgkmcnt(6)
  v_mfma_f32_32x32x16_bf16 a[0:15], a[240:243], v[128:131], a[0:15]
  ds_read_b64_tr_b16 a[236:237], v9 offset:55296
  ds_read_b64_tr_b16 a[238:239], v9 offset:56320
  v_mfma_f32_32x32x16_bf16 a[16:31], a[244:247], v[128:131], a[16:31]
  ds_read_b64_tr_b16 a[240:241], v8 offset:57344
  ds_read_b64_tr_b16 a[242:243], v8 offset:58368
  v_mfma_f32_32x32x16_bf16 a[0:15], a[248:251], v[132:135], a[0:15]
  ds_read_b64_tr_b16 a[244:245], v9 offset:57344
  ds_read_b64_tr_b16 a[246:247], v9 offset:58368
  v_mfma_f32_32x32x16_bf16 a[16:31], a[252:255], v[132:135], a[16:31]
  ds_read_b64_tr_b16 a[248:249], v8 offset:59392
  ds_read_b64_tr_b16 a[250:251], v8 offset:60416
  s_waitcnt lgkmcnt(6)
  v_mfma_f32_32x32x16_bf16 a[0:15], a[224:227], v[136:139], a[0:15]
  ds_read_b64_tr_b16 a[252:253], v9 offset:59392
  ds_read_b64_tr_b16 a[254:255], v9 offset:60416
  v_mfma_f32_32x32x16_bf16 a[16:31], a[228:231], v[136:139], a[16:31]
  ds_read_b64_tr_b16 a[224:225], v8 offset:61440
  ds_read_b64_tr_b16 a[226:227], v8 offset:62464
  v_mfma_f32_32x32x16_bf16 a[0:15], a[232:235], v[140:143], a[0:15]
  ds_read_b64_tr_b16 a[228:229], v9 offset:61440
  ds_read_b64_tr_b16 a[230:231], v9 offset:62464
  v_mfma_f32_32x32x16_bf16 a[16:31], a[236:239], v[140:143], a[16:31]
  ds_read_b64_tr_b16 a[232:233], v8 offset:63488
  ds_read_b64_tr_b16 a[234:235], v8 offset:64512
  s_waitcnt lgkmcnt(6)
  v_mfma_f32_32x32x16_bf16 a[0:15], a[240:243], v[160:163], a[0:15]
  ds_read_b64_tr_b16 a[236:237], v9 offset:63488
  ds_read_b64_tr_b16 a[238:239], v9 offset:64512
  v_mfma_f32_32x32x16_bf16 a[16:31], a[244:247], v[160:163], a[16:31]
  s_waitcnt vmcnt(12)
  s_barrier
  v_add_u32 v8, 0x10000, v8
  ds_read_b64_tr_b16 a[240:241], v8 offset:0
  ds_read_b64_tr_b16 a[242:243], v8 offset:1024
  v_mfma_f32_32x32x16_bf16 a[0:15], a[248:251], v[164:167], a[0:15]
  ds_read_b64_tr_b16 a[244:245], v8 offset:2048
  ds_read_b64_tr_b16 a[246:247], v8 offset:3072
  v_mfma_f32_32x32x16_bf16 a[16:31], a[252:255], v[164:167], a[16:31]
  ds_read_b64_tr_b16 a[248:249], v8 offset:4096
  ds_read_b64_tr_b16 a[250:251], v8 offset:5120
  s_waitcnt lgkmcnt(6)
  v_mfma_f32_32x32x16_bf16 a[0:15], a[224:227], v[168:171], a[0:15]
  ds_read_b64_tr_b16 a[252:253], v8 offset:6144
  ds_read_b64_tr_b16 a[254:255], v8 offset:7168
  v_mfma_f32_32x32x16_bf16 a[16:31], a[228:231], v[168:171], a[16:31]
  ds_read_b64_tr_b16 a[224:225], v8 offset:8192
  ds_read_b64_tr_b16 a[226:227], v8 offset:9216
  v_mfma_f32_32x32x16_bf16 a[0:15], a[232:235], v[172:175], a[0:15]
  ds_read_b64_tr_b16 a[228:229], v8 offset:10240
  ds_read_b64_tr_b16 a[230:231], v8 offset:11264
  v_mfma_f32_32x32x16_bf16 a[16:31], a[236:239], v[172:175], a[16:31]
  ds_read_b64_tr_b16 a[232:233], v8 offset:12288
  ds_read_b64_tr_b16 a[234:235], v8 offset:13312
  s_waitcnt lgkmcnt(6)
  v_mfma_f32_32x32x16_bf16 v[240:255], a[240:243], v[32:35], 0
  ds_read_b64_tr_b16 a[236:237], v8 offset:14336
  ds_read_b64_tr_b16 a[238:239], v8 offset:15360
  s_nop 2
  v_accvgpr_read_b32 v28, a0
  v_accvgpr_read_b32 v29, a1
  v_mul_f32 v28, v28, v25
  v_mul_f32 v29, v29, v25
  v_mfma_f32_32x32x16_bf16 v[240:255], a[244:247], v[36:39], v[240:255]
  ds_read_b64_tr_b16 a[240:241], v8 offset:16384
  ds_read_b64_tr_b16 a[242:243], v8 offset:17408
  v_cvt_pk_bf16_f32 v16, v28, v29
  v_accvgpr_read_b32 v26, a2
  v_accvgpr_read_b32 v27, a3
  v_mul_f32 v26, v26, v25
  v_mfma_f32_32x32x16_bf16 v[240:255], a[248:251], v[40:43], v[240:255]
  ds_read_b64_tr_b16 a[244:245], v8 offset:18432
  ds_read_b64_tr_b16 a[246:247], v8 offset:19456
  v_mul_f32 v27, v27, v25
  v_cvt_pk_bf16_f32 v17, v26, v27
  v_accvgpr_read_b32 v28, a4
  v_accvgpr_read_b32 v29, a5
  v_mfma_f32_32x32x16_bf16 v[240:255], a[252:255], v[44:47], v[240:255]
  ds_read_b64_tr_b16 a[248:249], v8 offset:20480
  ds_read_b64_tr_b16 a[250:251], v8 offset:21504
  v_mul_f32 v28, v28, v25
  v_mul_f32 v29, v29, v25
  v_cvt_pk_bf16_f32 v18, v28, v29
  s_waitcnt lgkmcnt(6)
  v_mfma_f32_32x32x16_bf16 v[240:255], a[224:227], v[48:51], v[240:255]
  ds_read_b64_tr_b16 a[252:253], v8 offset:22528
  ds_read_b64_tr_b16 a[254:255], v8 offset:23552
  v_accvgpr_read_b32 v26, a6
  v_accvgpr_read_b32 v27, a7
  v_mul_f32 v26, v26, v25
  v_mul_f32 v27, v27, v25
  v_mfma_f32_32x32x16_bf16 v[240:255], a[228:231], v[52:55], v[240:255]
  ds_read_b64_tr_b16 a[224:225], v8 offset:24576
  ds_read_b64_tr_b16 a[226:227], v8 offset:25600
  v_cvt_pk_bf16_f32 v19, v26, v27
  s_add_u32 s70, s70, 4096
  v_mfma_f32_32x32x16_bf16 v[240:255], a[232:235], v[56:59], v[240:255]
  ds_read_b64_tr_b16 a[228:229], v8 offset:26624
  ds_read_b64_tr_b16 a[230:231], v8 offset:27648
  buffer_store_dwordx4 v[16:19], v24, s[28:31], s70 offen offset:0 sc1
  v_accvgpr_read_b32 v28, a8
  v_mfma_f32_32x32x16_bf16 v[240:255], a[236:239], v[60:63], v[240:255]
  ds_read_b64_tr_b16 a[232:233], v8 offset:28672
  ds_read_b64_tr_b16 a[234:235], v8 offset:29696
  v_accvgpr_read_b32 v29, a9
  v_mul_f32 v28, v28, v25
  v_mul_f32 v29, v29, v25
  s_waitcnt lgkmcnt(6)
  v_mfma_f32_32x32x16_bf16 v[240:255], a[240:243], v[64:67], v[240:255]
  ds_read_b64_tr_b16 a[236:237], v8 offset:30720
  ds_read_b64_tr_b16 a[238:239], v8 offset:31744
  v_cvt_pk_bf16_f32 v20, v28, v29
  v_accvgpr_read_b32 v26, a10
  v_accvgpr_read_b32 v27, a11
  v_mul_f32 v26, v26, v25
  v_mfma_f32_32x32x16_bf16 v[240:255], a[244:247], v[68:71], v[240:255]
  s_waitcnt vmcnt(3)
  s_barrier
  v_add_u32 v8, 0xfffe0000, v8
  ds_read_b64_tr_b16 a[240:241], v8 offset:0
  ds_read_b64_tr_b16 a[242:243], v8 offset:1024
  v_mfma_f32_32x32x16_bf16 v[240:255], a[248:251], v[72:75], v[240:255]
  ds_read_b64_tr_b16 a[244:245], v8 offset:2048
  ds_read_b64_tr_b16 a[246:247], v8 offset:3072
  v_mul_f32 v27, v27, v25
  v_cvt_pk_bf16_f32 v21, v26, v27
  v_accvgpr_read_b32 v28, a12
  v_accvgpr_read_b32 v29, a13
  v_mfma_f32_32x32x16_bf16 v[240:255], a[252:255], v[76:79], v[240:255]
  ds_read_b64_tr_b16 a[248:249], v8 offset:4096
  ds_read_b64_tr_b16 a[250:251], v8 offset:5120
  v_mul_f32 v28, v28, v25
  v_mul_f32 v29, v29, v25
  v_cvt_pk_bf16_f32 v22, v28, v29
  s_waitcnt lgkmcnt(6)
  v_mfma_f32_32x32x16_bf16 v[240:255], a[224:227], v[80:83], v[240:255]
  ds_read_b64_tr_b16 a[252:253], v8 offset:6144
  ds_read_b64_tr_b16 a[254:255], v8 offset:7168
  v_accvgpr_read_b32 v26, a14
  v_accvgpr_read_b32 v27, a15
  v_mul_f32 v26, v26, v25
  v_mul_f32 v27, v27, v25
  v_mfma_f32_32x32x16_bf16 v[240:255], a[228:231], v[84:87], v[240:255]
  ds_read_b64_tr_b16 a[224:225], v8 offset:8192
  ds_read_b64_tr_b16 a[226:227], v8 offset:9216
  v_cvt_pk_bf16_f32 v23, v26, v27
  buffer_store_dwordx4 v[20:23], v24, s[28:31], s70 offen offset:1024 sc1
  v_mfma_f32_32x32x16_bf16 v[240:255], a[232:235], v[88:91], v[240:255]
  ds_read_b64_tr_b16 a[228:229], v8 offset:10240
  ds_read_b64_tr_b16 a[230:231], v8 offset:11264
  v_accvgpr_read_b32 v28, a16
  v_accvgpr_read_b32 v29, a17
  v_mul_f32 v28, v28, v25
  v_mul_f32 v29, v29, v25
  v_mfma_f32_32x32x16_bf16 v[240:255], a[236:239], v[92:95], v[240:255]
  ds_read_b64_tr_b16 a[232:233], v8 offset:12288
  ds_read_b64_tr_b16 a[234:235], v8 offset:13312
  v_cvt_pk_bf16_f32 v16, v28, v29
  v_accvgpr_read_b32 v26, a18
  v_accvgpr_read_b32 v27, a19
  s_waitcnt lgkmcnt(6)
  v_mfma_f32_32x32x16_bf16 v[240:255], a[240:243], v[96:99], v[240:255]
  ds_read_b64_tr_b16 a[236:237], v8 offset:14336
  ds_read_b64_tr_b16 a[238:239], v8 offset:15360
  v_mul_f32 v26, v26, v25
  v_mul_f32 v27, v27, v25
  v_cvt_pk_bf16_f32 v17, v26, v27
  v_accvgpr_read_b32 v28, a20
  v_mfma_f32_32x32x16_bf16 v[240:255], a[244:247], v[100:103], v[240:255]
  ds_read_b64_tr_b16 a[240:241], v8 offset:16384
  ds_read_b64_tr_b16 a[242:243], v8 offset:17408
  v_accvgpr_read_b32 v29, a21
  v_mul_f32 v28, v28, v25
  v_mul_f32 v29, v29, v25
  v_cvt_pk_bf16_f32 v18, v28, v29
  v_mfma_f32_32x32x16_bf16 v[240:255], a[248:251], v[104:107], v[240:255]
  ds_read_b64_tr_b16 a[244:245], v8 offset:18432
  ds_read_b64_tr_b16 a[246:247], v8 offset:19456
  v_accvgpr_read_b32 v26, a22
  v_accvgpr_read_b32 v27, a23
  v_mul_f32 v26, v26, v25
  v_mul_f32 v27, v27, v25
  v_mfma_f32_32x32x16_bf16 v[240:255], a[252:255], v[108:111], v[240:255]
  ds_read_b64_tr_b16 a[248:249], v8 offset:20480
  ds_read_b64_tr_b16 a[250:251], v8 offset:21504
  v_cvt_pk_bf16_f32 v19, v26, v27
  s_waitcnt lgkmcnt(6)
  v_mfma_f32_32x32x16_bf16 v[240:255], a[224:227], v[112:115], v[240:255]
  ds_read_b64_tr_b16 a[252:253], v8 offset:22528
  ds_read_b64_tr_b16 a[254:255], v8 offset:23552
  buffer_store_dwordx4 v[16:19], v24, s[28:31], s70 offen offset:2048 sc1
  v_accvgpr_read_b32 v28, a24
  v_mfma_f32_32x32x16_bf16 v[240:255], a[228:231], v[116:119], v[240:255]
  ds_read_b64_tr_b16 a[224:225], v8 offset:24576
  ds_read_b64_tr_b16 a[226:227], v8 offset:25600
  v_accvgpr_read_b32 v29, a25
  v_mul_f32 v28, v28, v25
  v_mul_f32 v29, v29, v25
  v_cvt_pk_bf16_f32 v20, v28, v29
  v_mfma_f32_32x32x16_bf16 v[240:255], a[232:235], v[120:123], v[240:255]
  ds_read_b64_tr_b16 a[228:229], v8 offset:26624
  ds_read_b64_tr_b16 a[230:231], v8 offset:27648
  v_accvgpr_read_b32 v26, a26
  v_accvgpr_read_b32 v27, a27
  v_mul_f32 v26, v26, v25
  v_mul_f32 v27, v27, v25
  v_mfma_f32_32x32x16_bf16 v[240:255], a[236:239], v[124:127], v[240:255]
  ds_read_b64_tr_b16 a[232:233], v8 offset:28672
  ds_read_b64_tr_b16 a[234:235], v8 offset:29696
  v_cvt_pk_bf16_f32 v21, v26, v27
  v_accvgpr_read_b32 v28, a28
  v_accvgpr_read_b32 v29, a29
  s_waitcnt lgkmcnt(6)
  v_mfma_f32_32x32x16_bf16 v[240:255], a[240:243], v[128:131], v[240:255]
  ds_read_b64_tr_b16 a[236:237], v8 offset:30720
  ds_read_b64_tr_b16 a[238:239], v8 offset:31744
  v_mul_f32 v28, v28, v25
  v_mul_f32 v29, v29, v25
  v_cvt_pk_bf16_f32 v22, v28, v29
  v_accvgpr_read_b32 v26, a30
  v_mfma_f32_32x32x16_bf16 v[240:255], a[244:247], v[132:135], v[240:255]
  v_add_u32 v9, 0x10000, v9
  ds_read_b64_tr_b16 a[240:241], v9 offset:0
  ds_read_b64_tr_b16 a[242:243], v9 offset:1024
  v_accvgpr_read_b32 v27, a31
  v_mul_f32 v26, v26, v25
  v_mul_f32 v27, v27, v25
  v_mfma_f32_32x32x16_bf16 v[240:255], a[248:251], v[136:139], v[240:255]
  ds_read_b64_tr_b16 a[244:245], v9 offset:2048
  ds_read_b64_tr_b16 a[246:247], v9 offset:3072
  v_cvt_pk_bf16_f32 v23, v26, v27
  buffer_store_dwordx4 v[20:23], v24, s[28:31], s70 offen offset:3072 sc1
  v_mfma_f32_32x32x16_bf16 v[240:255], a[252:255], v[140:143], v[240:255]
  ds_read_b64_tr_b16 a[248:249], v9 offset:4096
  ds_read_b64_tr_b16 a[250:251], v9 offset:5120
  s_waitcnt lgkmcnt(6)
  v_mfma_f32_32x32x16_bf16 v[240:255], a[224:227], v[160:163], v[240:255]
  ds_read_b64_tr_b16 a[252:253], v9 offset:6144
  ds_read_b64_tr_b16 a[254:255], v9 offset:7168
  s_lshr_b32 s4, s2, 3
  s_mul_i32 s4, s4, 9363
  s_lshr_b32 s4, s4, 16
  s_min_u32 s4, s4, 3
  v_mfma_f32_32x32x16_bf16 v[240:255], a[228:231], v[164:167], v[240:255]
  ds_read_b64_tr_b16 a[224:225], v9 offset:8192
  ds_read_b64_tr_b16 a[226:227], v9 offset:9216
  s_and_b32 s3, s2, 3
  s_lshl_b32 s3, s3, 2
  s_add_u32 s4, s4, s3
  s_lshl_b32 s4, s4, 4
  v_mfma_f32_32x32x16_bf16 v[240:255], a[232:235], v[168:171], v[240:255]
  ds_read_b64_tr_b16 a[228:229], v9 offset:10240
  ds_read_b64_tr_b16 a[230:231], v9 offset:11264
  v_and_b32 v27, 3, v0
  v_lshl_add_u32 v27, v27, 2, s4
  v_mfma_f32_32x32x16_bf16 v[240:255], a[236:239], v[172:175], v[240:255]
  ds_read_b64_tr_b16 a[232:233], v9 offset:12288
  ds_read_b64_tr_b16 a[234:235], v9 offset:13312
  buffer_load_dword a200, v27, s[8:11], 0 offen offset:0 sc1
  s_waitcnt lgkmcnt(6)
  v_mfma_f32_32x32x16_bf16 v[192:207], a[240:243], v[32:35], 0
  ds_read_b64_tr_b16 a[236:237], v9 offset:14336
  ds_read_b64_tr_b16 a[238:239], v9 offset:15360
  v_mfma_f32_32x32x16_bf16 v[192:207], a[244:247], v[36:39], v[192:207]
  ds_read_b64_tr_b16 a[240:241], v9 offset:16384
  ds_read_b64_tr_b16 a[242:243], v9 offset:17408
  s_nop 1
  v_mul_f32 v28, v240, v25
  v_mul_f32 v29, v241, v25
  v_cvt_pk_bf16_f32 v16, v28, v29
  v_mul_f32 v26, v242, v25
  v_mfma_f32_32x32x16_bf16 v[192:207], a[248:251], v[40:43], v[192:207]
  ds_read_b64_tr_b16 a[244:245], v9 offset:18432
  ds_read_b64_tr_b16 a[246:247], v9 offset:19456
  v_mul_f32 v27, v243, v25
  v_cvt_pk_bf16_f32 v17, v26, v27
  v_mul_f32 v28, v244, v25
  v_mul_f32 v29, v245, v25
  v_mfma_f32_32x32x16_bf16 v[192:207], a[252:255], v[44:47], v[192:207]
  ds_read_b64_tr_b16 a[248:249], v9 offset:20480
  ds_read_b64_tr_b16 a[250:251], v9 offset:21504
  v_cvt_pk_bf16_f32 v18, v28, v29
  v_mul_f32 v26, v246, v25
  v_mul_f32 v27, v247, v25
  s_waitcnt lgkmcnt(6)
  v_mfma_f32_32x32x16_bf16 v[192:207], a[224:227], v[48:51], v[192:207]
  ds_read_b64_tr_b16 a[252:253], v9 offset:22528
  ds_read_b64_tr_b16 a[254:255], v9 offset:23552
  v_cvt_pk_bf16_f32 v19, v26, v27
  s_add_u32 s70, s70, 4096
  v_mfma_f32_32x32x16_bf16 v[192:207], a[228:231], v[52:55], v[192:207]
  ds_read_b64_tr_b16 a[224:225], v9 offset:24576
  ds_read_b64_tr_b16 a[226:227], v9 offset:25600
  buffer_store_dwordx4 v[16:19], v24, s[28:31], s70 offen offset:0 sc1
  v_mul_f32 v28, v248, v25
  v_mfma_f32_32x32x16_bf16 v[192:207], a[232:235], v[56:59], v[192:207]
  ds_read_b64_tr_b16 a[228:229], v9 offset:26624
  ds_read_b64_tr_b16 a[230:231], v9 offset:27648
  v_mul_f32 v29, v249, v25
  v_cvt_pk_bf16_f32 v20, v28, v29
  v_mul_f32 v26, v250, v25
  v_mul_f32 v27, v251, v25
  v_mfma_f32_32x32x16_bf16 v[192:207], a[236:239], v[60:63], v[192:207]
  ds_read_b64_tr_b16 a[232:233], v9 offset:28672
  ds_read_b64_tr_b16 a[234:235], v9 offset:29696
  v_cvt_pk_bf16_f32 v21, v26, v27
  v_mul_f32 v28, v252, v25
  v_mul_f32 v29, v253, v25
  s_waitcnt lgkmcnt(6)
  v_mfma_f32_32x32x16_bf16 v[192:207], a[240:243], v[64:67], v[192:207]
  ds_read_b64_tr_b16 a[236:237], v9 offset:30720
  ds_read_b64_tr_b16 a[238:239], v9 offset:31744
  v_cvt_pk_bf16_f32 v22, v28, v29
  v_mul_f32 v26, v254, v25
  v_mul_f32 v27, v255, v25
  v_cvt_pk_bf16_f32 v23, v26, v27
  v_mfma_f32_32x32x16_bf16 v[192:207], a[244:247], v[68:71], v[192:207]
  v_add_u32 v9, 0xfffe0000, v9
  ds_read_b64_tr_b16 a[240:241], v9 offset:0
  ds_read_b64_tr_b16 a[242:243], v9 offset:1024
  buffer_store_dwordx4 v[20:23], v24, s[28:31], s70 offen offset:1024 sc1
  v_mfma_f32_32x32x16_bf16 v[192:207], a[248:251], v[72:75], v[192:207]
  ds_read_b64_tr_b16 a[244:245], v9 offset:2048
  ds_read_b64_tr_b16 a[246:247], v9 offset:3072
  v_mfma_f32_32x32x16_bf16 v[192:207], a[252:255], v[76:79], v[192:207]
  ds_read_b64_tr_b16 a[248:249], v9 offset:4096
  ds_read_b64_tr_b16 a[250:251], v9 offset:5120
  s_waitcnt lgkmcnt(6)
  v_mfma_f32_32x32x16_bf16 v[192:207], a[224:227], v[80:83], v[192:207]
  ds_read_b64_tr_b16 a[252:253], v9 offset:6144
  ds_read_b64_tr_b16 a[254:255], v9 offset:7168
  v_mfma_f32_32x32x16_bf16 v[192:207], a[228:231], v[84:87], v[192:207]
  ds_read_b64_tr_b16 a[224:225], v9 offset:8192
  ds_read_b64_tr_b16 a[226:227], v9 offset:9216
  v_mfma_f32_32x32x16_bf16 v[192:207], a[232:235], v[88:91], v[192:207]
  ds_read_b64_tr_b16 a[228:229], v9 offset:10240
  ds_read_b64_tr_b16 a[230:231], v9 offset:11264
  v_mfma_f32_32x32x16_bf16 v[192:207], a[236:239], v[92:95], v[192:207]
  ds_read_b64_tr_b16 a[232:233], v9 offset:12288
  ds_read_b64_tr_b16 a[234:235], v9 offset:13312
  s_waitcnt lgkmcnt(6)
  v_mfma_f32_32x32x16_bf16 v[192:207], a[240:243], v[96:99], v[192:207]
  ds_read_b64_tr_b16 a[236:237], v9 offset:14336
  ds_read_b64_tr_b16 a[238:239], v9 offset:15360
  v_mfma_f32_32x32x16_bf16 v[192:207], a[244:247], v[100:103], v[192:207]
  ds_read_b64_tr_b16 a[240:241], v9 offset:16384
  ds_read_b64_tr_b16 a[242:243], v9 offset:17408
  v_mfma_f32_32x32x16_bf16 v[192:207], a[248:251], v[104:107], v[192:207]
  ds_read_b64_tr_b16 a[244:245], v9 offset:18432
  ds_read_b64_tr_b16 a[246:247], v9 offset:19456
  v_mfma_f32_32x32x16_bf16 v[192:207], a[252:255], v[108:111], v[192:207]
  ds_read_b64_tr_b16 a[248:249], v9 offset:20480
  ds_read_b64_tr_b16 a[250:251], v9 offset:21504
  s_waitcnt lgkmcnt(6)
  v_mfma_f32_32x32x16_bf16 v[192:207], a[224:227], v[112:115], v[192:207]
  ds_read_b64_tr_b16 a[252:253], v9 offset:22528
  ds_read_b64_tr_b16 a[254:255], v9 offset:23552
  v_mfma_f32_32x32x16_bf16 v[192:207], a[228:231], v[116:119], v[192:207]
  ds_read_b64_tr_b16 a[224:225], v9 offset:24576
  ds_read_b64_tr_b16 a[226:227], v9 offset:25600
  v_mfma_f32_32x32x16_bf16 v[192:207], a[232:235], v[120:123], v[192:207]
  ds_read_b64_tr_b16 a[228:229], v9 offset:26624
  ds_read_b64_tr_b16 a[230:231], v9 offset:27648
  v_mfma_f32_32x32x16_bf16 v[192:207], a[236:239], v[124:127], v[192:207]
  ds_read_b64_tr_b16 a[232:233], v9 offset:28672
  ds_read_b64_tr_b16 a[234:235], v9 offset:29696
  s_waitcnt lgkmcnt(6)
  v_mfma_f32_32x32x16_bf16 v[192:207], a[240:243], v[128:131], v[192:207]
  ds_read_b64_tr_b16 a[236:237], v9 offset:30720
  ds_read_b64_tr_b16 a[238:239], v9 offset:31744
  v_mfma_f32_32x32x16_bf16 v[192:207], a[244:247], v[132:135], v[192:207]
  v_mfma_f32_32x32x16_bf16 v[192:207], a[248:251], v[136:139], v[192:207]
  v_mfma_f32_32x32x16_bf16 v[192:207], a[252:255], v[140:143], v[192:207]
  s_waitcnt lgkmcnt(0)
  v_mfma_f32_32x32x16_bf16 v[192:207], a[224:227], v[160:163], v[192:207]
  v_mfma_f32_32x32x16_bf16 v[192:207], a[228:231], v[164:167], v[192:207]
  v_mfma_f32_32x32x16_bf16 v[192:207], a[232:235], v[168:171], v[192:207]
  v_mfma_f32_32x32x16_bf16 v[192:207], a[236:239], v[172:175], v[192:207]
  s_nop 11
  v_mul_f32 v28, v192, v25
  v_mul_f32 v29, v193, v25
  v_cvt_pk_bf16_f32 v16, v28, v29
  v_mul_f32 v26, v194, v25
  v_mul_f32 v27, v195, v25
  v_cvt_pk_bf16_f32 v17, v26, v27
  v_mul_f32 v28, v196, v25
  v_mul_f32 v29, v197, v25
  v_cvt_pk_bf16_f32 v18, v28, v29
  v_mul_f32 v26, v198, v25
  v_mul_f32 v27, v199, v25
  v_cvt_pk_bf16_f32 v19, v26, v27
  buffer_store_dwordx4 v[16:19], v24, s[28:31], s70 offen offset:2048 sc1
  v_mul_f32 v28, v200, v25
  v_mul_f32 v29, v201, v25
  v_cvt_pk_bf16_f32 v20, v28, v29
  v_mul_f32 v26, v202, v25
  v_mul_f32 v27, v203, v25
  v_cvt_pk_bf16_f32 v21, v26, v27
  v_mul_f32 v28, v204, v25
  v_mul_f32 v29, v205, v25
  v_cvt_pk_bf16_f32 v22, v28, v29
  v_mul_f32 v26, v206, v25
  v_mul_f32 v27, v207, v25
  v_cvt_pk_bf16_f32 v23, v26, v27
  buffer_store_dwordx4 v[20:23], v24, s[28:31], s70 offen offset:3072 sc1
  s_waitcnt vmcnt(4)
  s_cbranch_vccz K1_FIN
  s_waitcnt vmcnt(0) lgkmcnt(0)
  s_nop 7
  s_nop 7
  v_and_b32 v1, 31, v0
  v_lshrrev_b32 v2, 5, v0
  v_lshlrev_b32 v3, 9, v1
  v_lshl_add_u32 v3, v2, 4, v3
  v_lshlrev_b32 v4, 11, v2
  v_lshl_add_u32 v4, v1, 1, v4
  v_add_u32 v5, 4096, v4
  v_mov_b32 v30, 0xff800000
  v_mov_b32 v14, 0
  v_accvgpr_write_b32 a0, 0
  v_accvgpr_write_b32 a1, 0
  v_accvgpr_write_b32 a2, 0
  v_accvgpr_write_b32 a3, 0
  v_accvgpr_write_b32 a4, 0
  v_accvgpr_write_b32 a5, 0
  v_accvgpr_write_b32 a6, 0
  v_accvgpr_write_b32 a7, 0
  v_accvgpr_write_b32 a8, 0
  v_accvgpr_write_b32 a9, 0
  v_accvgpr_write_b32 a10, 0
  v_accvgpr_write_b32 a11, 0
  v_accvgpr_write_b32 a12, 0
  v_accvgpr_write_b32 a13, 0
  v_accvgpr_write_b32 a14, 0
  v_accvgpr_write_b32 a15, 0
  v_accvgpr_write_b32 a16, 0
  v_accvgpr_write_b32 a17, 0
  v_accvgpr_write_b32 a18, 0
  v_accvgpr_write_b32 a19, 0
  v_accvgpr_write_b32 a20, 0
  v_accvgpr_write_b32 a21, 0
  v_accvgpr_write_b32 a22, 0
  v_accvgpr_write_b32 a23, 0
  v_accvgpr_write_b32 a24, 0
  v_accvgpr_write_b32 a25, 0
  v_accvgpr_write_b32 a26, 0
  v_accvgpr_write_b32 a27, 0
  v_accvgpr_write_b32 a28, 0
  v_accvgpr_write_b32 a29, 0
  v_accvgpr_write_b32 a30, 0
  v_accvgpr_write_b32 a31, 0
  v_accvgpr_write_b32 a32, 0
  v_accvgpr_write_b32 a33, 0
  v_accvgpr_write_b32 a34, 0
  v_accvgpr_write_b32 a35, 0
  v_accvgpr_write_b32 a36, 0
  v_accvgpr_write_b32 a37, 0
  v_accvgpr_write_b32 a38, 0
  v_accvgpr_write_b32 a39, 0
  v_accvgpr_write_b32 a40, 0
  v_accvgpr_write_b32 a41, 0
  v_accvgpr_write_b32 a42, 0
  v_accvgpr_write_b32 a43, 0
  v_accvgpr_write_b32 a44, 0
  v_accvgpr_write_b32 a45, 0
  v_accvgpr_write_b32 a46, 0
  v_accvgpr_write_b32 a47, 0
  v_accvgpr_write_b32 a48, 0
  v_accvgpr_write_b32 a49, 0
  v_accvgpr_write_b32 a50, 0
  v_accvgpr_write_b32 a51, 0
  v_accvgpr_write_b32 a52, 0
  v_accvgpr_write_b32 a53, 0
  v_accvgpr_write_b32 a54, 0
  v_accvgpr_write_b32 a55, 0
  v_accvgpr_write_b32 a56, 0
  v_accvgpr_write_b32 a57, 0
  v_accvgpr_write_b32 a58, 0
  v_accvgpr_write_b32 a59, 0
  v_accvgpr_write_b32 a60, 0
  v_accvgpr_write_b32 a61, 0
  v_accvgpr_write_b32 a62, 0
  v_accvgpr_write_b32 a63, 0
  v_accvgpr_write_b32 a64, 0
  v_accvgpr_write_b32 a65, 0
  v_accvgpr_write_b32 a66, 0
  v_accvgpr_write_b32 a67, 0
  v_accvgpr_write_b32 a68, 0
  v_accvgpr_write_b32 a69, 0
  v_accvgpr_write_b32 a70, 0
  v_accvgpr_write_b32 a71, 0
  v_accvgpr_write_b32 a72, 0
  v_accvgpr_write_b32 a73, 0
  v_accvgpr_write_b32 a74, 0
  v_accvgpr_write_b32 a75, 0
  v_accvgpr_write_b32 a76, 0
  v_accvgpr_write_b32 a77, 0
  v_accvgpr_write_b32 a78, 0
  v_accvgpr_write_b32 a79, 0
  v_accvgpr_write_b32 a80, 0
  v_accvgpr_write_b32 a81, 0
  v_accvgpr_write_b32 a82, 0
  v_accvgpr_write_b32 a83, 0
  v_accvgpr_write_b32 a84, 0
  v_accvgpr_write_b32 a85, 0
  v_accvgpr_write_b32 a86, 0
  v_accvgpr_write_b32 a87, 0
  v_accvgpr_write_b32 a88, 0
  v_accvgpr_write_b32 a89, 0
  v_accvgpr_write_b32 a90, 0
  v_accvgpr_write_b32 a91, 0
  v_accvgpr_write_b32 a92, 0
  v_accvgpr_write_b32 a93, 0
  v_accvgpr_write_b32 a94, 0
  v_accvgpr_write_b32 a95, 0
  v_accvgpr_write_b32 a96, 0
  v_accvgpr_write_b32 a97, 0
  v_accvgpr_write_b32 a98, 0
  v_accvgpr_write_b32 a99, 0
  v_accvgpr_write_b32 a100, 0
  v_accvgpr_write_b32 a101, 0
  v_accvgpr_write_b32 a102, 0
  v_accvgpr_write_b32 a103, 0
  v_accvgpr_write_b32 a104, 0
  v_accvgpr_write_b32 a105, 0
  v_accvgpr_write_b32 a106, 0
  v_accvgpr_write_b32 a107, 0
  v_accvgpr_write_b32 a108, 0
  v_accvgpr_write_b32 a109, 0
  v_accvgpr_write_b32 a110, 0
  v_accvgpr_write_b32 a111, 0
  v_accvgpr_write_b32 a112, 0
  v_accvgpr_write_b32 a113, 0
  v_accvgpr_write_b32 a114, 0
  v_accvgpr_write_b32 a115, 0
  v_accvgpr_write_b32 a116, 0
  v_accvgpr_write_b32 a117, 0
  v_accvgpr_write_b32 a118, 0
  v_accvgpr_write_b32 a119, 0
  v_accvgpr_write_b32 a120, 0
  v_accvgpr_write_b32 a121, 0
  v_accvgpr_write_b32 a122, 0
  v_accvgpr_write_b32 a123, 0
  v_accvgpr_write_b32 a124, 0
  v_accvgpr_write_b32 a125, 0
  v_accvgpr_write_b32 a126, 0
  v_accvgpr_write_b32 a127, 0
  s_mov_b32 s62, 0
K1_SL1:
  s_nop 7
  buffer_load_dwordx4 v[32:35], v3, s[20:23], s62 offen offset:0
  buffer_load_dwordx4 v[36:39], v3, s[20:23], s62 offen offset:32
  buffer_load_dwordx4 v[40:43], v3, s[20:23], s62 offen offset:64
  buffer_load_dwordx4 v[44:47], v3, s[20:23], s62 offen offset:96
  buffer_load_dwordx4 v[48:51], v3, s[20:23], s62 offen offset:128
  buffer_load_dwordx4 v[52:55], v3, s[20:23], s62 offen offset:160
  buffer_load_dwordx4 v[56:59], v3, s[20:23], s62 offen offset:192
  buffer_load_dwordx4 v[60:63], v3, s[20:23], s62 offen offset:224
  buffer_load_dwordx4 v[64:67], v3, s[20:23], s62 offen offset:256
  buffer_load_dwordx4 v[68:71], v3, s[20:23], s62 offen offset:288
  buffer_load_dwordx4 v[72:75], v3, s[20:23], s62 offen offset:320
  buffer_load_dwordx4 v[76:79], v3, s[20:23], s62 offen offset:352
  buffer_load_dwordx4 v[80:83], v3, s[20:23], s62 offen offset:384
  buffer_load_dwordx4 v[84:87], v3, s[20:23], s62 offen offset:416
  buffer_load_dwordx4 v[88:91], v3, s[20:23], s62 offen offset:448
  buffer_load_dwordx4 v[92:95], v3, s[20:23], s62 offen offset:480
  s_waitcnt vmcnt(0)
  v_mfma_f32_32x32x16_bf16 v[96:111], v[32:35], v[208:211], 0
  v_mfma_f32_32x32x16_bf16 v[96:111], v[36:39], v[212:215], v[96:111]
  v_mfma_f32_32x32x16_bf16 v[96:111], v[40:43], v[216:219], v[96:111]
  v_mfma_f32_32x32x16_bf16 v[96:111], v[44:47], v[220:223], v[96:111]
  v_mfma_f32_32x32x16_bf16 v[96:111], v[48:51], v[224:227], v[96:111]
  v_mfma_f32_32x32x16_bf16 v[96:111], v[52:55], v[228:231], v[96:111]
  v_mfma_f32_32x32x16_bf16 v[96:111], v[56:59], v[232:235], v[96:111]
  v_mfma_f32_32x32x16_bf16 v[96:111], v[60:63], v[236:239], v[96:111]
  v_mfma_f32_32x32x16_bf16 v[96:111], v[64:67], v[144:147], v[96:111]
  v_mfma_f32_32x32x16_bf16 v[96:111], v[68:71], v[148:151], v[96:111]
  v_mfma_f32_32x32x16_bf16 v[96:111], v[72:75], v[152:155], v[96:111]
  v_mfma_f32_32x32x16_bf16 v[96:111], v[76:79], v[156:159], v[96:111]
  v_mfma_f32_32x32x16_bf16 v[96:111], v[80:83], v[176:179], v[96:111]
  v_mfma_f32_32x32x16_bf16 v[96:111], v[84:87], v[180:183], v[96:111]
  v_mfma_f32_32x32x16_bf16 v[96:111], v[88:91], v[184:187], v[96:111]
  v_mfma_f32_32x32x16_bf16 v[96:111], v[92:95], v[188:191], v[96:111]
  s_nop 7
  s_nop 7
  v_max3_f32 v30, v30, v96, v97
  v_max3_f32 v30, v30, v98, v99
  v_max3_f32 v30, v30, v100, v101
  v_max3_f32 v30, v30, v102, v103
  v_max3_f32 v30, v30, v104, v105
  v_max3_f32 v30, v30, v106, v107
  v_max3_f32 v30, v30, v108, v109
  v_max3_f32 v30, v30, v110, v111
  s_add_u32 s62, s62, 16384
  s_cmp_lt_u32 s62, 0x40000
  s_cbranch_scc1 K1_SL1
  v_mov_b32 v31, v30
  s_nop 1
  v_permlane32_swap_b32 v30, v31
  v_max_f32 v30, v30, v31
  s_mov_b32 s62, 0
K1_SL2:
  s_nop 7
  buffer_load_dwordx4 v[32:35], v3, s[20:23], s62 offen offset:0
  buffer_load_dwordx4 v[36:39], v3, s[20:23], s62 offen offset:32
  buffer_load_dwordx4 v[40:43], v3, s[20:23], s62 offen offset:64
  buffer_load_dwordx4 v[44:47], v3, s[20:23], s62 offen offset:96
  buffer_load_dwordx4 v[48:51], v3, s[20:23], s62 offen offset:128
  buffer_load_dwordx4 v[52:55], v3, s[20:23], s62 offen offset:160
  buffer_load_dwordx4 v[56:59], v3, s[20:23], s62 offen offset:192
  buffer_load_dwordx4 v[60:63], v3, s[20:23], s62 offen offset:224
  buffer_load_dwordx4 v[64:67], v3, s[20:23], s62 offen offset:256
  buffer_load_dwordx4 v[68:71], v3, s[20:23], s62 offen offset:288
  buffer_load_dwordx4 v[72:75], v3, s[20:23], s62 offen offset:320
  buffer_load_dwordx4 v[76:79], v3, s[20:23], s62 offen offset:352
  buffer_load_dwordx4 v[80:83], v3, s[20:23], s62 offen offset:384
  buffer_load_dwordx4 v[84:87], v3, s[20:23], s62 offen offset:416
  buffer_load_dwordx4 v[88:91], v3, s[20:23], s62 offen offset:448
  buffer_load_dwordx4 v[92:95], v3, s[20:23], s62 offen offset:480
  s_waitcnt vmcnt(0)
  v_mfma_f32_32x32x16_bf16 v[96:111], v[32:35], v[208:211], 0
  v_mfma_f32_32x32x16_bf16 v[96:111], v[36:39], v[212:215], v[96:111]
  v_mfma_f32_32x32x16_bf16 v[96:111], v[40:43], v[216:219], v[96:111]
  v_mfma_f32_32x32x16_bf16 v[96:111], v[44:47], v[220:223], v[96:111]
  v_mfma_f32_32x32x16_bf16 v[96:111], v[48:51], v[224:227], v[96:111]
  v_mfma_f32_32x32x16_bf16 v[96:111], v[52:55], v[228:231], v[96:111]
  v_mfma_f32_32x32x16_bf16 v[96:111], v[56:59], v[232:235], v[96:111]
  v_mfma_f32_32x32x16_bf16 v[96:111], v[60:63], v[236:239], v[96:111]
  v_mfma_f32_32x32x16_bf16 v[96:111], v[64:67], v[144:147], v[96:111]
  v_mfma_f32_32x32x16_bf16 v[96:111], v[68:71], v[148:151], v[96:111]
  v_mfma_f32_32x32x16_bf16 v[96:111], v[72:75], v[152:155], v[96:111]
  v_mfma_f32_32x32x16_bf16 v[96:111], v[76:79], v[156:159], v[96:111]
  v_mfma_f32_32x32x16_bf16 v[96:111], v[80:83], v[176:179], v[96:111]
  v_mfma_f32_32x32x16_bf16 v[96:111], v[84:87], v[180:183], v[96:111]
  v_mfma_f32_32x32x16_bf16 v[96:111], v[88:91], v[184:187], v[96:111]
  v_mfma_f32_32x32x16_bf16 v[96:111], v[92:95], v[188:191], v[96:111]
  s_nop 7
  s_nop 7
  v_sub_f32 v96, v96, v30
  v_exp_f32 v96, v96
  v_sub_f32 v97, v97, v30
  v_exp_f32 v97, v97
  v_sub_f32 v98, v98, v30
  v_exp_f32 v98, v98
  v_sub_f32 v99, v99, v30
  v_exp_f32 v99, v99
  v_sub_f32 v100, v100, v30
  v_exp_f32 v100, v100
  v_sub_f32 v101, v101, v30
  v_exp_f32 v101, v101
  v_sub_f32 v102, v102, v30
  v_exp_f32 v102, v102
  v_sub_f32 v103, v103, v30
  v_exp_f32 v103, v103
  v_sub_f32 v104, v104, v30
  v_exp_f32 v104, v104
  v_sub_f32 v105, v105, v30
  v_exp_f32 v105, v105
  v_sub_f32 v106, v106, v30
  v_exp_f32 v106, v106
  v_sub_f32 v107, v107, v30
  v_exp_f32 v107, v107
  v_sub_f32 v108, v108, v30
  v_exp_f32 v108, v108
  v_sub_f32 v109, v109, v30
  v_exp_f32 v109, v109
  v_sub_f32 v110, v110, v30
  v_exp_f32 v110, v110
  v_sub_f32 v111, v111, v30
  v_exp_f32 v111, v111
  v_add_f32 v14, v14, v96
  v_add_f32 v14, v14, v97
  v_add_f32 v14, v14, v98
  v_add_f32 v14, v14, v99
  v_add_f32 v14, v14, v100
  v_add_f32 v14, v14, v101
  v_add_f32 v14, v14, v102
  v_add_f32 v14, v14, v103
  v_add_f32 v14, v14, v104
  v_add_f32 v14, v14, v105
  v_add_f32 v14, v14, v106
  v_add_f32 v14, v14, v107
  v_add_f32 v14, v14, v108
  v_add_f32 v14, v14, v109
  v_add_f32 v14, v14, v110
  v_add_f32 v14, v14, v111
  v_cvt_pk_bf16_f32 v112, v96, v97
  v_cvt_pk_bf16_f32 v113, v98, v99
  v_cvt_pk_bf16_f32 v114, v100, v101
  v_cvt_pk_bf16_f32 v115, v102, v103
  v_cvt_pk_bf16_f32 v116, v104, v105
  v_cvt_pk_bf16_f32 v117, v106, v107
  v_cvt_pk_bf16_f32 v118, v108, v109
  v_cvt_pk_bf16_f32 v119, v110, v111
  s_add_u32 s63, s62, 0
  buffer_load_ushort v128, v4, s[24:27], s63 offen offset:0
  buffer_load_ushort v129, v4, s[24:27], s63 offen offset:512
  buffer_load_ushort v130, v4, s[24:27], s63 offen offset:1024
  buffer_load_ushort v131, v4, s[24:27], s63 offen offset:1536
  buffer_load_ushort v132, v5, s[24:27], s63 offen offset:0
  buffer_load_ushort v133, v5, s[24:27], s63 offen offset:512
  buffer_load_ushort v134, v5, s[24:27], s63 offen offset:1024
  buffer_load_ushort v135, v5, s[24:27], s63 offen offset:1536
  s_waitcnt vmcnt(0)
  v_lshl_or_b32 v120, v129, 16, v128
  v_lshl_or_b32 v121, v131, 16, v130
  v_lshl_or_b32 v122, v133, 16, v132
  v_lshl_or_b32 v123, v135, 16, v134
  s_nop 1
  v_mfma_f32_32x32x16_bf16 a[0:15], v[120:123], v[112:115], a[0:15]
  buffer_load_ushort v128, v4, s[24:27], s63 offen offset:64
  buffer_load_ushort v129, v4, s[24:27], s63 offen offset:576
  buffer_load_ushort v130, v4, s[24:27], s63 offen offset:1088
  buffer_load_ushort v131, v4, s[24:27], s63 offen offset:1600
  buffer_load_ushort v132, v5, s[24:27], s63 offen offset:64
  buffer_load_ushort v133, v5, s[24:27], s63 offen offset:576
  buffer_load_ushort v134, v5, s[24:27], s63 offen offset:1088
  buffer_load_ushort v135, v5, s[24:27], s63 offen offset:1600
  s_waitcnt vmcnt(0)
  v_lshl_or_b32 v124, v129, 16, v128
  v_lshl_or_b32 v125, v131, 16, v130
  v_lshl_or_b32 v126, v133, 16, v132
  v_lshl_or_b32 v127, v135, 16, v134
  s_nop 1
  v_mfma_f32_32x32x16_bf16 a[16:31], v[124:127], v[112:115], a[16:31]
  buffer_load_ushort v128, v4, s[24:27], s63 offen offset:128
  buffer_load_ushort v129, v4, s[24:27], s63 offen offset:640
  buffer_load_ushort v130, v4, s[24:27], s63 offen offset:1152
  buffer_load_ushort v131, v4, s[24:27], s63 offen offset:1664
  buffer_load_ushort v132, v5, s[24:27], s63 offen offset:128
  buffer_load_ushort v133, v5, s[24:27], s63 offen offset:640
  buffer_load_ushort v134, v5, s[24:27], s63 offen offset:1152
  buffer_load_ushort v135, v5, s[24:27], s63 offen offset:1664
  s_waitcnt vmcnt(0)
  v_lshl_or_b32 v120, v129, 16, v128
  v_lshl_or_b32 v121, v131, 16, v130
  v_lshl_or_b32 v122, v133, 16, v132
  v_lshl_or_b32 v123, v135, 16, v134
  s_nop 1
  v_mfma_f32_32x32x16_bf16 a[32:47], v[120:123], v[112:115], a[32:47]
  buffer_load_ushort v128, v4, s[24:27], s63 offen offset:192
  buffer_load_ushort v129, v4, s[24:27], s63 offen offset:704
  buffer_load_ushort v130, v4, s[24:27], s63 offen offset:1216
  buffer_load_ushort v131, v4, s[24:27], s63 offen offset:1728
  buffer_load_ushort v132, v5, s[24:27], s63 offen offset:192
  buffer_load_ushort v133, v5, s[24:27], s63 offen offset:704
  buffer_load_ushort v134, v5, s[24:27], s63 offen offset:1216
  buffer_load_ushort v135, v5, s[24:27], s63 offen offset:1728
  s_waitcnt vmcnt(0)
  v_lshl_or_b32 v124, v129, 16, v128
  v_lshl_or_b32 v125, v131, 16, v130
  v_lshl_or_b32 v126, v133, 16, v132
  v_lshl_or_b32 v127, v135, 16, v134
  s_nop 1
  v_mfma_f32_32x32x16_bf16 a[48:63], v[124:127], v[112:115], a[48:63]
  buffer_load_ushort v128, v4, s[24:27], s63 offen offset:256
  buffer_load_ushort v129, v4, s[24:27], s63 offen offset:768
  buffer_load_ushort v130, v4, s[24:27], s63 offen offset:1280
  buffer_load_ushort v131, v4, s[24:27], s63 offen offset:1792
  buffer_load_ushort v132, v5, s[24:27], s63 offen offset:256
  buffer_load_ushort v133, v5, s[24:27], s63 offen offset:768
  buffer_load_ushort v134, v5, s[24:27], s63 offen offset:1280
  buffer_load_ushort v135, v5, s[24:27], s63 offen offset:1792
  s_waitcnt vmcnt(0)
  v_lshl_or_b32 v120, v129, 16, v128
  v_lshl_or_b32 v121, v131, 16, v130
  v_lshl_or_b32 v122, v133, 16, v132
  v_lshl_or_b32 v123, v135, 16, v134
  s_nop 1
  v_mfma_f32_32x32x16_bf16 a[64:79], v[120:123], v[112:115], a[64:79]
  buffer_load_ushort v128, v4, s[24:27], s63 offen offset:320
  buffer_load_ushort v129, v4, s[24:27], s63 offen offset:832
  buffer_load_ushort v130, v4, s[24:27], s63 offen offset:1344
  buffer_load_ushort v131, v4, s[24:27], s63 offen offset:1856
  buffer_load_ushort v132, v5, s[24:27], s63 offen offset:320
  buffer_load_ushort v133, v5, s[24:27], s63 offen offset:832
  buffer_load_ushort v134, v5, s[24:27], s63 offen offset:1344
  buffer_load_ushort v135, v5, s[24:27], s63 offen offset:1856
  s_waitcnt vmcnt(0)
  v_lshl_or_b32 v124, v129, 16, v128
  v_lshl_or_b32 v125, v131, 16, v130
  v_lshl_or_b32 v126, v133, 16, v132
  v_lshl_or_b32 v127, v135, 16, v134
  s_nop 1
  v_mfma_f32_32x32x16_bf16 a[80:95], v[124:127], v[112:115], a[80:95]
  buffer_load_ushort v128, v4, s[24:27], s63 offen offset:384
  buffer_load_ushort v129, v4, s[24:27], s63 offen offset:896
  buffer_load_ushort v130, v4, s[24:27], s63 offen offset:1408
  buffer_load_ushort v131, v4, s[24:27], s63 offen offset:1920
  buffer_load_ushort v132, v5, s[24:27], s63 offen offset:384
  buffer_load_ushort v133, v5, s[24:27], s63 offen offset:896
  buffer_load_ushort v134, v5, s[24:27], s63 offen offset:1408
  buffer_load_ushort v135, v5, s[24:27], s63 offen offset:1920
  s_waitcnt vmcnt(0)
  v_lshl_or_b32 v120, v129, 16, v128
  v_lshl_or_b32 v121, v131, 16, v130
  v_lshl_or_b32 v122, v133, 16, v132
  v_lshl_or_b32 v123, v135, 16, v134
  s_nop 1
  v_mfma_f32_32x32x16_bf16 a[96:111], v[120:123], v[112:115], a[96:111]
  buffer_load_ushort v128, v4, s[24:27], s63 offen offset:448
  buffer_load_ushort v129, v4, s[24:27], s63 offen offset:960
  buffer_load_ushort v130, v4, s[24:27], s63 offen offset:1472
  buffer_load_ushort v131, v4, s[24:27], s63 offen offset:1984
  buffer_load_ushort v132, v5, s[24:27], s63 offen offset:448
  buffer_load_ushort v133, v5, s[24:27], s63 offen offset:960
  buffer_load_ushort v134, v5, s[24:27], s63 offen offset:1472
  buffer_load_ushort v135, v5, s[24:27], s63 offen offset:1984
  s_waitcnt vmcnt(0)
  v_lshl_or_b32 v124, v129, 16, v128
  v_lshl_or_b32 v125, v131, 16, v130
  v_lshl_or_b32 v126, v133, 16, v132
  v_lshl_or_b32 v127, v135, 16, v134
  s_nop 1
  v_mfma_f32_32x32x16_bf16 a[112:127], v[124:127], v[112:115], a[112:127]
  s_add_u32 s63, s62, 8192
  buffer_load_ushort v128, v4, s[24:27], s63 offen offset:0
  buffer_load_ushort v129, v4, s[24:27], s63 offen offset:512
  buffer_load_ushort v130, v4, s[24:27], s63 offen offset:1024
  buffer_load_ushort v131, v4, s[24:27], s63 offen offset:1536
  buffer_load_ushort v132, v5, s[24:27], s63 offen offset:0
  buffer_load_ushort v133, v5, s[24:27], s63 offen offset:512
  buffer_load_ushort v134, v5, s[24:27], s63 offen offset:1024
  buffer_load_ushort v135, v5, s[24:27], s63 offen offset:1536
  s_waitcnt vmcnt(0)
  v_lshl_or_b32 v120, v129, 16, v128
  v_lshl_or_b32 v121, v131, 16, v130
  v_lshl_or_b32 v122, v133, 16, v132
  v_lshl_or_b32 v123, v135, 16, v134
  s_nop 1
  v_mfma_f32_32x32x16_bf16 a[0:15], v[120:123], v[116:119], a[0:15]
  buffer_load_ushort v128, v4, s[24:27], s63 offen offset:64
  buffer_load_ushort v129, v4, s[24:27], s63 offen offset:576
  buffer_load_ushort v130, v4, s[24:27], s63 offen offset:1088
  buffer_load_ushort v131, v4, s[24:27], s63 offen offset:1600
  buffer_load_ushort v132, v5, s[24:27], s63 offen offset:64
  buffer_load_ushort v133, v5, s[24:27], s63 offen offset:576
  buffer_load_ushort v134, v5, s[24:27], s63 offen offset:1088
  buffer_load_ushort v135, v5, s[24:27], s63 offen offset:1600
  s_waitcnt vmcnt(0)
  v_lshl_or_b32 v124, v129, 16, v128
  v_lshl_or_b32 v125, v131, 16, v130
  v_lshl_or_b32 v126, v133, 16, v132
  v_lshl_or_b32 v127, v135, 16, v134
  s_nop 1
  v_mfma_f32_32x32x16_bf16 a[16:31], v[124:127], v[116:119], a[16:31]
  buffer_load_ushort v128, v4, s[24:27], s63 offen offset:128
  buffer_load_ushort v129, v4, s[24:27], s63 offen offset:640
  buffer_load_ushort v130, v4, s[24:27], s63 offen offset:1152
  buffer_load_ushort v131, v4, s[24:27], s63 offen offset:1664
  buffer_load_ushort v132, v5, s[24:27], s63 offen offset:128
  buffer_load_ushort v133, v5, s[24:27], s63 offen offset:640
  buffer_load_ushort v134, v5, s[24:27], s63 offen offset:1152
  buffer_load_ushort v135, v5, s[24:27], s63 offen offset:1664
  s_waitcnt vmcnt(0)
  v_lshl_or_b32 v120, v129, 16, v128
  v_lshl_or_b32 v121, v131, 16, v130
  v_lshl_or_b32 v122, v133, 16, v132
  v_lshl_or_b32 v123, v135, 16, v134
  s_nop 1
  v_mfma_f32_32x32x16_bf16 a[32:47], v[120:123], v[116:119], a[32:47]
  buffer_load_ushort v128, v4, s[24:27], s63 offen offset:192
  buffer_load_ushort v129, v4, s[24:27], s63 offen offset:704
  buffer_load_ushort v130, v4, s[24:27], s63 offen offset:1216
  buffer_load_ushort v131, v4, s[24:27], s63 offen offset:1728
  buffer_load_ushort v132, v5, s[24:27], s63 offen offset:192
  buffer_load_ushort v133, v5, s[24:27], s63 offen offset:704
  buffer_load_ushort v134, v5, s[24:27], s63 offen offset:1216
  buffer_load_ushort v135, v5, s[24:27], s63 offen offset:1728
  s_waitcnt vmcnt(0)
  v_lshl_or_b32 v124, v129, 16, v128
  v_lshl_or_b32 v125, v131, 16, v130
  v_lshl_or_b32 v126, v133, 16, v132
  v_lshl_or_b32 v127, v135, 16, v134
  s_nop 1
  v_mfma_f32_32x32x16_bf16 a[48:63], v[124:127], v[116:119], a[48:63]
  buffer_load_ushort v128, v4, s[24:27], s63 offen offset:256
  buffer_load_ushort v129, v4, s[24:27], s63 offen offset:768
  buffer_load_ushort v130, v4, s[24:27], s63 offen offset:1280
  buffer_load_ushort v131, v4, s[24:27], s63 offen offset:1792
  buffer_load_ushort v132, v5, s[24:27], s63 offen offset:256
  buffer_load_ushort v133, v5, s[24:27], s63 offen offset:768
  buffer_load_ushort v134, v5, s[24:27], s63 offen offset:1280
  buffer_load_ushort v135, v5, s[24:27], s63 offen offset:1792
  s_waitcnt vmcnt(0)
  v_lshl_or_b32 v120, v129, 16, v128
  v_lshl_or_b32 v121, v131, 16, v130
  v_lshl_or_b32 v122, v133, 16, v132
  v_lshl_or_b32 v123, v135, 16, v134
  s_nop 1
  v_mfma_f32_32x32x16_bf16 a[64:79], v[120:123], v[116:119], a[64:79]
  buffer_load_ushort v128, v4, s[24:27], s63 offen offset:320
  buffer_load_ushort v129, v4, s[24:27], s63 offen offset:832
  buffer_load_ushort v130, v4, s[24:27], s63 offen offset:1344
  buffer_load_ushort v131, v4, s[24:27], s63 offen offset:1856
  buffer_load_ushort v132, v5, s[24:27], s63 offen offset:320
  buffer_load_ushort v133, v5, s[24:27], s63 offen offset:832
  buffer_load_ushort v134, v5, s[24:27], s63 offen offset:1344
  buffer_load_ushort v135, v5, s[24:27], s63 offen offset:1856
  s_waitcnt vmcnt(0)
  v_lshl_or_b32 v124, v129, 16, v128
  v_lshl_or_b32 v125, v131, 16, v130
  v_lshl_or_b32 v126, v133, 16, v132
  v_lshl_or_b32 v127, v135, 16, v134
  s_nop 1
  v_mfma_f32_32x32x16_bf16 a[80:95], v[124:127], v[116:119], a[80:95]
  buffer_load_ushort v128, v4, s[24:27], s63 offen offset:384
  buffer_load_ushort v129, v4, s[24:27], s63 offen offset:896
  buffer_load_ushort v130, v4, s[24:27], s63 offen offset:1408
  buffer_load_ushort v131, v4, s[24:27], s63 offen offset:1920
  buffer_load_ushort v132, v5, s[24:27], s63 offen offset:384
  buffer_load_ushort v133, v5, s[24:27], s63 offen offset:896
  buffer_load_ushort v134, v5, s[24:27], s63 offen offset:1408
  buffer_load_ushort v135, v5, s[24:27], s63 offen offset:1920
  s_waitcnt vmcnt(0)
  v_lshl_or_b32 v120, v129, 16, v128
  v_lshl_or_b32 v121, v131, 16, v130
  v_lshl_or_b32 v122, v133, 16, v132
  v_lshl_or_b32 v123, v135, 16, v134
  s_nop 1
  v_mfma_f32_32x32x16_bf16 a[96:111], v[120:123], v[116:119], a[96:111]
  buffer_load_ushort v128, v4, s[24:27], s63 offen offset:448
  buffer_load_ushort v129, v4, s[24:27], s63 offen offset:960
  buffer_load_ushort v130, v4, s[24:27], s63 offen offset:1472
  buffer_load_ushort v131, v4, s[24:27], s63 offen offset:1984
  buffer_load_ushort v132, v5, s[24:27], s63 offen offset:448
  buffer_load_ushort v133, v5, s[24:27], s63 offen offset:960
  buffer_load_ushort v134, v5, s[24:27], s63 offen offset:1472
  buffer_load_ushort v135, v5, s[24:27], s63 offen offset:1984
  s_waitcnt vmcnt(0)
  v_lshl_or_b32 v124, v129, 16, v128
  v_lshl_or_b32 v125, v131, 16, v130
  v_lshl_or_b32 v126, v133, 16, v132
  v_lshl_or_b32 v127, v135, 16, v134
  s_nop 1
  v_mfma_f32_32x32x16_bf16 a[112:127], v[124:127], v[116:119], a[112:127]
  s_nop 7
  s_nop 7
  s_add_u32 s62, s62, 16384
  s_cmp_lt_u32 s62, 0x40000
  s_cbranch_scc1 K1_SL2
  v_mov_b32 v15, v14
  s_nop 1
  v_permlane32_swap_b32 v14, v15
  v_add_f32 v14, v14, v15
  v_rcp_f32 v25, v14
  s_lshl_b32 s70, s6, 14
  v_accvgpr_read_b32 v26, a0
  v_accvgpr_read_b32 v27, a1
  v_mul_f32 v26, v26, v25
  v_mul_f32 v27, v27, v25
  v_cvt_pk_bf16_f32 v16, v26, v27
  v_accvgpr_read_b32 v26, a2
  v_accvgpr_read_b32 v27, a3
  v_mul_f32 v26, v26, v25
  v_mul_f32 v27, v27, v25
  v_cvt_pk_bf16_f32 v17, v26, v27
  v_accvgpr_read_b32 v26, a4
  v_accvgpr_read_b32 v27, a5
  v_mul_f32 v26, v26, v25
  v_mul_f32 v27, v27, v25
  v_cvt_pk_bf16_f32 v18, v26, v27
  v_accvgpr_read_b32 v26, a6
  v_accvgpr_read_b32 v27, a7
  v_mul_f32 v26, v26, v25
  v_mul_f32 v27, v27, v25
  v_cvt_pk_bf16_f32 v19, v26, v27
  buffer_store_dwordx4 v[16:19], v24, s[28:31], s70 offen offset:0 sc1
  s_waitcnt vmcnt(0)
  v_accvgpr_read_b32 v26, a8
  v_accvgpr_read_b32 v27, a9
  v_mul_f32 v26, v26, v25
  v_mul_f32 v27, v27, v25
  v_cvt_pk_bf16_f32 v20, v26, v27
  v_accvgpr_read_b32 v26, a10
  v_accvgpr_read_b32 v27, a11
  v_mul_f32 v26, v26, v25
  v_mul_f32 v27, v27, v25
  v_cvt_pk_bf16_f32 v21, v26, v27
  v_accvgpr_read_b32 v26, a12
  v_accvgpr_read_b32 v27, a13
  v_mul_f32 v26, v26, v25
  v_mul_f32 v27, v27, v25
  v_cvt_pk_bf16_f32 v22, v26, v27
  v_accvgpr_read_b32 v26, a14
  v_accvgpr_read_b32 v27, a15
  v_mul_f32 v26, v26, v25
  v_mul_f32 v27, v27, v25
  v_cvt_pk_bf16_f32 v23, v26, v27
  buffer_store_dwordx4 v[20:23], v24, s[28:31], s70 offen offset:1024 sc1
  s_waitcnt vmcnt(0)
  v_accvgpr_read_b32 v26, a16
  v_accvgpr_read_b32 v27, a17
  v_mul_f32 v26, v26, v25
  v_mul_f32 v27, v27, v25
  v_cvt_pk_bf16_f32 v16, v26, v27
  v_accvgpr_read_b32 v26, a18
  v_accvgpr_read_b32 v27, a19
  v_mul_f32 v26, v26, v25
  v_mul_f32 v27, v27, v25
  v_cvt_pk_bf16_f32 v17, v26, v27
  v_accvgpr_read_b32 v26, a20
  v_accvgpr_read_b32 v27, a21
  v_mul_f32 v26, v26, v25
  v_mul_f32 v27, v27, v25
  v_cvt_pk_bf16_f32 v18, v26, v27
  v_accvgpr_read_b32 v26, a22
  v_accvgpr_read_b32 v27, a23
  v_mul_f32 v26, v26, v25
  v_mul_f32 v27, v27, v25
  v_cvt_pk_bf16_f32 v19, v26, v27
  buffer_store_dwordx4 v[16:19], v24, s[28:31], s70 offen offset:2048 sc1
  s_waitcnt vmcnt(0)
  v_accvgpr_read_b32 v26, a24
  v_accvgpr_read_b32 v27, a25
  v_mul_f32 v26, v26, v25
  v_mul_f32 v27, v27, v25
  v_cvt_pk_bf16_f32 v20, v26, v27
  v_accvgpr_read_b32 v26, a26
  v_accvgpr_read_b32 v27, a27
  v_mul_f32 v26, v26, v25
  v_mul_f32 v27, v27, v25
  v_cvt_pk_bf16_f32 v21, v26, v27
  v_accvgpr_read_b32 v26, a28
  v_accvgpr_read_b32 v27, a29
  v_mul_f32 v26, v26, v25
  v_mul_f32 v27, v27, v25
  v_cvt_pk_bf16_f32 v22, v26, v27
  v_accvgpr_read_b32 v26, a30
  v_accvgpr_read_b32 v27, a31
  v_mul_f32 v26, v26, v25
  v_mul_f32 v27, v27, v25
  v_cvt_pk_bf16_f32 v23, v26, v27
  buffer_store_dwordx4 v[20:23], v24, s[28:31], s70 offen offset:3072 sc1
  s_waitcnt vmcnt(0)
  v_accvgpr_read_b32 v26, a32
  v_accvgpr_read_b32 v27, a33
  v_mul_f32 v26, v26, v25
  v_mul_f32 v27, v27, v25
  v_cvt_pk_bf16_f32 v16, v26, v27
  v_accvgpr_read_b32 v26, a34
  v_accvgpr_read_b32 v27, a35
  v_mul_f32 v26, v26, v25
  v_mul_f32 v27, v27, v25
  v_cvt_pk_bf16_f32 v17, v26, v27
  v_accvgpr_read_b32 v26, a36
  v_accvgpr_read_b32 v27, a37
  v_mul_f32 v26, v26, v25
  v_mul_f32 v27, v27, v25
  v_cvt_pk_bf16_f32 v18, v26, v27
  v_accvgpr_read_b32 v26, a38
  v_accvgpr_read_b32 v27, a39
  v_mul_f32 v26, v26, v25
  v_mul_f32 v27, v27, v25
  v_cvt_pk_bf16_f32 v19, v26, v27
  s_add_u32 s70, s70, 4096
  buffer_store_dwordx4 v[16:19], v24, s[28:31], s70 offen offset:0 sc1
  s_waitcnt vmcnt(0)
  v_accvgpr_read_b32 v26, a40
  v_accvgpr_read_b32 v27, a41
  v_mul_f32 v26, v26, v25
  v_mul_f32 v27, v27, v25
  v_cvt_pk_bf16_f32 v20, v26, v27
  v_accvgpr_read_b32 v26, a42
  v_accvgpr_read_b32 v27, a43
  v_mul_f32 v26, v26, v25
  v_mul_f32 v27, v27, v25
  v_cvt_pk_bf16_f32 v21, v26, v27
  v_accvgpr_read_b32 v26, a44
  v_accvgpr_read_b32 v27, a45
  v_mul_f32 v26, v26, v25
  v_mul_f32 v27, v27, v25
  v_cvt_pk_bf16_f32 v22, v26, v27
  v_accvgpr_read_b32 v26, a46
  v_accvgpr_read_b32 v27, a47
  v_mul_f32 v26, v26, v25
  v_mul_f32 v27, v27, v25
  v_cvt_pk_bf16_f32 v23, v26, v27
  buffer_store_dwordx4 v[20:23], v24, s[28:31], s70 offen offset:1024 sc1
  s_waitcnt vmcnt(0)
  v_accvgpr_read_b32 v26, a48
  v_accvgpr_read_b32 v27, a49
  v_mul_f32 v26, v26, v25
  v_mul_f32 v27, v27, v25
  v_cvt_pk_bf16_f32 v16, v26, v27
  v_accvgpr_read_b32 v26, a50
  v_accvgpr_read_b32 v27, a51
  v_mul_f32 v26, v26, v25
  v_mul_f32 v27, v27, v25
  v_cvt_pk_bf16_f32 v17, v26, v27
  v_accvgpr_read_b32 v26, a52
  v_accvgpr_read_b32 v27, a53
  v_mul_f32 v26, v26, v25
  v_mul_f32 v27, v27, v25
  v_cvt_pk_bf16_f32 v18, v26, v27
  v_accvgpr_read_b32 v26, a54
  v_accvgpr_read_b32 v27, a55
  v_mul_f32 v26, v26, v25
  v_mul_f32 v27, v27, v25
  v_cvt_pk_bf16_f32 v19, v26, v27
  buffer_store_dwordx4 v[16:19], v24, s[28:31], s70 offen offset:2048 sc1
  s_waitcnt vmcnt(0)
  v_accvgpr_read_b32 v26, a56
  v_accvgpr_read_b32 v27, a57
  v_mul_f32 v26, v26, v25
  v_mul_f32 v27, v27, v25
  v_cvt_pk_bf16_f32 v20, v26, v27
  v_accvgpr_read_b32 v26, a58
  v_accvgpr_read_b32 v27, a59
  v_mul_f32 v26, v26, v25
  v_mul_f32 v27, v27, v25
  v_cvt_pk_bf16_f32 v21, v26, v27
  v_accvgpr_read_b32 v26, a60
  v_accvgpr_read_b32 v27, a61
  v_mul_f32 v26, v26, v25
  v_mul_f32 v27, v27, v25
  v_cvt_pk_bf16_f32 v22, v26, v27
  v_accvgpr_read_b32 v26, a62
  v_accvgpr_read_b32 v27, a63
  v_mul_f32 v26, v26, v25
  v_mul_f32 v27, v27, v25
  v_cvt_pk_bf16_f32 v23, v26, v27
  buffer_store_dwordx4 v[20:23], v24, s[28:31], s70 offen offset:3072 sc1
  s_waitcnt vmcnt(0)
  v_accvgpr_read_b32 v26, a64
  v_accvgpr_read_b32 v27, a65
  v_mul_f32 v26, v26, v25
  v_mul_f32 v27, v27, v25
  v_cvt_pk_bf16_f32 v16, v26, v27
  v_accvgpr_read_b32 v26, a66
  v_accvgpr_read_b32 v27, a67
  v_mul_f32 v26, v26, v25
  v_mul_f32 v27, v27, v25
  v_cvt_pk_bf16_f32 v17, v26, v27
  v_accvgpr_read_b32 v26, a68
  v_accvgpr_read_b32 v27, a69
  v_mul_f32 v26, v26, v25
  v_mul_f32 v27, v27, v25
  v_cvt_pk_bf16_f32 v18, v26, v27
  v_accvgpr_read_b32 v26, a70
  v_accvgpr_read_b32 v27, a71
  v_mul_f32 v26, v26, v25
  v_mul_f32 v27, v27, v25
  v_cvt_pk_bf16_f32 v19, v26, v27
  s_add_u32 s70, s70, 4096
  buffer_store_dwordx4 v[16:19], v24, s[28:31], s70 offen offset:0 sc1
  s_waitcnt vmcnt(0)
  v_accvgpr_read_b32 v26, a72
  v_accvgpr_read_b32 v27, a73
  v_mul_f32 v26, v26, v25
  v_mul_f32 v27, v27, v25
  v_cvt_pk_bf16_f32 v20, v26, v27
  v_accvgpr_read_b32 v26, a74
  v_accvgpr_read_b32 v27, a75
  v_mul_f32 v26, v26, v25
  v_mul_f32 v27, v27, v25
  v_cvt_pk_bf16_f32 v21, v26, v27
  v_accvgpr_read_b32 v26, a76
  v_accvgpr_read_b32 v27, a77
  v_mul_f32 v26, v26, v25
  v_mul_f32 v27, v27, v25
  v_cvt_pk_bf16_f32 v22, v26, v27
  v_accvgpr_read_b32 v26, a78
  v_accvgpr_read_b32 v27, a79
  v_mul_f32 v26, v26, v25
  v_mul_f32 v27, v27, v25
  v_cvt_pk_bf16_f32 v23, v26, v27
  buffer_store_dwordx4 v[20:23], v24, s[28:31], s70 offen offset:1024 sc1
  s_waitcnt vmcnt(0)
  v_accvgpr_read_b32 v26, a80
  v_accvgpr_read_b32 v27, a81
  v_mul_f32 v26, v26, v25
  v_mul_f32 v27, v27, v25
  v_cvt_pk_bf16_f32 v16, v26, v27
  v_accvgpr_read_b32 v26, a82
  v_accvgpr_read_b32 v27, a83
  v_mul_f32 v26, v26, v25
  v_mul_f32 v27, v27, v25
  v_cvt_pk_bf16_f32 v17, v26, v27
  v_accvgpr_read_b32 v26, a84
  v_accvgpr_read_b32 v27, a85
  v_mul_f32 v26, v26, v25
  v_mul_f32 v27, v27, v25
  v_cvt_pk_bf16_f32 v18, v26, v27
  v_accvgpr_read_b32 v26, a86
  v_accvgpr_read_b32 v27, a87
  v_mul_f32 v26, v26, v25
  v_mul_f32 v27, v27, v25
  v_cvt_pk_bf16_f32 v19, v26, v27
  buffer_store_dwordx4 v[16:19], v24, s[28:31], s70 offen offset:2048 sc1
  s_waitcnt vmcnt(0)
  v_accvgpr_read_b32 v26, a88
  v_accvgpr_read_b32 v27, a89
  v_mul_f32 v26, v26, v25
  v_mul_f32 v27, v27, v25
  v_cvt_pk_bf16_f32 v20, v26, v27
  v_accvgpr_read_b32 v26, a90
  v_accvgpr_read_b32 v27, a91
  v_mul_f32 v26, v26, v25
  v_mul_f32 v27, v27, v25
  v_cvt_pk_bf16_f32 v21, v26, v27
  v_accvgpr_read_b32 v26, a92
  v_accvgpr_read_b32 v27, a93
  v_mul_f32 v26, v26, v25
  v_mul_f32 v27, v27, v25
  v_cvt_pk_bf16_f32 v22, v26, v27
  v_accvgpr_read_b32 v26, a94
  v_accvgpr_read_b32 v27, a95
  v_mul_f32 v26, v26, v25
  v_mul_f32 v27, v27, v25
  v_cvt_pk_bf16_f32 v23, v26, v27
  buffer_store_dwordx4 v[20:23], v24, s[28:31], s70 offen offset:3072 sc1
  s_waitcnt vmcnt(0)
  v_accvgpr_read_b32 v26, a96
  v_accvgpr_read_b32 v27, a97
  v_mul_f32 v26, v26, v25
  v_mul_f32 v27, v27, v25
  v_cvt_pk_bf16_f32 v16, v26, v27
  v_accvgpr_read_b32 v26, a98
  v_accvgpr_read_b32 v27, a99
  v_mul_f32 v26, v26, v25
  v_mul_f32 v27, v27, v25
  v_cvt_pk_bf16_f32 v17, v26, v27
  v_accvgpr_read_b32 v26, a100
  v_accvgpr_read_b32 v27, a101
  v_mul_f32 v26, v26, v25
  v_mul_f32 v27, v27, v25
  v_cvt_pk_bf16_f32 v18, v26, v27
  v_accvgpr_read_b32 v26, a102
  v_accvgpr_read_b32 v27, a103
  v_mul_f32 v26, v26, v25
  v_mul_f32 v27, v27, v25
  v_cvt_pk_bf16_f32 v19, v26, v27
  s_add_u32 s70, s70, 4096
  buffer_store_dwordx4 v[16:19], v24, s[28:31], s70 offen offset:0 sc1
  s_waitcnt vmcnt(0)
  v_accvgpr_read_b32 v26, a104
  v_accvgpr_read_b32 v27, a105
  v_mul_f32 v26, v26, v25
  v_mul_f32 v27, v27, v25
  v_cvt_pk_bf16_f32 v20, v26, v27
  v_accvgpr_read_b32 v26, a106
  v_accvgpr_read_b32 v27, a107
  v_mul_f32 v26, v26, v25
  v_mul_f32 v27, v27, v25
  v_cvt_pk_bf16_f32 v21, v26, v27
  v_accvgpr_read_b32 v26, a108
  v_accvgpr_read_b32 v27, a109
  v_mul_f32 v26, v26, v25
  v_mul_f32 v27, v27, v25
  v_cvt_pk_bf16_f32 v22, v26, v27
  v_accvgpr_read_b32 v26, a110
  v_accvgpr_read_b32 v27, a111
  v_mul_f32 v26, v26, v25
  v_mul_f32 v27, v27, v25
  v_cvt_pk_bf16_f32 v23, v26, v27
  buffer_store_dwordx4 v[20:23], v24, s[28:31], s70 offen offset:1024 sc1
  s_waitcnt vmcnt(0)
  v_accvgpr_read_b32 v26, a112
  v_accvgpr_read_b32 v27, a113
  v_mul_f32 v26, v26, v25
  v_mul_f32 v27, v27, v25
  v_cvt_pk_bf16_f32 v16, v26, v27
  v_accvgpr_read_b32 v26, a114
  v_accvgpr_read_b32 v27, a115
  v_mul_f32 v26, v26, v25
  v_mul_f32 v27, v27, v25
  v_cvt_pk_bf16_f32 v17, v26, v27
  v_accvgpr_read_b32 v26, a116
  v_accvgpr_read_b32 v27, a117
  v_mul_f32 v26, v26, v25
  v_mul_f32 v27, v27, v25
  v_cvt_pk_bf16_f32 v18, v26, v27
  v_accvgpr_read_b32 v26, a118
  v_accvgpr_read_b32 v27, a119
  v_mul_f32 v26, v26, v25
  v_mul_f32 v27, v27, v25
  v_cvt_pk_bf16_f32 v19, v26, v27
  buffer_store_dwordx4 v[16:19], v24, s[28:31], s70 offen offset:2048 sc1
  s_waitcnt vmcnt(0)
  v_accvgpr_read_b32 v26, a120
  v_accvgpr_read_b32 v27, a121
  v_mul_f32 v26, v26, v25
  v_mul_f32 v27, v27, v25
  v_cvt_pk_bf16_f32 v20, v26, v27
  v_accvgpr_read_b32 v26, a122
  v_accvgpr_read_b32 v27, a123
  v_mul_f32 v26, v26, v25
  v_mul_f32 v27, v27, v25
  v_cvt_pk_bf16_f32 v21, v26, v27
  v_accvgpr_read_b32 v26, a124
  v_accvgpr_read_b32 v27, a125
  v_mul_f32 v26, v26, v25
  v_mul_f32 v27, v27, v25
  v_cvt_pk_bf16_f32 v22, v26, v27
  v_accvgpr_read_b32 v26, a126
  v_accvgpr_read_b32 v27, a127
  v_mul_f32 v26, v26, v25
  v_mul_f32 v27, v27, v25
  v_cvt_pk_bf16_f32 v23, v26, v27
  buffer_store_dwordx4 v[20:23], v24, s[28:31], s70 offen offset:3072 sc1
  s_waitcnt vmcnt(0)
  v_accvgpr_write_b32 a200, 0
K1_FIN:
  s_mov_b32 s65, s5
  s_mov_b32 s88, s52
  s_mov_b32 s89, s53
  s_mov_b32 s90, 256
  s_mov_b32 s91, 0x20000
  v_mov_b32 v11, 3
  s_add_u32 s68, s54, 0x1800080
  s_addc_u32 s69, s55, 0
  s_mov_b32 s71, 0x20000
  s_lshl_b32 s65, s65, 8
  s_cmp_eq_u32 s56, 0
  s_cselect_b32 s90, 256, 0
  s_cselect_b32 s70, 65536, 0
  v_lshl_add_u32 v29, v0, 16, s65
  s_cmp_ge_u32 s2, 224
  s_cbranch_scc0 K2_GO
  s_waitcnt vmcnt(0)
  s_barrier
  buffer_store_byte v11, v29, s[68:71], 0 offen sc1
  s_branch K2_END
K2_GO:
  s_and_b32 s3, s2, 3
  s_lshr_b32 s4, s2, 3
  s_mul_i32 s5, s4, 9363
  s_lshr_b32 s5, s5, 16
  s_mul_i32 s6, s5, 7
  s_sub_u32 s6, s4, s6
  s_sub_u32 s7, s5, s6
  s_and_b32 s7, s7, 3
  s_lshl_b32 s58, s7, 3
  s_lshl_b32 s3, s3, 2
  s_add_u32 s5, s5, s3
  s_lshl_b32 s57, s56, 12
  v_lshrrev_b32 v27, 3, v0
  v_and_b32 v28, 7, v0
  v_lshrrev_b32 v19, 2, v0
  v_and_b32 v19, 4, v19
  v_xor_b32 v19, v28, v19
  v_lshlrev_b32 v19, 4, v19
  s_mul_i32 s61, s56, 28672
  v_mul_u32_u24 v1, 896, v27
  v_add3_u32 v1, v1, v19, s61
  v_add_u32 v2, 6144, v1
  v_add_u32 v3, 6144, v2
  v_add_u32 v4, 6144, v3
  v_lshlrev_b32 v5, 4, v0
  v_add_u32 v6, 4096, v5
  s_lshl_b32 s60, s5, 2
  s_add_u32 s60, s60, s56
  s_waitcnt lgkmcnt(0)
  s_lshl_b32 s61, s6, 7
  s_add_u32 s8, s48, s61
  s_addc_u32 s9, s49, 0
  s_sub_u32 s10, 0x188000, s61
  s_mov_b32 s11, 0x20000
  s_add_u32 s12, s40, s61
  s_addc_u32 s13, s41, 0
  s_sub_u32 s14, 0x380000, s61
  s_mov_b32 s15, 0x20000
  s_mul_i32 s61, s60, 376832
  s_add_u32 s16, s54, s61
  s_addc_u32 s17, s55, 0
  s_sub_u32 s18, 0x1700000, s61
  s_mov_b32 s19, 0x20000
  s_lshl_b32 s4, s5, 4
  s_lshl_b32 s65, s5, 12
  v_and_b32 v30, 15, v0
  s_cmp_eq_u32 s56, 0
  s_cbranch_scc0 K2_HE
  v_and_b32 v31, 3, v0
  v_lshl_add_u32 v31, v31, 2, s4
  v_accvgpr_read_b32 v128, a200
  s_mov_b32 s59, 0x1010101
  s_mov_b32 s3, 65536
  s_branch K2_HC
K2_HL:
  buffer_load_dword v128, v31, s[88:91], 0 offen sc1
  s_waitcnt vmcnt(0)
K2_HC:
  v_cmp_ne_u32 vcc, s59, v128
  s_sub_u32 s3, s3, 1
  s_nop 4
  s_cmp_eq_u64 vcc, 0
  s_cselect_b32 s3, 0, s3
  s_cmp_lg_u32 s3, 0
  s_cbranch_scc1 K2_HL
K2_HE:
  s_barrier
  s_bitcmp1_b32 s2, 2
  s_cbranch_scc1 K2_PROD
  v_med3_u32 v31, v30, 0, 4
  v_lshlrev_b32 v31, 8, v31
  s_lshr_b32 s61, 0x1010000, s58
  s_and_b32 s61, s61, 255
  s_mul_i32 s92, s61, 114688
  s_lshl_b32 s93, s61, 13
  s_add_u32 s93, s93, 0x40000
  s_add_u32 m0, s57, 0
  s_nop 0
  buffer_load_dwordx4 v1, s[8:11], s92 offen offset:0 lds
  buffer_load_dwordx4 v2, s[8:11], s92 offen offset:1024 lds
  buffer_load_dwordx4 v3, s[8:11], s92 offen offset:2048 lds
  buffer_load_dwordx4 v4, s[8:11], s92 offen offset:3072 lds
  buffer_load_dwordx4 v[64:67], v5, s[16:19], s93 offen offset:0
  buffer_load_dwordx4 v[68:71], v5, s[16:19], s93 offen offset:1024
  buffer_load_dwordx4 v[72:75], v5, s[16:19], s93 offen offset:2048
  buffer_load_dwordx4 v[76:79], v5, s[16:19], s93 offen offset:3072
  buffer_load_dwordx4 v[80:83], v6, s[16:19], s93 offen offset:0
  buffer_load_dwordx4 v[84:87], v6, s[16:19], s93 offen offset:1024
  buffer_load_dwordx4 v[88:91], v6, s[16:19], s93 offen offset:2048
  buffer_load_dwordx4 v[92:95], v6, s[16:19], s93 offen offset:3072
  v_lshrrev_b32 v20, 5, v0
  v_bfe_u32 v21, v0, 4, 1
  v_bfe_u32 v22, v0, 2, 2
  v_and_b32 v23, 3, v0
  v_lshlrev_b32 v16, 7, v22
  v_lshrrev_b32 v17, 1, v22
  v_lshl_add_u32 v16, v17, 6, v16
  v_lshl_add_u32 v16, v20, 9, v16
  v_and_b32 v17, 1, v23
  v_lshl_add_u32 v16, v17, 5, v16
  v_lshl_add_u32 v16, v21, 4, v16
  v_lshrrev_b32 v17, 1, v23
  v_lshl_add_u32 v8, v17, 3, v16
  v_xor_b32 v9, 64, v8
  s_add_u32 s20, s54, 0x1800000
  s_addc_u32 s21, s55, 0
  s_mov_b32 s22, 8388608
  s_mov_b32 s23, 0x20000
  s_mul_i32 s61, s5, 7
  s_add_u32 s61, s61, s6
  s_lshl_b32 s66, s5, 4
  s_add_u32 s66, s66, s6
  s_lshl_b32 s66, s66, 8
  s_lshl_b32 s67, s61, 15
  s_lshl_b32 s61, s56, 13
  s_add_u32 s67, s67, s61
  s_add_u32 s67, s67, 0x100000
  v_mov_b32 v10, 0
  v_accvgpr_write_b32 a32, 0
  v_accvgpr_write_b32 a33, 0
  v_accvgpr_write_b32 a34, 0
  v_accvgpr_write_b32 a35, 0
  v_accvgpr_write_b32 a36, 0
  v_accvgpr_write_b32 a37, 0
  v_accvgpr_write_b32 a38, 0
  v_accvgpr_write_b32 a39, 0
  v_accvgpr_write_b32 a40, 0
  v_accvgpr_write_b32 a41, 0
  v_accvgpr_write_b32 a42, 0
  v_accvgpr_write_b32 a43, 0
  v_accvgpr_write_b32 a44, 0
  v_accvgpr_write_b32 a45, 0
  v_accvgpr_write_b32 a46, 0
  v_accvgpr_write_b32 a47, 0
  v_accvgpr_write_b32 a48, 0
  v_accvgpr_write_b32 a49, 0
  v_accvgpr_write_b32 a50, 0
  v_accvgpr_write_b32 a51, 0
  v_accvgpr_write_b32 a52, 0
  v_accvgpr_write_b32 a53, 0
  v_accvgpr_write_b32 a54, 0
  v_accvgpr_write_b32 a55, 0
  v_accvgpr_write_b32 a56, 0
  v_accvgpr_write_b32 a57, 0
  v_accvgpr_write_b32 a58, 0
  v_accvgpr_write_b32 a59, 0
  v_accvgpr_write_b32 a60, 0
  v_accvgpr_write_b32 a61, 0
  v_accvgpr_write_b32 a62, 0
  v_accvgpr_write_b32 a63, 0
  s_mov_b32 s24, s50
  s_mov_b32 s25, s51
  s_mov_b32 s26, 0x1c0000
  s_mov_b32 s27, 0x20000
  s_mov_b32 s28, s32
  s_mov_b32 s29, s33
  s_mov_b32 s30, 0x1c0000
  s_mov_b32 s31, 0x20000
  s_mul_i32 s61, s60, 28672
  s_lshl_b32 s59, s6, 7
  s_add_u32 s61, s61, s59
  v_mul_u32_u24 v16, 896, v27
  v_lshl_add_u32 v16, v28, 4, v16
  v_add_u32 v7, s61, v16
  s_mov_b32 s62, 7168
  s_mov_b32 s63, 14336
  s_mov_b32 s64, 21504
  s_lshl_b32 s61, s56, 13
  s_add_u32 s61, s61, 65536
  v_and_b32 v16, 31, v0
  v_lshlrev_b32 v17, 2, v20
  v_xor_b32 v17, v17, v28
  v_lshlrev_b32 v17, 4, v17
  v_lshl_add_u32 v16, v16, 8, v17
  v_add_u32 v12, s61, v16
  v_xor_b32 v13, 16, v12
  v_xor_b32 v14, 32, v12
  v_xor_b32 v15, 48, v12
  v_lshlrev_b32 v17, 1, v28
  v_xor_b32 v17, v17, v27
  v_lshlrev_b32 v17, 4, v17
  v_lshl_add_u32 v16, v27, 8, v17
  v_add_u32 v24, s61, v16
  v_xor_b32 v25, 16, v24
  s_lshr_b32 s61, 0x30102, s58
  s_and_b32 s61, s61, 255
  s_mul_i32 s94, s61, 114688
  s_lshl_b32 s95, s61, 13
  s_add_u32 s95, s95, 0x40000
  s_add_u32 m0, s57, 16384
  s_nop 0
  buffer_load_dwordx4 v1, s[8:11], s94 offen offset:0 lds
  buffer_load_dwordx4 v2, s[8:11], s94 offen offset:1024 lds
  buffer_load_dwordx4 v3, s[8:11], s94 offen offset:2048 lds
  buffer_load_dwordx4 v4, s[8:11], s94 offen offset:3072 lds
  s_waitcnt vmcnt(16)
  s_barrier
  buffer_store_byte v11, v29, s[68:71], 0 offen sc1
  s_waitcnt vmcnt(13)
  s_barrier
  ds_read_b64_tr_b16 v[32:33], v8 offset:0
  ds_read_b64_tr_b16 v[34:35], v8 offset:1024
  ds_read_b64_tr_b16 v[36:37], v9 offset:0
  ds_read_b64_tr_b16 v[38:39], v9 offset:1024
  ds_read_b64_tr_b16 v[40:41], v8 offset:2048
  ds_read_b64_tr_b16 v[42:43], v8 offset:3072
  ds_read_b64_tr_b16 v[44:45], v9 offset:2048
  ds_read_b64_tr_b16 v[46:47], v9 offset:3072
  ds_read_b64_tr_b16 v[48:49], v8 offset:4096
  ds_read_b64_tr_b16 v[50:51], v8 offset:5120
  ds_read_b64_tr_b16 v[52:53], v9 offset:4096
  ds_read_b64_tr_b16 v[54:55], v9 offset:5120
  s_lshr_b32 s61, 0x5000401, s58
  s_and_b32 s61, s61, 255
  s_mul_i32 s96, s61, 114688
  s_lshl_b32 s97, s61, 13
  s_add_u32 s97, s97, 0x40000
  s_add_u32 m0, s57, 32768
  s_nop 0
  buffer_load_dwordx4 v1, s[8:11], s96 offen offset:0 lds
  buffer_load_dwordx4 v2, s[8:11], s96 offen offset:1024 lds
  buffer_load_dwordx4 v3, s[8:11], s96 offen offset:2048 lds
  buffer_load_dwordx4 v4, s[8:11], s96 offen offset:3072 lds
  s_waitcnt vmcnt(16)
  s_waitcnt lgkmcnt(8)
  v_mfma_f32_32x32x16_bf16 a[0:15], v[32:35], v[64:67], 0
  ds_read_b64_tr_b16 v[56:57], v8 offset:6144
  ds_read_b64_tr_b16 v[58:59], v8 offset:7168
  ds_read_b64_tr_b16 v[60:61], v9 offset:6144
  ds_read_b64_tr_b16 v[62:63], v9 offset:7168
  v_mfma_f32_32x32x16_bf16 a[16:31], v[36:39], v[64:67], 0
  buffer_load_dwordx4 v[96:99], v5, s[16:19], s95 offen offset:0
  s_waitcnt vmcnt(16)
  s_waitcnt lgkmcnt(8)
  v_mfma_f32_32x32x16_bf16 a[0:15], v[40:43], v[68:71], a[0:15]
  ds_read_b64_tr_b16 v[32:33], v8 offset:8192
  ds_read_b64_tr_b16 v[34:35], v8 offset:9216
  ds_read_b64_tr_b16 v[36:37], v9 offset:8192
  ds_read_b64_tr_b16 v[38:39], v9 offset:9216
  v_mfma_f32_32x32x16_bf16 a[16:31], v[44:47], v[68:71], a[16:31]
  buffer_load_dwordx4 v[100:103], v5, s[16:19], s95 offen offset:1024
  s_waitcnt vmcnt(16)
  s_waitcnt lgkmcnt(8)
  v_mfma_f32_32x32x16_bf16 a[0:15], v[48:51], v[72:75], a[0:15]
  ds_read_b64_tr_b16 v[40:41], v8 offset:10240
  ds_read_b64_tr_b16 v[42:43], v8 offset:11264
  ds_read_b64_tr_b16 v[44:45], v9 offset:10240
  ds_read_b64_tr_b16 v[46:47], v9 offset:11264
  v_mfma_f32_32x32x16_bf16 a[16:31], v[52:55], v[72:75], a[16:31]
  buffer_load_dwordx4 v[104:107], v5, s[16:19], s95 offen offset:2048
  s_waitcnt vmcnt(16)
  s_waitcnt lgkmcnt(8)
  v_mfma_f32_32x32x16_bf16 a[0:15], v[56:59], v[76:79], a[0:15]
  ds_read_b64_tr_b16 v[48:49], v8 offset:12288
  ds_read_b64_tr_b16 v[50:51], v8 offset:13312
  ds_read_b64_tr_b16 v[52:53], v9 offset:12288
  ds_read_b64_tr_b16 v[54:55], v9 offset:13312
  v_mfma_f32_32x32x16_bf16 a[16:31], v[60:63], v[76:79], a[16:31]
  buffer_load_dwordx4 v[108:111], v5, s[16:19], s95 offen offset:3072
  s_waitcnt vmcnt(16)
  s_waitcnt lgkmcnt(8)
  v_mfma_f32_32x32x16_bf16 a[0:15], v[32:35], v[80:83], a[0:15]
  ds_read_b64_tr_b16 v[56:57], v8 offset:14336
  ds_read_b64_tr_b16 v[58:59], v8 offset:15360
  ds_read_b64_tr_b16 v[60:61], v9 offset:14336
  ds_read_b64_tr_b16 v[62:63], v9 offset:15360
  v_mfma_f32_32x32x16_bf16 a[16:31], v[36:39], v[80:83], a[16:31]
  buffer_load_dwordx4 v[112:115], v6, s[16:19], s95 offen offset:0
  s_waitcnt vmcnt(16)
  s_waitcnt lgkmcnt(8)
  v_mfma_f32_32x32x16_bf16 a[0:15], v[40:43], v[84:87], a[0:15]
  s_waitcnt vmcnt(10)
  s_barrier
  ds_read_b64_tr_b16 v[32:33], v8 offset:16384
  ds_read_b64_tr_b16 v[34:35], v8 offset:17408
  ds_read_b64_tr_b16 v[36:37], v9 offset:16384
  ds_read_b64_tr_b16 v[38:39], v9 offset:17408
  v_mfma_f32_32x32x16_bf16 a[16:31], v[44:47], v[84:87], a[16:31]
  buffer_load_dwordx4 v[116:119], v6, s[16:19], s95 offen offset:1024
  s_waitcnt lgkmcnt(8)
  v_mfma_f32_32x32x16_bf16 a[0:15], v[48:51], v[88:91], a[0:15]
  ds_read_b64_tr_b16 v[40:41], v8 offset:18432
  ds_read_b64_tr_b16 v[42:43], v8 offset:19456
  ds_read_b64_tr_b16 v[44:45], v9 offset:18432
  ds_read_b64_tr_b16 v[46:47], v9 offset:19456
  v_mfma_f32_32x32x16_bf16 a[16:31], v[52:55], v[88:91], a[16:31]
  buffer_load_dwordx4 v[120:123], v6, s[16:19], s95 offen offset:2048
  s_waitcnt lgkmcnt(8)
  v_mfma_f32_32x32x16_bf16 a[0:15], v[56:59], v[92:95], a[0:15]
  ds_read_b64_tr_b16 v[48:49], v8 offset:20480
  ds_read_b64_tr_b16 v[50:51], v8 offset:21504
  ds_read_b64_tr_b16 v[52:53], v9 offset:20480
  ds_read_b64_tr_b16 v[54:55], v9 offset:21504
  v_mfma_f32_32x32x16_bf16 a[16:31], v[60:63], v[92:95], a[16:31]
  buffer_load_dwordx4 v[124:127], v6, s[16:19], s95 offen offset:3072
  s_lshr_b32 s61, 0x6020203, s58
  s_and_b32 s61, s61, 255
  s_mul_i32 s98, s61, 114688
  s_lshl_b32 s99, s61, 13
  s_add_u32 s99, s99, 0x40000
  s_add_u32 m0, s57, 49152
  s_nop 0
  buffer_load_dwordx4 v1, s[8:11], s98 offen offset:0 lds
  buffer_load_dwordx4 v2, s[8:11], s98 offen offset:1024 lds
  buffer_load_dwordx4 v3, s[8:11], s98 offen offset:2048 lds
  buffer_load_dwordx4 v4, s[8:11], s98 offen offset:3072 lds
  s_waitcnt vmcnt(11)
  s_waitcnt lgkmcnt(8)
  v_mfma_f32_32x32x16_bf16 a[0:15], v[32:35], v[96:99], a[0:15]
  ds_read_b64_tr_b16 v[56:57], v8 offset:22528
  ds_read_b64_tr_b16 v[58:59], v8 offset:23552
  ds_read_b64_tr_b16 v[60:61], v9 offset:22528
  ds_read_b64_tr_b16 v[62:63], v9 offset:23552
  v_mfma_f32_32x32x16_bf16 a[16:31], v[36:39], v[96:99], a[16:31]
  buffer_load_dwordx4 v[64:67], v5, s[16:19], s97 offen offset:0
  s_waitcnt vmcnt(11)
  s_waitcnt lgkmcnt(8)
  v_mfma_f32_32x32x16_bf16 a[0:15], v[40:43], v[100:103], a[0:15]
  ds_read_b64_tr_b16 v[32:33], v8 offset:24576
  ds_read_b64_tr_b16 v[34:35], v8 offset:25600
  ds_read_b64_tr_b16 v[36:37], v9 offset:24576
  ds_read_b64_tr_b16 v[38:39], v9 offset:25600
  v_mfma_f32_32x32x16_bf16 a[16:31], v[44:47], v[100:103], a[16:31]
  buffer_load_dwordx4 v[68:71], v5, s[16:19], s97 offen offset:1024
  s_waitcnt vmcnt(11)
  s_waitcnt lgkmcnt(8)
  v_mfma_f32_32x32x16_bf16 a[0:15], v[48:51], v[104:107], a[0:15]
  ds_read_b64_tr_b16 v[40:41], v8 offset:26624
  ds_read_b64_tr_b16 v[42:43], v8 offset:27648
  ds_read_b64_tr_b16 v[44:45], v9 offset:26624
  ds_read_b64_tr_b16 v[46:47], v9 offset:27648
  v_mfma_f32_32x32x16_bf16 a[16:31], v[52:55], v[104:107], a[16:31]
  buffer_load_dwordx4 v[72:75], v5, s[16:19], s97 offen offset:2048
  s_waitcnt vmcnt(11)
  s_waitcnt lgkmcnt(8)
  v_mfma_f32_32x32x16_bf16 a[0:15], v[56:59], v[108:111], a[0:15]
  ds_read_b64_tr_b16 v[48:49], v8 offset:28672
  ds_read_b64_tr_b16 v[50:51], v8 offset:29696
  ds_read_b64_tr_b16 v[52:53], v9 offset:28672
  ds_read_b64_tr_b16 v[54:55], v9 offset:29696
  v_mfma_f32_32x32x16_bf16 a[16:31], v[60:63], v[108:111], a[16:31]
  buffer_load_dwordx4 v[76:79], v5, s[16:19], s97 offen offset:3072
  s_waitcnt vmcnt(11)
  s_waitcnt lgkmcnt(8)
  v_mfma_f32_32x32x16_bf16 a[0:15], v[32:35], v[112:115], a[0:15]
  ds_read_b64_tr_b16 v[56:57], v8 offset:30720
  ds_read_b64_tr_b16 v[58:59], v8 offset:31744
  ds_read_b64_tr_b16 v[60:61], v9 offset:30720
  ds_read_b64_tr_b16 v[62:63], v9 offset:31744
  v_mfma_f32_32x32x16_bf16 a[16:31], v[36:39], v[112:115], a[16:31]
  buffer_load_dwordx4 v[80:83], v6, s[16:19], s97 offen offset:0
  s_waitcnt vmcnt(11)
  s_waitcnt lgkmcnt(8)
  v_mfma_f32_32x32x16_bf16 a[0:15], v[40:43], v[116:119], a[0:15]
  s_barrier
  ds_read_b64_tr_b16 v[32:33], v8 offset:32768
  ds_read_b64_tr_b16 v[34:35], v8 offset:33792
  ds_read_b64_tr_b16 v[36:37], v9 offset:32768
  ds_read_b64_tr_b16 v[38:39], v9 offset:33792
  v_mfma_f32_32x32x16_bf16 a[16:31], v[44:47], v[116:119], a[16:31]
  buffer_load_dwordx4 v[84:87], v6, s[16:19], s97 offen offset:1024
  s_waitcnt vmcnt(11)
  s_waitcnt lgkmcnt(8)
  v_mfma_f32_32x32x16_bf16 a[0:15], v[48:51], v[120:123], a[0:15]
  ds_read_b64_tr_b16 v[40:41], v8 offset:34816
  ds_read_b64_tr_b16 v[42:43], v8 offset:35840
  ds_read_b64_tr_b16 v[44:45], v9 offset:34816
  ds_read_b64_tr_b16 v[46:47], v9 offset:35840
  v_mfma_f32_32x32x16_bf16 a[16:31], v[52:55], v[120:123], a[16:31]
  buffer_load_dwordx4 v[88:91], v6, s[16:19], s97 offen offset:2048
  s_waitcnt vmcnt(11)
  s_waitcnt lgkmcnt(8)
  v_mfma_f32_32x32x16_bf16 a[0:15], v[56:59], v[124:127], a[0:15]
  ds_read_b64_tr_b16 v[48:49], v8 offset:36864
  ds_read_b64_tr_b16 v[50:51], v8 offset:37888
  ds_read_b64_tr_b16 v[52:53], v9 offset:36864
  ds_read_b64_tr_b16 v[54:55], v9 offset:37888
  v_mfma_f32_32x32x16_bf16 a[16:31], v[60:63], v[124:127], a[16:31]
  buffer_load_dwordx4 v[92:95], v6, s[16:19], s97 offen offset:3072
  s_lshr_b32 s61, 0x2040307, s58
  s_and_b32 s61, s61, 255
  s_mul_i32 s92, s61, 114688
  s_lshl_b32 s93, s61, 13
  s_add_u32 s93, s93, 0x40000
  s_add_u32 m0, s57, 0
  s_nop 0
  buffer_load_dwordx4 v1, s[8:11], s92 offen offset:0 lds
  buffer_load_dwordx4 v2, s[8:11], s92 offen offset:1024 lds
  buffer_load_dwordx4 v3, s[8:11], s92 offen offset:2048 lds
  buffer_load_dwordx4 v4, s[8:11], s92 offen offset:3072 lds
  s_waitcnt vmcnt(11)
  s_waitcnt lgkmcnt(8)
  v_mfma_f32_32x32x16_bf16 a[0:15], v[32:35], v[64:67], a[0:15]
  ds_read_b64_tr_b16 v[56:57], v8 offset:38912
  ds_read_b64_tr_b16 v[58:59], v8 offset:39936
  ds_read_b64_tr_b16 v[60:61], v9 offset:38912
  ds_read_b64_tr_b16 v[62:63], v9 offset:39936
  v_mfma_f32_32x32x16_bf16 a[16:31], v[36:39], v[64:67], a[16:31]
  buffer_load_dwordx4 v[96:99], v5, s[16:19], s99 offen offset:0
  s_waitcnt vmcnt(11)
  s_waitcnt lgkmcnt(8)
  v_mfma_f32_32x32x16_bf16 a[0:15], v[40:43], v[68:71], a[0:15]
  ds_read_b64_tr_b16 v[32:33], v8 offset:40960
  ds_read_b64_tr_b16 v[34:35], v8 offset:41984
  ds_read_b64_tr_b16 v[36:37], v9 offset:40960
  ds_read_b64_tr_b16 v[38:39], v9 offset:41984
  v_mfma_f32_32x32x16_bf16 a[16:31], v[44:47], v[68:71], a[16:31]
  buffer_load_dwordx4 v[100:103], v5, s[16:19], s99 offen offset:1024
  s_waitcnt vmcnt(11)
  s_waitcnt lgkmcnt(8)
  v_mfma_f32_32x32x16_bf16 a[0:15], v[48:51], v[72:75], a[0:15]
  ds_read_b64_tr_b16 v[40:41], v8 offset:43008
  ds_read_b64_tr_b16 v[42:43], v8 offset:44032
  ds_read_b64_tr_b16 v[44:45], v9 offset:43008
  ds_read_b64_tr_b16 v[46:47], v9 offset:44032
  v_mfma_f32_32x32x16_bf16 a[16:31], v[52:55], v[72:75], a[16:31]
  buffer_load_dwordx4 v[104:107], v5, s[16:19], s99 offen offset:2048
  s_waitcnt vmcnt(11)
  s_waitcnt lgkmcnt(8)
  v_mfma_f32_32x32x16_bf16 a[0:15], v[56:59], v[76:79], a[0:15]
  ds_read_b64_tr_b16 v[48:49], v8 offset:45056
  ds_read_b64_tr_b16 v[50:51], v8 offset:46080
  ds_read_b64_tr_b16 v[52:53], v9 offset:45056
  ds_read_b64_tr_b16 v[54:55], v9 offset:46080
  v_mfma_f32_32x32x16_bf16 a[16:31], v[60:63], v[76:79], a[16:31]
  buffer_load_dwordx4 v[108:111], v5, s[16:19], s99 offen offset:3072
  s_waitcnt vmcnt(11)
  s_waitcnt lgkmcnt(8)
  v_mfma_f32_32x32x16_bf16 a[0:15], v[32:35], v[80:83], a[0:15]
  ds_read_b64_tr_b16 v[56:57], v8 offset:47104
  ds_read_b64_tr_b16 v[58:59], v8 offset:48128
  ds_read_b64_tr_b16 v[60:61], v9 offset:47104
  ds_read_b64_tr_b16 v[62:63], v9 offset:48128
  v_mfma_f32_32x32x16_bf16 a[16:31], v[36:39], v[80:83], a[16:31]
  buffer_load_dwordx4 v[112:115], v6, s[16:19], s99 offen offset:0
  s_waitcnt vmcnt(11)
  s_waitcnt lgkmcnt(8)
  v_mfma_f32_32x32x16_bf16 a[0:15], v[40:43], v[84:87], a[0:15]
  s_barrier
  ds_read_b64_tr_b16 v[32:33], v8 offset:49152
  ds_read_b64_tr_b16 v[34:35], v8 offset:50176
  ds_read_b64_tr_b16 v[36:37], v9 offset:49152
  ds_read_b64_tr_b16 v[38:39], v9 offset:50176
  v_mfma_f32_32x32x16_bf16 a[16:31], v[44:47], v[84:87], a[16:31]
  buffer_load_dwordx4 v[116:119], v6, s[16:19], s99 offen offset:1024
  s_waitcnt vmcnt(11)
  s_waitcnt lgkmcnt(8)
  v_mfma_f32_32x32x16_bf16 a[0:15], v[48:51], v[88:91], a[0:15]
  ds_read_b64_tr_b16 v[40:41], v8 offset:51200
  ds_read_b64_tr_b16 v[42:43], v8 offset:52224
  ds_read_b64_tr_b16 v[44:45], v9 offset:51200
  ds_read_b64_tr_b16 v[46:47], v9 offset:52224
  v_mfma_f32_32x32x16_bf16 a[16:31], v[52:55], v[88:91], a[16:31]
  buffer_load_dwordx4 v[120:123], v6, s[16:19], s99 offen offset:2048
  s_waitcnt vmcnt(11)
  s_waitcnt lgkmcnt(8)
  v_mfma_f32_32x32x16_bf16 a[0:15], v[56:59], v[92:95], a[0:15]
  ds_read_b64_tr_b16 v[48:49], v8 offset:53248
  ds_read_b64_tr_b16 v[50:51], v8 offset:54272
  ds_read_b64_tr_b16 v[52:53], v9 offset:53248
  ds_read_b64_tr_b16 v[54:55], v9 offset:54272
  v_mfma_f32_32x32x16_bf16 a[16:31], v[60:63], v[92:95], a[16:31]
  buffer_load_dwordx4 v[124:127], v6, s[16:19], s99 offen offset:3072
  s_lshr_b32 s61, 0x3050804, s58
  s_and_b32 s61, s61, 255
  s_mul_i32 s94, s61, 114688
  s_lshl_b32 s95, s61, 13
  s_add_u32 s95, s95, 0x40000
  s_add_u32 m0, s57, 16384
  s_nop 0
  buffer_load_dwordx4 v1, s[8:11], s94 offen offset:0 lds
  buffer_load_dwordx4 v2, s[8:11], s94 offen offset:1024 lds
  buffer_load_dwordx4 v3, s[8:11], s94 offen offset:2048 lds
  buffer_load_dwordx4 v4, s[8:11], s94 offen offset:3072 lds
  s_waitcnt vmcnt(11)
  s_waitcnt lgkmcnt(8)
  v_mfma_f32_32x32x16_bf16 a[0:15], v[32:35], v[96:99], a[0:15]
  ds_read_b64_tr_b16 v[56:57], v8 offset:55296
  ds_read_b64_tr_b16 v[58:59], v8 offset:56320
  ds_read_b64_tr_b16 v[60:61], v9 offset:55296
  ds_read_b64_tr_b16 v[62:63], v9 offset:56320
  v_mfma_f32_32x32x16_bf16 a[16:31], v[36:39], v[96:99], a[16:31]
  buffer_load_dwordx4 v[64:67], v5, s[16:19], s93 offen offset:0
  s_waitcnt vmcnt(11)
  s_waitcnt lgkmcnt(8)
  v_mfma_f32_32x32x16_bf16 a[0:15], v[40:43], v[100:103], a[0:15]
  ds_read_b64_tr_b16 v[32:33], v8 offset:57344
  ds_read_b64_tr_b16 v[34:35], v8 offset:58368
  ds_read_b64_tr_b16 v[36:37], v9 offset:57344
  ds_read_b64_tr_b16 v[38:39], v9 offset:58368
  v_mfma_f32_32x32x16_bf16 a[16:31], v[44:47], v[100:103], a[16:31]
  buffer_load_dwordx4 v[68:71], v5, s[16:19], s93 offen offset:1024
  s_waitcnt vmcnt(11)
  s_waitcnt lgkmcnt(8)
  v_mfma_f32_32x32x16_bf16 a[0:15], v[48:51], v[104:107], a[0:15]
  ds_read_b64_tr_b16 v[40:41], v8 offset:59392
  ds_read_b64_tr_b16 v[42:43], v8 offset:60416
  ds_read_b64_tr_b16 v[44:45], v9 offset:59392
  ds_read_b64_tr_b16 v[46:47], v9 offset:60416
  v_mfma_f32_32x32x16_bf16 a[16:31], v[52:55], v[104:107], a[16:31]
  buffer_load_dwordx4 v[72:75], v5, s[16:19], s93 offen offset:2048
  s_waitcnt vmcnt(11)
  s_waitcnt lgkmcnt(8)
  v_mfma_f32_32x32x16_bf16 a[0:15], v[56:59], v[108:111], a[0:15]
  ds_read_b64_tr_b16 v[48:49], v8 offset:61440
  ds_read_b64_tr_b16 v[50:51], v8 offset:62464
  ds_read_b64_tr_b16 v[52:53], v9 offset:61440
  ds_read_b64_tr_b16 v[54:55], v9 offset:62464
  v_mfma_f32_32x32x16_bf16 a[16:31], v[60:63], v[108:111], a[16:31]
  buffer_load_dwordx4 v[76:79], v5, s[16:19], s93 offen offset:3072
  s_waitcnt vmcnt(11)
  s_waitcnt lgkmcnt(8)
  v_mfma_f32_32x32x16_bf16 a[0:15], v[32:35], v[112:115], a[0:15]
  ds_read_b64_tr_b16 v[56:57], v8 offset:63488
  ds_read_b64_tr_b16 v[58:59], v8 offset:64512
  ds_read_b64_tr_b16 v[60:61], v9 offset:63488
  ds_read_b64_tr_b16 v[62:63], v9 offset:64512
  v_mfma_f32_32x32x16_bf16 a[16:31], v[36:39], v[112:115], a[16:31]
  buffer_load_dwordx4 v[80:83], v6, s[16:19], s93 offen offset:0
  s_waitcnt vmcnt(11)
  s_waitcnt lgkmcnt(8)
  v_mfma_f32_32x32x16_bf16 a[0:15], v[40:43], v[116:119], a[0:15]
  s_barrier
  ds_read_b64_tr_b16 v[32:33], v8 offset:0
  ds_read_b64_tr_b16 v[34:35], v8 offset:1024
  ds_read_b64_tr_b16 v[36:37], v9 offset:0
  ds_read_b64_tr_b16 v[38:39], v9 offset:1024
  v_mfma_f32_32x32x16_bf16 a[16:31], v[44:47], v[116:119], a[16:31]
  buffer_load_dwordx4 v[84:87], v6, s[16:19], s93 offen offset:1024
  s_waitcnt vmcnt(11)
  s_waitcnt lgkmcnt(8)
  v_mfma_f32_32x32x16_bf16 a[0:15], v[48:51], v[120:123], a[0:15]
  ds_read_b64_tr_b16 v[40:41], v8 offset:2048
  ds_read_b64_tr_b16 v[42:43], v8 offset:3072
  ds_read_b64_tr_b16 v[44:45], v9 offset:2048
  ds_read_b64_tr_b16 v[46:47], v9 offset:3072
  v_mfma_f32_32x32x16_bf16 a[16:31], v[52:55], v[120:123], a[16:31]
  buffer_load_dwordx4 v[88:91], v6, s[16:19], s93 offen offset:2048
  s_waitcnt vmcnt(11)
  s_waitcnt lgkmcnt(8)
  v_mfma_f32_32x32x16_bf16 a[0:15], v[56:59], v[124:127], a[0:15]
  ds_read_b64_tr_b16 v[48:49], v8 offset:4096
  ds_read_b64_tr_b16 v[50:51], v8 offset:5120
  ds_read_b64_tr_b16 v[52:53], v9 offset:4096
  ds_read_b64_tr_b16 v[54:55], v9 offset:5120
  v_mfma_f32_32x32x16_bf16 a[16:31], v[60:63], v[124:127], a[16:31]
  buffer_load_dwordx4 v[92:95], v6, s[16:19], s93 offen offset:3072
  s_lshr_b32 s61, 0x4090505, s58
  s_and_b32 s61, s61, 255
  s_mul_i32 s96, s61, 114688
  s_lshl_b32 s97, s61, 13
  s_add_u32 s97, s97, 0x40000
  s_add_u32 m0, s57, 32768
  s_nop 0
  buffer_load_dwordx4 v1, s[8:11], s96 offen offset:0 lds
  buffer_load_dwordx4 v2, s[8:11], s96 offen offset:1024 lds
  buffer_load_dwordx4 v3, s[8:11], s96 offen offset:2048 lds
  buffer_load_dwordx4 v4, s[8:11], s96 offen offset:3072 lds
  s_waitcnt vmcnt(11)
  s_waitcnt lgkmcnt(8)
  v_mfma_f32_32x32x16_bf16 a[0:15], v[32:35], v[64:67], a[0:15]
  ds_read_b64_tr_b16 v[56:57], v8 offset:6144
  ds_read_b64_tr_b16 v[58:59], v8 offset:7168
  ds_read_b64_tr_b16 v[60:61], v9 offset:6144
  ds_read_b64_tr_b16 v[62:63], v9 offset:7168
  v_mfma_f32_32x32x16_bf16 a[16:31], v[36:39], v[64:67], a[16:31]
  buffer_load_dwordx4 v[96:99], v5, s[16:19], s95 offen offset:0
  s_waitcnt vmcnt(11)
  s_waitcnt lgkmcnt(8)
  v_mfma_f32_32x32x16_bf16 a[0:15], v[40:43], v[68:71], a[0:15]
  ds_read_b64_tr_b16 v[32:33], v8 offset:8192
  ds_read_b64_tr_b16 v[34:35], v8 offset:9216
  ds_read_b64_tr_b16 v[36:37], v9 offset:8192
  ds_read_b64_tr_b16 v[38:39], v9 offset:9216
  v_mfma_f32_32x32x16_bf16 a[16:31], v[44:47], v[68:71], a[16:31]
  buffer_load_dwordx4 v[100:103], v5, s[16:19], s95 offen offset:1024
  s_waitcnt vmcnt(11)
  s_waitcnt lgkmcnt(8)
  v_mfma_f32_32x32x16_bf16 a[0:15], v[48:51], v[72:75], a[0:15]
  ds_read_b64_tr_b16 v[40:41], v8 offset:10240
  ds_read_b64_tr_b16 v[42:43], v8 offset:11264
  ds_read_b64_tr_b16 v[44:45], v9 offset:10240
  ds_read_b64_tr_b16 v[46:47], v9 offset:11264
  v_mfma_f32_32x32x16_bf16 a[16:31], v[52:55], v[72:75], a[16:31]
  buffer_load_dwordx4 v[104:107], v5, s[16:19], s95 offen offset:2048
  s_waitcnt vmcnt(11)
  s_waitcnt lgkmcnt(8)
  v_mfma_f32_32x32x16_bf16 a[0:15], v[56:59], v[76:79], a[0:15]
  ds_read_b64_tr_b16 v[48:49], v8 offset:12288
  ds_read_b64_tr_b16 v[50:51], v8 offset:13312
  ds_read_b64_tr_b16 v[52:53], v9 offset:12288
  ds_read_b64_tr_b16 v[54:55], v9 offset:13312
  v_mfma_f32_32x32x16_bf16 a[16:31], v[60:63], v[76:79], a[16:31]
  buffer_load_dwordx4 v[108:111], v5, s[16:19], s95 offen offset:3072
  s_waitcnt vmcnt(11)
  s_waitcnt lgkmcnt(8)
  v_mfma_f32_32x32x16_bf16 a[0:15], v[32:35], v[80:83], a[0:15]
  ds_read_b64_tr_b16 v[56:57], v8 offset:14336
  ds_read_b64_tr_b16 v[58:59], v8 offset:15360
  ds_read_b64_tr_b16 v[60:61], v9 offset:14336
  ds_read_b64_tr_b16 v[62:63], v9 offset:15360
  v_mfma_f32_32x32x16_bf16 a[16:31], v[36:39], v[80:83], a[16:31]
  buffer_load_dwordx4 v[112:115], v6, s[16:19], s95 offen offset:0
  s_waitcnt vmcnt(11)
  s_waitcnt lgkmcnt(8)
  v_mfma_f32_32x32x16_bf16 a[0:15], v[40:43], v[84:87], a[0:15]
  s_barrier
  ds_read_b64_tr_b16 v[32:33], v8 offset:16384
  ds_read_b64_tr_b16 v[34:35], v8 offset:17408
  ds_read_b64_tr_b16 v[36:37], v9 offset:16384
  ds_read_b64_tr_b16 v[38:39], v9 offset:17408
  v_mfma_f32_32x32x16_bf16 a[16:31], v[44:47], v[84:87], a[16:31]
  buffer_load_dwordx4 v[116:119], v6, s[16:19], s95 offen offset:1024
  s_waitcnt vmcnt(11)
  s_waitcnt lgkmcnt(8)
  v_mfma_f32_32x32x16_bf16 a[0:15], v[48:51], v[88:91], a[0:15]
  ds_read_b64_tr_b16 v[40:41], v8 offset:18432
  ds_read_b64_tr_b16 v[42:43], v8 offset:19456
  ds_read_b64_tr_b16 v[44:45], v9 offset:18432
  ds_read_b64_tr_b16 v[46:47], v9 offset:19456
  v_mfma_f32_32x32x16_bf16 a[16:31], v[52:55], v[88:91], a[16:31]
  buffer_load_dwordx4 v[120:123], v6, s[16:19], s95 offen offset:2048
  s_waitcnt vmcnt(11)
  s_waitcnt lgkmcnt(8)
  v_mfma_f32_32x32x16_bf16 a[0:15], v[56:59], v[92:95], a[0:15]
  ds_read_b64_tr_b16 v[48:49], v8 offset:20480
  ds_read_b64_tr_b16 v[50:51], v8 offset:21504
  ds_read_b64_tr_b16 v[52:53], v9 offset:20480
  ds_read_b64_tr_b16 v[54:55], v9 offset:21504
  v_mfma_f32_32x32x16_bf16 a[16:31], v[60:63], v[92:95], a[16:31]
  buffer_load_dwordx4 v[124:127], v6, s[16:19], s95 offen offset:3072
  s_lshr_b32 s61, 0xa060606, s58
  s_and_b32 s61, s61, 255
  s_mul_i32 s98, s61, 114688
  s_lshl_b32 s99, s61, 13
  s_add_u32 s99, s99, 0x40000
  s_add_u32 m0, s57, 49152
  s_nop 0
  buffer_load_dwordx4 v1, s[8:11], s98 offen offset:0 lds
  buffer_load_dwordx4 v2, s[8:11], s98 offen offset:1024 lds
  buffer_load_dwordx4 v3, s[8:11], s98 offen offset:2048 lds
  buffer_load_dwordx4 v4, s[8:11], s98 offen offset:3072 lds
  s_waitcnt vmcnt(11)
  s_waitcnt lgkmcnt(8)
  v_mfma_f32_32x32x16_bf16 a[0:15], v[32:35], v[96:99], a[0:15]
  ds_read_b64_tr_b16 v[56:57], v8 offset:22528
  ds_read_b64_tr_b16 v[58:59], v8 offset:23552
  ds_read_b64_tr_b16 v[60:61], v9 offset:22528
  ds_read_b64_tr_b16 v[62:63], v9 offset:23552
  v_mfma_f32_32x32x16_bf16 a[16:31], v[36:39], v[96:99], a[16:31]
  buffer_load_dwordx4 v[64:67], v5, s[16:19], s97 offen offset:0
  s_waitcnt vmcnt(11)
  s_waitcnt lgkmcnt(8)
  v_mfma_f32_32x32x16_bf16 a[0:15], v[40:43], v[100:103], a[0:15]
  ds_read_b64_tr_b16 v[32:33], v8 offset:24576
  ds_read_b64_tr_b16 v[34:35], v8 offset:25600
  ds_read_b64_tr_b16 v[36:37], v9 offset:24576
  ds_read_b64_tr_b16 v[38:39], v9 offset:25600
  v_mfma_f32_32x32x16_bf16 a[16:31], v[44:47], v[100:103], a[16:31]
  buffer_load_dwordx4 v[68:71], v5, s[16:19], s97 offen offset:1024
  s_waitcnt vmcnt(11)
  s_waitcnt lgkmcnt(8)
  v_mfma_f32_32x32x16_bf16 a[0:15], v[48:51], v[104:107], a[0:15]
  ds_read_b64_tr_b16 v[40:41], v8 offset:26624
  ds_read_b64_tr_b16 v[42:43], v8 offset:27648
  ds_read_b64_tr_b16 v[44:45], v9 offset:26624
  ds_read_b64_tr_b16 v[46:47], v9 offset:27648
  v_mfma_f32_32x32x16_bf16 a[16:31], v[52:55], v[104:107], a[16:31]
  buffer_load_dwordx4 v[72:75], v5, s[16:19], s97 offen offset:2048
  s_waitcnt vmcnt(11)
  s_waitcnt lgkmcnt(8)
  v_mfma_f32_32x32x16_bf16 a[0:15], v[56:59], v[108:111], a[0:15]
  ds_read_b64_tr_b16 v[48:49], v8 offset:28672
  ds_read_b64_tr_b16 v[50:51], v8 offset:29696
  ds_read_b64_tr_b16 v[52:53], v9 offset:28672
  ds_read_b64_tr_b16 v[54:55], v9 offset:29696
  v_mfma_f32_32x32x16_bf16 a[16:31], v[60:63], v[108:111], a[16:31]
  buffer_load_dwordx4 v[76:79], v5, s[16:19], s97 offen offset:3072
  s_waitcnt vmcnt(11)
  s_waitcnt lgkmcnt(8)
  v_mfma_f32_32x32x16_bf16 a[0:15], v[32:35], v[112:115], a[0:15]
  ds_read_b64_tr_b16 v[56:57], v8 offset:30720
  ds_read_b64_tr_b16 v[58:59], v8 offset:31744
  ds_read_b64_tr_b16 v[60:61], v9 offset:30720
  ds_read_b64_tr_b16 v[62:63], v9 offset:31744
  v_mfma_f32_32x32x16_bf16 a[16:31], v[36:39], v[112:115], a[16:31]
  buffer_load_dwordx4 v[80:83], v6, s[16:19], s97 offen offset:0
  s_waitcnt vmcnt(11)
  s_waitcnt lgkmcnt(8)
  v_mfma_f32_32x32x16_bf16 a[0:15], v[40:43], v[116:119], a[0:15]
  s_barrier
  ds_read_b64_tr_b16 v[32:33], v8 offset:32768
  ds_read_b64_tr_b16 v[34:35], v8 offset:33792
  ds_read_b64_tr_b16 v[36:37], v9 offset:32768
  ds_read_b64_tr_b16 v[38:39], v9 offset:33792
  v_mfma_f32_32x32x16_bf16 a[16:31], v[44:47], v[116:119], a[16:31]
  buffer_load_dwordx4 v[84:87], v6, s[16:19], s97 offen offset:1024
  s_waitcnt vmcnt(11)
  s_waitcnt lgkmcnt(8)
  v_mfma_f32_32x32x16_bf16 a[0:15], v[48:51], v[120:123], a[0:15]
  ds_read_b64_tr_b16 v[40:41], v8 offset:34816
  ds_read_b64_tr_b16 v[42:43], v8 offset:35840
  ds_read_b64_tr_b16 v[44:45], v9 offset:34816
  ds_read_b64_tr_b16 v[46:47], v9 offset:35840
  v_mfma_f32_32x32x16_bf16 a[16:31], v[52:55], v[120:123], a[16:31]
  buffer_load_dwordx4 v[88:91], v6, s[16:19], s97 offen offset:2048
  s_waitcnt vmcnt(11)
  s_waitcnt lgkmcnt(8)
  v_mfma_f32_32x32x16_bf16 a[0:15], v[56:59], v[124:127], a[0:15]
  ds_read_b64_tr_b16 v[48:49], v8 offset:36864
  ds_read_b64_tr_b16 v[50:51], v8 offset:37888
  ds_read_b64_tr_b16 v[52:53], v9 offset:36864
  ds_read_b64_tr_b16 v[54:55], v9 offset:37888
  v_mfma_f32_32x32x16_bf16 a[16:31], v[60:63], v[124:127], a[16:31]
  buffer_load_dwordx4 v[92:95], v6, s[16:19], s97 offen offset:3072
  s_lshr_b32 s61, 0x707070b, s58
  s_and_b32 s61, s61, 255
  s_mul_i32 s92, s61, 114688
  s_lshl_b32 s93, s61, 13
  s_add_u32 s93, s93, 0x40000
  s_add_u32 m0, s57, 0
  s_nop 0
  buffer_load_dwordx4 v1, s[8:11], s92 offen offset:0 lds
  buffer_load_dwordx4 v2, s[8:11], s92 offen offset:1024 lds
  buffer_load_dwordx4 v3, s[8:11], s92 offen offset:2048 lds
  buffer_load_dwordx4 v4, s[8:11], s92 offen offset:3072 lds
  s_waitcnt vmcnt(11)
  s_waitcnt lgkmcnt(8)
  v_mfma_f32_32x32x16_bf16 a[0:15], v[32:35], v[64:67], a[0:15]
  ds_read_b64_tr_b16 v[56:57], v8 offset:38912
  ds_read_b64_tr_b16 v[58:59], v8 offset:39936
  ds_read_b64_tr_b16 v[60:61], v9 offset:38912
  ds_read_b64_tr_b16 v[62:63], v9 offset:39936
  v_mfma_f32_32x32x16_bf16 a[16:31], v[36:39], v[64:67], a[16:31]
  buffer_load_dwordx4 v[96:99], v5, s[16:19], s99 offen offset:0
  s_waitcnt vmcnt(11)
  s_waitcnt lgkmcnt(8)
  v_mfma_f32_32x32x16_bf16 a[0:15], v[40:43], v[68:71], a[0:15]
  ds_read_b64_tr_b16 v[32:33], v8 offset:40960
  ds_read_b64_tr_b16 v[34:35], v8 offset:41984
  ds_read_b64_tr_b16 v[36:37], v9 offset:40960
  ds_read_b64_tr_b16 v[38:39], v9 offset:41984
  v_mfma_f32_32x32x16_bf16 a[16:31], v[44:47], v[68:71], a[16:31]
  buffer_load_dwordx4 v[100:103], v5, s[16:19], s99 offen offset:1024
  s_waitcnt vmcnt(11)
  s_waitcnt lgkmcnt(8)
  v_mfma_f32_32x32x16_bf16 a[0:15], v[48:51], v[72:75], a[0:15]
  ds_read_b64_tr_b16 v[40:41], v8 offset:43008
  ds_read_b64_tr_b16 v[42:43], v8 offset:44032
  ds_read_b64_tr_b16 v[44:45], v9 offset:43008
  ds_read_b64_tr_b16 v[46:47], v9 offset:44032
  v_mfma_f32_32x32x16_bf16 a[16:31], v[52:55], v[72:75], a[16:31]
  buffer_load_dwordx4 v[104:107], v5, s[16:19], s99 offen offset:2048
  s_waitcnt vmcnt(11)
  s_waitcnt lgkmcnt(8)
  v_mfma_f32_32x32x16_bf16 a[0:15], v[56:59], v[76:79], a[0:15]
  ds_read_b64_tr_b16 v[48:49], v8 offset:45056
  ds_read_b64_tr_b16 v[50:51], v8 offset:46080
  ds_read_b64_tr_b16 v[52:53], v9 offset:45056
  ds_read_b64_tr_b16 v[54:55], v9 offset:46080
  v_mfma_f32_32x32x16_bf16 a[16:31], v[60:63], v[76:79], a[16:31]
  buffer_load_dwordx4 v[108:111], v5, s[16:19], s99 offen offset:3072
  s_waitcnt vmcnt(11)
  s_waitcnt lgkmcnt(8)
  v_mfma_f32_32x32x16_bf16 a[0:15], v[32:35], v[80:83], a[0:15]
  ds_read_b64_tr_b16 v[56:57], v8 offset:47104
  ds_read_b64_tr_b16 v[58:59], v8 offset:48128
  ds_read_b64_tr_b16 v[60:61], v9 offset:47104
  ds_read_b64_tr_b16 v[62:63], v9 offset:48128
  v_mfma_f32_32x32x16_bf16 a[16:31], v[36:39], v[80:83], a[16:31]
  buffer_load_dwordx4 v[112:115], v6, s[16:19], s99 offen offset:0
  s_waitcnt vmcnt(11)
  s_waitcnt lgkmcnt(8)
  v_mfma_f32_32x32x16_bf16 a[0:15], v[40:43], v[84:87], a[0:15]
  s_barrier
  ds_read_b64_tr_b16 v[32:33], v8 offset:49152
  ds_read_b64_tr_b16 v[34:35], v8 offset:50176
  ds_read_b64_tr_b16 v[36:37], v9 offset:49152
  ds_read_b64_tr_b16 v[38:39], v9 offset:50176
  v_mfma_f32_32x32x16_bf16 a[16:31], v[44:47], v[84:87], a[16:31]
  buffer_load_dwordx4 v[116:119], v6, s[16:19], s99 offen offset:1024
  s_waitcnt vmcnt(11)
  s_waitcnt lgkmcnt(8)
  v_mfma_f32_32x32x16_bf16 a[0:15], v[48:51], v[88:91], a[0:15]
  ds_read_b64_tr_b16 v[40:41], v8 offset:51200
  ds_read_b64_tr_b16 v[42:43], v8 offset:52224
  ds_read_b64_tr_b16 v[44:45], v9 offset:51200
  ds_read_b64_tr_b16 v[46:47], v9 offset:52224
  v_mfma_f32_32x32x16_bf16 a[16:31], v[52:55], v[88:91], a[16:31]
  buffer_load_dwordx4 v[120:123], v6, s[16:19], s99 offen offset:2048
  s_waitcnt vmcnt(11)
  s_waitcnt lgkmcnt(8)
  v_mfma_f32_32x32x16_bf16 a[0:15], v[56:59], v[92:95], a[0:15]
  ds_read_b64_tr_b16 v[48:49], v8 offset:53248
  ds_read_b64_tr_b16 v[50:51], v8 offset:54272
  ds_read_b64_tr_b16 v[52:53], v9 offset:53248
  ds_read_b64_tr_b16 v[54:55], v9 offset:54272
  v_mfma_f32_32x32x16_bf16 a[16:31], v[60:63], v[92:95], a[16:31]
  buffer_load_dwordx4 v[124:127], v6, s[16:19], s99 offen offset:3072
  s_lshr_b32 s61, 0x8080c08, s58
  s_and_b32 s61, s61, 255
  s_mul_i32 s94, s61, 114688
  s_lshl_b32 s95, s61, 13
  s_add_u32 s95, s95, 0x40000
  s_add_u32 m0, s57, 16384
  s_nop 0
  buffer_load_dwordx4 v1, s[8:11], s94 offen offset:0 lds
  buffer_load_dwordx4 v2, s[8:11], s94 offen offset:1024 lds
  buffer_load_dwordx4 v3, s[8:11], s94 offen offset:2048 lds
  buffer_load_dwordx4 v4, s[8:11], s94 offen offset:3072 lds
  s_waitcnt vmcnt(11)
  s_waitcnt lgkmcnt(8)
  v_mfma_f32_32x32x16_bf16 a[0:15], v[32:35], v[96:99], a[0:15]
  ds_read_b64_tr_b16 v[56:57], v8 offset:55296
  ds_read_b64_tr_b16 v[58:59], v8 offset:56320
  ds_read_b64_tr_b16 v[60:61], v9 offset:55296
  ds_read_b64_tr_b16 v[62:63], v9 offset:56320
  v_mfma_f32_32x32x16_bf16 a[16:31], v[36:39], v[96:99], a[16:31]
  buffer_load_dwordx4 v[64:67], v5, s[16:19], s93 offen offset:0
  s_waitcnt vmcnt(11)
  s_waitcnt lgkmcnt(8)
  v_mfma_f32_32x32x16_bf16 a[0:15], v[40:43], v[100:103], a[0:15]
  ds_read_b64_tr_b16 v[32:33], v8 offset:57344
  ds_read_b64_tr_b16 v[34:35], v8 offset:58368
  ds_read_b64_tr_b16 v[36:37], v9 offset:57344
  ds_read_b64_tr_b16 v[38:39], v9 offset:58368
  v_mfma_f32_32x32x16_bf16 a[16:31], v[44:47], v[100:103], a[16:31]
  buffer_load_dwordx4 v[68:71], v5, s[16:19], s93 offen offset:1024
  s_waitcnt vmcnt(11)
  s_waitcnt lgkmcnt(8)
  v_mfma_f32_32x32x16_bf16 a[0:15], v[48:51], v[104:107], a[0:15]
  ds_read_b64_tr_b16 v[40:41], v8 offset:59392
  ds_read_b64_tr_b16 v[42:43], v8 offset:60416
  ds_read_b64_tr_b16 v[44:45], v9 offset:59392
  ds_read_b64_tr_b16 v[46:47], v9 offset:60416
  v_mfma_f32_32x32x16_bf16 a[16:31], v[52:55], v[104:107], a[16:31]
  buffer_load_dwordx4 v[72:75], v5, s[16:19], s93 offen offset:2048
  s_waitcnt vmcnt(11)
  s_waitcnt lgkmcnt(8)
  v_mfma_f32_32x32x16_bf16 a[0:15], v[56:59], v[108:111], a[0:15]
  ds_read_b64_tr_b16 v[48:49], v8 offset:61440
  ds_read_b64_tr_b16 v[50:51], v8 offset:62464
  ds_read_b64_tr_b16 v[52:53], v9 offset:61440
  ds_read_b64_tr_b16 v[54:55], v9 offset:62464
  v_mfma_f32_32x32x16_bf16 a[16:31], v[60:63], v[108:111], a[16:31]
  buffer_load_dwordx4 v[76:79], v5, s[16:19], s93 offen offset:3072
  s_waitcnt vmcnt(11)
  s_waitcnt lgkmcnt(8)
  v_mfma_f32_32x32x16_bf16 a[0:15], v[32:35], v[112:115], a[0:15]
  ds_read_b64_tr_b16 v[56:57], v8 offset:63488
  ds_read_b64_tr_b16 v[58:59], v8 offset:64512
  ds_read_b64_tr_b16 v[60:61], v9 offset:63488
  ds_read_b64_tr_b16 v[62:63], v9 offset:64512
  v_mfma_f32_32x32x16_bf16 a[16:31], v[36:39], v[112:115], a[16:31]
  buffer_load_dwordx4 v[80:83], v6, s[16:19], s93 offen offset:0
  s_waitcnt vmcnt(11)
  s_waitcnt lgkmcnt(8)
  v_mfma_f32_32x32x16_bf16 a[0:15], v[40:43], v[116:119], a[0:15]
  s_barrier
  ds_read_b64_tr_b16 v[32:33], v8 offset:0
  ds_read_b64_tr_b16 v[34:35], v8 offset:1024
  ds_read_b64_tr_b16 v[36:37], v9 offset:0
  ds_read_b64_tr_b16 v[38:39], v9 offset:1024
  v_mfma_f32_32x32x16_bf16 a[16:31], v[44:47], v[116:119], a[16:31]
  buffer_load_dwordx4 v[84:87], v6, s[16:19], s93 offen offset:1024
  s_waitcnt vmcnt(11)
  s_waitcnt lgkmcnt(8)
  v_mfma_f32_32x32x16_bf16 a[0:15], v[48:51], v[120:123], a[0:15]
  ds_read_b64_tr_b16 v[40:41], v8 offset:2048
  ds_read_b64_tr_b16 v[42:43], v8 offset:3072
  ds_read_b64_tr_b16 v[44:45], v9 offset:2048
  ds_read_b64_tr_b16 v[46:47], v9 offset:3072
  v_mfma_f32_32x32x16_bf16 a[16:31], v[52:55], v[120:123], a[16:31]
  buffer_load_dwordx4 v[88:91], v6, s[16:19], s93 offen offset:2048
  s_waitcnt vmcnt(11)
  s_waitcnt lgkmcnt(8)
  v_mfma_f32_32x32x16_bf16 a[0:15], v[56:59], v[124:127], a[0:15]
  ds_read_b64_tr_b16 v[48:49], v8 offset:4096
  ds_read_b64_tr_b16 v[50:51], v8 offset:5120
  ds_read_b64_tr_b16 v[52:53], v9 offset:4096
  ds_read_b64_tr_b16 v[54:55], v9 offset:5120
  v_mfma_f32_32x32x16_bf16 a[16:31], v[60:63], v[124:127], a[16:31]
  buffer_load_dwordx4 v[92:95], v6, s[16:19], s93 offen offset:3072
  s_lshr_b32 s61, 0x90d0909, s58
  s_and_b32 s61, s61, 255
  s_mul_i32 s96, s61, 114688
  s_lshl_b32 s97, s61, 13
  s_add_u32 s97, s97, 0x40000
  s_add_u32 m0, s57, 32768
  s_nop 0
  buffer_load_dwordx4 v1, s[8:11], s96 offen offset:0 lds
  buffer_load_dwordx4 v2, s[8:11], s96 offen offset:1024 lds
  buffer_load_dwordx4 v3, s[8:11], s96 offen offset:2048 lds
  buffer_load_dwordx4 v4, s[8:11], s96 offen offset:3072 lds
  s_waitcnt vmcnt(11)
  s_waitcnt lgkmcnt(8)
  v_mfma_f32_32x32x16_bf16 a[0:15], v[32:35], v[64:67], a[0:15]
  ds_read_b64_tr_b16 v[56:57], v8 offset:6144
  ds_read_b64_tr_b16 v[58:59], v8 offset:7168
  ds_read_b64_tr_b16 v[60:61], v9 offset:6144
  ds_read_b64_tr_b16 v[62:63], v9 offset:7168
  v_mfma_f32_32x32x16_bf16 a[16:31], v[36:39], v[64:67], a[16:31]
  buffer_load_dwordx4 v[96:99], v5, s[16:19], s95 offen offset:0
  s_waitcnt vmcnt(11)
  s_waitcnt lgkmcnt(8)
  v_mfma_f32_32x32x16_bf16 a[0:15], v[40:43], v[68:71], a[0:15]
  ds_read_b64_tr_b16 v[32:33], v8 offset:8192
  ds_read_b64_tr_b16 v[34:35], v8 offset:9216
  ds_read_b64_tr_b16 v[36:37], v9 offset:8192
  ds_read_b64_tr_b16 v[38:39], v9 offset:9216
  v_mfma_f32_32x32x16_bf16 a[16:31], v[44:47], v[68:71], a[16:31]
  buffer_load_dwordx4 v[100:103], v5, s[16:19], s95 offen offset:1024
  s_waitcnt vmcnt(11)
  s_waitcnt lgkmcnt(8)
  v_mfma_f32_32x32x16_bf16 a[0:15], v[48:51], v[72:75], a[0:15]
  ds_read_b64_tr_b16 v[40:41], v8 offset:10240
  ds_read_b64_tr_b16 v[42:43], v8 offset:11264
  ds_read_b64_tr_b16 v[44:45], v9 offset:10240
  ds_read_b64_tr_b16 v[46:47], v9 offset:11264
  v_mfma_f32_32x32x16_bf16 a[16:31], v[52:55], v[72:75], a[16:31]
  buffer_load_dwordx4 v[104:107], v5, s[16:19], s95 offen offset:2048
  s_waitcnt vmcnt(11)
  s_waitcnt lgkmcnt(8)
  v_mfma_f32_32x32x16_bf16 a[0:15], v[56:59], v[76:79], a[0:15]
  ds_read_b64_tr_b16 v[48:49], v8 offset:12288
  ds_read_b64_tr_b16 v[50:51], v8 offset:13312
  ds_read_b64_tr_b16 v[52:53], v9 offset:12288
  ds_read_b64_tr_b16 v[54:55], v9 offset:13312
  v_mfma_f32_32x32x16_bf16 a[16:31], v[60:63], v[76:79], a[16:31]
  buffer_load_dwordx4 v[108:111], v5, s[16:19], s95 offen offset:3072
  s_waitcnt vmcnt(11)
  s_waitcnt lgkmcnt(8)
  v_mfma_f32_32x32x16_bf16 a[0:15], v[32:35], v[80:83], a[0:15]
  ds_read_b64_tr_b16 v[56:57], v8 offset:14336
  ds_read_b64_tr_b16 v[58:59], v8 offset:15360
  ds_read_b64_tr_b16 v[60:61], v9 offset:14336
  ds_read_b64_tr_b16 v[62:63], v9 offset:15360
  v_mfma_f32_32x32x16_bf16 a[16:31], v[36:39], v[80:83], a[16:31]
  buffer_load_dwordx4 v[112:115], v6, s[16:19], s95 offen offset:0
  s_waitcnt vmcnt(11)
  s_waitcnt lgkmcnt(8)
  v_mfma_f32_32x32x16_bf16 a[0:15], v[40:43], v[84:87], a[0:15]
  s_barrier
  ds_read_b64_tr_b16 v[32:33], v8 offset:16384
  ds_read_b64_tr_b16 v[34:35], v8 offset:17408
  ds_read_b64_tr_b16 v[36:37], v9 offset:16384
  ds_read_b64_tr_b16 v[38:39], v9 offset:17408
  v_mfma_f32_32x32x16_bf16 a[16:31], v[44:47], v[84:87], a[16:31]
  buffer_load_dwordx4 v[116:119], v6, s[16:19], s95 offen offset:1024
  s_waitcnt vmcnt(11)
  s_waitcnt lgkmcnt(8)
  v_mfma_f32_32x32x16_bf16 a[0:15], v[48:51], v[88:91], a[0:15]
  ds_read_b64_tr_b16 v[40:41], v8 offset:18432
  ds_read_b64_tr_b16 v[42:43], v8 offset:19456
  ds_read_b64_tr_b16 v[44:45], v9 offset:18432
  ds_read_b64_tr_b16 v[46:47], v9 offset:19456
  v_mfma_f32_32x32x16_bf16 a[16:31], v[52:55], v[88:91], a[16:31]
  buffer_load_dword v128, v31, s[20:23], s65 offen offset:128 sc1
  buffer_load_dwordx4 v[120:123], v6, s[16:19], s95 offen offset:2048
  s_waitcnt vmcnt(12)
  s_waitcnt lgkmcnt(8)
  v_mfma_f32_32x32x16_bf16 a[0:15], v[56:59], v[92:95], a[0:15]
  ds_read_b64_tr_b16 v[48:49], v8 offset:20480
  ds_read_b64_tr_b16 v[50:51], v8 offset:21504
  ds_read_b64_tr_b16 v[52:53], v9 offset:20480
  ds_read_b64_tr_b16 v[54:55], v9 offset:21504
  v_mfma_f32_32x32x16_bf16 a[16:31], v[60:63], v[92:95], a[16:31]
  buffer_load_dwordx4 v[124:127], v6, s[16:19], s95 offen offset:3072
  s_lshr_b32 s61, 0xe0a0a0a, s58
  s_and_b32 s61, s61, 255
  s_mul_i32 s98, s61, 114688
  s_lshl_b32 s99, s61, 13
  s_cmp_lt_u32 s61, 14
  s_cselect_b32 s68, s8, s12
  s_cselect_b32 s69, s9, s13
  s_cselect_b32 s70, s10, s14
  s_cselect_b32 s59, 0, 0xffe78000
  s_mov_b32 s61, 0xfffe4000
  s_cselect_b32 s61, 0x40000, s61
  s_mov_b32 s71, 0x20000
  s_add_u32 s98, s98, s59
  s_add_u32 s99, s99, s61
  s_add_u32 m0, s57, 49152
  s_nop 0
  buffer_load_dwordx4 v1, s[68:71], s98 offen offset:0 lds
  buffer_load_dwordx4 v2, s[68:71], s98 offen offset:1024 lds
  buffer_load_dwordx4 v3, s[68:71], s98 offen offset:2048 lds
  buffer_load_dwordx4 v4, s[68:71], s98 offen offset:3072 lds
  s_waitcnt vmcnt(12)
  s_waitcnt lgkmcnt(8)
  v_mfma_f32_32x32x16_bf16 a[0:15], v[32:35], v[96:99], a[0:15]
  ds_read_b64_tr_b16 v[56:57], v8 offset:22528
  ds_read_b64_tr_b16 v[58:59], v8 offset:23552
  ds_read_b64_tr_b16 v[60:61], v9 offset:22528
  ds_read_b64_tr_b16 v[62:63], v9 offset:23552
  v_mfma_f32_32x32x16_bf16 a[16:31], v[36:39], v[96:99], a[16:31]
  buffer_load_dwordx4 v[64:67], v5, s[16:19], s97 offen offset:0
  s_waitcnt vmcnt(12)
  s_waitcnt lgkmcnt(8)
  v_mfma_f32_32x32x16_bf16 a[0:15], v[40:43], v[100:103], a[0:15]
  ds_read_b64_tr_b16 v[32:33], v8 offset:24576
  ds_read_b64_tr_b16 v[34:35], v8 offset:25600
  ds_read_b64_tr_b16 v[36:37], v9 offset:24576
  ds_read_b64_tr_b16 v[38:39], v9 offset:25600
  v_mfma_f32_32x32x16_bf16 a[16:31], v[44:47], v[100:103], a[16:31]
  buffer_load_dwordx4 v[68:71], v5, s[16:19], s97 offen offset:1024
  s_waitcnt vmcnt(12)
  s_waitcnt lgkmcnt(8)
  v_mfma_f32_32x32x16_bf16 a[0:15], v[48:51], v[104:107], a[0:15]
  ds_read_b64_tr_b16 v[40:41], v8 offset:26624
  ds_read_b64_tr_b16 v[42:43], v8 offset:27648
  ds_read_b64_tr_b16 v[44:45], v9 offset:26624
  ds_read_b64_tr_b16 v[46:47], v9 offset:27648
  v_mfma_f32_32x32x16_bf16 a[16:31], v[52:55], v[104:107], a[16:31]
  buffer_load_dwordx4 v[72:75], v5, s[16:19], s97 offen offset:2048
  s_waitcnt vmcnt(12)
  s_waitcnt lgkmcnt(8)
  v_mfma_f32_32x32x16_bf16 a[0:15], v[56:59], v[108:111], a[0:15]
  ds_read_b64_tr_b16 v[48:49], v8 offset:28672
  ds_read_b64_tr_b16 v[50:51], v8 offset:29696
  ds_read_b64_tr_b16 v[52:53], v9 offset:28672
  ds_read_b64_tr_b16 v[54:55], v9 offset:29696
  v_mfma_f32_32x32x16_bf16 a[16:31], v[60:63], v[108:111], a[16:31]
  buffer_load_dwordx4 v[76:79], v5, s[16:19], s97 offen offset:3072
  s_waitcnt vmcnt(12)
  s_waitcnt lgkmcnt(8)
  v_mfma_f32_32x32x16_bf16 a[0:15], v[32:35], v[112:115], a[0:15]
  ds_read_b64_tr_b16 v[56:57], v8 offset:30720
  ds_read_b64_tr_b16 v[58:59], v8 offset:31744
  ds_read_b64_tr_b16 v[60:61], v9 offset:30720
  ds_read_b64_tr_b16 v[62:63], v9 offset:31744
  v_mfma_f32_32x32x16_bf16 a[16:31], v[36:39], v[112:115], a[16:31]
  buffer_load_dwordx4 v[80:83], v6, s[16:19], s97 offen offset:0
  s_waitcnt vmcnt(12)
  s_waitcnt lgkmcnt(8)
  v_mfma_f32_32x32x16_bf16 a[0:15], v[40:43], v[116:119], a[0:15]
  s_barrier
  ds_read_b64_tr_b16 v[32:33], v8 offset:32768
  ds_read_b64_tr_b16 v[34:35], v8 offset:33792
  ds_read_b64_tr_b16 v[36:37], v9 offset:32768
  ds_read_b64_tr_b16 v[38:39], v9 offset:33792
  v_mfma_f32_32x32x16_bf16 a[16:31], v[44:47], v[116:119], a[16:31]
  buffer_load_dwordx4 v[84:87], v6, s[16:19], s97 offen offset:1024
  s_waitcnt vmcnt(11)
  s_waitcnt lgkmcnt(8)
  v_mfma_f32_32x32x16_bf16 a[0:15], v[48:51], v[120:123], a[0:15]
  ds_read_b64_tr_b16 v[40:41], v8 offset:34816
  ds_read_b64_tr_b16 v[42:43], v8 offset:35840
  ds_read_b64_tr_b16 v[44:45], v9 offset:34816
  ds_read_b64_tr_b16 v[46:47], v9 offset:35840
  v_mfma_f32_32x32x16_bf16 a[16:31], v[52:55], v[120:123], a[16:31]
  buffer_load_dwordx4 v[88:91], v6, s[16:19], s97 offen offset:2048
  s_waitcnt vmcnt(11)
  s_waitcnt lgkmcnt(8)
  v_mfma_f32_32x32x16_bf16 a[0:15], v[56:59], v[124:127], a[0:15]
  ds_read_b64_tr_b16 v[48:49], v8 offset:36864
  ds_read_b64_tr_b16 v[50:51], v8 offset:37888
  ds_read_b64_tr_b16 v[52:53], v9 offset:36864
  ds_read_b64_tr_b16 v[54:55], v9 offset:37888
  v_mfma_f32_32x32x16_bf16 a[16:31], v[60:63], v[124:127], a[16:31]
  buffer_load_dwordx4 v[92:95], v6, s[16:19], s97 offen offset:3072
  s_lshr_b32 s61, 0xb0b0b0f, s58
  s_and_b32 s61, s61, 255
  s_mul_i32 s92, s61, 114688
  s_lshl_b32 s93, s61, 13
  s_cmp_lt_u32 s61, 14
  s_cselect_b32 s68, s8, s12
  s_cselect_b32 s69, s9, s13
  s_cselect_b32 s70, s10, s14
  s_cselect_b32 s59, 0, 0xffe78000
  s_mov_b32 s61, 0xfffe4000
  s_cselect_b32 s61, 0x40000, s61
  s_mov_b32 s71, 0x20000
  s_add_u32 s92, s92, s59
  s_add_u32 s93, s93, s61
  s_add_u32 m0, s57, 0
  s_nop 0
  buffer_load_dwordx4 v1, s[68:71], s92 offen offset:0 lds
  buffer_load_dwordx4 v2, s[68:71], s92 offen offset:1024 lds
  buffer_load_dwordx4 v3, s[68:71], s92 offen offset:2048 lds
  buffer_load_dwordx4 v4, s[68:71], s92 offen offset:3072 lds
  s_waitcnt vmcnt(11)
  s_waitcnt lgkmcnt(8)
  v_mfma_f32_32x32x16_bf16 a[0:15], v[32:35], v[64:67], a[0:15]
  ds_read_b64_tr_b16 v[56:57], v8 offset:38912
  ds_read_b64_tr_b16 v[58:59], v8 offset:39936
  ds_read_b64_tr_b16 v[60:61], v9 offset:38912
  ds_read_b64_tr_b16 v[62:63], v9 offset:39936
  v_mfma_f32_32x32x16_bf16 a[16:31], v[36:39], v[64:67], a[16:31]
  s_mov_b32 s3, 65536
  s_branch K2_OC_C
K2_OC_L:
  buffer_load_dword v128, v31, s[20:23], s65 offen offset:128 sc1
  s_waitcnt vmcnt(0)
K2_OC_C:
  v_cmp_eq_u32 vcc, 0, v128
  s_sub_u32 s3, s3, 1
  s_nop 4
  s_cmp_eq_u64 vcc, 0
  s_cselect_b32 s3, 0, s3
  s_cmp_lg_u32 s3, 0
  s_cbranch_scc1 K2_OC_L
  buffer_load_dwordx4 v[96:99], v5, s[16:19], s99 offen offset:0
  s_waitcnt vmcnt(11)
  s_waitcnt lgkmcnt(8)
  v_mfma_f32_32x32x16_bf16 a[0:15], v[40:43], v[68:71], a[0:15]
  ds_read_b64_tr_b16 v[32:33], v8 offset:40960
  ds_read_b64_tr_b16 v[34:35], v8 offset:41984
  ds_read_b64_tr_b16 v[36:37], v9 offset:40960
  ds_read_b64_tr_b16 v[38:39], v9 offset:41984
  v_mfma_f32_32x32x16_bf16 a[16:31], v[44:47], v[68:71], a[16:31]
  buffer_load_dwordx4 v[100:103], v5, s[16:19], s99 offen offset:1024
  s_waitcnt vmcnt(11)
  s_waitcnt lgkmcnt(8)
  v_mfma_f32_32x32x16_bf16 a[0:15], v[48:51], v[72:75], a[0:15]
  ds_read_b64_tr_b16 v[40:41], v8 offset:43008
  ds_read_b64_tr_b16 v[42:43], v8 offset:44032
  ds_read_b64_tr_b16 v[44:45], v9 offset:43008
  ds_read_b64_tr_b16 v[46:47], v9 offset:44032
  v_mfma_f32_32x32x16_bf16 a[16:31], v[52:55], v[72:75], a[16:31]
  buffer_load_dwordx4 v[104:107], v5, s[16:19], s99 offen offset:2048
  s_waitcnt vmcnt(11)
  s_waitcnt lgkmcnt(8)
  v_mfma_f32_32x32x16_bf16 a[0:15], v[56:59], v[76:79], a[0:15]
  ds_read_b64_tr_b16 v[48:49], v8 offset:45056
  ds_read_b64_tr_b16 v[50:51], v8 offset:46080
  ds_read_b64_tr_b16 v[52:53], v9 offset:45056
  ds_read_b64_tr_b16 v[54:55], v9 offset:46080
  v_mfma_f32_32x32x16_bf16 a[16:31], v[60:63], v[76:79], a[16:31]
  buffer_load_dwordx4 v[108:111], v5, s[16:19], s99 offen offset:3072
  s_waitcnt vmcnt(11)
  s_waitcnt lgkmcnt(8)
  v_mfma_f32_32x32x16_bf16 a[0:15], v[32:35], v[80:83], a[0:15]
  ds_read_b64_tr_b16 v[56:57], v8 offset:47104
  ds_read_b64_tr_b16 v[58:59], v8 offset:48128
  ds_read_b64_tr_b16 v[60:61], v9 offset:47104
  ds_read_b64_tr_b16 v[62:63], v9 offset:48128
  v_mfma_f32_32x32x16_bf16 a[16:31], v[36:39], v[80:83], a[16:31]
  buffer_load_dwordx4 v[112:115], v6, s[16:19], s99 offen offset:0
  s_waitcnt vmcnt(11)
  s_waitcnt lgkmcnt(8)
  v_mfma_f32_32x32x16_bf16 a[0:15], v[40:43], v[84:87], a[0:15]
  s_barrier
  ds_read_b64_tr_b16 v[32:33], v8 offset:49152
  ds_read_b64_tr_b16 v[34:35], v8 offset:50176
  ds_read_b64_tr_b16 v[36:37], v9 offset:49152
  ds_read_b64_tr_b16 v[38:39], v9 offset:50176
  v_mfma_f32_32x32x16_bf16 a[16:31], v[44:47], v[84:87], a[16:31]
  buffer_load_dwordx4 v[116:119], v6, s[16:19], s99 offen offset:1024
  s_waitcnt vmcnt(11)
  s_waitcnt lgkmcnt(8)
  v_mfma_f32_32x32x16_bf16 a[0:15], v[48:51], v[88:91], a[0:15]
  ds_read_b64_tr_b16 v[40:41], v8 offset:51200
  ds_read_b64_tr_b16 v[42:43], v8 offset:52224
  ds_read_b64_tr_b16 v[44:45], v9 offset:51200
  ds_read_b64_tr_b16 v[46:47], v9 offset:52224
  v_mfma_f32_32x32x16_bf16 a[16:31], v[52:55], v[88:91], a[16:31]
  buffer_load_dwordx4 v[120:123], v6, s[16:19], s99 offen offset:2048
  s_waitcnt vmcnt(11)
  s_waitcnt lgkmcnt(8)
  v_mfma_f32_32x32x16_bf16 a[0:15], v[56:59], v[92:95], a[0:15]
  ds_read_b64_tr_b16 v[48:49], v8 offset:53248
  ds_read_b64_tr_b16 v[50:51], v8 offset:54272
  ds_read_b64_tr_b16 v[52:53], v9 offset:53248
  ds_read_b64_tr_b16 v[54:55], v9 offset:54272
  v_mfma_f32_32x32x16_bf16 a[16:31], v[60:63], v[92:95], a[16:31]
  buffer_load_dwordx4 v[124:127], v6, s[16:19], s99 offen offset:3072
  s_lshr_b32 s61, 0xe0a0a0a, s58
  s_and_b32 s61, s61, 255
  s_cmp_ge_u32 s61, 14
  s_cbranch_scc1 K2_S11
  s_lshr_b32 s61, 0xc0c100c, s58
  s_and_b32 s61, s61, 255
  s_mul_i32 s94, s61, 114688
  s_lshl_b32 s95, s61, 13
  s_cmp_lt_u32 s61, 14
  s_cselect_b32 s68, s8, s12
  s_cselect_b32 s69, s9, s13
  s_cselect_b32 s70, s10, s14
  s_cselect_b32 s59, 0, 0xffe78000
  s_mov_b32 s61, 0xfffe4000
  s_cselect_b32 s61, 0x40000, s61
  s_mov_b32 s71, 0x20000
  s_add_u32 s94, s94, s59
  s_add_u32 s95, s95, s61
  s_add_u32 m0, s57, 16384
  s_nop 0
  buffer_load_dwordx4 v1, s[68:71], s94 offen offset:0 lds
  buffer_load_dwordx4 v2, s[68:71], s94 offen offset:1024 lds
  buffer_load_dwordx4 v3, s[68:71], s94 offen offset:2048 lds
  buffer_load_dwordx4 v4, s[68:71], s94 offen offset:3072 lds
  s_waitcnt vmcnt(11)
  s_waitcnt lgkmcnt(8)
  v_mfma_f32_32x32x16_bf16 a[0:15], v[32:35], v[96:99], a[0:15]
  ds_read_b64_tr_b16 v[56:57], v8 offset:55296
  ds_read_b64_tr_b16 v[58:59], v8 offset:56320
  ds_read_b64_tr_b16 v[60:61], v9 offset:55296
  ds_read_b64_tr_b16 v[62:63], v9 offset:56320
  v_mfma_f32_32x32x16_bf16 a[16:31], v[36:39], v[96:99], a[16:31]
  buffer_load_dwordx4 v[64:67], v5, s[16:19], s93 offen offset:0
  s_waitcnt vmcnt(11)
  s_waitcnt lgkmcnt(8)
  v_mfma_f32_32x32x16_bf16 a[0:15], v[40:43], v[100:103], a[0:15]
  ds_read_b64_tr_b16 v[32:33], v8 offset:57344
  ds_read_b64_tr_b16 v[34:35], v8 offset:58368
  ds_read_b64_tr_b16 v[36:37], v9 offset:57344
  ds_read_b64_tr_b16 v[38:39], v9 offset:58368
  v_mfma_f32_32x32x16_bf16 a[16:31], v[44:47], v[100:103], a[16:31]
  buffer_load_dwordx4 v[68:71], v5, s[16:19], s93 offen offset:1024
  s_waitcnt vmcnt(11)
  s_waitcnt lgkmcnt(8)
  v_mfma_f32_32x32x16_bf16 a[0:15], v[48:51], v[104:107], a[0:15]
  ds_read_b64_tr_b16 v[40:41], v8 offset:59392
  ds_read_b64_tr_b16 v[42:43], v8 offset:60416
  ds_read_b64_tr_b16 v[44:45], v9 offset:59392
  ds_read_b64_tr_b16 v[46:47], v9 offset:60416
  v_mfma_f32_32x32x16_bf16 a[16:31], v[52:55], v[104:107], a[16:31]
  buffer_load_dwordx4 v[72:75], v5, s[16:19], s93 offen offset:2048
  s_waitcnt vmcnt(11)
  s_waitcnt lgkmcnt(8)
  v_mfma_f32_32x32x16_bf16 a[0:15], v[56:59], v[108:111], a[0:15]
  ds_read_b64_tr_b16 v[48:49], v8 offset:61440
  ds_read_b64_tr_b16 v[50:51], v8 offset:62464
  ds_read_b64_tr_b16 v[52:53], v9 offset:61440
  ds_read_b64_tr_b16 v[54:55], v9 offset:62464
  v_mfma_f32_32x32x16_bf16 a[16:31], v[60:63], v[108:111], a[16:31]
  buffer_load_dwordx4 v[76:79], v5, s[16:19], s93 offen offset:3072
  s_waitcnt vmcnt(11)
  s_waitcnt lgkmcnt(8)
  v_mfma_f32_32x32x16_bf16 a[0:15], v[32:35], v[112:115], a[0:15]
  ds_read_b64_tr_b16 v[56:57], v8 offset:63488
  ds_read_b64_tr_b16 v[58:59], v8 offset:64512
  ds_read_b64_tr_b16 v[60:61], v9 offset:63488
  ds_read_b64_tr_b16 v[62:63], v9 offset:64512
  v_mfma_f32_32x32x16_bf16 a[16:31], v[36:39], v[112:115], a[16:31]
  buffer_load_dwordx4 v[80:83], v6, s[16:19], s93 offen offset:0
  s_waitcnt vmcnt(11)
  s_waitcnt lgkmcnt(8)
  v_mfma_f32_32x32x16_bf16 a[0:15], v[40:43], v[116:119], a[0:15]
  s_barrier
  ds_read_b64_tr_b16 v[32:33], v8 offset:0
  ds_read_b64_tr_b16 v[34:35], v8 offset:1024
  ds_read_b64_tr_b16 v[36:37], v9 offset:0
  ds_read_b64_tr_b16 v[38:39], v9 offset:1024
  v_mfma_f32_32x32x16_bf16 a[16:31], v[44:47], v[116:119], a[16:31]
  buffer_load_dwordx4 v[84:87], v6, s[16:19], s93 offen offset:1024
  s_waitcnt vmcnt(11)
  s_waitcnt lgkmcnt(8)
  v_mfma_f32_32x32x16_bf16 a[0:15], v[48:51], v[120:123], a[0:15]
  ds_read_b64_tr_b16 v[40:41], v8 offset:2048
  ds_read_b64_tr_b16 v[42:43], v8 offset:3072
  ds_read_b64_tr_b16 v[44:45], v9 offset:2048
  ds_read_b64_tr_b16 v[46:47], v9 offset:3072
  v_mfma_f32_32x32x16_bf16 a[16:31], v[52:55], v[120:123], a[16:31]
  buffer_load_dwordx4 v[88:91], v6, s[16:19], s93 offen offset:2048
  s_waitcnt vmcnt(11)
  s_waitcnt lgkmcnt(8)
  v_mfma_f32_32x32x16_bf16 a[0:15], v[56:59], v[124:127], a[0:15]
  ds_read_b64_tr_b16 v[48:49], v8 offset:4096
  ds_read_b64_tr_b16 v[50:51], v8 offset:5120
  ds_read_b64_tr_b16 v[52:53], v9 offset:4096
  ds_read_b64_tr_b16 v[54:55], v9 offset:5120
  v_mfma_f32_32x32x16_bf16 a[16:31], v[60:63], v[124:127], a[16:31]
  buffer_load_dwordx4 v[92:95], v6, s[16:19], s93 offen offset:3072
  s_branch K2_E11
K2_S11:
  s_lshr_b32 s61, 0xc0c100c, s58
  s_and_b32 s61, s61, 255
  s_mul_i32 s94, s61, 114688
  s_lshl_b32 s95, s61, 13
  s_cmp_lt_u32 s61, 14
  s_cselect_b32 s68, s8, s12
  s_cselect_b32 s69, s9, s13
  s_cselect_b32 s70, s10, s14
  s_cselect_b32 s59, 0, 0xffe78000
  s_mov_b32 s61, 0xfffe4000
  s_cselect_b32 s61, 0x40000, s61
  s_mov_b32 s71, 0x20000
  s_add_u32 s94, s94, s59
  s_add_u32 s95, s95, s61
  s_add_u32 m0, s57, 16384
  s_nop 0
  buffer_load_dwordx4 v1, s[68:71], s94 offen offset:0 lds
  buffer_load_dwordx4 v2, s[68:71], s94 offen offset:1024 lds
  buffer_load_dwordx4 v3, s[68:71], s94 offen offset:2048 lds
  buffer_load_dwordx4 v4, s[68:71], s94 offen offset:3072 lds
  s_waitcnt vmcnt(11)
  s_waitcnt lgkmcnt(8)
  v_mfma_f32_32x32x16_bf16 a[32:47], v[32:35], v[96:99], a[32:47]
  ds_read_b64_tr_b16 v[56:57], v8 offset:55296
  ds_read_b64_tr_b16 v[58:59], v8 offset:56320
  ds_read_b64_tr_b16 v[60:61], v9 offset:55296
  ds_read_b64_tr_b16 v[62:63], v9 offset:56320
  v_mfma_f32_32x32x16_bf16 a[48:63], v[36:39], v[96:99], a[48:63]
  buffer_load_dwordx4 v[64:67], v5, s[16:19], s93 offen offset:0
  s_waitcnt vmcnt(11)
  s_waitcnt lgkmcnt(8)
  v_mfma_f32_32x32x16_bf16 a[32:47], v[40:43], v[100:103], a[32:47]
  ds_read_b64_tr_b16 v[32:33], v8 offset:57344
  ds_read_b64_tr_b16 v[34:35], v8 offset:58368
  ds_read_b64_tr_b16 v[36:37], v9 offset:57344
  ds_read_b64_tr_b16 v[38:39], v9 offset:58368
  v_mfma_f32_32x32x16_bf16 a[48:63], v[44:47], v[100:103], a[48:63]
  buffer_load_dwordx4 v[68:71], v5, s[16:19], s93 offen offset:1024
  s_waitcnt vmcnt(11)
  s_waitcnt lgkmcnt(8)
  v_mfma_f32_32x32x16_bf16 a[32:47], v[48:51], v[104:107], a[32:47]
  ds_read_b64_tr_b16 v[40:41], v8 offset:59392
  ds_read_b64_tr_b16 v[42:43], v8 offset:60416
  ds_read_b64_tr_b16 v[44:45], v9 offset:59392
  ds_read_b64_tr_b16 v[46:47], v9 offset:60416
  v_mfma_f32_32x32x16_bf16 a[48:63], v[52:55], v[104:107], a[48:63]
  buffer_load_dwordx4 v[72:75], v5, s[16:19], s93 offen offset:2048
  s_waitcnt vmcnt(11)
  s_waitcnt lgkmcnt(8)
  v_mfma_f32_32x32x16_bf16 a[32:47], v[56:59], v[108:111], a[32:47]
  ds_read_b64_tr_b16 v[48:49], v8 offset:61440
  ds_read_b64_tr_b16 v[50:51], v8 offset:62464
  ds_read_b64_tr_b16 v[52:53], v9 offset:61440
  ds_read_b64_tr_b16 v[54:55], v9 offset:62464
  v_mfma_f32_32x32x16_bf16 a[48:63], v[60:63], v[108:111], a[48:63]
  buffer_load_dwordx4 v[76:79], v5, s[16:19], s93 offen offset:3072
  s_waitcnt vmcnt(11)
  s_waitcnt lgkmcnt(8)
  v_mfma_f32_32x32x16_bf16 a[32:47], v[32:35], v[112:115], a[32:47]
  ds_read_b64_tr_b16 v[56:57], v8 offset:63488
  ds_read_b64_tr_b16 v[58:59], v8 offset:64512
  ds_read_b64_tr_b16 v[60:61], v9 offset:63488
  ds_read_b64_tr_b16 v[62:63], v9 offset:64512
  v_mfma_f32_32x32x16_bf16 a[48:63], v[36:39], v[112:115], a[48:63]
  buffer_load_dwordx4 v[80:83], v6, s[16:19], s93 offen offset:0
  s_waitcnt vmcnt(11)
  s_waitcnt lgkmcnt(8)
  v_mfma_f32_32x32x16_bf16 a[32:47], v[40:43], v[116:119], a[32:47]
  s_barrier
  ds_read_b64_tr_b16 v[32:33], v8 offset:0
  ds_read_b64_tr_b16 v[34:35], v8 offset:1024
  ds_read_b64_tr_b16 v[36:37], v9 offset:0
  ds_read_b64_tr_b16 v[38:39], v9 offset:1024
  v_mfma_f32_32x32x16_bf16 a[48:63], v[44:47], v[116:119], a[48:63]
  buffer_load_dwordx4 v[84:87], v6, s[16:19], s93 offen offset:1024
  s_waitcnt vmcnt(11)
  s_waitcnt lgkmcnt(8)
  v_mfma_f32_32x32x16_bf16 a[32:47], v[48:51], v[120:123], a[32:47]
  ds_read_b64_tr_b16 v[40:41], v8 offset:2048
  ds_read_b64_tr_b16 v[42:43], v8 offset:3072
  ds_read_b64_tr_b16 v[44:45], v9 offset:2048
  ds_read_b64_tr_b16 v[46:47], v9 offset:3072
  v_mfma_f32_32x32x16_bf16 a[48:63], v[52:55], v[120:123], a[48:63]
  buffer_load_dwordx4 v[88:91], v6, s[16:19], s93 offen offset:2048
  s_waitcnt vmcnt(11)
  s_waitcnt lgkmcnt(8)
  v_mfma_f32_32x32x16_bf16 a[32:47], v[56:59], v[124:127], a[32:47]
  ds_read_b64_tr_b16 v[48:49], v8 offset:4096
  ds_read_b64_tr_b16 v[50:51], v8 offset:5120
  ds_read_b64_tr_b16 v[52:53], v9 offset:4096
  ds_read_b64_tr_b16 v[54:55], v9 offset:5120
  v_mfma_f32_32x32x16_bf16 a[48:63], v[60:63], v[124:127], a[48:63]
  buffer_load_dwordx4 v[92:95], v6, s[16:19], s93 offen offset:3072
K2_E11:
  s_lshr_b32 s61, 0xb0b0b0f, s58
  s_and_b32 s61, s61, 255
  s_cmp_ge_u32 s61, 14
  s_cbranch_scc1 K2_S12
  s_lshr_b32 s61, 0xd110d0d, s58
  s_and_b32 s61, s61, 255
  s_mul_i32 s96, s61, 114688
  s_lshl_b32 s97, s61, 13
  s_cmp_lt_u32 s61, 14
  s_cselect_b32 s68, s8, s12
  s_cselect_b32 s69, s9, s13
  s_cselect_b32 s70, s10, s14
  s_cselect_b32 s59, 0, 0xffe78000
  s_mov_b32 s61, 0xfffe4000
  s_cselect_b32 s61, 0x40000, s61
  s_mov_b32 s71, 0x20000
  s_add_u32 s96, s96, s59
  s_add_u32 s97, s97, s61
  s_add_u32 m0, s57, 32768
  s_nop 0
  buffer_load_dwordx4 v1, s[68:71], s96 offen offset:0 lds
  buffer_load_dwordx4 v2, s[68:71], s96 offen offset:1024 lds
  buffer_load_dwordx4 v3, s[68:71], s96 offen offset:2048 lds
  buffer_load_dwordx4 v4, s[68:71], s96 offen offset:3072 lds
  s_waitcnt vmcnt(11)
  s_waitcnt lgkmcnt(8)
  v_mfma_f32_32x32x16_bf16 a[0:15], v[32:35], v[64:67], a[0:15]
  ds_read_b64_tr_b16 v[56:57], v8 offset:6144
  ds_read_b64_tr_b16 v[58:59], v8 offset:7168
  ds_read_b64_tr_b16 v[60:61], v9 offset:6144
  ds_read_b64_tr_b16 v[62:63], v9 offset:7168
  v_mfma_f32_32x32x16_bf16 a[16:31], v[36:39], v[64:67], a[16:31]
  buffer_load_dwordx4 v[96:99], v5, s[16:19], s95 offen offset:0
  s_waitcnt vmcnt(11)
  s_waitcnt lgkmcnt(8)
  v_mfma_f32_32x32x16_bf16 a[0:15], v[40:43], v[68:71], a[0:15]
  ds_read_b64_tr_b16 v[32:33], v8 offset:8192
  ds_read_b64_tr_b16 v[34:35], v8 offset:9216
  ds_read_b64_tr_b16 v[36:37], v9 offset:8192
  ds_read_b64_tr_b16 v[38:39], v9 offset:9216
  v_mfma_f32_32x32x16_bf16 a[16:31], v[44:47], v[68:71], a[16:31]
  buffer_load_dwordx4 v[100:103], v5, s[16:19], s95 offen offset:1024
  s_waitcnt vmcnt(11)
  s_waitcnt lgkmcnt(8)
  v_mfma_f32_32x32x16_bf16 a[0:15], v[48:51], v[72:75], a[0:15]
  ds_read_b64_tr_b16 v[40:41], v8 offset:10240
  ds_read_b64_tr_b16 v[42:43], v8 offset:11264
  ds_read_b64_tr_b16 v[44:45], v9 offset:10240
  ds_read_b64_tr_b16 v[46:47], v9 offset:11264
  v_mfma_f32_32x32x16_bf16 a[16:31], v[52:55], v[72:75], a[16:31]
  buffer_load_dwordx4 v[104:107], v5, s[16:19], s95 offen offset:2048
  s_waitcnt vmcnt(11)
  s_waitcnt lgkmcnt(8)
  v_mfma_f32_32x32x16_bf16 a[0:15], v[56:59], v[76:79], a[0:15]
  ds_read_b64_tr_b16 v[48:49], v8 offset:12288
  ds_read_b64_tr_b16 v[50:51], v8 offset:13312
  ds_read_b64_tr_b16 v[52:53], v9 offset:12288
  ds_read_b64_tr_b16 v[54:55], v9 offset:13312
  v_mfma_f32_32x32x16_bf16 a[16:31], v[60:63], v[76:79], a[16:31]
  buffer_load_dwordx4 v[108:111], v5, s[16:19], s95 offen offset:3072
  s_waitcnt vmcnt(11)
  s_waitcnt lgkmcnt(8)
  v_mfma_f32_32x32x16_bf16 a[0:15], v[32:35], v[80:83], a[0:15]
  ds_read_b64_tr_b16 v[56:57], v8 offset:14336
  ds_read_b64_tr_b16 v[58:59], v8 offset:15360
  ds_read_b64_tr_b16 v[60:61], v9 offset:14336
  ds_read_b64_tr_b16 v[62:63], v9 offset:15360
  v_mfma_f32_32x32x16_bf16 a[16:31], v[36:39], v[80:83], a[16:31]
  buffer_load_dwordx4 v[112:115], v6, s[16:19], s95 offen offset:0
  s_waitcnt vmcnt(11)
  s_waitcnt lgkmcnt(8)
  v_mfma_f32_32x32x16_bf16 a[0:15], v[40:43], v[84:87], a[0:15]
  s_barrier
  ds_read_b64_tr_b16 v[32:33], v8 offset:16384
  ds_read_b64_tr_b16 v[34:35], v8 offset:17408
  ds_read_b64_tr_b16 v[36:37], v9 offset:16384
  ds_read_b64_tr_b16 v[38:39], v9 offset:17408
  v_mfma_f32_32x32x16_bf16 a[16:31], v[44:47], v[84:87], a[16:31]
  buffer_load_dwordx4 v[116:119], v6, s[16:19], s95 offen offset:1024
  s_waitcnt vmcnt(11)
  s_waitcnt lgkmcnt(8)
  v_mfma_f32_32x32x16_bf16 a[0:15], v[48:51], v[88:91], a[0:15]
  ds_read_b64_tr_b16 v[40:41], v8 offset:18432
  ds_read_b64_tr_b16 v[42:43], v8 offset:19456
  ds_read_b64_tr_b16 v[44:45], v9 offset:18432
  ds_read_b64_tr_b16 v[46:47], v9 offset:19456
  v_mfma_f32_32x32x16_bf16 a[16:31], v[52:55], v[88:91], a[16:31]
  buffer_load_dwordx4 v[120:123], v6, s[16:19], s95 offen offset:2048
  s_waitcnt vmcnt(11)
  s_waitcnt lgkmcnt(8)
  v_mfma_f32_32x32x16_bf16 a[0:15], v[56:59], v[92:95], a[0:15]
  ds_read_b64_tr_b16 v[48:49], v8 offset:20480
  ds_read_b64_tr_b16 v[50:51], v8 offset:21504
  ds_read_b64_tr_b16 v[52:53], v9 offset:20480
  ds_read_b64_tr_b16 v[54:55], v9 offset:21504
  v_mfma_f32_32x32x16_bf16 a[16:31], v[60:63], v[92:95], a[16:31]
  buffer_load_dwordx4 v[124:127], v6, s[16:19], s95 offen offset:3072
  s_branch K2_E12
K2_S12:
  s_lshr_b32 s61, 0xd110d0d, s58
  s_and_b32 s61, s61, 255
  s_mul_i32 s96, s61, 114688
  s_lshl_b32 s97, s61, 13
  s_cmp_lt_u32 s61, 14
  s_cselect_b32 s68, s8, s12
  s_cselect_b32 s69, s9, s13
  s_cselect_b32 s70, s10, s14
  s_cselect_b32 s59, 0, 0xffe78000
  s_mov_b32 s61, 0xfffe4000
  s_cselect_b32 s61, 0x40000, s61
  s_mov_b32 s71, 0x20000
  s_add_u32 s96, s96, s59
  s_add_u32 s97, s97, s61
  s_add_u32 m0, s57, 32768
  s_nop 0
  buffer_load_dwordx4 v1, s[68:71], s96 offen offset:0 lds
  buffer_load_dwordx4 v2, s[68:71], s96 offen offset:1024 lds
  buffer_load_dwordx4 v3, s[68:71], s96 offen offset:2048 lds
  buffer_load_dwordx4 v4, s[68:71], s96 offen offset:3072 lds
  s_waitcnt vmcnt(11)
  s_waitcnt lgkmcnt(8)
  v_mfma_f32_32x32x16_bf16 a[32:47], v[32:35], v[64:67], a[32:47]
  ds_read_b64_tr_b16 v[56:57], v8 offset:6144
  ds_read_b64_tr_b16 v[58:59], v8 offset:7168
  ds_read_b64_tr_b16 v[60:61], v9 offset:6144
  ds_read_b64_tr_b16 v[62:63], v9 offset:7168
  v_mfma_f32_32x32x16_bf16 a[48:63], v[36:39], v[64:67], a[48:63]
  buffer_load_dwordx4 v[96:99], v5, s[16:19], s95 offen offset:0
  s_waitcnt vmcnt(11)
  s_waitcnt lgkmcnt(8)
  v_mfma_f32_32x32x16_bf16 a[32:47], v[40:43], v[68:71], a[32:47]
  ds_read_b64_tr_b16 v[32:33], v8 offset:8192
  ds_read_b64_tr_b16 v[34:35], v8 offset:9216
  ds_read_b64_tr_b16 v[36:37], v9 offset:8192
  ds_read_b64_tr_b16 v[38:39], v9 offset:9216
  v_mfma_f32_32x32x16_bf16 a[48:63], v[44:47], v[68:71], a[48:63]
  buffer_load_dwordx4 v[100:103], v5, s[16:19], s95 offen offset:1024
  s_waitcnt vmcnt(11)
  s_waitcnt lgkmcnt(8)
  v_mfma_f32_32x32x16_bf16 a[32:47], v[48:51], v[72:75], a[32:47]
  ds_read_b64_tr_b16 v[40:41], v8 offset:10240
  ds_read_b64_tr_b16 v[42:43], v8 offset:11264
  ds_read_b64_tr_b16 v[44:45], v9 offset:10240
  ds_read_b64_tr_b16 v[46:47], v9 offset:11264
  v_mfma_f32_32x32x16_bf16 a[48:63], v[52:55], v[72:75], a[48:63]
  buffer_load_dwordx4 v[104:107], v5, s[16:19], s95 offen offset:2048
  s_waitcnt vmcnt(11)
  s_waitcnt lgkmcnt(8)
  v_mfma_f32_32x32x16_bf16 a[32:47], v[56:59], v[76:79], a[32:47]
  ds_read_b64_tr_b16 v[48:49], v8 offset:12288
  ds_read_b64_tr_b16 v[50:51], v8 offset:13312
  ds_read_b64_tr_b16 v[52:53], v9 offset:12288
  ds_read_b64_tr_b16 v[54:55], v9 offset:13312
  v_mfma_f32_32x32x16_bf16 a[48:63], v[60:63], v[76:79], a[48:63]
  buffer_load_dwordx4 v[108:111], v5, s[16:19], s95 offen offset:3072
  s_waitcnt vmcnt(11)
  s_waitcnt lgkmcnt(8)
  v_mfma_f32_32x32x16_bf16 a[32:47], v[32:35], v[80:83], a[32:47]
  ds_read_b64_tr_b16 v[56:57], v8 offset:14336
  ds_read_b64_tr_b16 v[58:59], v8 offset:15360
  ds_read_b64_tr_b16 v[60:61], v9 offset:14336
  ds_read_b64_tr_b16 v[62:63], v9 offset:15360
  v_mfma_f32_32x32x16_bf16 a[48:63], v[36:39], v[80:83], a[48:63]
  buffer_load_dwordx4 v[112:115], v6, s[16:19], s95 offen offset:0
  s_waitcnt vmcnt(11)
  s_waitcnt lgkmcnt(8)
  v_mfma_f32_32x32x16_bf16 a[32:47], v[40:43], v[84:87], a[32:47]
  s_barrier
  ds_read_b64_tr_b16 v[32:33], v8 offset:16384
  ds_read_b64_tr_b16 v[34:35], v8 offset:17408
  ds_read_b64_tr_b16 v[36:37], v9 offset:16384
  ds_read_b64_tr_b16 v[38:39], v9 offset:17408
  v_mfma_f32_32x32x16_bf16 a[48:63], v[44:47], v[84:87], a[48:63]
  buffer_load_dwordx4 v[116:119], v6, s[16:19], s95 offen offset:1024
  s_waitcnt vmcnt(11)
  s_waitcnt lgkmcnt(8)
  v_mfma_f32_32x32x16_bf16 a[32:47], v[48:51], v[88:91], a[32:47]
  ds_read_b64_tr_b16 v[40:41], v8 offset:18432
  ds_read_b64_tr_b16 v[42:43], v8 offset:19456
  ds_read_b64_tr_b16 v[44:45], v9 offset:18432
  ds_read_b64_tr_b16 v[46:47], v9 offset:19456
  v_mfma_f32_32x32x16_bf16 a[48:63], v[52:55], v[88:91], a[48:63]
  buffer_load_dwordx4 v[120:123], v6, s[16:19], s95 offen offset:2048
  s_waitcnt vmcnt(11)
  s_waitcnt lgkmcnt(8)
  v_mfma_f32_32x32x16_bf16 a[32:47], v[56:59], v[92:95], a[32:47]
  ds_read_b64_tr_b16 v[48:49], v8 offset:20480
  ds_read_b64_tr_b16 v[50:51], v8 offset:21504
  ds_read_b64_tr_b16 v[52:53], v9 offset:20480
  ds_read_b64_tr_b16 v[54:55], v9 offset:21504
  v_mfma_f32_32x32x16_bf16 a[48:63], v[60:63], v[92:95], a[48:63]
  buffer_load_dwordx4 v[124:127], v6, s[16:19], s95 offen offset:3072
K2_E12:
  s_lshr_b32 s61, 0xc0c100c, s58
  s_and_b32 s61, s61, 255
  s_cmp_ge_u32 s61, 14
  s_cbranch_scc1 K2_S13
  s_lshr_b32 s61, 0x120e0e0e, s58
  s_and_b32 s61, s61, 255
  s_mul_i32 s98, s61, 114688
  s_lshl_b32 s99, s61, 13
  s_add_u32 s98, s98, 0xffe78000
  s_add_u32 s99, s99, 0xfffe4000
  s_add_u32 m0, s57, 49152
  s_nop 0
  buffer_load_dwordx4 v1, s[12:15], s98 offen offset:0 lds
  buffer_load_dwordx4 v2, s[12:15], s98 offen offset:1024 lds
  buffer_load_dwordx4 v3, s[12:15], s98 offen offset:2048 lds
  buffer_load_dwordx4 v4, s[12:15], s98 offen offset:3072 lds
  s_waitcnt vmcnt(11)
  s_waitcnt lgkmcnt(8)
  v_mfma_f32_32x32x16_bf16 a[0:15], v[32:35], v[96:99], a[0:15]
  ds_read_b64_tr_b16 v[56:57], v8 offset:22528
  ds_read_b64_tr_b16 v[58:59], v8 offset:23552
  ds_read_b64_tr_b16 v[60:61], v9 offset:22528
  ds_read_b64_tr_b16 v[62:63], v9 offset:23552
  v_mfma_f32_32x32x16_bf16 a[16:31], v[36:39], v[96:99], a[16:31]
  buffer_load_dwordx4 v[64:67], v5, s[16:19], s97 offen offset:0
  s_waitcnt vmcnt(11)
  s_waitcnt lgkmcnt(8)
  v_mfma_f32_32x32x16_bf16 a[0:15], v[40:43], v[100:103], a[0:15]
  ds_read_b64_tr_b16 v[32:33], v8 offset:24576
  ds_read_b64_tr_b16 v[34:35], v8 offset:25600
  ds_read_b64_tr_b16 v[36:37], v9 offset:24576
  ds_read_b64_tr_b16 v[38:39], v9 offset:25600
  v_mfma_f32_32x32x16_bf16 a[16:31], v[44:47], v[100:103], a[16:31]
  buffer_load_dwordx4 v[68:71], v5, s[16:19], s97 offen offset:1024
  s_waitcnt vmcnt(11)
  s_waitcnt lgkmcnt(8)
  v_mfma_f32_32x32x16_bf16 a[0:15], v[48:51], v[104:107], a[0:15]
  ds_read_b64_tr_b16 v[40:41], v8 offset:26624
  ds_read_b64_tr_b16 v[42:43], v8 offset:27648
  ds_read_b64_tr_b16 v[44:45], v9 offset:26624
  ds_read_b64_tr_b16 v[46:47], v9 offset:27648
  v_mfma_f32_32x32x16_bf16 a[16:31], v[52:55], v[104:107], a[16:31]
  buffer_load_dwordx4 v[72:75], v5, s[16:19], s97 offen offset:2048
  s_waitcnt vmcnt(11)
  s_waitcnt lgkmcnt(8)
  v_mfma_f32_32x32x16_bf16 a[0:15], v[56:59], v[108:111], a[0:15]
  ds_read_b64_tr_b16 v[48:49], v8 offset:28672
  ds_read_b64_tr_b16 v[50:51], v8 offset:29696
  ds_read_b64_tr_b16 v[52:53], v9 offset:28672
  ds_read_b64_tr_b16 v[54:55], v9 offset:29696
  v_mfma_f32_32x32x16_bf16 a[16:31], v[60:63], v[108:111], a[16:31]
  buffer_load_dwordx4 v[76:79], v5, s[16:19], s97 offen offset:3072
  s_waitcnt vmcnt(11)
  s_waitcnt lgkmcnt(8)
  v_mfma_f32_32x32x16_bf16 a[0:15], v[32:35], v[112:115], a[0:15]
  ds_read_b64_tr_b16 v[56:57], v8 offset:30720
  ds_read_b64_tr_b16 v[58:59], v8 offset:31744
  ds_read_b64_tr_b16 v[60:61], v9 offset:30720
  ds_read_b64_tr_b16 v[62:63], v9 offset:31744
  v_mfma_f32_32x32x16_bf16 a[16:31], v[36:39], v[112:115], a[16:31]
  buffer_load_dwordx4 v[80:83], v6, s[16:19], s97 offen offset:0
  s_waitcnt vmcnt(11)
  s_waitcnt lgkmcnt(8)
  v_mfma_f32_32x32x16_bf16 a[0:15], v[40:43], v[116:119], a[0:15]
  s_barrier
  ds_read_b64_tr_b16 v[32:33], v8 offset:32768
  ds_read_b64_tr_b16 v[34:35], v8 offset:33792
  ds_read_b64_tr_b16 v[36:37], v9 offset:32768
  ds_read_b64_tr_b16 v[38:39], v9 offset:33792
  v_mfma_f32_32x32x16_bf16 a[16:31], v[44:47], v[116:119], a[16:31]
  buffer_load_dwordx4 v[84:87], v6, s[16:19], s97 offen offset:1024
  s_waitcnt vmcnt(11)
  s_waitcnt lgkmcnt(8)
  v_mfma_f32_32x32x16_bf16 a[0:15], v[48:51], v[120:123], a[0:15]
  ds_read_b64_tr_b16 v[40:41], v8 offset:34816
  ds_read_b64_tr_b16 v[42:43], v8 offset:35840
  ds_read_b64_tr_b16 v[44:45], v9 offset:34816
  ds_read_b64_tr_b16 v[46:47], v9 offset:35840
  v_mfma_f32_32x32x16_bf16 a[16:31], v[52:55], v[120:123], a[16:31]
  buffer_load_dwordx4 v[88:91], v6, s[16:19], s97 offen offset:2048
  s_waitcnt vmcnt(11)
  s_waitcnt lgkmcnt(8)
  v_mfma_f32_32x32x16_bf16 a[0:15], v[56:59], v[124:127], a[0:15]
  ds_read_b64_tr_b16 v[48:49], v8 offset:36864
  ds_read_b64_tr_b16 v[50:51], v8 offset:37888
  ds_read_b64_tr_b16 v[52:53], v9 offset:36864
  ds_read_b64_tr_b16 v[54:55], v9 offset:37888
  v_mfma_f32_32x32x16_bf16 a[16:31], v[60:63], v[124:127], a[16:31]
  buffer_load_dwordx4 v[92:95], v6, s[16:19], s97 offen offset:3072
  s_branch K2_E13
K2_S13:
  s_lshr_b32 s61, 0x120e0e0e, s58
  s_and_b32 s61, s61, 255
  s_mul_i32 s98, s61, 114688
  s_lshl_b32 s99, s61, 13
  s_add_u32 s98, s98, 0xffe78000
  s_add_u32 s99, s99, 0xfffe4000
  s_add_u32 m0, s57, 49152
  s_nop 0
  buffer_load_dwordx4 v1, s[12:15], s98 offen offset:0 lds
  buffer_load_dwordx4 v2, s[12:15], s98 offen offset:1024 lds
  buffer_load_dwordx4 v3, s[12:15], s98 offen offset:2048 lds
  buffer_load_dwordx4 v4, s[12:15], s98 offen offset:3072 lds
  s_waitcnt vmcnt(11)
  s_waitcnt lgkmcnt(8)
  v_mfma_f32_32x32x16_bf16 a[32:47], v[32:35], v[96:99], a[32:47]
  ds_read_b64_tr_b16 v[56:57], v8 offset:22528
  ds_read_b64_tr_b16 v[58:59], v8 offset:23552
  ds_read_b64_tr_b16 v[60:61], v9 offset:22528
  ds_read_b64_tr_b16 v[62:63], v9 offset:23552
  v_mfma_f32_32x32x16_bf16 a[48:63], v[36:39], v[96:99], a[48:63]
  buffer_load_dwordx4 v[64:67], v5, s[16:19], s97 offen offset:0
  s_waitcnt vmcnt(11)
  s_waitcnt lgkmcnt(8)
  v_mfma_f32_32x32x16_bf16 a[32:47], v[40:43], v[100:103], a[32:47]
  ds_read_b64_tr_b16 v[32:33], v8 offset:24576
  ds_read_b64_tr_b16 v[34:35], v8 offset:25600
  ds_read_b64_tr_b16 v[36:37], v9 offset:24576
  ds_read_b64_tr_b16 v[38:39], v9 offset:25600
  v_mfma_f32_32x32x16_bf16 a[48:63], v[44:47], v[100:103], a[48:63]
  buffer_load_dwordx4 v[68:71], v5, s[16:19], s97 offen offset:1024
  s_waitcnt vmcnt(11)
  s_waitcnt lgkmcnt(8)
  v_mfma_f32_32x32x16_bf16 a[32:47], v[48:51], v[104:107], a[32:47]
  ds_read_b64_tr_b16 v[40:41], v8 offset:26624
  ds_read_b64_tr_b16 v[42:43], v8 offset:27648
  ds_read_b64_tr_b16 v[44:45], v9 offset:26624
  ds_read_b64_tr_b16 v[46:47], v9 offset:27648
  v_mfma_f32_32x32x16_bf16 a[48:63], v[52:55], v[104:107], a[48:63]
  buffer_load_dwordx4 v[72:75], v5, s[16:19], s97 offen offset:2048
  s_waitcnt vmcnt(11)
  s_waitcnt lgkmcnt(8)
  v_mfma_f32_32x32x16_bf16 a[32:47], v[56:59], v[108:111], a[32:47]
  ds_read_b64_tr_b16 v[48:49], v8 offset:28672
  ds_read_b64_tr_b16 v[50:51], v8 offset:29696
  ds_read_b64_tr_b16 v[52:53], v9 offset:28672
  ds_read_b64_tr_b16 v[54:55], v9 offset:29696
  v_mfma_f32_32x32x16_bf16 a[48:63], v[60:63], v[108:111], a[48:63]
  buffer_load_dwordx4 v[76:79], v5, s[16:19], s97 offen offset:3072
  s_waitcnt vmcnt(11)
  s_waitcnt lgkmcnt(8)
  v_mfma_f32_32x32x16_bf16 a[32:47], v[32:35], v[112:115], a[32:47]
  ds_read_b64_tr_b16 v[56:57], v8 offset:30720
  ds_read_b64_tr_b16 v[58:59], v8 offset:31744
  ds_read_b64_tr_b16 v[60:61], v9 offset:30720
  ds_read_b64_tr_b16 v[62:63], v9 offset:31744
  v_mfma_f32_32x32x16_bf16 a[48:63], v[36:39], v[112:115], a[48:63]
  buffer_load_dwordx4 v[80:83], v6, s[16:19], s97 offen offset:0
  s_waitcnt vmcnt(11)
  s_waitcnt lgkmcnt(8)
  v_mfma_f32_32x32x16_bf16 a[32:47], v[40:43], v[116:119], a[32:47]
  s_barrier
  ds_read_b64_tr_b16 v[32:33], v8 offset:32768
  ds_read_b64_tr_b16 v[34:35], v8 offset:33792
  ds_read_b64_tr_b16 v[36:37], v9 offset:32768
  ds_read_b64_tr_b16 v[38:39], v9 offset:33792
  v_mfma_f32_32x32x16_bf16 a[48:63], v[44:47], v[116:119], a[48:63]
  buffer_load_dwordx4 v[84:87], v6, s[16:19], s97 offen offset:1024
  s_waitcnt vmcnt(11)
  s_waitcnt lgkmcnt(8)
  v_mfma_f32_32x32x16_bf16 a[32:47], v[48:51], v[120:123], a[32:47]
  ds_read_b64_tr_b16 v[40:41], v8 offset:34816
  ds_read_b64_tr_b16 v[42:43], v8 offset:35840
  ds_read_b64_tr_b16 v[44:45], v9 offset:34816
  ds_read_b64_tr_b16 v[46:47], v9 offset:35840
  v_mfma_f32_32x32x16_bf16 a[48:63], v[52:55], v[120:123], a[48:63]
  buffer_load_dwordx4 v[88:91], v6, s[16:19], s97 offen offset:2048
  s_waitcnt vmcnt(11)
  s_waitcnt lgkmcnt(8)
  v_mfma_f32_32x32x16_bf16 a[32:47], v[56:59], v[124:127], a[32:47]
  ds_read_b64_tr_b16 v[48:49], v8 offset:36864
  ds_read_b64_tr_b16 v[50:51], v8 offset:37888
  ds_read_b64_tr_b16 v[52:53], v9 offset:36864
  ds_read_b64_tr_b16 v[54:55], v9 offset:37888
  v_mfma_f32_32x32x16_bf16 a[48:63], v[60:63], v[124:127], a[48:63]
  buffer_load_dwordx4 v[92:95], v6, s[16:19], s97 offen offset:3072
K2_E13:
  s_lshr_b32 s61, 0xd110d0d, s58
  s_and_b32 s61, s61, 255
  s_cmp_ge_u32 s61, 14
  s_cbranch_scc1 K2_S14
  s_lshr_b32 s61, 0xf0f0f13, s58
  s_and_b32 s61, s61, 255
  s_mul_i32 s92, s61, 114688
  s_lshl_b32 s93, s61, 13
  s_add_u32 s92, s92, 0xffe78000
  s_add_u32 s93, s93, 0xfffe4000
  s_add_u32 m0, s57, 0
  s_nop 0
  buffer_load_dwordx4 v1, s[12:15], s92 offen offset:0 lds
  buffer_load_dwordx4 v2, s[12:15], s92 offen offset:1024 lds
  buffer_load_dwordx4 v3, s[12:15], s92 offen offset:2048 lds
  buffer_load_dwordx4 v4, s[12:15], s92 offen offset:3072 lds
  s_waitcnt vmcnt(11)
  s_waitcnt lgkmcnt(8)
  v_mfma_f32_32x32x16_bf16 a[0:15], v[32:35], v[64:67], a[0:15]
  ds_read_b64_tr_b16 v[56:57], v8 offset:38912
  ds_read_b64_tr_b16 v[58:59], v8 offset:39936
  ds_read_b64_tr_b16 v[60:61], v9 offset:38912
  ds_read_b64_tr_b16 v[62:63], v9 offset:39936
  v_mfma_f32_32x32x16_bf16 a[16:31], v[36:39], v[64:67], a[16:31]
  buffer_load_dwordx4 v[96:99], v5, s[16:19], s99 offen offset:0
  s_waitcnt vmcnt(11)
  s_waitcnt lgkmcnt(8)
  v_mfma_f32_32x32x16_bf16 a[0:15], v[40:43], v[68:71], a[0:15]
  ds_read_b64_tr_b16 v[32:33], v8 offset:40960
  ds_read_b64_tr_b16 v[34:35], v8 offset:41984
  ds_read_b64_tr_b16 v[36:37], v9 offset:40960
  ds_read_b64_tr_b16 v[38:39], v9 offset:41984
  v_mfma_f32_32x32x16_bf16 a[16:31], v[44:47], v[68:71], a[16:31]
  buffer_load_dwordx4 v[100:103], v5, s[16:19], s99 offen offset:1024
  s_waitcnt vmcnt(11)
  s_waitcnt lgkmcnt(8)
  v_mfma_f32_32x32x16_bf16 a[0:15], v[48:51], v[72:75], a[0:15]
  ds_read_b64_tr_b16 v[40:41], v8 offset:43008
  ds_read_b64_tr_b16 v[42:43], v8 offset:44032
  ds_read_b64_tr_b16 v[44:45], v9 offset:43008
  ds_read_b64_tr_b16 v[46:47], v9 offset:44032
  v_mfma_f32_32x32x16_bf16 a[16:31], v[52:55], v[72:75], a[16:31]
  buffer_load_dwordx4 v[104:107], v5, s[16:19], s99 offen offset:2048
  s_waitcnt vmcnt(11)
  s_waitcnt lgkmcnt(8)
  v_mfma_f32_32x32x16_bf16 a[0:15], v[56:59], v[76:79], a[0:15]
  ds_read_b64_tr_b16 v[48:49], v8 offset:45056
  ds_read_b64_tr_b16 v[50:51], v8 offset:46080
  ds_read_b64_tr_b16 v[52:53], v9 offset:45056
  ds_read_b64_tr_b16 v[54:55], v9 offset:46080
  v_mfma_f32_32x32x16_bf16 a[16:31], v[60:63], v[76:79], a[16:31]
  buffer_load_dwordx4 v[108:111], v5, s[16:19], s99 offen offset:3072
  s_waitcnt vmcnt(11)
  s_waitcnt lgkmcnt(8)
  v_mfma_f32_32x32x16_bf16 a[0:15], v[32:35], v[80:83], a[0:15]
  ds_read_b64_tr_b16 v[56:57], v8 offset:47104
  ds_read_b64_tr_b16 v[58:59], v8 offset:48128
  ds_read_b64_tr_b16 v[60:61], v9 offset:47104
  ds_read_b64_tr_b16 v[62:63], v9 offset:48128
  v_mfma_f32_32x32x16_bf16 a[16:31], v[36:39], v[80:83], a[16:31]
  buffer_load_dwordx4 v[112:115], v6, s[16:19], s99 offen offset:0
  s_waitcnt vmcnt(11)
  s_waitcnt lgkmcnt(8)
  v_mfma_f32_32x32x16_bf16 a[0:15], v[40:43], v[84:87], a[0:15]
  s_barrier
  ds_read_b64_tr_b16 v[32:33], v8 offset:49152
  ds_read_b64_tr_b16 v[34:35], v8 offset:50176
  ds_read_b64_tr_b16 v[36:37], v9 offset:49152
  ds_read_b64_tr_b16 v[38:39], v9 offset:50176
  v_mfma_f32_32x32x16_bf16 a[16:31], v[44:47], v[84:87], a[16:31]
  buffer_load_dwordx4 v[116:119], v6, s[16:19], s99 offen offset:1024
  s_waitcnt vmcnt(11)
  s_waitcnt lgkmcnt(8)
  v_mfma_f32_32x32x16_bf16 a[0:15], v[48:51], v[88:91], a[0:15]
  ds_read_b64_tr_b16 v[40:41], v8 offset:51200
  ds_read_b64_tr_b16 v[42:43], v8 offset:52224
  ds_read_b64_tr_b16 v[44:45], v9 offset:51200
  ds_read_b64_tr_b16 v[46:47], v9 offset:52224
  v_mfma_f32_32x32x16_bf16 a[16:31], v[52:55], v[88:91], a[16:31]
  buffer_load_dwordx4 v[120:123], v6, s[16:19], s99 offen offset:2048
  s_waitcnt vmcnt(11)
  s_waitcnt lgkmcnt(8)
  v_mfma_f32_32x32x16_bf16 a[0:15], v[56:59], v[92:95], a[0:15]
  ds_read_b64_tr_b16 v[48:49], v8 offset:53248
  ds_read_b64_tr_b16 v[50:51], v8 offset:54272
  ds_read_b64_tr_b16 v[52:53], v9 offset:53248
  ds_read_b64_tr_b16 v[54:55], v9 offset:54272
  v_mfma_f32_32x32x16_bf16 a[16:31], v[60:63], v[92:95], a[16:31]
  buffer_load_dwordx4 v[124:127], v6, s[16:19], s99 offen offset:3072
  s_branch K2_E14
K2_S14:
  s_lshr_b32 s61, 0xf0f0f13, s58
  s_and_b32 s61, s61, 255
  s_mul_i32 s92, s61, 114688
  s_lshl_b32 s93, s61, 13
  s_add_u32 s92, s92, 0xffe78000
  s_add_u32 s93, s93, 0xfffe4000
  s_add_u32 m0, s57, 0
  s_nop 0
  buffer_load_dwordx4 v1, s[12:15], s92 offen offset:0 lds
  buffer_load_dwordx4 v2, s[12:15], s92 offen offset:1024 lds
  buffer_load_dwordx4 v3, s[12:15], s92 offen offset:2048 lds
  buffer_load_dwordx4 v4, s[12:15], s92 offen offset:3072 lds
  s_waitcnt vmcnt(11)
  s_waitcnt lgkmcnt(8)
  v_mfma_f32_32x32x16_bf16 a[32:47], v[32:35], v[64:67], a[32:47]
  ds_read_b64_tr_b16 v[56:57], v8 offset:38912
  ds_read_b64_tr_b16 v[58:59], v8 offset:39936
  ds_read_b64_tr_b16 v[60:61], v9 offset:38912
  ds_read_b64_tr_b16 v[62:63], v9 offset:39936
  v_mfma_f32_32x32x16_bf16 a[48:63], v[36:39], v[64:67], a[48:63]
  buffer_load_dwordx4 v[96:99], v5, s[16:19], s99 offen offset:0
  s_waitcnt vmcnt(11)
  s_waitcnt lgkmcnt(8)
  v_mfma_f32_32x32x16_bf16 a[32:47], v[40:43], v[68:71], a[32:47]
  ds_read_b64_tr_b16 v[32:33], v8 offset:40960
  ds_read_b64_tr_b16 v[34:35], v8 offset:41984
  ds_read_b64_tr_b16 v[36:37], v9 offset:40960
  ds_read_b64_tr_b16 v[38:39], v9 offset:41984
  v_mfma_f32_32x32x16_bf16 a[48:63], v[44:47], v[68:71], a[48:63]
  buffer_load_dwordx4 v[100:103], v5, s[16:19], s99 offen offset:1024
  s_waitcnt vmcnt(11)
  s_waitcnt lgkmcnt(8)
  v_mfma_f32_32x32x16_bf16 a[32:47], v[48:51], v[72:75], a[32:47]
  ds_read_b64_tr_b16 v[40:41], v8 offset:43008
  ds_read_b64_tr_b16 v[42:43], v8 offset:44032
  ds_read_b64_tr_b16 v[44:45], v9 offset:43008
  ds_read_b64_tr_b16 v[46:47], v9 offset:44032
  v_mfma_f32_32x32x16_bf16 a[48:63], v[52:55], v[72:75], a[48:63]
  buffer_load_dwordx4 v[104:107], v5, s[16:19], s99 offen offset:2048
  s_waitcnt vmcnt(11)
  s_waitcnt lgkmcnt(8)
  v_mfma_f32_32x32x16_bf16 a[32:47], v[56:59], v[76:79], a[32:47]
  ds_read_b64_tr_b16 v[48:49], v8 offset:45056
  ds_read_b64_tr_b16 v[50:51], v8 offset:46080
  ds_read_b64_tr_b16 v[52:53], v9 offset:45056
  ds_read_b64_tr_b16 v[54:55], v9 offset:46080
  v_mfma_f32_32x32x16_bf16 a[48:63], v[60:63], v[76:79], a[48:63]
  buffer_load_dwordx4 v[108:111], v5, s[16:19], s99 offen offset:3072
  s_waitcnt vmcnt(11)
  s_waitcnt lgkmcnt(8)
  v_mfma_f32_32x32x16_bf16 a[32:47], v[32:35], v[80:83], a[32:47]
  ds_read_b64_tr_b16 v[56:57], v8 offset:47104
  ds_read_b64_tr_b16 v[58:59], v8 offset:48128
  ds_read_b64_tr_b16 v[60:61], v9 offset:47104
  ds_read_b64_tr_b16 v[62:63], v9 offset:48128
  v_mfma_f32_32x32x16_bf16 a[48:63], v[36:39], v[80:83], a[48:63]
  buffer_load_dwordx4 v[112:115], v6, s[16:19], s99 offen offset:0
  s_waitcnt vmcnt(11)
  s_waitcnt lgkmcnt(8)
  v_mfma_f32_32x32x16_bf16 a[32:47], v[40:43], v[84:87], a[32:47]
  s_barrier
  ds_read_b64_tr_b16 v[32:33], v8 offset:49152
  ds_read_b64_tr_b16 v[34:35], v8 offset:50176
  ds_read_b64_tr_b16 v[36:37], v9 offset:49152
  ds_read_b64_tr_b16 v[38:39], v9 offset:50176
  v_mfma_f32_32x32x16_bf16 a[48:63], v[44:47], v[84:87], a[48:63]
  buffer_load_dwordx4 v[116:119], v6, s[16:19], s99 offen offset:1024
  s_waitcnt vmcnt(11)
  s_waitcnt lgkmcnt(8)
  v_mfma_f32_32x32x16_bf16 a[32:47], v[48:51], v[88:91], a[32:47]
  ds_read_b64_tr_b16 v[40:41], v8 offset:51200
  ds_read_b64_tr_b16 v[42:43], v8 offset:52224
  ds_read_b64_tr_b16 v[44:45], v9 offset:51200
  ds_read_b64_tr_b16 v[46:47], v9 offset:52224
  v_mfma_f32_32x32x16_bf16 a[48:63], v[52:55], v[88:91], a[48:63]
  buffer_load_dwordx4 v[120:123], v6, s[16:19], s99 offen offset:2048
  s_waitcnt vmcnt(11)
  s_waitcnt lgkmcnt(8)
  v_mfma_f32_32x32x16_bf16 a[32:47], v[56:59], v[92:95], a[32:47]
  ds_read_b64_tr_b16 v[48:49], v8 offset:53248
  ds_read_b64_tr_b16 v[50:51], v8 offset:54272
  ds_read_b64_tr_b16 v[52:53], v9 offset:53248
  ds_read_b64_tr_b16 v[54:55], v9 offset:54272
  v_mfma_f32_32x32x16_bf16 a[48:63], v[60:63], v[92:95], a[48:63]
  buffer_load_dwordx4 v[124:127], v6, s[16:19], s99 offen offset:3072
K2_E14:
  s_lshr_b32 s61, 0x10101410, s58
  s_and_b32 s61, s61, 255
  s_mul_i32 s94, s61, 114688
  s_lshl_b32 s95, s61, 13
  s_add_u32 s94, s94, 0xffe78000
  s_add_u32 s95, s95, 0xfffe4000
  s_add_u32 m0, s57, 16384
  s_nop 0
  buffer_load_dwordx4 v1, s[12:15], s94 offen offset:0 lds
  buffer_load_dwordx4 v2, s[12:15], s94 offen offset:1024 lds
  buffer_load_dwordx4 v3, s[12:15], s94 offen offset:2048 lds
  buffer_load_dwordx4 v4, s[12:15], s94 offen offset:3072 lds
  s_waitcnt vmcnt(11)
  s_waitcnt lgkmcnt(8)
  v_mfma_f32_32x32x16_bf16 a[32:47], v[32:35], v[96:99], a[32:47]
  ds_read_b64_tr_b16 v[56:57], v8 offset:55296
  ds_read_b64_tr_b16 v[58:59], v8 offset:56320
  ds_read_b64_tr_b16 v[60:61], v9 offset:55296
  ds_read_b64_tr_b16 v[62:63], v9 offset:56320
  v_mfma_f32_32x32x16_bf16 a[48:63], v[36:39], v[96:99], a[48:63]
  buffer_load_dwordx4 v[64:67], v5, s[16:19], s93 offen offset:0
  s_waitcnt vmcnt(11)
  s_waitcnt lgkmcnt(8)
  v_mfma_f32_32x32x16_bf16 a[32:47], v[40:43], v[100:103], a[32:47]
  ds_read_b64_tr_b16 v[32:33], v8 offset:57344
  ds_read_b64_tr_b16 v[34:35], v8 offset:58368
  ds_read_b64_tr_b16 v[36:37], v9 offset:57344
  ds_read_b64_tr_b16 v[38:39], v9 offset:58368
  v_mfma_f32_32x32x16_bf16 a[48:63], v[44:47], v[100:103], a[48:63]
  buffer_load_dwordx4 v[68:71], v5, s[16:19], s93 offen offset:1024
  s_waitcnt vmcnt(11)
  s_waitcnt lgkmcnt(8)
  v_mfma_f32_32x32x16_bf16 a[32:47], v[48:51], v[104:107], a[32:47]
  ds_read_b64_tr_b16 v[40:41], v8 offset:59392
  ds_read_b64_tr_b16 v[42:43], v8 offset:60416
  ds_read_b64_tr_b16 v[44:45], v9 offset:59392
  ds_read_b64_tr_b16 v[46:47], v9 offset:60416
  v_mfma_f32_32x32x16_bf16 a[48:63], v[52:55], v[104:107], a[48:63]
  buffer_load_dwordx4 v[72:75], v5, s[16:19], s93 offen offset:2048
  v_accvgpr_read_b32 v192, a0
  v_mul_f32 v192, 0x42f5fdf0, v192
  v_mul_f32 v16, 0xbfb8aa3b, v192
  v_exp_f32 v16, v16
  s_waitcnt vmcnt(11)
  s_waitcnt lgkmcnt(8)
  v_mfma_f32_32x32x16_bf16 a[32:47], v[56:59], v[108:111], a[32:47]
  ds_read_b64_tr_b16 v[48:49], v8 offset:61440
  ds_read_b64_tr_b16 v[50:51], v8 offset:62464
  ds_read_b64_tr_b16 v[52:53], v9 offset:61440
  ds_read_b64_tr_b16 v[54:55], v9 offset:62464
  v_mfma_f32_32x32x16_bf16 a[48:63], v[60:63], v[108:111], a[48:63]
  buffer_load_dwordx4 v[76:79], v5, s[16:19], s93 offen offset:3072
  v_add_f32 v16, 1.0, v16
  v_rcp_f32 v17, v16
  v_accvgpr_read_b32 v193, a1
  v_mul_f32 v193, 0x42f5fdf0, v193
  v_mul_f32 v16, 0xbfb8aa3b, v193
  v_mul_f32 v192, v192, v17
  v_exp_f32 v16, v16
  s_waitcnt vmcnt(11)
  s_waitcnt lgkmcnt(8)
  v_mfma_f32_32x32x16_bf16 a[32:47], v[32:35], v[112:115], a[32:47]
  ds_read_b64_tr_b16 v[56:57], v8 offset:63488
  ds_read_b64_tr_b16 v[58:59], v8 offset:64512
  ds_read_b64_tr_b16 v[60:61], v9 offset:63488
  ds_read_b64_tr_b16 v[62:63], v9 offset:64512
  v_mfma_f32_32x32x16_bf16 a[48:63], v[36:39], v[112:115], a[48:63]
  buffer_load_dwordx4 v[80:83], v6, s[16:19], s93 offen offset:0
  v_add_f32 v16, 1.0, v16
  v_rcp_f32 v17, v16
  v_accvgpr_read_b32 v194, a2
  v_mul_f32 v194, 0x42f5fdf0, v194
  v_mul_f32 v16, 0xbfb8aa3b, v194
  v_mul_f32 v193, v193, v17
  v_exp_f32 v16, v16
  s_waitcnt vmcnt(11)
  s_waitcnt lgkmcnt(8)
  v_mfma_f32_32x32x16_bf16 a[32:47], v[40:43], v[116:119], a[32:47]
  s_barrier
  ds_read_b64_tr_b16 v[32:33], v8 offset:0
  ds_read_b64_tr_b16 v[34:35], v8 offset:1024
  ds_read_b64_tr_b16 v[36:37], v9 offset:0
  ds_read_b64_tr_b16 v[38:39], v9 offset:1024
  v_mfma_f32_32x32x16_bf16 a[48:63], v[44:47], v[116:119], a[48:63]
  buffer_load_dwordx4 v[84:87], v6, s[16:19], s93 offen offset:1024
  v_add_f32 v16, 1.0, v16
  v_rcp_f32 v17, v16
  v_accvgpr_read_b32 v195, a3
  v_mul_f32 v195, 0x42f5fdf0, v195
  v_mul_f32 v16, 0xbfb8aa3b, v195
  v_mul_f32 v194, v194, v17
  v_exp_f32 v16, v16
  s_waitcnt vmcnt(11)
  s_waitcnt lgkmcnt(8)
  v_mfma_f32_32x32x16_bf16 a[32:47], v[48:51], v[120:123], a[32:47]
  ds_read_b64_tr_b16 v[40:41], v8 offset:2048
  ds_read_b64_tr_b16 v[42:43], v8 offset:3072
  ds_read_b64_tr_b16 v[44:45], v9 offset:2048
  ds_read_b64_tr_b16 v[46:47], v9 offset:3072
  v_mfma_f32_32x32x16_bf16 a[48:63], v[52:55], v[120:123], a[48:63]
  buffer_load_dwordx4 v[88:91], v6, s[16:19], s93 offen offset:2048
  v_add_f32 v16, 1.0, v16
  v_rcp_f32 v17, v16
  v_accvgpr_read_b32 v196, a4
  v_mul_f32 v196, 0x42f5fdf0, v196
  v_mul_f32 v16, 0xbfb8aa3b, v196
  v_mul_f32 v195, v195, v17
  v_exp_f32 v16, v16
  s_waitcnt vmcnt(11)
  s_waitcnt lgkmcnt(8)
  v_mfma_f32_32x32x16_bf16 a[32:47], v[56:59], v[124:127], a[32:47]
  ds_read_b64_tr_b16 v[48:49], v8 offset:4096
  ds_read_b64_tr_b16 v[50:51], v8 offset:5120
  ds_read_b64_tr_b16 v[52:53], v9 offset:4096
  ds_read_b64_tr_b16 v[54:55], v9 offset:5120
  v_mfma_f32_32x32x16_bf16 a[48:63], v[60:63], v[124:127], a[48:63]
  buffer_load_dwordx4 v[92:95], v6, s[16:19], s93 offen offset:3072
  v_add_f32 v16, 1.0, v16
  v_rcp_f32 v17, v16
  v_accvgpr_read_b32 v197, a5
  v_mul_f32 v197, 0x42f5fdf0, v197
  v_mul_f32 v16, 0xbfb8aa3b, v197
  v_mul_f32 v196, v196, v17
  v_exp_f32 v16, v16
  s_lshr_b32 s61, 0x11151111, s58
  s_and_b32 s61, s61, 255
  s_mul_i32 s96, s61, 114688
  s_lshl_b32 s97, s61, 13
  s_add_u32 s96, s96, 0xffe78000
  s_add_u32 s97, s97, 0xfffe4000
  s_add_u32 m0, s57, 32768
  s_nop 0
  buffer_load_dwordx4 v1, s[12:15], s96 offen offset:0 lds
  buffer_load_dwordx4 v2, s[12:15], s96 offen offset:1024 lds
  buffer_load_dwordx4 v3, s[12:15], s96 offen offset:2048 lds
  buffer_load_dwordx4 v4, s[12:15], s96 offen offset:3072 lds
  s_waitcnt vmcnt(11)
  s_waitcnt lgkmcnt(8)
  v_mfma_f32_32x32x16_bf16 a[32:47], v[32:35], v[64:67], a[32:47]
  ds_read_b64_tr_b16 v[56:57], v8 offset:6144
  ds_read_b64_tr_b16 v[58:59], v8 offset:7168
  ds_read_b64_tr_b16 v[60:61], v9 offset:6144
  ds_read_b64_tr_b16 v[62:63], v9 offset:7168
  v_mfma_f32_32x32x16_bf16 a[48:63], v[36:39], v[64:67], a[48:63]
  buffer_load_dwordx4 v[96:99], v5, s[16:19], s95 offen offset:0
  v_add_f32 v16, 1.0, v16
  v_rcp_f32 v17, v16
  v_accvgpr_read_b32 v198, a6
  v_mul_f32 v198, 0x42f5fdf0, v198
  v_mul_f32 v16, 0xbfb8aa3b, v198
  v_mul_f32 v197, v197, v17
  v_exp_f32 v16, v16
  s_waitcnt vmcnt(11)
  s_waitcnt lgkmcnt(8)
  v_mfma_f32_32x32x16_bf16 a[32:47], v[40:43], v[68:71], a[32:47]
  ds_read_b64_tr_b16 v[32:33], v8 offset:8192
  ds_read_b64_tr_b16 v[34:35], v8 offset:9216
  ds_read_b64_tr_b16 v[36:37], v9 offset:8192
  ds_read_b64_tr_b16 v[38:39], v9 offset:9216
  v_mfma_f32_32x32x16_bf16 a[48:63], v[44:47], v[68:71], a[48:63]
  buffer_load_dwordx4 v[100:103], v5, s[16:19], s95 offen offset:1024
  v_add_f32 v16, 1.0, v16
  v_rcp_f32 v17, v16
  v_accvgpr_read_b32 v199, a7
  v_mul_f32 v199, 0x42f5fdf0, v199
  v_mul_f32 v16, 0xbfb8aa3b, v199
  v_mul_f32 v198, v198, v17
  v_exp_f32 v16, v16
  s_waitcnt vmcnt(11)
  s_waitcnt lgkmcnt(8)
  v_mfma_f32_32x32x16_bf16 a[32:47], v[48:51], v[72:75], a[32:47]
  ds_read_b64_tr_b16 v[40:41], v8 offset:10240
  ds_read_b64_tr_b16 v[42:43], v8 offset:11264
  ds_read_b64_tr_b16 v[44:45], v9 offset:10240
  ds_read_b64_tr_b16 v[46:47], v9 offset:11264
  v_mfma_f32_32x32x16_bf16 a[48:63], v[52:55], v[72:75], a[48:63]
  buffer_load_dwordx4 v[104:107], v5, s[16:19], s95 offen offset:2048
  v_add_f32 v16, 1.0, v16
  v_rcp_f32 v17, v16
  v_accvgpr_read_b32 v200, a8
  v_mul_f32 v200, 0x42f5fdf0, v200
  v_mul_f32 v16, 0xbfb8aa3b, v200
  v_mul_f32 v199, v199, v17
  v_exp_f32 v16, v16
  s_waitcnt vmcnt(11)
  s_waitcnt lgkmcnt(8)
  v_mfma_f32_32x32x16_bf16 a[32:47], v[56:59], v[76:79], a[32:47]
  ds_read_b64_tr_b16 v[48:49], v8 offset:12288
  ds_read_b64_tr_b16 v[50:51], v8 offset:13312
  ds_read_b64_tr_b16 v[52:53], v9 offset:12288
  ds_read_b64_tr_b16 v[54:55], v9 offset:13312
  v_mfma_f32_32x32x16_bf16 a[48:63], v[60:63], v[76:79], a[48:63]
  buffer_load_dwordx4 v[108:111], v5, s[16:19], s95 offen offset:3072
  v_add_f32 v16, 1.0, v16
  v_rcp_f32 v17, v16
  v_accvgpr_read_b32 v201, a9
  v_mul_f32 v201, 0x42f5fdf0, v201
  v_mul_f32 v16, 0xbfb8aa3b, v201
  v_mul_f32 v200, v200, v17
  v_exp_f32 v16, v16
  s_waitcnt vmcnt(11)
  s_waitcnt lgkmcnt(8)
  v_mfma_f32_32x32x16_bf16 a[32:47], v[32:35], v[80:83], a[32:47]
  ds_read_b64_tr_b16 v[56:57], v8 offset:14336
  ds_read_b64_tr_b16 v[58:59], v8 offset:15360
  ds_read_b64_tr_b16 v[60:61], v9 offset:14336
  ds_read_b64_tr_b16 v[62:63], v9 offset:15360
  v_mfma_f32_32x32x16_bf16 a[48:63], v[36:39], v[80:83], a[48:63]
  buffer_load_dwordx4 v[112:115], v6, s[16:19], s95 offen offset:0
  v_add_f32 v16, 1.0, v16
  v_rcp_f32 v17, v16
  v_accvgpr_read_b32 v202, a10
  v_mul_f32 v202, 0x42f5fdf0, v202
  v_mul_f32 v16, 0xbfb8aa3b, v202
  v_mul_f32 v201, v201, v17
  v_exp_f32 v16, v16
  s_waitcnt vmcnt(11)
  s_waitcnt lgkmcnt(8)
  v_mfma_f32_32x32x16_bf16 a[32:47], v[40:43], v[84:87], a[32:47]
  s_barrier
  ds_read_b64_tr_b16 v[32:33], v8 offset:16384
  ds_read_b64_tr_b16 v[34:35], v8 offset:17408
  ds_read_b64_tr_b16 v[36:37], v9 offset:16384
  ds_read_b64_tr_b16 v[38:39], v9 offset:17408
  v_mfma_f32_32x32x16_bf16 a[48:63], v[44:47], v[84:87], a[48:63]
  buffer_load_dwordx4 v[116:119], v6, s[16:19], s95 offen offset:1024
  v_add_f32 v16, 1.0, v16
  v_rcp_f32 v17, v16
  v_accvgpr_read_b32 v203, a11
  v_mul_f32 v203, 0x42f5fdf0, v203
  v_mul_f32 v16, 0xbfb8aa3b, v203
  v_mul_f32 v202, v202, v17
  v_exp_f32 v16, v16
  s_waitcnt vmcnt(11)
  s_waitcnt lgkmcnt(8)
  v_mfma_f32_32x32x16_bf16 a[32:47], v[48:51], v[88:91], a[32:47]
  ds_read_b64_tr_b16 v[40:41], v8 offset:18432
  ds_read_b64_tr_b16 v[42:43], v8 offset:19456
  ds_read_b64_tr_b16 v[44:45], v9 offset:18432
  ds_read_b64_tr_b16 v[46:47], v9 offset:19456
  v_mfma_f32_32x32x16_bf16 a[48:63], v[52:55], v[88:91], a[48:63]
  buffer_load_dwordx4 v[120:123], v6, s[16:19], s95 offen offset:2048
  v_add_f32 v16, 1.0, v16
  v_rcp_f32 v17, v16
  v_accvgpr_read_b32 v204, a12
  v_mul_f32 v204, 0x42f5fdf0, v204
  v_mul_f32 v16, 0xbfb8aa3b, v204
  v_mul_f32 v203, v203, v17
  v_exp_f32 v16, v16
  s_waitcnt vmcnt(11)
  s_waitcnt lgkmcnt(8)
  v_mfma_f32_32x32x16_bf16 a[32:47], v[56:59], v[92:95], a[32:47]
  ds_read_b64_tr_b16 v[48:49], v8 offset:20480
  ds_read_b64_tr_b16 v[50:51], v8 offset:21504
  ds_read_b64_tr_b16 v[52:53], v9 offset:20480
  ds_read_b64_tr_b16 v[54:55], v9 offset:21504
  v_mfma_f32_32x32x16_bf16 a[48:63], v[60:63], v[92:95], a[48:63]
  buffer_load_dwordx4 v[124:127], v6, s[16:19], s95 offen offset:3072
  v_add_f32 v16, 1.0, v16
  v_rcp_f32 v17, v16
  v_accvgpr_read_b32 v205, a13
  v_mul_f32 v205, 0x42f5fdf0, v205
  v_mul_f32 v16, 0xbfb8aa3b, v205
  v_mul_f32 v204, v204, v17
  v_exp_f32 v16, v16
  s_lshr_b32 s61, 0x16121212, s58
  s_and_b32 s61, s61, 255
  s_mul_i32 s98, s61, 114688
  s_lshl_b32 s99, s61, 13
  s_add_u32 s98, s98, 0xffe78000
  s_add_u32 s99, s99, 0xfffe4000
  s_add_u32 m0, s57, 49152
  s_nop 0
  buffer_load_dwordx4 v1, s[12:15], s98 offen offset:0 lds
  buffer_load_dwordx4 v2, s[12:15], s98 offen offset:1024 lds
  buffer_load_dwordx4 v3, s[12:15], s98 offen offset:2048 lds
  buffer_load_dwordx4 v4, s[12:15], s98 offen offset:3072 lds
  s_waitcnt vmcnt(11)
  s_waitcnt lgkmcnt(8)
  v_mfma_f32_32x32x16_bf16 a[32:47], v[32:35], v[96:99], a[32:47]
  ds_read_b64_tr_b16 v[56:57], v8 offset:22528
  ds_read_b64_tr_b16 v[58:59], v8 offset:23552
  ds_read_b64_tr_b16 v[60:61], v9 offset:22528
  ds_read_b64_tr_b16 v[62:63], v9 offset:23552
  v_mfma_f32_32x32x16_bf16 a[48:63], v[36:39], v[96:99], a[48:63]
  buffer_load_dwordx4 v[64:67], v5, s[16:19], s97 offen offset:0
  v_add_f32 v16, 1.0, v16
  v_rcp_f32 v17, v16
  v_accvgpr_read_b32 v206, a14
  v_mul_f32 v206, 0x42f5fdf0, v206
  v_mul_f32 v16, 0xbfb8aa3b, v206
  v_mul_f32 v205, v205, v17
  v_exp_f32 v16, v16
  s_waitcnt vmcnt(11)
  s_waitcnt lgkmcnt(8)
  v_mfma_f32_32x32x16_bf16 a[32:47], v[40:43], v[100:103], a[32:47]
  ds_read_b64_tr_b16 v[32:33], v8 offset:24576
  ds_read_b64_tr_b16 v[34:35], v8 offset:25600
  ds_read_b64_tr_b16 v[36:37], v9 offset:24576
  ds_read_b64_tr_b16 v[38:39], v9 offset:25600
  v_mfma_f32_32x32x16_bf16 a[48:63], v[44:47], v[100:103], a[48:63]
  buffer_load_dwordx4 v[68:71], v5, s[16:19], s97 offen offset:1024
  v_add_f32 v16, 1.0, v16
  v_rcp_f32 v17, v16
  v_accvgpr_read_b32 v207, a15
  v_mul_f32 v207, 0x42f5fdf0, v207
  v_mul_f32 v16, 0xbfb8aa3b, v207
  v_mul_f32 v206, v206, v17
  v_exp_f32 v16, v16
  s_waitcnt vmcnt(11)
  s_waitcnt lgkmcnt(8)
  v_mfma_f32_32x32x16_bf16 a[32:47], v[48:51], v[104:107], a[32:47]
  ds_read_b64_tr_b16 v[40:41], v8 offset:26624
  ds_read_b64_tr_b16 v[42:43], v8 offset:27648
  ds_read_b64_tr_b16 v[44:45], v9 offset:26624
  ds_read_b64_tr_b16 v[46:47], v9 offset:27648
  v_mfma_f32_32x32x16_bf16 a[48:63], v[52:55], v[104:107], a[48:63]
  buffer_load_dwordx4 v[72:75], v5, s[16:19], s97 offen offset:2048
  v_add_f32 v16, 1.0, v16
  v_rcp_f32 v17, v16
  v_accvgpr_read_b32 v208, a16
  v_mul_f32 v208, 0x42f5fdf0, v208
  v_mul_f32 v16, 0xbfb8aa3b, v208
  v_mul_f32 v207, v207, v17
  v_exp_f32 v16, v16
  s_waitcnt vmcnt(11)
  s_waitcnt lgkmcnt(8)
  v_mfma_f32_32x32x16_bf16 a[32:47], v[56:59], v[108:111], a[32:47]
  ds_read_b64_tr_b16 v[48:49], v8 offset:28672
  ds_read_b64_tr_b16 v[50:51], v8 offset:29696
  ds_read_b64_tr_b16 v[52:53], v9 offset:28672
  ds_read_b64_tr_b16 v[54:55], v9 offset:29696
  v_mfma_f32_32x32x16_bf16 a[48:63], v[60:63], v[108:111], a[48:63]
  buffer_load_dwordx4 v[76:79], v5, s[16:19], s97 offen offset:3072
  v_add_f32 v16, 1.0, v16
  v_rcp_f32 v17, v16
  v_accvgpr_read_b32 v209, a17
  v_mul_f32 v209, 0x42f5fdf0, v209
  v_mul_f32 v16, 0xbfb8aa3b, v209
  v_mul_f32 v208, v208, v17
  v_exp_f32 v16, v16
  s_waitcnt vmcnt(11)
  s_waitcnt lgkmcnt(8)
  v_mfma_f32_32x32x16_bf16 a[32:47], v[32:35], v[112:115], a[32:47]
  ds_read_b64_tr_b16 v[56:57], v8 offset:30720
  ds_read_b64_tr_b16 v[58:59], v8 offset:31744
  ds_read_b64_tr_b16 v[60:61], v9 offset:30720
  ds_read_b64_tr_b16 v[62:63], v9 offset:31744
  v_mfma_f32_32x32x16_bf16 a[48:63], v[36:39], v[112:115], a[48:63]
  buffer_load_dwordx4 v[80:83], v6, s[16:19], s97 offen offset:0
  v_add_f32 v16, 1.0, v16
  v_rcp_f32 v17, v16
  v_accvgpr_read_b32 v210, a18
  v_mul_f32 v210, 0x42f5fdf0, v210
  v_mul_f32 v16, 0xbfb8aa3b, v210
  v_mul_f32 v209, v209, v17
  v_exp_f32 v16, v16
  s_waitcnt vmcnt(11)
  s_waitcnt lgkmcnt(8)
  v_mfma_f32_32x32x16_bf16 a[32:47], v[40:43], v[116:119], a[32:47]
  s_barrier
  ds_read_b64_tr_b16 v[32:33], v8 offset:32768
  ds_read_b64_tr_b16 v[34:35], v8 offset:33792
  ds_read_b64_tr_b16 v[36:37], v9 offset:32768
  ds_read_b64_tr_b16 v[38:39], v9 offset:33792
  v_mfma_f32_32x32x16_bf16 a[48:63], v[44:47], v[116:119], a[48:63]
  buffer_load_dwordx4 v[84:87], v6, s[16:19], s97 offen offset:1024
  v_add_f32 v16, 1.0, v16
  v_rcp_f32 v17, v16
  v_accvgpr_read_b32 v211, a19
  v_mul_f32 v211, 0x42f5fdf0, v211
  v_mul_f32 v16, 0xbfb8aa3b, v211
  v_mul_f32 v210, v210, v17
  v_exp_f32 v16, v16
  s_waitcnt vmcnt(11)
  s_waitcnt lgkmcnt(8)
  v_mfma_f32_32x32x16_bf16 a[32:47], v[48:51], v[120:123], a[32:47]
  ds_read_b64_tr_b16 v[40:41], v8 offset:34816
  ds_read_b64_tr_b16 v[42:43], v8 offset:35840
  ds_read_b64_tr_b16 v[44:45], v9 offset:34816
  ds_read_b64_tr_b16 v[46:47], v9 offset:35840
  v_mfma_f32_32x32x16_bf16 a[48:63], v[52:55], v[120:123], a[48:63]
  buffer_load_dwordx4 v[88:91], v6, s[16:19], s97 offen offset:2048
  v_add_f32 v16, 1.0, v16
  v_rcp_f32 v17, v16
  v_accvgpr_read_b32 v212, a20
  v_mul_f32 v212, 0x42f5fdf0, v212
  v_mul_f32 v16, 0xbfb8aa3b, v212
  v_mul_f32 v211, v211, v17
  v_exp_f32 v16, v16
  s_waitcnt vmcnt(11)
  s_waitcnt lgkmcnt(8)
  v_mfma_f32_32x32x16_bf16 a[32:47], v[56:59], v[124:127], a[32:47]
  ds_read_b64_tr_b16 v[48:49], v8 offset:36864
  ds_read_b64_tr_b16 v[50:51], v8 offset:37888
  ds_read_b64_tr_b16 v[52:53], v9 offset:36864
  ds_read_b64_tr_b16 v[54:55], v9 offset:37888
  v_mfma_f32_32x32x16_bf16 a[48:63], v[60:63], v[124:127], a[48:63]
  buffer_load_dwordx4 v[92:95], v6, s[16:19], s97 offen offset:3072
  v_add_f32 v16, 1.0, v16
  v_rcp_f32 v17, v16
  v_accvgpr_read_b32 v213, a21
  v_mul_f32 v213, 0x42f5fdf0, v213
  v_mul_f32 v16, 0xbfb8aa3b, v213
  v_mul_f32 v212, v212, v17
  v_exp_f32 v16, v16
  s_lshr_b32 s61, 0x13131317, s58
  s_and_b32 s61, s61, 255
  s_mul_i32 s92, s61, 114688
  s_lshl_b32 s93, s61, 13
  s_add_u32 s92, s92, 0xffe78000
  s_add_u32 s93, s93, 0xfffe4000
  s_add_u32 m0, s57, 0
  s_nop 0
  buffer_load_dwordx4 v1, s[12:15], s92 offen offset:0 lds
  buffer_load_dwordx4 v2, s[12:15], s92 offen offset:1024 lds
  buffer_load_dwordx4 v3, s[12:15], s92 offen offset:2048 lds
  buffer_load_dwordx4 v4, s[12:15], s92 offen offset:3072 lds
  s_waitcnt vmcnt(11)
  s_waitcnt lgkmcnt(8)
  v_mfma_f32_32x32x16_bf16 a[32:47], v[32:35], v[64:67], a[32:47]
  ds_read_b64_tr_b16 v[56:57], v8 offset:38912
  ds_read_b64_tr_b16 v[58:59], v8 offset:39936
  ds_read_b64_tr_b16 v[60:61], v9 offset:38912
  ds_read_b64_tr_b16 v[62:63], v9 offset:39936
  v_mfma_f32_32x32x16_bf16 a[48:63], v[36:39], v[64:67], a[48:63]
  buffer_load_dwordx4 v[96:99], v5, s[16:19], s99 offen offset:0
  v_add_f32 v16, 1.0, v16
  v_rcp_f32 v17, v16
  v_accvgpr_read_b32 v214, a22
  v_mul_f32 v214, 0x42f5fdf0, v214
  v_mul_f32 v16, 0xbfb8aa3b, v214
  v_mul_f32 v213, v213, v17
  v_exp_f32 v16, v16
  s_waitcnt vmcnt(11)
  s_waitcnt lgkmcnt(8)
  v_mfma_f32_32x32x16_bf16 a[32:47], v[40:43], v[68:71], a[32:47]
  ds_read_b64_tr_b16 v[32:33], v8 offset:40960
  ds_read_b64_tr_b16 v[34:35], v8 offset:41984
  ds_read_b64_tr_b16 v[36:37], v9 offset:40960
  ds_read_b64_tr_b16 v[38:39], v9 offset:41984
  v_mfma_f32_32x32x16_bf16 a[48:63], v[44:47], v[68:71], a[48:63]
  buffer_load_dwordx4 v[100:103], v5, s[16:19], s99 offen offset:1024
  v_add_f32 v16, 1.0, v16
  v_rcp_f32 v17, v16
  v_accvgpr_read_b32 v215, a23
  v_mul_f32 v215, 0x42f5fdf0, v215
  v_mul_f32 v16, 0xbfb8aa3b, v215
  v_mul_f32 v214, v214, v17
  v_exp_f32 v16, v16
  s_waitcnt vmcnt(11)
  s_waitcnt lgkmcnt(8)
  v_mfma_f32_32x32x16_bf16 a[32:47], v[48:51], v[72:75], a[32:47]
  ds_read_b64_tr_b16 v[40:41], v8 offset:43008
  ds_read_b64_tr_b16 v[42:43], v8 offset:44032
  ds_read_b64_tr_b16 v[44:45], v9 offset:43008
  ds_read_b64_tr_b16 v[46:47], v9 offset:44032
  v_mfma_f32_32x32x16_bf16 a[48:63], v[52:55], v[72:75], a[48:63]
  buffer_load_dwordx4 v[104:107], v5, s[16:19], s99 offen offset:2048
  v_add_f32 v16, 1.0, v16
  v_rcp_f32 v17, v16
  v_accvgpr_read_b32 v216, a24
  v_mul_f32 v216, 0x42f5fdf0, v216
  v_mul_f32 v16, 0xbfb8aa3b, v216
  v_mul_f32 v215, v215, v17
  v_exp_f32 v16, v16
  s_waitcnt vmcnt(11)
  s_waitcnt lgkmcnt(8)
  v_mfma_f32_32x32x16_bf16 a[32:47], v[56:59], v[76:79], a[32:47]
  ds_read_b64_tr_b16 v[48:49], v8 offset:45056
  ds_read_b64_tr_b16 v[50:51], v8 offset:46080
  ds_read_b64_tr_b16 v[52:53], v9 offset:45056
  ds_read_b64_tr_b16 v[54:55], v9 offset:46080
  v_mfma_f32_32x32x16_bf16 a[48:63], v[60:63], v[76:79], a[48:63]
  buffer_load_dwordx4 v[108:111], v5, s[16:19], s99 offen offset:3072
  v_add_f32 v16, 1.0, v16
  v_rcp_f32 v17, v16
  v_accvgpr_read_b32 v217, a25
  v_mul_f32 v217, 0x42f5fdf0, v217
  v_mul_f32 v16, 0xbfb8aa3b, v217
  v_mul_f32 v216, v216, v17
  v_exp_f32 v16, v16
  s_waitcnt vmcnt(11)
  s_waitcnt lgkmcnt(8)
  v_mfma_f32_32x32x16_bf16 a[32:47], v[32:35], v[80:83], a[32:47]
  ds_read_b64_tr_b16 v[56:57], v8 offset:47104
  ds_read_b64_tr_b16 v[58:59], v8 offset:48128
  ds_read_b64_tr_b16 v[60:61], v9 offset:47104
  ds_read_b64_tr_b16 v[62:63], v9 offset:48128
  v_mfma_f32_32x32x16_bf16 a[48:63], v[36:39], v[80:83], a[48:63]
  buffer_load_dwordx4 v[112:115], v6, s[16:19], s99 offen offset:0
  v_add_f32 v16, 1.0, v16
  v_rcp_f32 v17, v16
  v_accvgpr_read_b32 v218, a26
  v_mul_f32 v218, 0x42f5fdf0, v218
  v_mul_f32 v16, 0xbfb8aa3b, v218
  v_mul_f32 v217, v217, v17
  v_exp_f32 v16, v16
  s_waitcnt vmcnt(11)
  s_waitcnt lgkmcnt(8)
  v_mfma_f32_32x32x16_bf16 a[32:47], v[40:43], v[84:87], a[32:47]
  s_barrier
  ds_read_b64_tr_b16 v[32:33], v8 offset:49152
  ds_read_b64_tr_b16 v[34:35], v8 offset:50176
  ds_read_b64_tr_b16 v[36:37], v9 offset:49152
  ds_read_b64_tr_b16 v[38:39], v9 offset:50176
  v_mfma_f32_32x32x16_bf16 a[48:63], v[44:47], v[84:87], a[48:63]
  buffer_load_dwordx4 v[116:119], v6, s[16:19], s99 offen offset:1024
  v_add_f32 v16, 1.0, v16
  v_rcp_f32 v17, v16
  v_accvgpr_read_b32 v219, a27
  v_mul_f32 v219, 0x42f5fdf0, v219
  v_mul_f32 v16, 0xbfb8aa3b, v219
  v_mul_f32 v218, v218, v17
  v_exp_f32 v16, v16
  s_waitcnt vmcnt(11)
  s_waitcnt lgkmcnt(8)
  v_mfma_f32_32x32x16_bf16 a[32:47], v[48:51], v[88:91], a[32:47]
  ds_read_b64_tr_b16 v[40:41], v8 offset:51200
  ds_read_b64_tr_b16 v[42:43], v8 offset:52224
  ds_read_b64_tr_b16 v[44:45], v9 offset:51200
  ds_read_b64_tr_b16 v[46:47], v9 offset:52224
  v_mfma_f32_32x32x16_bf16 a[48:63], v[52:55], v[88:91], a[48:63]
  buffer_load_dwordx4 v[120:123], v6, s[16:19], s99 offen offset:2048
  v_add_f32 v16, 1.0, v16
  v_rcp_f32 v17, v16
  v_accvgpr_read_b32 v220, a28
  v_mul_f32 v220, 0x42f5fdf0, v220
  v_mul_f32 v16, 0xbfb8aa3b, v220
  v_mul_f32 v219, v219, v17
  v_exp_f32 v16, v16
  s_waitcnt vmcnt(11)
  s_waitcnt lgkmcnt(8)
  v_mfma_f32_32x32x16_bf16 a[32:47], v[56:59], v[92:95], a[32:47]
  ds_read_b64_tr_b16 v[48:49], v8 offset:53248
  ds_read_b64_tr_b16 v[50:51], v8 offset:54272
  ds_read_b64_tr_b16 v[52:53], v9 offset:53248
  ds_read_b64_tr_b16 v[54:55], v9 offset:54272
  v_mfma_f32_32x32x16_bf16 a[48:63], v[60:63], v[92:95], a[48:63]
  buffer_load_dwordx4 v[124:127], v6, s[16:19], s99 offen offset:3072
  v_add_f32 v16, 1.0, v16
  v_rcp_f32 v17, v16
  v_accvgpr_read_b32 v221, a29
  v_mul_f32 v221, 0x42f5fdf0, v221
  v_mul_f32 v16, 0xbfb8aa3b, v221
  v_mul_f32 v220, v220, v17
  v_exp_f32 v16, v16
  s_lshr_b32 s61, 0x14141514, s58
  s_and_b32 s61, s61, 255
  s_mul_i32 s94, s61, 114688
  s_lshl_b32 s95, s61, 13
  s_add_u32 s94, s94, 0xffe78000
  s_add_u32 s95, s95, 0xfffe4000
  s_add_u32 m0, s57, 16384
  s_nop 0
  buffer_load_dwordx4 v1, s[12:15], s94 offen offset:0 lds
  buffer_load_dwordx4 v2, s[12:15], s94 offen offset:1024 lds
  buffer_load_dwordx4 v3, s[12:15], s94 offen offset:2048 lds
  buffer_load_dwordx4 v4, s[12:15], s94 offen offset:3072 lds
  s_waitcnt vmcnt(11)
  s_waitcnt lgkmcnt(8)
  v_mfma_f32_32x32x16_bf16 a[32:47], v[32:35], v[96:99], a[32:47]
  ds_read_b64_tr_b16 v[56:57], v8 offset:55296
  ds_read_b64_tr_b16 v[58:59], v8 offset:56320
  ds_read_b64_tr_b16 v[60:61], v9 offset:55296
  ds_read_b64_tr_b16 v[62:63], v9 offset:56320
  v_mfma_f32_32x32x16_bf16 a[48:63], v[36:39], v[96:99], a[48:63]
  buffer_load_dwordx4 v[64:67], v5, s[16:19], s93 offen offset:0
  v_add_f32 v16, 1.0, v16
  v_rcp_f32 v17, v16
  v_accvgpr_read_b32 v222, a30
  v_mul_f32 v222, 0x42f5fdf0, v222
  v_mul_f32 v16, 0xbfb8aa3b, v222
  v_mul_f32 v221, v221, v17
  v_exp_f32 v16, v16
  s_waitcnt vmcnt(11)
  s_waitcnt lgkmcnt(8)
  v_mfma_f32_32x32x16_bf16 a[32:47], v[40:43], v[100:103], a[32:47]
  ds_read_b64_tr_b16 v[32:33], v8 offset:57344
  ds_read_b64_tr_b16 v[34:35], v8 offset:58368
  ds_read_b64_tr_b16 v[36:37], v9 offset:57344
  ds_read_b64_tr_b16 v[38:39], v9 offset:58368
  v_mfma_f32_32x32x16_bf16 a[48:63], v[44:47], v[100:103], a[48:63]
  buffer_load_dwordx4 v[68:71], v5, s[16:19], s93 offen offset:1024
  v_add_f32 v16, 1.0, v16
  v_rcp_f32 v17, v16
  v_accvgpr_read_b32 v223, a31
  v_mul_f32 v223, 0x42f5fdf0, v223
  v_mul_f32 v16, 0xbfb8aa3b, v223
  v_mul_f32 v222, v222, v17
  v_exp_f32 v16, v16
  s_waitcnt vmcnt(11)
  s_waitcnt lgkmcnt(8)
  v_mfma_f32_32x32x16_bf16 a[32:47], v[48:51], v[104:107], a[32:47]
  ds_read_b64_tr_b16 v[40:41], v8 offset:59392
  ds_read_b64_tr_b16 v[42:43], v8 offset:60416
  ds_read_b64_tr_b16 v[44:45], v9 offset:59392
  ds_read_b64_tr_b16 v[46:47], v9 offset:60416
  v_mfma_f32_32x32x16_bf16 a[48:63], v[52:55], v[104:107], a[48:63]
  buffer_load_dwordx4 v[72:75], v5, s[16:19], s93 offen offset:2048
  v_add_f32 v16, 1.0, v16
  v_rcp_f32 v17, v16
  s_nop 0
  v_mul_f32 v223, v223, v17
  s_waitcnt vmcnt(11)
  s_waitcnt lgkmcnt(8)
  v_mfma_f32_32x32x16_bf16 a[32:47], v[56:59], v[108:111], a[32:47]
  ds_read_b64_tr_b16 v[48:49], v8 offset:61440
  ds_read_b64_tr_b16 v[50:51], v8 offset:62464
  ds_read_b64_tr_b16 v[52:53], v9 offset:61440
  ds_read_b64_tr_b16 v[54:55], v9 offset:62464
  v_mfma_f32_32x32x16_bf16 a[48:63], v[60:63], v[108:111], a[48:63]
  buffer_load_dwordx4 v[76:79], v5, s[16:19], s93 offen offset:3072
  s_waitcnt vmcnt(11)
  s_waitcnt lgkmcnt(8)
  v_mfma_f32_32x32x16_bf16 a[32:47], v[32:35], v[112:115], a[32:47]
  ds_read_b64_tr_b16 v[56:57], v8 offset:63488
  ds_read_b64_tr_b16 v[58:59], v8 offset:64512
  ds_read_b64_tr_b16 v[60:61], v9 offset:63488
  ds_read_b64_tr_b16 v[62:63], v9 offset:64512
  v_mfma_f32_32x32x16_bf16 a[48:63], v[36:39], v[112:115], a[48:63]
  buffer_load_dwordx4 v[80:83], v6, s[16:19], s93 offen offset:0
  s_waitcnt vmcnt(11)
  s_waitcnt lgkmcnt(8)
  v_mfma_f32_32x32x16_bf16 a[32:47], v[40:43], v[116:119], a[32:47]
  s_barrier
  ds_read_b64_tr_b16 v[32:33], v8 offset:0
  ds_read_b64_tr_b16 v[34:35], v8 offset:1024
  ds_read_b64_tr_b16 v[36:37], v9 offset:0
  ds_read_b64_tr_b16 v[38:39], v9 offset:1024
  v_mfma_f32_32x32x16_bf16 a[48:63], v[44:47], v[116:119], a[48:63]
  buffer_load_dwordx4 v[84:87], v6, s[16:19], s93 offen offset:1024
  s_waitcnt vmcnt(11)
  s_waitcnt lgkmcnt(8)
  v_mfma_f32_32x32x16_bf16 a[32:47], v[48:51], v[120:123], a[32:47]
  ds_read_b64_tr_b16 v[40:41], v8 offset:2048
  ds_read_b64_tr_b16 v[42:43], v8 offset:3072
  ds_read_b64_tr_b16 v[44:45], v9 offset:2048
  ds_read_b64_tr_b16 v[46:47], v9 offset:3072
  v_mfma_f32_32x32x16_bf16 a[48:63], v[52:55], v[120:123], a[48:63]
  buffer_load_dwordx4 v[88:91], v6, s[16:19], s93 offen offset:2048
  s_waitcnt vmcnt(11)
  s_waitcnt lgkmcnt(8)
  v_mfma_f32_32x32x16_bf16 a[32:47], v[56:59], v[124:127], a[32:47]
  ds_read_b64_tr_b16 v[48:49], v8 offset:4096
  ds_read_b64_tr_b16 v[50:51], v8 offset:5120
  ds_read_b64_tr_b16 v[52:53], v9 offset:4096
  ds_read_b64_tr_b16 v[54:55], v9 offset:5120
  v_mfma_f32_32x32x16_bf16 a[48:63], v[60:63], v[124:127], a[48:63]
  buffer_load_dwordx4 v[92:95], v6, s[16:19], s93 offen offset:3072
  s_lshr_b32 s61, 0x15161615, s58
  s_and_b32 s61, s61, 255
  s_mul_i32 s96, s61, 114688
  s_lshl_b32 s97, s61, 13
  s_add_u32 s96, s96, 0xffe78000
  s_add_u32 s97, s97, 0xfffe4000
  s_add_u32 m0, s57, 32768
  s_nop 0
  buffer_load_dwordx4 v1, s[12:15], s96 offen offset:0 lds
  buffer_load_dwordx4 v2, s[12:15], s96 offen offset:1024 lds
  buffer_load_dwordx4 v3, s[12:15], s96 offen offset:2048 lds
  buffer_load_dwordx4 v4, s[12:15], s96 offen offset:3072 lds
  buffer_load_dwordx4 v[224:227], v7, s[28:31], 0 offen offset:0
  buffer_load_dwordx4 v[228:231], v7, s[28:31], s62 offen offset:0
  buffer_load_dwordx4 v[232:235], v7, s[28:31], s63 offen offset:0
  buffer_load_dwordx4 v[236:239], v7, s[28:31], s64 offen offset:0
  s_waitcnt vmcnt(15)
  s_waitcnt lgkmcnt(8)
  v_mfma_f32_32x32x16_bf16 a[32:47], v[32:35], v[64:67], a[32:47]
  ds_read_b64_tr_b16 v[56:57], v8 offset:6144
  ds_read_b64_tr_b16 v[58:59], v8 offset:7168
  ds_read_b64_tr_b16 v[60:61], v9 offset:6144
  ds_read_b64_tr_b16 v[62:63], v9 offset:7168
  v_mfma_f32_32x32x16_bf16 a[48:63], v[36:39], v[64:67], a[48:63]
  buffer_load_dwordx4 v[96:99], v5, s[16:19], s95 offen offset:0
  s_waitcnt vmcnt(15)
  s_waitcnt lgkmcnt(8)
  v_mfma_f32_32x32x16_bf16 a[32:47], v[40:43], v[68:71], a[32:47]
  ds_read_b64_tr_b16 v[32:33], v8 offset:8192
  ds_read_b64_tr_b16 v[34:35], v8 offset:9216
  ds_read_b64_tr_b16 v[36:37], v9 offset:8192
  ds_read_b64_tr_b16 v[38:39], v9 offset:9216
  v_mfma_f32_32x32x16_bf16 a[48:63], v[44:47], v[68:71], a[48:63]
  buffer_load_dwordx4 v[100:103], v5, s[16:19], s95 offen offset:1024
  s_waitcnt vmcnt(15)
  s_waitcnt lgkmcnt(8)
  v_mfma_f32_32x32x16_bf16 a[32:47], v[48:51], v[72:75], a[32:47]
  ds_read_b64_tr_b16 v[40:41], v8 offset:10240
  ds_read_b64_tr_b16 v[42:43], v8 offset:11264
  ds_read_b64_tr_b16 v[44:45], v9 offset:10240
  ds_read_b64_tr_b16 v[46:47], v9 offset:11264
  v_mfma_f32_32x32x16_bf16 a[48:63], v[52:55], v[72:75], a[48:63]
  buffer_load_dwordx4 v[104:107], v5, s[16:19], s95 offen offset:2048
  s_waitcnt vmcnt(15)
  s_waitcnt lgkmcnt(8)
  v_mfma_f32_32x32x16_bf16 a[32:47], v[56:59], v[76:79], a[32:47]
  ds_read_b64_tr_b16 v[48:49], v8 offset:12288
  ds_read_b64_tr_b16 v[50:51], v8 offset:13312
  ds_read_b64_tr_b16 v[52:53], v9 offset:12288
  ds_read_b64_tr_b16 v[54:55], v9 offset:13312
  v_mfma_f32_32x32x16_bf16 a[48:63], v[60:63], v[76:79], a[48:63]
  buffer_load_dwordx4 v[108:111], v5, s[16:19], s95 offen offset:3072
  s_waitcnt vmcnt(15)
  s_waitcnt lgkmcnt(8)
  v_mfma_f32_32x32x16_bf16 a[32:47], v[32:35], v[80:83], a[32:47]
  ds_read_b64_tr_b16 v[56:57], v8 offset:14336
  ds_read_b64_tr_b16 v[58:59], v8 offset:15360
  ds_read_b64_tr_b16 v[60:61], v9 offset:14336
  ds_read_b64_tr_b16 v[62:63], v9 offset:15360
  v_mfma_f32_32x32x16_bf16 a[48:63], v[36:39], v[80:83], a[48:63]
  buffer_load_dwordx4 v[112:115], v6, s[16:19], s95 offen offset:0
  s_waitcnt vmcnt(15)
  s_waitcnt lgkmcnt(8)
  v_mfma_f32_32x32x16_bf16 a[32:47], v[40:43], v[84:87], a[32:47]
  s_barrier
  ds_read_b64_tr_b16 v[32:33], v8 offset:16384
  ds_read_b64_tr_b16 v[34:35], v8 offset:17408
  ds_read_b64_tr_b16 v[36:37], v9 offset:16384
  ds_read_b64_tr_b16 v[38:39], v9 offset:17408
  v_mfma_f32_32x32x16_bf16 a[48:63], v[44:47], v[84:87], a[48:63]
  buffer_load_dwordx4 v[116:119], v6, s[16:19], s95 offen offset:1024
  s_waitcnt vmcnt(15)
  s_waitcnt lgkmcnt(8)
  v_mfma_f32_32x32x16_bf16 a[32:47], v[48:51], v[88:91], a[32:47]
  ds_read_b64_tr_b16 v[40:41], v8 offset:18432
  ds_read_b64_tr_b16 v[42:43], v8 offset:19456
  ds_read_b64_tr_b16 v[44:45], v9 offset:18432
  ds_read_b64_tr_b16 v[46:47], v9 offset:19456
  v_mfma_f32_32x32x16_bf16 a[48:63], v[52:55], v[88:91], a[48:63]
  buffer_load_dwordx4 v[120:123], v6, s[16:19], s95 offen offset:2048
  s_waitcnt vmcnt(15)
  s_waitcnt lgkmcnt(8)
  v_mfma_f32_32x32x16_bf16 a[32:47], v[56:59], v[92:95], a[32:47]
  ds_read_b64_tr_b16 v[48:49], v8 offset:20480
  ds_read_b64_tr_b16 v[50:51], v8 offset:21504
  ds_read_b64_tr_b16 v[52:53], v9 offset:20480
  ds_read_b64_tr_b16 v[54:55], v9 offset:21504
  v_mfma_f32_32x32x16_bf16 a[48:63], v[60:63], v[92:95], a[48:63]
  buffer_load_dwordx4 v[124:127], v6, s[16:19], s95 offen offset:3072
  s_lshr_b32 s61, 0x17171716, s58
  s_and_b32 s61, s61, 255
  s_mul_i32 s98, s61, 114688
  s_lshl_b32 s99, s61, 13
  s_add_u32 s98, s98, 0xffe78000
  s_add_u32 s99, s99, 0xfffe4000
  s_add_u32 m0, s57, 49152
  s_nop 0
  buffer_load_dwordx4 v1, s[12:15], s98 offen offset:0 lds
  buffer_load_dwordx4 v2, s[12:15], s98 offen offset:1024 lds
  buffer_load_dwordx4 v3, s[12:15], s98 offen offset:2048 lds
  buffer_load_dwordx4 v4, s[12:15], s98 offen offset:3072 lds
  s_waitcnt vmcnt(11)
  s_waitcnt lgkmcnt(8)
  v_mfma_f32_32x32x16_bf16 a[32:47], v[32:35], v[96:99], a[32:47]
  ds_read_b64_tr_b16 v[56:57], v8 offset:22528
  ds_read_b64_tr_b16 v[58:59], v8 offset:23552
  ds_read_b64_tr_b16 v[60:61], v9 offset:22528
  ds_read_b64_tr_b16 v[62:63], v9 offset:23552
  v_mfma_f32_32x32x16_bf16 a[48:63], v[36:39], v[96:99], a[48:63]
  buffer_load_dwordx4 v[64:67], v5, s[16:19], s97 offen offset:0
  s_waitcnt vmcnt(11)
  s_waitcnt lgkmcnt(8)
  v_mfma_f32_32x32x16_bf16 a[32:47], v[40:43], v[100:103], a[32:47]
  ds_read_b64_tr_b16 v[32:33], v8 offset:24576
  ds_read_b64_tr_b16 v[34:35], v8 offset:25600
  ds_read_b64_tr_b16 v[36:37], v9 offset:24576
  ds_read_b64_tr_b16 v[38:39], v9 offset:25600
  v_mfma_f32_32x32x16_bf16 a[48:63], v[44:47], v[100:103], a[48:63]
  buffer_load_dwordx4 v[68:71], v5, s[16:19], s97 offen offset:1024
  s_waitcnt vmcnt(11)
  s_waitcnt lgkmcnt(8)
  v_mfma_f32_32x32x16_bf16 a[32:47], v[48:51], v[104:107], a[32:47]
  ds_read_b64_tr_b16 v[40:41], v8 offset:26624
  ds_read_b64_tr_b16 v[42:43], v8 offset:27648
  ds_read_b64_tr_b16 v[44:45], v9 offset:26624
  ds_read_b64_tr_b16 v[46:47], v9 offset:27648
  v_mfma_f32_32x32x16_bf16 a[48:63], v[52:55], v[104:107], a[48:63]
  buffer_load_dwordx4 v[72:75], v5, s[16:19], s97 offen offset:2048
  s_waitcnt vmcnt(11)
  s_waitcnt lgkmcnt(8)
  v_mfma_f32_32x32x16_bf16 a[32:47], v[56:59], v[108:111], a[32:47]
  ds_read_b64_tr_b16 v[48:49], v8 offset:28672
  ds_read_b64_tr_b16 v[50:51], v8 offset:29696
  ds_read_b64_tr_b16 v[52:53], v9 offset:28672
  ds_read_b64_tr_b16 v[54:55], v9 offset:29696
  v_mfma_f32_32x32x16_bf16 a[48:63], v[60:63], v[108:111], a[48:63]
  buffer_load_dwordx4 v[76:79], v5, s[16:19], s97 offen offset:3072
  s_waitcnt vmcnt(11)
  s_waitcnt lgkmcnt(8)
  v_mfma_f32_32x32x16_bf16 a[32:47], v[32:35], v[112:115], a[32:47]
  ds_read_b64_tr_b16 v[56:57], v8 offset:30720
  ds_read_b64_tr_b16 v[58:59], v8 offset:31744
  ds_read_b64_tr_b16 v[60:61], v9 offset:30720
  ds_read_b64_tr_b16 v[62:63], v9 offset:31744
  v_mfma_f32_32x32x16_bf16 a[48:63], v[36:39], v[112:115], a[48:63]
  buffer_load_dwordx4 v[80:83], v6, s[16:19], s97 offen offset:0
  s_waitcnt vmcnt(11)
  s_waitcnt lgkmcnt(8)
  v_mfma_f32_32x32x16_bf16 a[32:47], v[40:43], v[116:119], a[32:47]
  s_barrier
  ds_read_b64_tr_b16 v[32:33], v8 offset:32768
  ds_read_b64_tr_b16 v[34:35], v8 offset:33792
  ds_read_b64_tr_b16 v[36:37], v9 offset:32768
  ds_read_b64_tr_b16 v[38:39], v9 offset:33792
  v_mfma_f32_32x32x16_bf16 a[48:63], v[44:47], v[116:119], a[48:63]
  buffer_load_dwordx4 v[84:87], v6, s[16:19], s97 offen offset:1024
  s_waitcnt vmcnt(11)
  s_waitcnt lgkmcnt(8)
  v_mfma_f32_32x32x16_bf16 a[32:47], v[48:51], v[120:123], a[32:47]
  ds_read_b64_tr_b16 v[40:41], v8 offset:34816
  ds_read_b64_tr_b16 v[42:43], v8 offset:35840
  ds_read_b64_tr_b16 v[44:45], v9 offset:34816
  ds_read_b64_tr_b16 v[46:47], v9 offset:35840
  v_mfma_f32_32x32x16_bf16 a[48:63], v[52:55], v[120:123], a[48:63]
  buffer_load_dwordx4 v[88:91], v6, s[16:19], s97 offen offset:2048
  s_waitcnt vmcnt(11)
  s_waitcnt lgkmcnt(8)
  v_mfma_f32_32x32x16_bf16 a[32:47], v[56:59], v[124:127], a[32:47]
  ds_read_b64_tr_b16 v[48:49], v8 offset:36864
  ds_read_b64_tr_b16 v[50:51], v8 offset:37888
  ds_read_b64_tr_b16 v[52:53], v9 offset:36864
  ds_read_b64_tr_b16 v[54:55], v9 offset:37888
  v_mfma_f32_32x32x16_bf16 a[48:63], v[60:63], v[124:127], a[48:63]
  buffer_load_dwordx4 v[92:95], v6, s[16:19], s97 offen offset:3072
  s_waitcnt vmcnt(7)
  s_waitcnt lgkmcnt(8)
  v_mfma_f32_32x32x16_bf16 a[32:47], v[32:35], v[64:67], a[32:47]
  ds_read_b64_tr_b16 v[56:57], v8 offset:38912
  ds_read_b64_tr_b16 v[58:59], v8 offset:39936
  ds_read_b64_tr_b16 v[60:61], v9 offset:38912
  ds_read_b64_tr_b16 v[62:63], v9 offset:39936
  v_mfma_f32_32x32x16_bf16 a[48:63], v[36:39], v[64:67], a[48:63]
  buffer_load_dwordx4 v[96:99], v5, s[16:19], s99 offen offset:0
  s_waitcnt vmcnt(7)
  s_waitcnt lgkmcnt(8)
  v_mfma_f32_32x32x16_bf16 a[32:47], v[40:43], v[68:71], a[32:47]
  ds_read_b64_tr_b16 v[32:33], v8 offset:40960
  ds_read_b64_tr_b16 v[34:35], v8 offset:41984
  ds_read_b64_tr_b16 v[36:37], v9 offset:40960
  ds_read_b64_tr_b16 v[38:39], v9 offset:41984
  v_mfma_f32_32x32x16_bf16 a[48:63], v[44:47], v[68:71], a[48:63]
  buffer_load_dwordx4 v[100:103], v5, s[16:19], s99 offen offset:1024
  s_waitcnt vmcnt(7)
  s_waitcnt lgkmcnt(8)
  v_mfma_f32_32x32x16_bf16 a[32:47], v[48:51], v[72:75], a[32:47]
  ds_read_b64_tr_b16 v[40:41], v8 offset:43008
  ds_read_b64_tr_b16 v[42:43], v8 offset:44032
  ds_read_b64_tr_b16 v[44:45], v9 offset:43008
  ds_read_b64_tr_b16 v[46:47], v9 offset:44032
  v_mfma_f32_32x32x16_bf16 a[48:63], v[52:55], v[72:75], a[48:63]
  buffer_load_dwordx4 v[104:107], v5, s[16:19], s99 offen offset:2048
  buffer_load_dword v11, v10, s[20:23], s66 offen offset:0 sc1
  s_waitcnt vmcnt(8)
  s_waitcnt lgkmcnt(8)
  v_mfma_f32_32x32x16_bf16 a[32:47], v[56:59], v[76:79], a[32:47]
  ds_read_b64_tr_b16 v[48:49], v8 offset:45056
  ds_read_b64_tr_b16 v[50:51], v8 offset:46080
  ds_read_b64_tr_b16 v[52:53], v9 offset:45056
  ds_read_b64_tr_b16 v[54:55], v9 offset:46080
  v_mfma_f32_32x32x16_bf16 a[48:63], v[60:63], v[76:79], a[48:63]
  buffer_load_dwordx4 v[108:111], v5, s[16:19], s99 offen offset:3072
  s_waitcnt vmcnt(8)
  s_waitcnt lgkmcnt(8)
  v_mfma_f32_32x32x16_bf16 a[32:47], v[32:35], v[80:83], a[32:47]
  ds_read_b64_tr_b16 v[56:57], v8 offset:47104
  ds_read_b64_tr_b16 v[58:59], v8 offset:48128
  ds_read_b64_tr_b16 v[60:61], v9 offset:47104
  ds_read_b64_tr_b16 v[62:63], v9 offset:48128
  v_mfma_f32_32x32x16_bf16 a[48:63], v[36:39], v[80:83], a[48:63]
  buffer_load_dwordx4 v[112:115], v6, s[16:19], s99 offen offset:0
  s_waitcnt vmcnt(8)
  s_waitcnt lgkmcnt(8)
  v_mfma_f32_32x32x16_bf16 a[32:47], v[40:43], v[84:87], a[32:47]
  s_barrier
  ds_read_b64_tr_b16 v[32:33], v8 offset:49152
  ds_read_b64_tr_b16 v[34:35], v8 offset:50176
  ds_read_b64_tr_b16 v[36:37], v9 offset:49152
  ds_read_b64_tr_b16 v[38:39], v9 offset:50176
  v_mfma_f32_32x32x16_bf16 a[48:63], v[44:47], v[84:87], a[48:63]
  buffer_load_dwordx4 v[116:119], v6, s[16:19], s99 offen offset:1024
  s_waitcnt vmcnt(8)
  s_waitcnt lgkmcnt(8)
  v_mfma_f32_32x32x16_bf16 a[32:47], v[48:51], v[88:91], a[32:47]
  ds_read_b64_tr_b16 v[40:41], v8 offset:51200
  ds_read_b64_tr_b16 v[42:43], v8 offset:52224
  ds_read_b64_tr_b16 v[44:45], v9 offset:51200
  ds_read_b64_tr_b16 v[46:47], v9 offset:52224
  v_mfma_f32_32x32x16_bf16 a[48:63], v[52:55], v[88:91], a[48:63]
  buffer_load_dwordx4 v[120:123], v6, s[16:19], s99 offen offset:2048
  s_waitcnt vmcnt(8)
  s_waitcnt lgkmcnt(8)
  v_mfma_f32_32x32x16_bf16 a[32:47], v[56:59], v[92:95], a[32:47]
  ds_read_b64_tr_b16 v[48:49], v8 offset:53248
  ds_read_b64_tr_b16 v[50:51], v8 offset:54272
  ds_read_b64_tr_b16 v[52:53], v9 offset:53248
  ds_read_b64_tr_b16 v[54:55], v9 offset:54272
  v_mfma_f32_32x32x16_bf16 a[48:63], v[60:63], v[92:95], a[48:63]
  buffer_load_dwordx4 v[124:127], v6, s[16:19], s99 offen offset:3072
  s_waitcnt vmcnt(8)
  s_waitcnt lgkmcnt(8)
  v_mfma_f32_32x32x16_bf16 a[32:47], v[32:35], v[96:99], a[32:47]
  ds_read_b64_tr_b16 v[56:57], v8 offset:55296
  ds_read_b64_tr_b16 v[58:59], v8 offset:56320
  ds_read_b64_tr_b16 v[60:61], v9 offset:55296
  ds_read_b64_tr_b16 v[62:63], v9 offset:56320
  v_mfma_f32_32x32x16_bf16 a[48:63], v[36:39], v[96:99], a[48:63]
  s_waitcnt vmcnt(5)
  v_readfirstlane_b32 s59, v11
  s_mov_b32 s61, 65536
  s_nop 3
  s_cmp_lg_u32 s59, 0
  s_cbranch_scc1 K2_GOT
K2_POLL:
  buffer_load_dword v11, v10, s[20:23], s66 offen sc1
  s_waitcnt vmcnt(0)
  v_readfirstlane_b32 s59, v11
  s_sub_u32 s61, s61, 1
  s_nop 3
  s_cmp_lg_u32 s59, 0
  s_cselect_b32 s61, 0, s61
  s_cmp_lg_u32 s61, 0
  s_cbranch_scc1 K2_POLL
K2_GOT:
  buffer_load_dwordx4 v[128:131], v5, s[20:23], s67 offen offset:0 sc1
  buffer_load_dwordx4 v[132:135], v5, s[20:23], s67 offen offset:1024 sc1
  buffer_load_dwordx4 v[136:139], v5, s[20:23], s67 offen offset:2048 sc1
  buffer_load_dwordx4 v[140:143], v5, s[20:23], s67 offen offset:3072 sc1
  buffer_load_dwordx4 v[144:147], v6, s[20:23], s67 offen offset:0 sc1
  buffer_load_dwordx4 v[148:151], v6, s[20:23], s67 offen offset:1024 sc1
  buffer_load_dwordx4 v[152:155], v6, s[20:23], s67 offen offset:2048 sc1
  buffer_load_dwordx4 v[156:159], v6, s[20:23], s67 offen offset:3072 sc1
  s_waitcnt lgkmcnt(8)
  v_mfma_f32_32x32x16_bf16 a[32:47], v[40:43], v[100:103], a[32:47]
  ds_read_b64_tr_b16 v[32:33], v8 offset:57344
  ds_read_b64_tr_b16 v[34:35], v8 offset:58368
  ds_read_b64_tr_b16 v[36:37], v9 offset:57344
  ds_read_b64_tr_b16 v[38:39], v9 offset:58368
  v_mfma_f32_32x32x16_bf16 a[48:63], v[44:47], v[100:103], a[48:63]
  s_waitcnt lgkmcnt(8)
  v_mfma_f32_32x32x16_bf16 a[32:47], v[48:51], v[104:107], a[32:47]
  ds_read_b64_tr_b16 v[40:41], v8 offset:59392
  ds_read_b64_tr_b16 v[42:43], v8 offset:60416
  ds_read_b64_tr_b16 v[44:45], v9 offset:59392
  ds_read_b64_tr_b16 v[46:47], v9 offset:60416
  v_mfma_f32_32x32x16_bf16 a[48:63], v[52:55], v[104:107], a[48:63]
  s_waitcnt vmcnt(12)
  s_waitcnt lgkmcnt(8)
  v_mfma_f32_32x32x16_bf16 a[32:47], v[56:59], v[108:111], a[32:47]
  ds_read_b64_tr_b16 v[48:49], v8 offset:61440
  ds_read_b64_tr_b16 v[50:51], v8 offset:62464
  ds_read_b64_tr_b16 v[52:53], v9 offset:61440
  ds_read_b64_tr_b16 v[54:55], v9 offset:62464
  v_mfma_f32_32x32x16_bf16 a[48:63], v[60:63], v[108:111], a[48:63]
  s_waitcnt vmcnt(11)
  s_waitcnt lgkmcnt(8)
  v_mfma_f32_32x32x16_bf16 a[32:47], v[32:35], v[112:115], a[32:47]
  ds_read_b64_tr_b16 v[56:57], v8 offset:63488
  ds_read_b64_tr_b16 v[58:59], v8 offset:64512
  ds_read_b64_tr_b16 v[60:61], v9 offset:63488
  ds_read_b64_tr_b16 v[62:63], v9 offset:64512
  v_mfma_f32_32x32x16_bf16 a[48:63], v[36:39], v[112:115], a[48:63]
  s_waitcnt vmcnt(10)
  s_waitcnt lgkmcnt(8)
  v_mfma_f32_32x32x16_bf16 a[32:47], v[40:43], v[116:119], a[32:47]
  v_mfma_f32_32x32x16_bf16 a[48:63], v[44:47], v[116:119], a[48:63]
  s_waitcnt vmcnt(9)
  s_waitcnt lgkmcnt(4)
  v_mfma_f32_32x32x16_bf16 a[32:47], v[48:51], v[120:123], a[32:47]
  v_mfma_f32_32x32x16_bf16 a[48:63], v[52:55], v[120:123], a[48:63]
  s_waitcnt vmcnt(8)
  s_waitcnt lgkmcnt(2)
  v_mfma_f32_32x32x16_bf16 a[32:47], v[56:59], v[124:127], a[32:47]
  s_waitcnt lgkmcnt(0)
  v_mfma_f32_32x32x16_bf16 a[48:63], v[60:63], v[124:127], a[48:63]
  s_nop 9
  v_accvgpr_read_b32 v160, a32
  v_accvgpr_read_b32 v161, a33
  v_accvgpr_read_b32 v162, a34
  v_accvgpr_read_b32 v163, a35
  s_waitcnt vmcnt(7)
  v_add_f32 v128, v128, v160
  v_add_f32 v129, v129, v161
  v_add_f32 v130, v130, v162
  v_add_f32 v131, v131, v163
  v_mul_f32 v128, v128, v192
  v_mul_f32 v129, v129, v193
  v_mul_f32 v130, v130, v194
  v_mul_f32 v131, v131, v195
  ds_write_b128 v12, v[128:131] offset:0
  v_accvgpr_read_b32 v164, a36
  v_accvgpr_read_b32 v165, a37
  v_accvgpr_read_b32 v166, a38
  v_accvgpr_read_b32 v167, a39
  s_waitcnt vmcnt(6)
  v_add_f32 v132, v132, v164
  v_add_f32 v133, v133, v165
  v_add_f32 v134, v134, v166
  v_add_f32 v135, v135, v167
  v_mul_f32 v132, v132, v196
  v_mul_f32 v133, v133, v197
  v_mul_f32 v134, v134, v198
  v_mul_f32 v135, v135, v199
  ds_write_b128 v13, v[132:135] offset:0
  v_accvgpr_read_b32 v168, a40
  v_accvgpr_read_b32 v169, a41
  v_accvgpr_read_b32 v170, a42
  v_accvgpr_read_b32 v171, a43
  s_waitcnt vmcnt(5)
  v_add_f32 v136, v136, v168
  v_add_f32 v137, v137, v169
  v_add_f32 v138, v138, v170
  v_add_f32 v139, v139, v171
  v_mul_f32 v136, v136, v200
  v_mul_f32 v137, v137, v201
  v_mul_f32 v138, v138, v202
  v_mul_f32 v139, v139, v203
  ds_write_b128 v14, v[136:139] offset:0
  v_accvgpr_read_b32 v172, a44
  v_accvgpr_read_b32 v173, a45
  v_accvgpr_read_b32 v174, a46
  v_accvgpr_read_b32 v175, a47
  s_waitcnt vmcnt(4)
  v_add_f32 v140, v140, v172
  v_add_f32 v141, v141, v173
  v_add_f32 v142, v142, v174
  v_add_f32 v143, v143, v175
  v_mul_f32 v140, v140, v204
  v_mul_f32 v141, v141, v205
  v_mul_f32 v142, v142, v206
  v_mul_f32 v143, v143, v207
  ds_write_b128 v15, v[140:143] offset:0
  v_accvgpr_read_b32 v176, a48
  v_accvgpr_read_b32 v177, a49
  v_accvgpr_read_b32 v178, a50
  v_accvgpr_read_b32 v179, a51
  s_waitcnt vmcnt(3)
  v_add_f32 v144, v144, v176
  v_add_f32 v145, v145, v177
  v_add_f32 v146, v146, v178
  v_add_f32 v147, v147, v179
  v_mul_f32 v144, v144, v208
  v_mul_f32 v145, v145, v209
  v_mul_f32 v146, v146, v210
  v_mul_f32 v147, v147, v211
  ds_write_b128 v12, v[144:147] offset:128
  v_accvgpr_read_b32 v180, a52
  v_accvgpr_read_b32 v181, a53
  v_accvgpr_read_b32 v182, a54
  v_accvgpr_read_b32 v183, a55
  s_waitcnt vmcnt(2)
  v_add_f32 v148, v148, v180
  v_add_f32 v149, v149, v181
  v_add_f32 v150, v150, v182
  v_add_f32 v151, v151, v183
  v_mul_f32 v148, v148, v212
  v_mul_f32 v149, v149, v213
  v_mul_f32 v150, v150, v214
  v_mul_f32 v151, v151, v215
  ds_write_b128 v13, v[148:151] offset:128
  v_accvgpr_read_b32 v184, a56
  v_accvgpr_read_b32 v185, a57
  v_accvgpr_read_b32 v186, a58
  v_accvgpr_read_b32 v187, a59
  s_waitcnt vmcnt(1)
  v_add_f32 v152, v152, v184
  v_add_f32 v153, v153, v185
  v_add_f32 v154, v154, v186
  v_add_f32 v155, v155, v187
  v_mul_f32 v152, v152, v216
  v_mul_f32 v153, v153, v217
  v_mul_f32 v154, v154, v218
  v_mul_f32 v155, v155, v219
  ds_write_b128 v14, v[152:155] offset:128
  v_accvgpr_read_b32 v188, a60
  v_accvgpr_read_b32 v189, a61
  v_accvgpr_read_b32 v190, a62
  v_accvgpr_read_b32 v191, a63
  s_waitcnt vmcnt(0)
  v_add_f32 v156, v156, v188
  v_add_f32 v157, v157, v189
  v_add_f32 v158, v158, v190
  v_add_f32 v159, v159, v191
  v_mul_f32 v156, v156, v220
  v_mul_f32 v157, v157, v221
  v_mul_f32 v158, v158, v222
  v_mul_f32 v159, v159, v223
  ds_write_b128 v15, v[156:159] offset:128
  ds_read_b128 v[160:163], v24 offset:0
  ds_read_b128 v[164:167], v25 offset:0
  ds_read_b128 v[168:171], v24 offset:2048
  ds_read_b128 v[172:175], v25 offset:2048
  ds_read_b128 v[176:179], v24 offset:4096
  ds_read_b128 v[180:183], v25 offset:4096
  ds_read_b128 v[184:187], v24 offset:6144
  ds_read_b128 v[188:191], v25 offset:6144
  v_lshlrev_b32 v128, 16, v224
  v_and_b32 v129, 0xffff0000, v224
  v_lshlrev_b32 v130, 16, v225
  v_and_b32 v131, 0xffff0000, v225
  v_lshlrev_b32 v132, 16, v226
  v_and_b32 v133, 0xffff0000, v226
  v_lshlrev_b32 v134, 16, v227
  v_and_b32 v135, 0xffff0000, v227
  s_waitcnt lgkmcnt(6)
  v_add_f32 v128, v128, v160
  v_add_f32 v129, v129, v161
  v_add_f32 v130, v130, v162
  v_add_f32 v131, v131, v163
  v_add_f32 v132, v132, v164
  v_add_f32 v133, v133, v165
  v_add_f32 v134, v134, v166
  v_add_f32 v135, v135, v167
  v_cvt_pk_bf16_f32 v224, v128, v129
  v_cvt_pk_bf16_f32 v225, v130, v131
  v_cvt_pk_bf16_f32 v226, v132, v133
  v_cvt_pk_bf16_f32 v227, v134, v135
  buffer_store_dwordx4 v[224:227], v7, s[24:27], 0 offen offset:0
  v_lshlrev_b32 v128, 16, v228
  v_and_b32 v129, 0xffff0000, v228
  v_lshlrev_b32 v130, 16, v229
  v_and_b32 v131, 0xffff0000, v229
  v_lshlrev_b32 v132, 16, v230
  v_and_b32 v133, 0xffff0000, v230
  v_lshlrev_b32 v134, 16, v231
  v_and_b32 v135, 0xffff0000, v231
  s_waitcnt lgkmcnt(4)
  v_add_f32 v128, v128, v168
  v_add_f32 v129, v129, v169
  v_add_f32 v130, v130, v170
  v_add_f32 v131, v131, v171
  v_add_f32 v132, v132, v172
  v_add_f32 v133, v133, v173
  v_add_f32 v134, v134, v174
  v_add_f32 v135, v135, v175
  v_cvt_pk_bf16_f32 v228, v128, v129
  v_cvt_pk_bf16_f32 v229, v130, v131
  v_cvt_pk_bf16_f32 v230, v132, v133
  v_cvt_pk_bf16_f32 v231, v134, v135
  buffer_store_dwordx4 v[228:231], v7, s[24:27], s62 offen offset:0
  v_lshlrev_b32 v128, 16, v232
  v_and_b32 v129, 0xffff0000, v232
  v_lshlrev_b32 v130, 16, v233
  v_and_b32 v131, 0xffff0000, v233
  v_lshlrev_b32 v132, 16, v234
  v_and_b32 v133, 0xffff0000, v234
  v_lshlrev_b32 v134, 16, v235
  v_and_b32 v135, 0xffff0000, v235
  s_waitcnt lgkmcnt(2)
  v_add_f32 v128, v128, v176
  v_add_f32 v129, v129, v177
  v_add_f32 v130, v130, v178
  v_add_f32 v131, v131, v179
  v_add_f32 v132, v132, v180
  v_add_f32 v133, v133, v181
  v_add_f32 v134, v134, v182
  v_add_f32 v135, v135, v183
  v_cvt_pk_bf16_f32 v232, v128, v129
  v_cvt_pk_bf16_f32 v233, v130, v131
  v_cvt_pk_bf16_f32 v234, v132, v133
  v_cvt_pk_bf16_f32 v235, v134, v135
  buffer_store_dwordx4 v[232:235], v7, s[24:27], s63 offen offset:0
  v_lshlrev_b32 v128, 16, v236
  v_and_b32 v129, 0xffff0000, v236
  v_lshlrev_b32 v130, 16, v237
  v_and_b32 v131, 0xffff0000, v237
  v_lshlrev_b32 v132, 16, v238
  v_and_b32 v133, 0xffff0000, v238
  v_lshlrev_b32 v134, 16, v239
  v_and_b32 v135, 0xffff0000, v239
  s_waitcnt lgkmcnt(0)
  v_add_f32 v128, v128, v184
  v_add_f32 v129, v129, v185
  v_add_f32 v130, v130, v186
  v_add_f32 v131, v131, v187
  v_add_f32 v132, v132, v188
  v_add_f32 v133, v133, v189
  v_add_f32 v134, v134, v190
  v_add_f32 v135, v135, v191
  v_cvt_pk_bf16_f32 v236, v128, v129
  v_cvt_pk_bf16_f32 v237, v130, v131
  v_cvt_pk_bf16_f32 v238, v132, v133
  v_cvt_pk_bf16_f32 v239, v134, v135
  buffer_store_dwordx4 v[236:239], v7, s[24:27], s64 offen offset:0
  s_branch K2_FIN
K2_PROD:
  v_med3_u32 v31, v30, 8, 15
  v_lshlrev_b32 v31, 8, v31
  v_med3_u32 v30, v30, 5, 7
  v_lshlrev_b32 v30, 8, v30
  s_lshr_b32 s61, 0x1010000, s58
  s_and_b32 s61, s61, 255
  s_mul_i32 s92, s61, 114688
  s_lshl_b32 s93, s61, 13
  s_add_u32 s92, s92, 0x118000
  s_add_u32 s93, s93, 0x14000
  s_add_u32 m0, s57, 0
  s_nop 0
  buffer_load_dwordx4 v1, s[12:15], s92 offen offset:0 lds
  buffer_load_dwordx4 v2, s[12:15], s92 offen offset:1024 lds
  buffer_load_dwordx4 v3, s[12:15], s92 offen offset:2048 lds
  buffer_load_dwordx4 v4, s[12:15], s92 offen offset:3072 lds
  v_lshrrev_b32 v20, 5, v0
  v_bfe_u32 v21, v0, 4, 1
  v_bfe_u32 v22, v0, 2, 2
  v_and_b32 v23, 3, v0
  v_lshlrev_b32 v16, 7, v22
  v_lshrrev_b32 v17, 1, v22
  v_lshl_add_u32 v16, v17, 6, v16
  v_lshl_add_u32 v16, v20, 9, v16
  v_and_b32 v17, 1, v23
  v_lshl_add_u32 v16, v17, 5, v16
  v_lshl_add_u32 v16, v21, 4, v16
  v_lshrrev_b32 v17, 1, v23
  v_lshl_add_u32 v8, v17, 3, v16
  v_xor_b32 v9, 64, v8
  s_add_u32 s20, s54, 0x1800000
  s_addc_u32 s21, s55, 0
  s_mov_b32 s22, 8388608
  s_mov_b32 s23, 0x20000
  s_mul_i32 s61, s5, 7
  s_add_u32 s61, s61, s6
  s_lshl_b32 s66, s5, 4
  s_add_u32 s66, s66, s6
  s_lshl_b32 s66, s66, 8
  s_lshl_b32 s67, s61, 15
  s_lshl_b32 s61, s56, 13
  s_add_u32 s67, s67, s61
  s_add_u32 s67, s67, 0x100000
  v_mov_b32 v10, 0
  s_lshr_b32 s61, 0x30102, s58
  s_and_b32 s61, s61, 255
  s_mul_i32 s94, s61, 114688
  s_lshl_b32 s95, s61, 13
  s_add_u32 s94, s94, 0x118000
  s_add_u32 s95, s95, 0x14000
  s_add_u32 m0, s57, 16384
  s_nop 0
  buffer_load_dwordx4 v1, s[12:15], s94 offen offset:0 lds
  buffer_load_dwordx4 v2, s[12:15], s94 offen offset:1024 lds
  buffer_load_dwordx4 v3, s[12:15], s94 offen offset:2048 lds
  buffer_load_dwordx4 v4, s[12:15], s94 offen offset:3072 lds
  s_waitcnt vmcnt(8)
  s_barrier
  buffer_store_byte v11, v29, s[68:71], 0 offen sc1
  s_mov_b32 s3, 65536
K2_OP_L:
  buffer_load_dword v128, v30, s[20:23], s65 offen offset:128 sc1
  s_waitcnt vmcnt(0)
K2_OP_C:
  v_cmp_eq_u32 vcc, 0, v128
  s_sub_u32 s3, s3, 1
  s_nop 4
  s_cmp_eq_u64 vcc, 0
  s_cselect_b32 s3, 0, s3
  s_cmp_lg_u32 s3, 0
  s_cbranch_scc1 K2_OP_L
  buffer_load_dwordx4 v[64:67], v5, s[16:19], s93 offen offset:0
  buffer_load_dwordx4 v[68:71], v5, s[16:19], s93 offen offset:1024
  buffer_load_dwordx4 v[72:75], v5, s[16:19], s93 offen offset:2048
  buffer_load_dwordx4 v[76:79], v5, s[16:19], s93 offen offset:3072
  buffer_load_dwordx4 v[80:83], v6, s[16:19], s93 offen offset:0
  buffer_load_dwordx4 v[84:87], v6, s[16:19], s93 offen offset:1024
  buffer_load_dwordx4 v[88:91], v6, s[16:19], s93 offen offset:2048
  buffer_load_dwordx4 v[92:95], v6, s[16:19], s93 offen offset:3072
  s_waitcnt vmcnt(13)
  s_barrier
  ds_read_b64_tr_b16 v[32:33], v8 offset:0
  ds_read_b64_tr_b16 v[34:35], v8 offset:1024
  ds_read_b64_tr_b16 v[36:37], v9 offset:0
  ds_read_b64_tr_b16 v[38:39], v9 offset:1024
  ds_read_b64_tr_b16 v[40:41], v8 offset:2048
  ds_read_b64_tr_b16 v[42:43], v8 offset:3072
  ds_read_b64_tr_b16 v[44:45], v9 offset:2048
  ds_read_b64_tr_b16 v[46:47], v9 offset:3072
  ds_read_b64_tr_b16 v[48:49], v8 offset:4096
  ds_read_b64_tr_b16 v[50:51], v8 offset:5120
  ds_read_b64_tr_b16 v[52:53], v9 offset:4096
  ds_read_b64_tr_b16 v[54:55], v9 offset:5120
  s_lshr_b32 s61, 0x5000401, s58
  s_and_b32 s61, s61, 255
  s_mul_i32 s96, s61, 114688
  s_lshl_b32 s97, s61, 13
  s_add_u32 s96, s96, 0x118000
  s_add_u32 s97, s97, 0x14000
  s_add_u32 m0, s57, 32768
  s_nop 0
  buffer_load_dwordx4 v1, s[12:15], s96 offen offset:0 lds
  buffer_load_dwordx4 v2, s[12:15], s96 offen offset:1024 lds
  buffer_load_dwordx4 v3, s[12:15], s96 offen offset:2048 lds
  buffer_load_dwordx4 v4, s[12:15], s96 offen offset:3072 lds
  s_waitcnt vmcnt(11)
  s_waitcnt lgkmcnt(8)
  v_mfma_f32_32x32x16_bf16 a[32:47], v[32:35], v[64:67], 0
  ds_read_b64_tr_b16 v[56:57], v8 offset:6144
  ds_read_b64_tr_b16 v[58:59], v8 offset:7168
  ds_read_b64_tr_b16 v[60:61], v9 offset:6144
  ds_read_b64_tr_b16 v[62:63], v9 offset:7168
  v_mfma_f32_32x32x16_bf16 a[48:63], v[36:39], v[64:67], 0
  buffer_load_dwordx4 v[96:99], v5, s[16:19], s95 offen offset:0
  s_waitcnt vmcnt(11)
  s_waitcnt lgkmcnt(8)
  v_mfma_f32_32x32x16_bf16 a[32:47], v[40:43], v[68:71], a[32:47]
  ds_read_b64_tr_b16 v[32:33], v8 offset:8192
  ds_read_b64_tr_b16 v[34:35], v8 offset:9216
  ds_read_b64_tr_b16 v[36:37], v9 offset:8192
  ds_read_b64_tr_b16 v[38:39], v9 offset:9216
  v_mfma_f32_32x32x16_bf16 a[48:63], v[44:47], v[68:71], a[48:63]
  buffer_load_dwordx4 v[100:103], v5, s[16:19], s95 offen offset:1024
  s_waitcnt vmcnt(11)
  s_waitcnt lgkmcnt(8)
  v_mfma_f32_32x32x16_bf16 a[32:47], v[48:51], v[72:75], a[32:47]
  ds_read_b64_tr_b16 v[40:41], v8 offset:10240
  ds_read_b64_tr_b16 v[42:43], v8 offset:11264
  ds_read_b64_tr_b16 v[44:45], v9 offset:10240
  ds_read_b64_tr_b16 v[46:47], v9 offset:11264
  v_mfma_f32_32x32x16_bf16 a[48:63], v[52:55], v[72:75], a[48:63]
  buffer_load_dwordx4 v[104:107], v5, s[16:19], s95 offen offset:2048
  s_waitcnt vmcnt(11)
  s_waitcnt lgkmcnt(8)
  v_mfma_f32_32x32x16_bf16 a[32:47], v[56:59], v[76:79], a[32:47]
  ds_read_b64_tr_b16 v[48:49], v8 offset:12288
  ds_read_b64_tr_b16 v[50:51], v8 offset:13312
  ds_read_b64_tr_b16 v[52:53], v9 offset:12288
  ds_read_b64_tr_b16 v[54:55], v9 offset:13312
  v_mfma_f32_32x32x16_bf16 a[48:63], v[60:63], v[76:79], a[48:63]
  buffer_load_dwordx4 v[108:111], v5, s[16:19], s95 offen offset:3072
  s_waitcnt vmcnt(11)
  s_waitcnt lgkmcnt(8)
  v_mfma_f32_32x32x16_bf16 a[32:47], v[32:35], v[80:83], a[32:47]
  ds_read_b64_tr_b16 v[56:57], v8 offset:14336
  ds_read_b64_tr_b16 v[58:59], v8 offset:15360
  ds_read_b64_tr_b16 v[60:61], v9 offset:14336
  ds_read_b64_tr_b16 v[62:63], v9 offset:15360
  v_mfma_f32_32x32x16_bf16 a[48:63], v[36:39], v[80:83], a[48:63]
  buffer_load_dwordx4 v[112:115], v6, s[16:19], s95 offen offset:0
  s_waitcnt vmcnt(11)
  s_waitcnt lgkmcnt(8)
  v_mfma_f32_32x32x16_bf16 a[32:47], v[40:43], v[84:87], a[32:47]
  s_barrier
  ds_read_b64_tr_b16 v[32:33], v8 offset:16384
  ds_read_b64_tr_b16 v[34:35], v8 offset:17408
  ds_read_b64_tr_b16 v[36:37], v9 offset:16384
  ds_read_b64_tr_b16 v[38:39], v9 offset:17408
  v_mfma_f32_32x32x16_bf16 a[48:63], v[44:47], v[84:87], a[48:63]
  buffer_load_dwordx4 v[116:119], v6, s[16:19], s95 offen offset:1024
  s_waitcnt vmcnt(11)
  s_waitcnt lgkmcnt(8)
  v_mfma_f32_32x32x16_bf16 a[32:47], v[48:51], v[88:91], a[32:47]
  ds_read_b64_tr_b16 v[40:41], v8 offset:18432
  ds_read_b64_tr_b16 v[42:43], v8 offset:19456
  ds_read_b64_tr_b16 v[44:45], v9 offset:18432
  ds_read_b64_tr_b16 v[46:47], v9 offset:19456
  v_mfma_f32_32x32x16_bf16 a[48:63], v[52:55], v[88:91], a[48:63]
  buffer_load_dword v128, v31, s[20:23], s65 offen offset:128 sc1
  buffer_load_dwordx4 v[120:123], v6, s[16:19], s95 offen offset:2048
  s_waitcnt vmcnt(12)
  s_waitcnt lgkmcnt(8)
  v_mfma_f32_32x32x16_bf16 a[32:47], v[56:59], v[92:95], a[32:47]
  ds_read_b64_tr_b16 v[48:49], v8 offset:20480
  ds_read_b64_tr_b16 v[50:51], v8 offset:21504
  ds_read_b64_tr_b16 v[52:53], v9 offset:20480
  ds_read_b64_tr_b16 v[54:55], v9 offset:21504
  v_mfma_f32_32x32x16_bf16 a[48:63], v[60:63], v[92:95], a[48:63]
  buffer_load_dwordx4 v[124:127], v6, s[16:19], s95 offen offset:3072
  s_lshr_b32 s61, 0x6020203, s58
  s_and_b32 s61, s61, 255
  s_mul_i32 s98, s61, 114688
  s_lshl_b32 s99, s61, 13
  s_add_u32 s98, s98, 0x118000
  s_add_u32 s99, s99, 0x14000
  s_add_u32 m0, s57, 49152
  s_nop 0
  buffer_load_dwordx4 v1, s[12:15], s98 offen offset:0 lds
  buffer_load_dwordx4 v2, s[12:15], s98 offen offset:1024 lds
  buffer_load_dwordx4 v3, s[12:15], s98 offen offset:2048 lds
  buffer_load_dwordx4 v4, s[12:15], s98 offen offset:3072 lds
  s_waitcnt vmcnt(12)
  s_waitcnt lgkmcnt(8)
  v_mfma_f32_32x32x16_bf16 a[32:47], v[32:35], v[96:99], a[32:47]
  ds_read_b64_tr_b16 v[56:57], v8 offset:22528
  ds_read_b64_tr_b16 v[58:59], v8 offset:23552
  ds_read_b64_tr_b16 v[60:61], v9 offset:22528
  ds_read_b64_tr_b16 v[62:63], v9 offset:23552
  v_mfma_f32_32x32x16_bf16 a[48:63], v[36:39], v[96:99], a[48:63]
  buffer_load_dwordx4 v[64:67], v5, s[16:19], s97 offen offset:0
  s_waitcnt vmcnt(12)
  s_waitcnt lgkmcnt(8)
  v_mfma_f32_32x32x16_bf16 a[32:47], v[40:43], v[100:103], a[32:47]
  ds_read_b64_tr_b16 v[32:33], v8 offset:24576
  ds_read_b64_tr_b16 v[34:35], v8 offset:25600
  ds_read_b64_tr_b16 v[36:37], v9 offset:24576
  ds_read_b64_tr_b16 v[38:39], v9 offset:25600
  v_mfma_f32_32x32x16_bf16 a[48:63], v[44:47], v[100:103], a[48:63]
  buffer_load_dwordx4 v[68:71], v5, s[16:19], s97 offen offset:1024
  s_waitcnt vmcnt(12)
  s_waitcnt lgkmcnt(8)
  v_mfma_f32_32x32x16_bf16 a[32:47], v[48:51], v[104:107], a[32:47]
  ds_read_b64_tr_b16 v[40:41], v8 offset:26624
  ds_read_b64_tr_b16 v[42:43], v8 offset:27648
  ds_read_b64_tr_b16 v[44:45], v9 offset:26624
  ds_read_b64_tr_b16 v[46:47], v9 offset:27648
  v_mfma_f32_32x32x16_bf16 a[48:63], v[52:55], v[104:107], a[48:63]
  buffer_load_dwordx4 v[72:75], v5, s[16:19], s97 offen offset:2048
  s_waitcnt vmcnt(12)
  s_waitcnt lgkmcnt(8)
  v_mfma_f32_32x32x16_bf16 a[32:47], v[56:59], v[108:111], a[32:47]
  ds_read_b64_tr_b16 v[48:49], v8 offset:28672
  ds_read_b64_tr_b16 v[50:51], v8 offset:29696
  ds_read_b64_tr_b16 v[52:53], v9 offset:28672
  ds_read_b64_tr_b16 v[54:55], v9 offset:29696
  v_mfma_f32_32x32x16_bf16 a[48:63], v[60:63], v[108:111], a[48:63]
  buffer_load_dwordx4 v[76:79], v5, s[16:19], s97 offen offset:3072
  s_waitcnt vmcnt(12)
  s_waitcnt lgkmcnt(8)
  v_mfma_f32_32x32x16_bf16 a[32:47], v[32:35], v[112:115], a[32:47]
  ds_read_b64_tr_b16 v[56:57], v8 offset:30720
  ds_read_b64_tr_b16 v[58:59], v8 offset:31744
  ds_read_b64_tr_b16 v[60:61], v9 offset:30720
  ds_read_b64_tr_b16 v[62:63], v9 offset:31744
  v_mfma_f32_32x32x16_bf16 a[48:63], v[36:39], v[112:115], a[48:63]
  buffer_load_dwordx4 v[80:83], v6, s[16:19], s97 offen offset:0
  s_waitcnt vmcnt(12)
  s_waitcnt lgkmcnt(8)
  v_mfma_f32_32x32x16_bf16 a[32:47], v[40:43], v[116:119], a[32:47]
  s_barrier
  ds_read_b64_tr_b16 v[32:33], v8 offset:32768
  ds_read_b64_tr_b16 v[34:35], v8 offset:33792
  ds_read_b64_tr_b16 v[36:37], v9 offset:32768
  ds_read_b64_tr_b16 v[38:39], v9 offset:33792
  v_mfma_f32_32x32x16_bf16 a[48:63], v[44:47], v[116:119], a[48:63]
  buffer_load_dwordx4 v[84:87], v6, s[16:19], s97 offen offset:1024
  s_waitcnt vmcnt(11)
  s_waitcnt lgkmcnt(8)
  v_mfma_f32_32x32x16_bf16 a[32:47], v[48:51], v[120:123], a[32:47]
  ds_read_b64_tr_b16 v[40:41], v8 offset:34816
  ds_read_b64_tr_b16 v[42:43], v8 offset:35840
  ds_read_b64_tr_b16 v[44:45], v9 offset:34816
  ds_read_b64_tr_b16 v[46:47], v9 offset:35840
  v_mfma_f32_32x32x16_bf16 a[48:63], v[52:55], v[120:123], a[48:63]
  buffer_load_dwordx4 v[88:91], v6, s[16:19], s97 offen offset:2048
  s_waitcnt vmcnt(11)
  s_waitcnt lgkmcnt(8)
  v_mfma_f32_32x32x16_bf16 a[32:47], v[56:59], v[124:127], a[32:47]
  ds_read_b64_tr_b16 v[48:49], v8 offset:36864
  ds_read_b64_tr_b16 v[50:51], v8 offset:37888
  ds_read_b64_tr_b16 v[52:53], v9 offset:36864
  ds_read_b64_tr_b16 v[54:55], v9 offset:37888
  v_mfma_f32_32x32x16_bf16 a[48:63], v[60:63], v[124:127], a[48:63]
  buffer_load_dwordx4 v[92:95], v6, s[16:19], s97 offen offset:3072
  s_lshr_b32 s61, 0x2040307, s58
  s_and_b32 s61, s61, 255
  s_mul_i32 s92, s61, 114688
  s_lshl_b32 s93, s61, 13
  s_add_u32 s92, s92, 0x118000
  s_add_u32 s93, s93, 0x14000
  s_add_u32 m0, s57, 0
  s_nop 0
  buffer_load_dwordx4 v1, s[12:15], s92 offen offset:0 lds
  buffer_load_dwordx4 v2, s[12:15], s92 offen offset:1024 lds
  buffer_load_dwordx4 v3, s[12:15], s92 offen offset:2048 lds
  buffer_load_dwordx4 v4, s[12:15], s92 offen offset:3072 lds
  s_waitcnt vmcnt(11)
  s_waitcnt lgkmcnt(8)
  v_mfma_f32_32x32x16_bf16 a[32:47], v[32:35], v[64:67], a[32:47]
  ds_read_b64_tr_b16 v[56:57], v8 offset:38912
  ds_read_b64_tr_b16 v[58:59], v8 offset:39936
  ds_read_b64_tr_b16 v[60:61], v9 offset:38912
  ds_read_b64_tr_b16 v[62:63], v9 offset:39936
  v_mfma_f32_32x32x16_bf16 a[48:63], v[36:39], v[64:67], a[48:63]
  s_mov_b32 s3, 65536
  s_branch K2_OQ_C
K2_OQ_L:
  buffer_load_dword v128, v31, s[20:23], s65 offen offset:128 sc1
  s_waitcnt vmcnt(0)
K2_OQ_C:
  v_cmp_eq_u32 vcc, 0, v128
  s_sub_u32 s3, s3, 1
  s_nop 4
  s_cmp_eq_u64 vcc, 0
  s_cselect_b32 s3, 0, s3
  s_cmp_lg_u32 s3, 0
  s_cbranch_scc1 K2_OQ_L
  buffer_load_dwordx4 v[96:99], v5, s[16:19], s99 offen offset:0
  s_waitcnt vmcnt(11)
  s_waitcnt lgkmcnt(8)
  v_mfma_f32_32x32x16_bf16 a[32:47], v[40:43], v[68:71], a[32:47]
  ds_read_b64_tr_b16 v[32:33], v8 offset:40960
  ds_read_b64_tr_b16 v[34:35], v8 offset:41984
  ds_read_b64_tr_b16 v[36:37], v9 offset:40960
  ds_read_b64_tr_b16 v[38:39], v9 offset:41984
  v_mfma_f32_32x32x16_bf16 a[48:63], v[44:47], v[68:71], a[48:63]
  buffer_load_dwordx4 v[100:103], v5, s[16:19], s99 offen offset:1024
  s_waitcnt vmcnt(11)
  s_waitcnt lgkmcnt(8)
  v_mfma_f32_32x32x16_bf16 a[32:47], v[48:51], v[72:75], a[32:47]
  ds_read_b64_tr_b16 v[40:41], v8 offset:43008
  ds_read_b64_tr_b16 v[42:43], v8 offset:44032
  ds_read_b64_tr_b16 v[44:45], v9 offset:43008
  ds_read_b64_tr_b16 v[46:47], v9 offset:44032
  v_mfma_f32_32x32x16_bf16 a[48:63], v[52:55], v[72:75], a[48:63]
  buffer_load_dwordx4 v[104:107], v5, s[16:19], s99 offen offset:2048
  s_waitcnt vmcnt(11)
  s_waitcnt lgkmcnt(8)
  v_mfma_f32_32x32x16_bf16 a[32:47], v[56:59], v[76:79], a[32:47]
  ds_read_b64_tr_b16 v[48:49], v8 offset:45056
  ds_read_b64_tr_b16 v[50:51], v8 offset:46080
  ds_read_b64_tr_b16 v[52:53], v9 offset:45056
  ds_read_b64_tr_b16 v[54:55], v9 offset:46080
  v_mfma_f32_32x32x16_bf16 a[48:63], v[60:63], v[76:79], a[48:63]
  buffer_load_dwordx4 v[108:111], v5, s[16:19], s99 offen offset:3072
  s_waitcnt vmcnt(11)
  s_waitcnt lgkmcnt(8)
  v_mfma_f32_32x32x16_bf16 a[32:47], v[32:35], v[80:83], a[32:47]
  ds_read_b64_tr_b16 v[56:57], v8 offset:47104
  ds_read_b64_tr_b16 v[58:59], v8 offset:48128
  ds_read_b64_tr_b16 v[60:61], v9 offset:47104
  ds_read_b64_tr_b16 v[62:63], v9 offset:48128
  v_mfma_f32_32x32x16_bf16 a[48:63], v[36:39], v[80:83], a[48:63]
  buffer_load_dwordx4 v[112:115], v6, s[16:19], s99 offen offset:0
  s_waitcnt vmcnt(11)
  s_waitcnt lgkmcnt(8)
  v_mfma_f32_32x32x16_bf16 a[32:47], v[40:43], v[84:87], a[32:47]
  s_barrier
  ds_read_b64_tr_b16 v[32:33], v8 offset:49152
  ds_read_b64_tr_b16 v[34:35], v8 offset:50176
  ds_read_b64_tr_b16 v[36:37], v9 offset:49152
  ds_read_b64_tr_b16 v[38:39], v9 offset:50176
  v_mfma_f32_32x32x16_bf16 a[48:63], v[44:47], v[84:87], a[48:63]
  buffer_load_dwordx4 v[116:119], v6, s[16:19], s99 offen offset:1024
  s_waitcnt vmcnt(11)
  s_waitcnt lgkmcnt(8)
  v_mfma_f32_32x32x16_bf16 a[32:47], v[48:51], v[88:91], a[32:47]
  ds_read_b64_tr_b16 v[40:41], v8 offset:51200
  ds_read_b64_tr_b16 v[42:43], v8 offset:52224
  ds_read_b64_tr_b16 v[44:45], v9 offset:51200
  ds_read_b64_tr_b16 v[46:47], v9 offset:52224
  v_mfma_f32_32x32x16_bf16 a[48:63], v[52:55], v[88:91], a[48:63]
  buffer_load_dwordx4 v[120:123], v6, s[16:19], s99 offen offset:2048
  s_waitcnt vmcnt(11)
  s_waitcnt lgkmcnt(8)
  v_mfma_f32_32x32x16_bf16 a[32:47], v[56:59], v[92:95], a[32:47]
  ds_read_b64_tr_b16 v[48:49], v8 offset:53248
  ds_read_b64_tr_b16 v[50:51], v8 offset:54272
  ds_read_b64_tr_b16 v[52:53], v9 offset:53248
  ds_read_b64_tr_b16 v[54:55], v9 offset:54272
  v_mfma_f32_32x32x16_bf16 a[48:63], v[60:63], v[92:95], a[48:63]
  buffer_load_dwordx4 v[124:127], v6, s[16:19], s99 offen offset:3072
  s_lshr_b32 s61, 0x3050804, s58
  s_and_b32 s61, s61, 255
  s_mul_i32 s94, s61, 114688
  s_lshl_b32 s95, s61, 13
  s_add_u32 s94, s94, 0x118000
  s_add_u32 s95, s95, 0x14000
  s_add_u32 m0, s57, 16384
  s_nop 0
  buffer_load_dwordx4 v1, s[12:15], s94 offen offset:0 lds
  buffer_load_dwordx4 v2, s[12:15], s94 offen offset:1024 lds
  buffer_load_dwordx4 v3, s[12:15], s94 offen offset:2048 lds
  buffer_load_dwordx4 v4, s[12:15], s94 offen offset:3072 lds
  s_waitcnt vmcnt(11)
  s_waitcnt lgkmcnt(8)
  v_mfma_f32_32x32x16_bf16 a[32:47], v[32:35], v[96:99], a[32:47]
  ds_read_b64_tr_b16 v[56:57], v8 offset:55296
  ds_read_b64_tr_b16 v[58:59], v8 offset:56320
  ds_read_b64_tr_b16 v[60:61], v9 offset:55296
  ds_read_b64_tr_b16 v[62:63], v9 offset:56320
  v_mfma_f32_32x32x16_bf16 a[48:63], v[36:39], v[96:99], a[48:63]
  buffer_load_dwordx4 v[64:67], v5, s[16:19], s93 offen offset:0
  s_waitcnt vmcnt(11)
  s_waitcnt lgkmcnt(8)
  v_mfma_f32_32x32x16_bf16 a[32:47], v[40:43], v[100:103], a[32:47]
  ds_read_b64_tr_b16 v[32:33], v8 offset:57344
  ds_read_b64_tr_b16 v[34:35], v8 offset:58368
  ds_read_b64_tr_b16 v[36:37], v9 offset:57344
  ds_read_b64_tr_b16 v[38:39], v9 offset:58368
  v_mfma_f32_32x32x16_bf16 a[48:63], v[44:47], v[100:103], a[48:63]
  buffer_load_dwordx4 v[68:71], v5, s[16:19], s93 offen offset:1024
  s_waitcnt vmcnt(11)
  s_waitcnt lgkmcnt(8)
  v_mfma_f32_32x32x16_bf16 a[32:47], v[48:51], v[104:107], a[32:47]
  ds_read_b64_tr_b16 v[40:41], v8 offset:59392
  ds_read_b64_tr_b16 v[42:43], v8 offset:60416
  ds_read_b64_tr_b16 v[44:45], v9 offset:59392
  ds_read_b64_tr_b16 v[46:47], v9 offset:60416
  v_mfma_f32_32x32x16_bf16 a[48:63], v[52:55], v[104:107], a[48:63]
  buffer_load_dwordx4 v[72:75], v5, s[16:19], s93 offen offset:2048
  s_waitcnt vmcnt(11)
  s_waitcnt lgkmcnt(8)
  v_mfma_f32_32x32x16_bf16 a[32:47], v[56:59], v[108:111], a[32:47]
  ds_read_b64_tr_b16 v[48:49], v8 offset:61440
  ds_read_b64_tr_b16 v[50:51], v8 offset:62464
  ds_read_b64_tr_b16 v[52:53], v9 offset:61440
  ds_read_b64_tr_b16 v[54:55], v9 offset:62464
  v_mfma_f32_32x32x16_bf16 a[48:63], v[60:63], v[108:111], a[48:63]
  buffer_load_dwordx4 v[76:79], v5, s[16:19], s93 offen offset:3072
  s_waitcnt vmcnt(11)
  s_waitcnt lgkmcnt(8)
  v_mfma_f32_32x32x16_bf16 a[32:47], v[32:35], v[112:115], a[32:47]
  ds_read_b64_tr_b16 v[56:57], v8 offset:63488
  ds_read_b64_tr_b16 v[58:59], v8 offset:64512
  ds_read_b64_tr_b16 v[60:61], v9 offset:63488
  ds_read_b64_tr_b16 v[62:63], v9 offset:64512
  v_mfma_f32_32x32x16_bf16 a[48:63], v[36:39], v[112:115], a[48:63]
  buffer_load_dwordx4 v[80:83], v6, s[16:19], s93 offen offset:0
  s_waitcnt vmcnt(11)
  s_waitcnt lgkmcnt(8)
  v_mfma_f32_32x32x16_bf16 a[32:47], v[40:43], v[116:119], a[32:47]
  s_barrier
  ds_read_b64_tr_b16 v[32:33], v8 offset:0
  ds_read_b64_tr_b16 v[34:35], v8 offset:1024
  ds_read_b64_tr_b16 v[36:37], v9 offset:0
  ds_read_b64_tr_b16 v[38:39], v9 offset:1024
  v_mfma_f32_32x32x16_bf16 a[48:63], v[44:47], v[116:119], a[48:63]
  buffer_load_dwordx4 v[84:87], v6, s[16:19], s93 offen offset:1024
  s_waitcnt vmcnt(11)
  s_waitcnt lgkmcnt(8)
  v_mfma_f32_32x32x16_bf16 a[32:47], v[48:51], v[120:123], a[32:47]
  ds_read_b64_tr_b16 v[40:41], v8 offset:2048
  ds_read_b64_tr_b16 v[42:43], v8 offset:3072
  ds_read_b64_tr_b16 v[44:45], v9 offset:2048
  ds_read_b64_tr_b16 v[46:47], v9 offset:3072
  v_mfma_f32_32x32x16_bf16 a[48:63], v[52:55], v[120:123], a[48:63]
  buffer_load_dwordx4 v[88:91], v6, s[16:19], s93 offen offset:2048
  s_waitcnt vmcnt(11)
  s_waitcnt lgkmcnt(8)
  v_mfma_f32_32x32x16_bf16 a[32:47], v[56:59], v[124:127], a[32:47]
  ds_read_b64_tr_b16 v[48:49], v8 offset:4096
  ds_read_b64_tr_b16 v[50:51], v8 offset:5120
  ds_read_b64_tr_b16 v[52:53], v9 offset:4096
  ds_read_b64_tr_b16 v[54:55], v9 offset:5120
  v_mfma_f32_32x32x16_bf16 a[48:63], v[60:63], v[124:127], a[48:63]
  buffer_load_dwordx4 v[92:95], v6, s[16:19], s93 offen offset:3072
  s_lshr_b32 s61, 0x4090505, s58
  s_and_b32 s61, s61, 255
  s_mul_i32 s96, s61, 114688
  s_lshl_b32 s97, s61, 13
  s_add_u32 s96, s96, 0x118000
  s_add_u32 s97, s97, 0x14000
  s_add_u32 m0, s57, 32768
  s_nop 0
  buffer_load_dwordx4 v1, s[12:15], s96 offen offset:0 lds
  buffer_load_dwordx4 v2, s[12:15], s96 offen offset:1024 lds
  buffer_load_dwordx4 v3, s[12:15], s96 offen offset:2048 lds
  buffer_load_dwordx4 v4, s[12:15], s96 offen offset:3072 lds
  s_waitcnt vmcnt(11)
  s_waitcnt lgkmcnt(8)
  v_mfma_f32_32x32x16_bf16 a[32:47], v[32:35], v[64:67], a[32:47]
  ds_read_b64_tr_b16 v[56:57], v8 offset:6144
  ds_read_b64_tr_b16 v[58:59], v8 offset:7168
  ds_read_b64_tr_b16 v[60:61], v9 offset:6144
  ds_read_b64_tr_b16 v[62:63], v9 offset:7168
  v_mfma_f32_32x32x16_bf16 a[48:63], v[36:39], v[64:67], a[48:63]
  buffer_load_dwordx4 v[96:99], v5, s[16:19], s95 offen offset:0
  s_waitcnt vmcnt(11)
  s_waitcnt lgkmcnt(8)
  v_mfma_f32_32x32x16_bf16 a[32:47], v[40:43], v[68:71], a[32:47]
  ds_read_b64_tr_b16 v[32:33], v8 offset:8192
  ds_read_b64_tr_b16 v[34:35], v8 offset:9216
  ds_read_b64_tr_b16 v[36:37], v9 offset:8192
  ds_read_b64_tr_b16 v[38:39], v9 offset:9216
  v_mfma_f32_32x32x16_bf16 a[48:63], v[44:47], v[68:71], a[48:63]
  buffer_load_dwordx4 v[100:103], v5, s[16:19], s95 offen offset:1024
  s_waitcnt vmcnt(11)
  s_waitcnt lgkmcnt(8)
  v_mfma_f32_32x32x16_bf16 a[32:47], v[48:51], v[72:75], a[32:47]
  ds_read_b64_tr_b16 v[40:41], v8 offset:10240
  ds_read_b64_tr_b16 v[42:43], v8 offset:11264
  ds_read_b64_tr_b16 v[44:45], v9 offset:10240
  ds_read_b64_tr_b16 v[46:47], v9 offset:11264
  v_mfma_f32_32x32x16_bf16 a[48:63], v[52:55], v[72:75], a[48:63]
  buffer_load_dwordx4 v[104:107], v5, s[16:19], s95 offen offset:2048
  s_waitcnt vmcnt(11)
  s_waitcnt lgkmcnt(8)
  v_mfma_f32_32x32x16_bf16 a[32:47], v[56:59], v[76:79], a[32:47]
  ds_read_b64_tr_b16 v[48:49], v8 offset:12288
  ds_read_b64_tr_b16 v[50:51], v8 offset:13312
  ds_read_b64_tr_b16 v[52:53], v9 offset:12288
  ds_read_b64_tr_b16 v[54:55], v9 offset:13312
  v_mfma_f32_32x32x16_bf16 a[48:63], v[60:63], v[76:79], a[48:63]
  buffer_load_dwordx4 v[108:111], v5, s[16:19], s95 offen offset:3072
  s_waitcnt vmcnt(11)
  s_waitcnt lgkmcnt(8)
  v_mfma_f32_32x32x16_bf16 a[32:47], v[32:35], v[80:83], a[32:47]
  ds_read_b64_tr_b16 v[56:57], v8 offset:14336
  ds_read_b64_tr_b16 v[58:59], v8 offset:15360
  ds_read_b64_tr_b16 v[60:61], v9 offset:14336
  ds_read_b64_tr_b16 v[62:63], v9 offset:15360
  v_mfma_f32_32x32x16_bf16 a[48:63], v[36:39], v[80:83], a[48:63]
  buffer_load_dwordx4 v[112:115], v6, s[16:19], s95 offen offset:0
  s_waitcnt vmcnt(11)
  s_waitcnt lgkmcnt(8)
  v_mfma_f32_32x32x16_bf16 a[32:47], v[40:43], v[84:87], a[32:47]
  s_barrier
  ds_read_b64_tr_b16 v[32:33], v8 offset:16384
  ds_read_b64_tr_b16 v[34:35], v8 offset:17408
  ds_read_b64_tr_b16 v[36:37], v9 offset:16384
  ds_read_b64_tr_b16 v[38:39], v9 offset:17408
  v_mfma_f32_32x32x16_bf16 a[48:63], v[44:47], v[84:87], a[48:63]
  buffer_load_dwordx4 v[116:119], v6, s[16:19], s95 offen offset:1024
  s_waitcnt vmcnt(11)
  s_waitcnt lgkmcnt(8)
  v_mfma_f32_32x32x16_bf16 a[32:47], v[48:51], v[88:91], a[32:47]
  ds_read_b64_tr_b16 v[40:41], v8 offset:18432
  ds_read_b64_tr_b16 v[42:43], v8 offset:19456
  ds_read_b64_tr_b16 v[44:45], v9 offset:18432
  ds_read_b64_tr_b16 v[46:47], v9 offset:19456
  v_mfma_f32_32x32x16_bf16 a[48:63], v[52:55], v[88:91], a[48:63]
  buffer_load_dwordx4 v[120:123], v6, s[16:19], s95 offen offset:2048
  s_waitcnt vmcnt(11)
  s_waitcnt lgkmcnt(8)
  v_mfma_f32_32x32x16_bf16 a[32:47], v[56:59], v[92:95], a[32:47]
  ds_read_b64_tr_b16 v[48:49], v8 offset:20480
  ds_read_b64_tr_b16 v[50:51], v8 offset:21504
  ds_read_b64_tr_b16 v[52:53], v9 offset:20480
  ds_read_b64_tr_b16 v[54:55], v9 offset:21504
  v_mfma_f32_32x32x16_bf16 a[48:63], v[60:63], v[92:95], a[48:63]
  buffer_load_dwordx4 v[124:127], v6, s[16:19], s95 offen offset:3072
  s_lshr_b32 s61, 0xa060606, s58
  s_and_b32 s61, s61, 255
  s_mul_i32 s98, s61, 114688
  s_lshl_b32 s99, s61, 13
  s_add_u32 s98, s98, 0x118000
  s_add_u32 s99, s99, 0x14000
  s_add_u32 m0, s57, 49152
  s_nop 0
  buffer_load_dwordx4 v1, s[12:15], s98 offen offset:0 lds
  buffer_load_dwordx4 v2, s[12:15], s98 offen offset:1024 lds
  buffer_load_dwordx4 v3, s[12:15], s98 offen offset:2048 lds
  buffer_load_dwordx4 v4, s[12:15], s98 offen offset:3072 lds
  s_waitcnt vmcnt(11)
  s_waitcnt lgkmcnt(8)
  v_mfma_f32_32x32x16_bf16 a[32:47], v[32:35], v[96:99], a[32:47]
  ds_read_b64_tr_b16 v[56:57], v8 offset:22528
  ds_read_b64_tr_b16 v[58:59], v8 offset:23552
  ds_read_b64_tr_b16 v[60:61], v9 offset:22528
  ds_read_b64_tr_b16 v[62:63], v9 offset:23552
  v_mfma_f32_32x32x16_bf16 a[48:63], v[36:39], v[96:99], a[48:63]
  buffer_load_dwordx4 v[64:67], v5, s[16:19], s97 offen offset:0
  s_waitcnt vmcnt(11)
  s_waitcnt lgkmcnt(8)
  v_mfma_f32_32x32x16_bf16 a[32:47], v[40:43], v[100:103], a[32:47]
  ds_read_b64_tr_b16 v[32:33], v8 offset:24576
  ds_read_b64_tr_b16 v[34:35], v8 offset:25600
  ds_read_b64_tr_b16 v[36:37], v9 offset:24576
  ds_read_b64_tr_b16 v[38:39], v9 offset:25600
  v_mfma_f32_32x32x16_bf16 a[48:63], v[44:47], v[100:103], a[48:63]
  buffer_load_dwordx4 v[68:71], v5, s[16:19], s97 offen offset:1024
  s_waitcnt vmcnt(11)
  s_waitcnt lgkmcnt(8)
  v_mfma_f32_32x32x16_bf16 a[32:47], v[48:51], v[104:107], a[32:47]
  ds_read_b64_tr_b16 v[40:41], v8 offset:26624
  ds_read_b64_tr_b16 v[42:43], v8 offset:27648
  ds_read_b64_tr_b16 v[44:45], v9 offset:26624
  ds_read_b64_tr_b16 v[46:47], v9 offset:27648
  v_mfma_f32_32x32x16_bf16 a[48:63], v[52:55], v[104:107], a[48:63]
  buffer_load_dwordx4 v[72:75], v5, s[16:19], s97 offen offset:2048
  s_waitcnt vmcnt(11)
  s_waitcnt lgkmcnt(8)
  v_mfma_f32_32x32x16_bf16 a[32:47], v[56:59], v[108:111], a[32:47]
  ds_read_b64_tr_b16 v[48:49], v8 offset:28672
  ds_read_b64_tr_b16 v[50:51], v8 offset:29696
  ds_read_b64_tr_b16 v[52:53], v9 offset:28672
  ds_read_b64_tr_b16 v[54:55], v9 offset:29696
  v_mfma_f32_32x32x16_bf16 a[48:63], v[60:63], v[108:111], a[48:63]
  buffer_load_dwordx4 v[76:79], v5, s[16:19], s97 offen offset:3072
  s_waitcnt vmcnt(11)
  s_waitcnt lgkmcnt(8)
  v_mfma_f32_32x32x16_bf16 a[32:47], v[32:35], v[112:115], a[32:47]
  ds_read_b64_tr_b16 v[56:57], v8 offset:30720
  ds_read_b64_tr_b16 v[58:59], v8 offset:31744
  ds_read_b64_tr_b16 v[60:61], v9 offset:30720
  ds_read_b64_tr_b16 v[62:63], v9 offset:31744
  v_mfma_f32_32x32x16_bf16 a[48:63], v[36:39], v[112:115], a[48:63]
  buffer_load_dwordx4 v[80:83], v6, s[16:19], s97 offen offset:0
  s_waitcnt vmcnt(11)
  s_waitcnt lgkmcnt(8)
  v_mfma_f32_32x32x16_bf16 a[32:47], v[40:43], v[116:119], a[32:47]
  s_barrier
  ds_read_b64_tr_b16 v[32:33], v8 offset:32768
  ds_read_b64_tr_b16 v[34:35], v8 offset:33792
  ds_read_b64_tr_b16 v[36:37], v9 offset:32768
  ds_read_b64_tr_b16 v[38:39], v9 offset:33792
  v_mfma_f32_32x32x16_bf16 a[48:63], v[44:47], v[116:119], a[48:63]
  buffer_load_dwordx4 v[84:87], v6, s[16:19], s97 offen offset:1024
  s_waitcnt vmcnt(11)
  s_waitcnt lgkmcnt(8)
  v_mfma_f32_32x32x16_bf16 a[32:47], v[48:51], v[120:123], a[32:47]
  ds_read_b64_tr_b16 v[40:41], v8 offset:34816
  ds_read_b64_tr_b16 v[42:43], v8 offset:35840
  ds_read_b64_tr_b16 v[44:45], v9 offset:34816
  ds_read_b64_tr_b16 v[46:47], v9 offset:35840
  v_mfma_f32_32x32x16_bf16 a[48:63], v[52:55], v[120:123], a[48:63]
  buffer_load_dwordx4 v[88:91], v6, s[16:19], s97 offen offset:2048
  s_waitcnt vmcnt(11)
  s_waitcnt lgkmcnt(8)
  v_mfma_f32_32x32x16_bf16 a[32:47], v[56:59], v[124:127], a[32:47]
  ds_read_b64_tr_b16 v[48:49], v8 offset:36864
  ds_read_b64_tr_b16 v[50:51], v8 offset:37888
  ds_read_b64_tr_b16 v[52:53], v9 offset:36864
  ds_read_b64_tr_b16 v[54:55], v9 offset:37888
  v_mfma_f32_32x32x16_bf16 a[48:63], v[60:63], v[124:127], a[48:63]
  buffer_load_dwordx4 v[92:95], v6, s[16:19], s97 offen offset:3072
  s_lshr_b32 s61, 0x707070b, s58
  s_and_b32 s61, s61, 255
  s_mul_i32 s92, s61, 114688
  s_lshl_b32 s93, s61, 13
  s_add_u32 s92, s92, 0x118000
  s_add_u32 s93, s93, 0x14000
  s_add_u32 m0, s57, 0
  s_nop 0
  buffer_load_dwordx4 v1, s[12:15], s92 offen offset:0 lds
  buffer_load_dwordx4 v2, s[12:15], s92 offen offset:1024 lds
  buffer_load_dwordx4 v3, s[12:15], s92 offen offset:2048 lds
  buffer_load_dwordx4 v4, s[12:15], s92 offen offset:3072 lds
  s_waitcnt vmcnt(11)
  s_waitcnt lgkmcnt(8)
  v_mfma_f32_32x32x16_bf16 a[32:47], v[32:35], v[64:67], a[32:47]
  ds_read_b64_tr_b16 v[56:57], v8 offset:38912
  ds_read_b64_tr_b16 v[58:59], v8 offset:39936
  ds_read_b64_tr_b16 v[60:61], v9 offset:38912
  ds_read_b64_tr_b16 v[62:63], v9 offset:39936
  v_mfma_f32_32x32x16_bf16 a[48:63], v[36:39], v[64:67], a[48:63]
  buffer_load_dwordx4 v[96:99], v5, s[16:19], s99 offen offset:0
  s_waitcnt vmcnt(11)
  s_waitcnt lgkmcnt(8)
  v_mfma_f32_32x32x16_bf16 a[32:47], v[40:43], v[68:71], a[32:47]
  ds_read_b64_tr_b16 v[32:33], v8 offset:40960
  ds_read_b64_tr_b16 v[34:35], v8 offset:41984
  ds_read_b64_tr_b16 v[36:37], v9 offset:40960
  ds_read_b64_tr_b16 v[38:39], v9 offset:41984
  v_mfma_f32_32x32x16_bf16 a[48:63], v[44:47], v[68:71], a[48:63]
  buffer_load_dwordx4 v[100:103], v5, s[16:19], s99 offen offset:1024
  s_waitcnt vmcnt(11)
  s_waitcnt lgkmcnt(8)
  v_mfma_f32_32x32x16_bf16 a[32:47], v[48:51], v[72:75], a[32:47]
  ds_read_b64_tr_b16 v[40:41], v8 offset:43008
  ds_read_b64_tr_b16 v[42:43], v8 offset:44032
  ds_read_b64_tr_b16 v[44:45], v9 offset:43008
  ds_read_b64_tr_b16 v[46:47], v9 offset:44032
  v_mfma_f32_32x32x16_bf16 a[48:63], v[52:55], v[72:75], a[48:63]
  buffer_load_dwordx4 v[104:107], v5, s[16:19], s99 offen offset:2048
  s_waitcnt vmcnt(11)
  s_waitcnt lgkmcnt(8)
  v_mfma_f32_32x32x16_bf16 a[32:47], v[56:59], v[76:79], a[32:47]
  ds_read_b64_tr_b16 v[48:49], v8 offset:45056
  ds_read_b64_tr_b16 v[50:51], v8 offset:46080
  ds_read_b64_tr_b16 v[52:53], v9 offset:45056
  ds_read_b64_tr_b16 v[54:55], v9 offset:46080
  v_mfma_f32_32x32x16_bf16 a[48:63], v[60:63], v[76:79], a[48:63]
  buffer_load_dwordx4 v[108:111], v5, s[16:19], s99 offen offset:3072
  s_waitcnt vmcnt(11)
  s_waitcnt lgkmcnt(8)
  v_mfma_f32_32x32x16_bf16 a[32:47], v[32:35], v[80:83], a[32:47]
  ds_read_b64_tr_b16 v[56:57], v8 offset:47104
  ds_read_b64_tr_b16 v[58:59], v8 offset:48128
  ds_read_b64_tr_b16 v[60:61], v9 offset:47104
  ds_read_b64_tr_b16 v[62:63], v9 offset:48128
  v_mfma_f32_32x32x16_bf16 a[48:63], v[36:39], v[80:83], a[48:63]
  buffer_load_dwordx4 v[112:115], v6, s[16:19], s99 offen offset:0
  s_waitcnt vmcnt(11)
  s_waitcnt lgkmcnt(8)
  v_mfma_f32_32x32x16_bf16 a[32:47], v[40:43], v[84:87], a[32:47]
  s_barrier
  ds_read_b64_tr_b16 v[32:33], v8 offset:49152
  ds_read_b64_tr_b16 v[34:35], v8 offset:50176
  ds_read_b64_tr_b16 v[36:37], v9 offset:49152
  ds_read_b64_tr_b16 v[38:39], v9 offset:50176
  v_mfma_f32_32x32x16_bf16 a[48:63], v[44:47], v[84:87], a[48:63]
  buffer_load_dwordx4 v[116:119], v6, s[16:19], s99 offen offset:1024
  s_waitcnt vmcnt(11)
  s_waitcnt lgkmcnt(8)
  v_mfma_f32_32x32x16_bf16 a[32:47], v[48:51], v[88:91], a[32:47]
  ds_read_b64_tr_b16 v[40:41], v8 offset:51200
  ds_read_b64_tr_b16 v[42:43], v8 offset:52224
  ds_read_b64_tr_b16 v[44:45], v9 offset:51200
  ds_read_b64_tr_b16 v[46:47], v9 offset:52224
  v_mfma_f32_32x32x16_bf16 a[48:63], v[52:55], v[88:91], a[48:63]
  buffer_load_dwordx4 v[120:123], v6, s[16:19], s99 offen offset:2048
  s_waitcnt vmcnt(11)
  s_waitcnt lgkmcnt(8)
  v_mfma_f32_32x32x16_bf16 a[32:47], v[56:59], v[92:95], a[32:47]
  ds_read_b64_tr_b16 v[48:49], v8 offset:53248
  ds_read_b64_tr_b16 v[50:51], v8 offset:54272
  ds_read_b64_tr_b16 v[52:53], v9 offset:53248
  ds_read_b64_tr_b16 v[54:55], v9 offset:54272
  v_mfma_f32_32x32x16_bf16 a[48:63], v[60:63], v[92:95], a[48:63]
  buffer_load_dwordx4 v[124:127], v6, s[16:19], s99 offen offset:3072
  s_lshr_b32 s61, 0x8080c08, s58
  s_and_b32 s61, s61, 255
  s_mul_i32 s94, s61, 114688
  s_lshl_b32 s95, s61, 13
  s_add_u32 s94, s94, 0x118000
  s_add_u32 s95, s95, 0x14000
  s_add_u32 m0, s57, 16384
  s_nop 0
  buffer_load_dwordx4 v1, s[12:15], s94 offen offset:0 lds
  buffer_load_dwordx4 v2, s[12:15], s94 offen offset:1024 lds
  buffer_load_dwordx4 v3, s[12:15], s94 offen offset:2048 lds
  buffer_load_dwordx4 v4, s[12:15], s94 offen offset:3072 lds
  s_waitcnt vmcnt(11)
  s_waitcnt lgkmcnt(8)
  v_mfma_f32_32x32x16_bf16 a[32:47], v[32:35], v[96:99], a[32:47]
  ds_read_b64_tr_b16 v[56:57], v8 offset:55296
  ds_read_b64_tr_b16 v[58:59], v8 offset:56320
  ds_read_b64_tr_b16 v[60:61], v9 offset:55296
  ds_read_b64_tr_b16 v[62:63], v9 offset:56320
  v_mfma_f32_32x32x16_bf16 a[48:63], v[36:39], v[96:99], a[48:63]
  buffer_load_dwordx4 v[64:67], v5, s[16:19], s93 offen offset:0
  s_waitcnt vmcnt(11)
  s_waitcnt lgkmcnt(8)
  v_mfma_f32_32x32x16_bf16 a[32:47], v[40:43], v[100:103], a[32:47]
  ds_read_b64_tr_b16 v[32:33], v8 offset:57344
  ds_read_b64_tr_b16 v[34:35], v8 offset:58368
  ds_read_b64_tr_b16 v[36:37], v9 offset:57344
  ds_read_b64_tr_b16 v[38:39], v9 offset:58368
  v_mfma_f32_32x32x16_bf16 a[48:63], v[44:47], v[100:103], a[48:63]
  buffer_load_dwordx4 v[68:71], v5, s[16:19], s93 offen offset:1024
  s_waitcnt vmcnt(11)
  s_waitcnt lgkmcnt(8)
  v_mfma_f32_32x32x16_bf16 a[32:47], v[48:51], v[104:107], a[32:47]
  ds_read_b64_tr_b16 v[40:41], v8 offset:59392
  ds_read_b64_tr_b16 v[42:43], v8 offset:60416
  ds_read_b64_tr_b16 v[44:45], v9 offset:59392
  ds_read_b64_tr_b16 v[46:47], v9 offset:60416
  v_mfma_f32_32x32x16_bf16 a[48:63], v[52:55], v[104:107], a[48:63]
  buffer_load_dwordx4 v[72:75], v5, s[16:19], s93 offen offset:2048
  s_waitcnt vmcnt(11)
  s_waitcnt lgkmcnt(8)
  v_mfma_f32_32x32x16_bf16 a[32:47], v[56:59], v[108:111], a[32:47]
  ds_read_b64_tr_b16 v[48:49], v8 offset:61440
  ds_read_b64_tr_b16 v[50:51], v8 offset:62464
  ds_read_b64_tr_b16 v[52:53], v9 offset:61440
  ds_read_b64_tr_b16 v[54:55], v9 offset:62464
  v_mfma_f32_32x32x16_bf16 a[48:63], v[60:63], v[108:111], a[48:63]
  buffer_load_dwordx4 v[76:79], v5, s[16:19], s93 offen offset:3072
  s_waitcnt vmcnt(11)
  s_waitcnt lgkmcnt(8)
  v_mfma_f32_32x32x16_bf16 a[32:47], v[32:35], v[112:115], a[32:47]
  ds_read_b64_tr_b16 v[56:57], v8 offset:63488
  ds_read_b64_tr_b16 v[58:59], v8 offset:64512
  ds_read_b64_tr_b16 v[60:61], v9 offset:63488
  ds_read_b64_tr_b16 v[62:63], v9 offset:64512
  v_mfma_f32_32x32x16_bf16 a[48:63], v[36:39], v[112:115], a[48:63]
  buffer_load_dwordx4 v[80:83], v6, s[16:19], s93 offen offset:0
  s_waitcnt vmcnt(11)
  s_waitcnt lgkmcnt(8)
  v_mfma_f32_32x32x16_bf16 a[32:47], v[40:43], v[116:119], a[32:47]
  s_barrier
  ds_read_b64_tr_b16 v[32:33], v8 offset:0
  ds_read_b64_tr_b16 v[34:35], v8 offset:1024
  ds_read_b64_tr_b16 v[36:37], v9 offset:0
  ds_read_b64_tr_b16 v[38:39], v9 offset:1024
  v_mfma_f32_32x32x16_bf16 a[48:63], v[44:47], v[116:119], a[48:63]
  buffer_load_dwordx4 v[84:87], v6, s[16:19], s93 offen offset:1024
  s_waitcnt vmcnt(11)
  s_waitcnt lgkmcnt(8)
  v_mfma_f32_32x32x16_bf16 a[32:47], v[48:51], v[120:123], a[32:47]
  ds_read_b64_tr_b16 v[40:41], v8 offset:2048
  ds_read_b64_tr_b16 v[42:43], v8 offset:3072
  ds_read_b64_tr_b16 v[44:45], v9 offset:2048
  ds_read_b64_tr_b16 v[46:47], v9 offset:3072
  v_mfma_f32_32x32x16_bf16 a[48:63], v[52:55], v[120:123], a[48:63]
  buffer_load_dwordx4 v[88:91], v6, s[16:19], s93 offen offset:2048
  s_waitcnt vmcnt(11)
  s_waitcnt lgkmcnt(8)
  v_mfma_f32_32x32x16_bf16 a[32:47], v[56:59], v[124:127], a[32:47]
  ds_read_b64_tr_b16 v[48:49], v8 offset:4096
  ds_read_b64_tr_b16 v[50:51], v8 offset:5120
  ds_read_b64_tr_b16 v[52:53], v9 offset:4096
  ds_read_b64_tr_b16 v[54:55], v9 offset:5120
  v_mfma_f32_32x32x16_bf16 a[48:63], v[60:63], v[124:127], a[48:63]
  buffer_load_dwordx4 v[92:95], v6, s[16:19], s93 offen offset:3072
  s_lshr_b32 s61, 0x90d0909, s58
  s_and_b32 s61, s61, 255
  s_mul_i32 s96, s61, 114688
  s_lshl_b32 s97, s61, 13
  s_add_u32 s96, s96, 0x118000
  s_add_u32 s97, s97, 0x14000
  s_add_u32 m0, s57, 32768
  s_nop 0
  buffer_load_dwordx4 v1, s[12:15], s96 offen offset:0 lds
  buffer_load_dwordx4 v2, s[12:15], s96 offen offset:1024 lds
  buffer_load_dwordx4 v3, s[12:15], s96 offen offset:2048 lds
  buffer_load_dwordx4 v4, s[12:15], s96 offen offset:3072 lds
  s_waitcnt vmcnt(11)
  s_waitcnt lgkmcnt(8)
  v_mfma_f32_32x32x16_bf16 a[32:47], v[32:35], v[64:67], a[32:47]
  ds_read_b64_tr_b16 v[56:57], v8 offset:6144
  ds_read_b64_tr_b16 v[58:59], v8 offset:7168
  ds_read_b64_tr_b16 v[60:61], v9 offset:6144
  ds_read_b64_tr_b16 v[62:63], v9 offset:7168
  v_mfma_f32_32x32x16_bf16 a[48:63], v[36:39], v[64:67], a[48:63]
  buffer_load_dwordx4 v[96:99], v5, s[16:19], s95 offen offset:0
  s_waitcnt vmcnt(11)
  s_waitcnt lgkmcnt(8)
  v_mfma_f32_32x32x16_bf16 a[32:47], v[40:43], v[68:71], a[32:47]
  ds_read_b64_tr_b16 v[32:33], v8 offset:8192
  ds_read_b64_tr_b16 v[34:35], v8 offset:9216
  ds_read_b64_tr_b16 v[36:37], v9 offset:8192
  ds_read_b64_tr_b16 v[38:39], v9 offset:9216
  v_mfma_f32_32x32x16_bf16 a[48:63], v[44:47], v[68:71], a[48:63]
  buffer_load_dwordx4 v[100:103], v5, s[16:19], s95 offen offset:1024
  s_waitcnt vmcnt(11)
  s_waitcnt lgkmcnt(8)
  v_mfma_f32_32x32x16_bf16 a[32:47], v[48:51], v[72:75], a[32:47]
  ds_read_b64_tr_b16 v[40:41], v8 offset:10240
  ds_read_b64_tr_b16 v[42:43], v8 offset:11264
  ds_read_b64_tr_b16 v[44:45], v9 offset:10240
  ds_read_b64_tr_b16 v[46:47], v9 offset:11264
  v_mfma_f32_32x32x16_bf16 a[48:63], v[52:55], v[72:75], a[48:63]
  buffer_load_dwordx4 v[104:107], v5, s[16:19], s95 offen offset:2048
  s_waitcnt vmcnt(11)
  s_waitcnt lgkmcnt(8)
  v_mfma_f32_32x32x16_bf16 a[32:47], v[56:59], v[76:79], a[32:47]
  ds_read_b64_tr_b16 v[48:49], v8 offset:12288
  ds_read_b64_tr_b16 v[50:51], v8 offset:13312
  ds_read_b64_tr_b16 v[52:53], v9 offset:12288
  ds_read_b64_tr_b16 v[54:55], v9 offset:13312
  v_mfma_f32_32x32x16_bf16 a[48:63], v[60:63], v[76:79], a[48:63]
  buffer_load_dwordx4 v[108:111], v5, s[16:19], s95 offen offset:3072
  s_waitcnt vmcnt(11)
  s_waitcnt lgkmcnt(8)
  v_mfma_f32_32x32x16_bf16 a[32:47], v[32:35], v[80:83], a[32:47]
  ds_read_b64_tr_b16 v[56:57], v8 offset:14336
  ds_read_b64_tr_b16 v[58:59], v8 offset:15360
  ds_read_b64_tr_b16 v[60:61], v9 offset:14336
  ds_read_b64_tr_b16 v[62:63], v9 offset:15360
  v_mfma_f32_32x32x16_bf16 a[48:63], v[36:39], v[80:83], a[48:63]
  buffer_load_dwordx4 v[112:115], v6, s[16:19], s95 offen offset:0
  s_waitcnt vmcnt(11)
  s_waitcnt lgkmcnt(8)
  v_mfma_f32_32x32x16_bf16 a[32:47], v[40:43], v[84:87], a[32:47]
  s_barrier
  ds_read_b64_tr_b16 v[32:33], v8 offset:16384
  ds_read_b64_tr_b16 v[34:35], v8 offset:17408
  ds_read_b64_tr_b16 v[36:37], v9 offset:16384
  ds_read_b64_tr_b16 v[38:39], v9 offset:17408
  v_mfma_f32_32x32x16_bf16 a[48:63], v[44:47], v[84:87], a[48:63]
  buffer_load_dwordx4 v[116:119], v6, s[16:19], s95 offen offset:1024
  s_waitcnt vmcnt(11)
  s_waitcnt lgkmcnt(8)
  v_mfma_f32_32x32x16_bf16 a[32:47], v[48:51], v[88:91], a[32:47]
  ds_read_b64_tr_b16 v[40:41], v8 offset:18432
  ds_read_b64_tr_b16 v[42:43], v8 offset:19456
  ds_read_b64_tr_b16 v[44:45], v9 offset:18432
  ds_read_b64_tr_b16 v[46:47], v9 offset:19456
  v_mfma_f32_32x32x16_bf16 a[48:63], v[52:55], v[88:91], a[48:63]
  buffer_load_dwordx4 v[120:123], v6, s[16:19], s95 offen offset:2048
  s_waitcnt vmcnt(11)
  s_waitcnt lgkmcnt(8)
  v_mfma_f32_32x32x16_bf16 a[32:47], v[56:59], v[92:95], a[32:47]
  ds_read_b64_tr_b16 v[48:49], v8 offset:20480
  ds_read_b64_tr_b16 v[50:51], v8 offset:21504
  ds_read_b64_tr_b16 v[52:53], v9 offset:20480
  ds_read_b64_tr_b16 v[54:55], v9 offset:21504
  v_mfma_f32_32x32x16_bf16 a[48:63], v[60:63], v[92:95], a[48:63]
  buffer_load_dwordx4 v[124:127], v6, s[16:19], s95 offen offset:3072
  s_lshr_b32 s61, 0xe0a0a0a, s58
  s_and_b32 s61, s61, 255
  s_mul_i32 s98, s61, 114688
  s_lshl_b32 s99, s61, 13
  s_add_u32 s98, s98, 0x118000
  s_add_u32 s99, s99, 0x14000
  s_add_u32 m0, s57, 49152
  s_nop 0
  buffer_load_dwordx4 v1, s[12:15], s98 offen offset:0 lds
  buffer_load_dwordx4 v2, s[12:15], s98 offen offset:1024 lds
  buffer_load_dwordx4 v3, s[12:15], s98 offen offset:2048 lds
  buffer_load_dwordx4 v4, s[12:15], s98 offen offset:3072 lds
  s_waitcnt vmcnt(11)
  s_waitcnt lgkmcnt(8)
  v_mfma_f32_32x32x16_bf16 a[32:47], v[32:35], v[96:99], a[32:47]
  ds_read_b64_tr_b16 v[56:57], v8 offset:22528
  ds_read_b64_tr_b16 v[58:59], v8 offset:23552
  ds_read_b64_tr_b16 v[60:61], v9 offset:22528
  ds_read_b64_tr_b16 v[62:63], v9 offset:23552
  v_mfma_f32_32x32x16_bf16 a[48:63], v[36:39], v[96:99], a[48:63]
  buffer_load_dwordx4 v[64:67], v5, s[16:19], s97 offen offset:0
  s_waitcnt vmcnt(11)
  s_waitcnt lgkmcnt(8)
  v_mfma_f32_32x32x16_bf16 a[32:47], v[40:43], v[100:103], a[32:47]
  ds_read_b64_tr_b16 v[32:33], v8 offset:24576
  ds_read_b64_tr_b16 v[34:35], v8 offset:25600
  ds_read_b64_tr_b16 v[36:37], v9 offset:24576
  ds_read_b64_tr_b16 v[38:39], v9 offset:25600
  v_mfma_f32_32x32x16_bf16 a[48:63], v[44:47], v[100:103], a[48:63]
  buffer_load_dwordx4 v[68:71], v5, s[16:19], s97 offen offset:1024
  s_waitcnt vmcnt(11)
  s_waitcnt lgkmcnt(8)
  v_mfma_f32_32x32x16_bf16 a[32:47], v[48:51], v[104:107], a[32:47]
  ds_read_b64_tr_b16 v[40:41], v8 offset:26624
  ds_read_b64_tr_b16 v[42:43], v8 offset:27648
  ds_read_b64_tr_b16 v[44:45], v9 offset:26624
  ds_read_b64_tr_b16 v[46:47], v9 offset:27648
  v_mfma_f32_32x32x16_bf16 a[48:63], v[52:55], v[104:107], a[48:63]
  buffer_load_dwordx4 v[72:75], v5, s[16:19], s97 offen offset:2048
  s_waitcnt vmcnt(11)
  s_waitcnt lgkmcnt(8)
  v_mfma_f32_32x32x16_bf16 a[32:47], v[56:59], v[108:111], a[32:47]
  ds_read_b64_tr_b16 v[48:49], v8 offset:28672
  ds_read_b64_tr_b16 v[50:51], v8 offset:29696
  ds_read_b64_tr_b16 v[52:53], v9 offset:28672
  ds_read_b64_tr_b16 v[54:55], v9 offset:29696
  v_mfma_f32_32x32x16_bf16 a[48:63], v[60:63], v[108:111], a[48:63]
  buffer_load_dwordx4 v[76:79], v5, s[16:19], s97 offen offset:3072
  s_waitcnt vmcnt(11)
  s_waitcnt lgkmcnt(8)
  v_mfma_f32_32x32x16_bf16 a[32:47], v[32:35], v[112:115], a[32:47]
  ds_read_b64_tr_b16 v[56:57], v8 offset:30720
  ds_read_b64_tr_b16 v[58:59], v8 offset:31744
  ds_read_b64_tr_b16 v[60:61], v9 offset:30720
  ds_read_b64_tr_b16 v[62:63], v9 offset:31744
  v_mfma_f32_32x32x16_bf16 a[48:63], v[36:39], v[112:115], a[48:63]
  buffer_load_dwordx4 v[80:83], v6, s[16:19], s97 offen offset:0
  s_waitcnt vmcnt(11)
  s_waitcnt lgkmcnt(8)
  v_mfma_f32_32x32x16_bf16 a[32:47], v[40:43], v[116:119], a[32:47]
  s_barrier
  ds_read_b64_tr_b16 v[32:33], v8 offset:32768
  ds_read_b64_tr_b16 v[34:35], v8 offset:33792
  ds_read_b64_tr_b16 v[36:37], v9 offset:32768
  ds_read_b64_tr_b16 v[38:39], v9 offset:33792
  v_mfma_f32_32x32x16_bf16 a[48:63], v[44:47], v[116:119], a[48:63]
  buffer_load_dwordx4 v[84:87], v6, s[16:19], s97 offen offset:1024
  s_waitcnt vmcnt(11)
  s_waitcnt lgkmcnt(8)
  v_mfma_f32_32x32x16_bf16 a[32:47], v[48:51], v[120:123], a[32:47]
  ds_read_b64_tr_b16 v[40:41], v8 offset:34816
  ds_read_b64_tr_b16 v[42:43], v8 offset:35840
  ds_read_b64_tr_b16 v[44:45], v9 offset:34816
  ds_read_b64_tr_b16 v[46:47], v9 offset:35840
  v_mfma_f32_32x32x16_bf16 a[48:63], v[52:55], v[120:123], a[48:63]
  buffer_load_dwordx4 v[88:91], v6, s[16:19], s97 offen offset:2048
  s_waitcnt vmcnt(11)
  s_waitcnt lgkmcnt(8)
  v_mfma_f32_32x32x16_bf16 a[32:47], v[56:59], v[124:127], a[32:47]
  ds_read_b64_tr_b16 v[48:49], v8 offset:36864
  ds_read_b64_tr_b16 v[50:51], v8 offset:37888
  ds_read_b64_tr_b16 v[52:53], v9 offset:36864
  ds_read_b64_tr_b16 v[54:55], v9 offset:37888
  v_mfma_f32_32x32x16_bf16 a[48:63], v[60:63], v[124:127], a[48:63]
  buffer_load_dwordx4 v[92:95], v6, s[16:19], s97 offen offset:3072
  s_lshr_b32 s61, 0xb0b0b0f, s58
  s_and_b32 s61, s61, 255
  s_mul_i32 s92, s61, 114688
  s_lshl_b32 s93, s61, 13
  s_add_u32 s92, s92, 0x118000
  s_add_u32 s93, s93, 0x14000
  s_add_u32 m0, s57, 0
  s_nop 0
  buffer_load_dwordx4 v1, s[12:15], s92 offen offset:0 lds
  buffer_load_dwordx4 v2, s[12:15], s92 offen offset:1024 lds
  buffer_load_dwordx4 v3, s[12:15], s92 offen offset:2048 lds
  buffer_load_dwordx4 v4, s[12:15], s92 offen offset:3072 lds
  s_waitcnt vmcnt(11)
  s_waitcnt lgkmcnt(8)
  v_mfma_f32_32x32x16_bf16 a[32:47], v[32:35], v[64:67], a[32:47]
  ds_read_b64_tr_b16 v[56:57], v8 offset:38912
  ds_read_b64_tr_b16 v[58:59], v8 offset:39936
  ds_read_b64_tr_b16 v[60:61], v9 offset:38912
  ds_read_b64_tr_b16 v[62:63], v9 offset:39936
  v_mfma_f32_32x32x16_bf16 a[48:63], v[36:39], v[64:67], a[48:63]
  buffer_load_dwordx4 v[96:99], v5, s[16:19], s99 offen offset:0
  s_waitcnt vmcnt(11)
  s_waitcnt lgkmcnt(8)
  v_mfma_f32_32x32x16_bf16 a[32:47], v[40:43], v[68:71], a[32:47]
  ds_read_b64_tr_b16 v[32:33], v8 offset:40960
  ds_read_b64_tr_b16 v[34:35], v8 offset:41984
  ds_read_b64_tr_b16 v[36:37], v9 offset:40960
  ds_read_b64_tr_b16 v[38:39], v9 offset:41984
  v_mfma_f32_32x32x16_bf16 a[48:63], v[44:47], v[68:71], a[48:63]
  buffer_load_dwordx4 v[100:103], v5, s[16:19], s99 offen offset:1024
  s_waitcnt vmcnt(11)
  s_waitcnt lgkmcnt(8)
  v_mfma_f32_32x32x16_bf16 a[32:47], v[48:51], v[72:75], a[32:47]
  ds_read_b64_tr_b16 v[40:41], v8 offset:43008
  ds_read_b64_tr_b16 v[42:43], v8 offset:44032
  ds_read_b64_tr_b16 v[44:45], v9 offset:43008
  ds_read_b64_tr_b16 v[46:47], v9 offset:44032
  v_mfma_f32_32x32x16_bf16 a[48:63], v[52:55], v[72:75], a[48:63]
  buffer_load_dwordx4 v[104:107], v5, s[16:19], s99 offen offset:2048
  s_waitcnt vmcnt(11)
  s_waitcnt lgkmcnt(8)
  v_mfma_f32_32x32x16_bf16 a[32:47], v[56:59], v[76:79], a[32:47]
  ds_read_b64_tr_b16 v[48:49], v8 offset:45056
  ds_read_b64_tr_b16 v[50:51], v8 offset:46080
  ds_read_b64_tr_b16 v[52:53], v9 offset:45056
  ds_read_b64_tr_b16 v[54:55], v9 offset:46080
  v_mfma_f32_32x32x16_bf16 a[48:63], v[60:63], v[76:79], a[48:63]
  buffer_load_dwordx4 v[108:111], v5, s[16:19], s99 offen offset:3072
  s_waitcnt vmcnt(11)
  s_waitcnt lgkmcnt(8)
  v_mfma_f32_32x32x16_bf16 a[32:47], v[32:35], v[80:83], a[32:47]
  ds_read_b64_tr_b16 v[56:57], v8 offset:47104
  ds_read_b64_tr_b16 v[58:59], v8 offset:48128
  ds_read_b64_tr_b16 v[60:61], v9 offset:47104
  ds_read_b64_tr_b16 v[62:63], v9 offset:48128
  v_mfma_f32_32x32x16_bf16 a[48:63], v[36:39], v[80:83], a[48:63]
  buffer_load_dwordx4 v[112:115], v6, s[16:19], s99 offen offset:0
  s_waitcnt vmcnt(11)
  s_waitcnt lgkmcnt(8)
  v_mfma_f32_32x32x16_bf16 a[32:47], v[40:43], v[84:87], a[32:47]
  s_barrier
  ds_read_b64_tr_b16 v[32:33], v8 offset:49152
  ds_read_b64_tr_b16 v[34:35], v8 offset:50176
  ds_read_b64_tr_b16 v[36:37], v9 offset:49152
  ds_read_b64_tr_b16 v[38:39], v9 offset:50176
  v_mfma_f32_32x32x16_bf16 a[48:63], v[44:47], v[84:87], a[48:63]
  buffer_load_dwordx4 v[116:119], v6, s[16:19], s99 offen offset:1024
  s_waitcnt vmcnt(11)
  s_waitcnt lgkmcnt(8)
  v_mfma_f32_32x32x16_bf16 a[32:47], v[48:51], v[88:91], a[32:47]
  ds_read_b64_tr_b16 v[40:41], v8 offset:51200
  ds_read_b64_tr_b16 v[42:43], v8 offset:52224
  ds_read_b64_tr_b16 v[44:45], v9 offset:51200
  ds_read_b64_tr_b16 v[46:47], v9 offset:52224
  v_mfma_f32_32x32x16_bf16 a[48:63], v[52:55], v[88:91], a[48:63]
  buffer_load_dwordx4 v[120:123], v6, s[16:19], s99 offen offset:2048
  s_waitcnt vmcnt(11)
  s_waitcnt lgkmcnt(8)
  v_mfma_f32_32x32x16_bf16 a[32:47], v[56:59], v[92:95], a[32:47]
  ds_read_b64_tr_b16 v[48:49], v8 offset:53248
  ds_read_b64_tr_b16 v[50:51], v8 offset:54272
  ds_read_b64_tr_b16 v[52:53], v9 offset:53248
  ds_read_b64_tr_b16 v[54:55], v9 offset:54272
  v_mfma_f32_32x32x16_bf16 a[48:63], v[60:63], v[92:95], a[48:63]
  buffer_load_dwordx4 v[124:127], v6, s[16:19], s99 offen offset:3072
  s_lshr_b32 s61, 0xc0c100c, s58
  s_and_b32 s61, s61, 255
  s_mul_i32 s94, s61, 114688
  s_lshl_b32 s95, s61, 13
  s_add_u32 s94, s94, 0x118000
  s_add_u32 s95, s95, 0x14000
  s_add_u32 m0, s57, 16384
  s_nop 0
  buffer_load_dwordx4 v1, s[12:15], s94 offen offset:0 lds
  buffer_load_dwordx4 v2, s[12:15], s94 offen offset:1024 lds
  buffer_load_dwordx4 v3, s[12:15], s94 offen offset:2048 lds
  buffer_load_dwordx4 v4, s[12:15], s94 offen offset:3072 lds
  s_waitcnt vmcnt(11)
  s_waitcnt lgkmcnt(8)
  v_mfma_f32_32x32x16_bf16 a[32:47], v[32:35], v[96:99], a[32:47]
  ds_read_b64_tr_b16 v[56:57], v8 offset:55296
  ds_read_b64_tr_b16 v[58:59], v8 offset:56320
  ds_read_b64_tr_b16 v[60:61], v9 offset:55296
  ds_read_b64_tr_b16 v[62:63], v9 offset:56320
  v_mfma_f32_32x32x16_bf16 a[48:63], v[36:39], v[96:99], a[48:63]
  buffer_load_dwordx4 v[64:67], v5, s[16:19], s93 offen offset:0
  s_waitcnt vmcnt(11)
  s_waitcnt lgkmcnt(8)
  v_mfma_f32_32x32x16_bf16 a[32:47], v[40:43], v[100:103], a[32:47]
  ds_read_b64_tr_b16 v[32:33], v8 offset:57344
  ds_read_b64_tr_b16 v[34:35], v8 offset:58368
  ds_read_b64_tr_b16 v[36:37], v9 offset:57344
  ds_read_b64_tr_b16 v[38:39], v9 offset:58368
  v_mfma_f32_32x32x16_bf16 a[48:63], v[44:47], v[100:103], a[48:63]
  buffer_load_dwordx4 v[68:71], v5, s[16:19], s93 offen offset:1024
  s_waitcnt vmcnt(11)
  s_waitcnt lgkmcnt(8)
  v_mfma_f32_32x32x16_bf16 a[32:47], v[48:51], v[104:107], a[32:47]
  ds_read_b64_tr_b16 v[40:41], v8 offset:59392
  ds_read_b64_tr_b16 v[42:43], v8 offset:60416
  ds_read_b64_tr_b16 v[44:45], v9 offset:59392
  ds_read_b64_tr_b16 v[46:47], v9 offset:60416
  v_mfma_f32_32x32x16_bf16 a[48:63], v[52:55], v[104:107], a[48:63]
  buffer_load_dwordx4 v[72:75], v5, s[16:19], s93 offen offset:2048
  s_waitcnt vmcnt(11)
  s_waitcnt lgkmcnt(8)
  v_mfma_f32_32x32x16_bf16 a[32:47], v[56:59], v[108:111], a[32:47]
  ds_read_b64_tr_b16 v[48:49], v8 offset:61440
  ds_read_b64_tr_b16 v[50:51], v8 offset:62464
  ds_read_b64_tr_b16 v[52:53], v9 offset:61440
  ds_read_b64_tr_b16 v[54:55], v9 offset:62464
  v_mfma_f32_32x32x16_bf16 a[48:63], v[60:63], v[108:111], a[48:63]
  buffer_load_dwordx4 v[76:79], v5, s[16:19], s93 offen offset:3072
  s_waitcnt vmcnt(11)
  s_waitcnt lgkmcnt(8)
  v_mfma_f32_32x32x16_bf16 a[32:47], v[32:35], v[112:115], a[32:47]
  ds_read_b64_tr_b16 v[56:57], v8 offset:63488
  ds_read_b64_tr_b16 v[58:59], v8 offset:64512
  ds_read_b64_tr_b16 v[60:61], v9 offset:63488
  ds_read_b64_tr_b16 v[62:63], v9 offset:64512
  v_mfma_f32_32x32x16_bf16 a[48:63], v[36:39], v[112:115], a[48:63]
  buffer_load_dwordx4 v[80:83], v6, s[16:19], s93 offen offset:0
  s_waitcnt vmcnt(11)
  s_waitcnt lgkmcnt(8)
  v_mfma_f32_32x32x16_bf16 a[32:47], v[40:43], v[116:119], a[32:47]
  s_barrier
  ds_read_b64_tr_b16 v[32:33], v8 offset:0
  ds_read_b64_tr_b16 v[34:35], v8 offset:1024
  ds_read_b64_tr_b16 v[36:37], v9 offset:0
  ds_read_b64_tr_b16 v[38:39], v9 offset:1024
  v_mfma_f32_32x32x16_bf16 a[48:63], v[44:47], v[116:119], a[48:63]
  buffer_load_dwordx4 v[84:87], v6, s[16:19], s93 offen offset:1024
  s_waitcnt vmcnt(11)
  s_waitcnt lgkmcnt(8)
  v_mfma_f32_32x32x16_bf16 a[32:47], v[48:51], v[120:123], a[32:47]
  ds_read_b64_tr_b16 v[40:41], v8 offset:2048
  ds_read_b64_tr_b16 v[42:43], v8 offset:3072
  ds_read_b64_tr_b16 v[44:45], v9 offset:2048
  ds_read_b64_tr_b16 v[46:47], v9 offset:3072
  v_mfma_f32_32x32x16_bf16 a[48:63], v[52:55], v[120:123], a[48:63]
  buffer_load_dwordx4 v[88:91], v6, s[16:19], s93 offen offset:2048
  s_waitcnt vmcnt(11)
  s_waitcnt lgkmcnt(8)
  v_mfma_f32_32x32x16_bf16 a[32:47], v[56:59], v[124:127], a[32:47]
  ds_read_b64_tr_b16 v[48:49], v8 offset:4096
  ds_read_b64_tr_b16 v[50:51], v8 offset:5120
  ds_read_b64_tr_b16 v[52:53], v9 offset:4096
  ds_read_b64_tr_b16 v[54:55], v9 offset:5120
  v_mfma_f32_32x32x16_bf16 a[48:63], v[60:63], v[124:127], a[48:63]
  buffer_load_dwordx4 v[92:95], v6, s[16:19], s93 offen offset:3072
  s_lshr_b32 s61, 0xd110d0d, s58
  s_and_b32 s61, s61, 255
  s_mul_i32 s96, s61, 114688
  s_lshl_b32 s97, s61, 13
  s_add_u32 s96, s96, 0x118000
  s_add_u32 s97, s97, 0x14000
  s_add_u32 m0, s57, 32768
  s_nop 0
  buffer_load_dwordx4 v1, s[12:15], s96 offen offset:0 lds
  buffer_load_dwordx4 v2, s[12:15], s96 offen offset:1024 lds
  buffer_load_dwordx4 v3, s[12:15], s96 offen offset:2048 lds
  buffer_load_dwordx4 v4, s[12:15], s96 offen offset:3072 lds
  s_waitcnt vmcnt(11)
  s_waitcnt lgkmcnt(8)
  v_mfma_f32_32x32x16_bf16 a[32:47], v[32:35], v[64:67], a[32:47]
  ds_read_b64_tr_b16 v[56:57], v8 offset:6144
  ds_read_b64_tr_b16 v[58:59], v8 offset:7168
  ds_read_b64_tr_b16 v[60:61], v9 offset:6144
  ds_read_b64_tr_b16 v[62:63], v9 offset:7168
  v_mfma_f32_32x32x16_bf16 a[48:63], v[36:39], v[64:67], a[48:63]
  buffer_load_dwordx4 v[96:99], v5, s[16:19], s95 offen offset:0
  s_waitcnt vmcnt(11)
  s_waitcnt lgkmcnt(8)
  v_mfma_f32_32x32x16_bf16 a[32:47], v[40:43], v[68:71], a[32:47]
  ds_read_b64_tr_b16 v[32:33], v8 offset:8192
  ds_read_b64_tr_b16 v[34:35], v8 offset:9216
  ds_read_b64_tr_b16 v[36:37], v9 offset:8192
  ds_read_b64_tr_b16 v[38:39], v9 offset:9216
  v_mfma_f32_32x32x16_bf16 a[48:63], v[44:47], v[68:71], a[48:63]
  buffer_load_dwordx4 v[100:103], v5, s[16:19], s95 offen offset:1024
  s_waitcnt vmcnt(11)
  s_waitcnt lgkmcnt(8)
  v_mfma_f32_32x32x16_bf16 a[32:47], v[48:51], v[72:75], a[32:47]
  ds_read_b64_tr_b16 v[40:41], v8 offset:10240
  ds_read_b64_tr_b16 v[42:43], v8 offset:11264
  ds_read_b64_tr_b16 v[44:45], v9 offset:10240
  ds_read_b64_tr_b16 v[46:47], v9 offset:11264
  v_mfma_f32_32x32x16_bf16 a[48:63], v[52:55], v[72:75], a[48:63]
  buffer_load_dwordx4 v[104:107], v5, s[16:19], s95 offen offset:2048
  s_waitcnt vmcnt(11)
  s_waitcnt lgkmcnt(8)
  v_mfma_f32_32x32x16_bf16 a[32:47], v[56:59], v[76:79], a[32:47]
  ds_read_b64_tr_b16 v[48:49], v8 offset:12288
  ds_read_b64_tr_b16 v[50:51], v8 offset:13312
  ds_read_b64_tr_b16 v[52:53], v9 offset:12288
  ds_read_b64_tr_b16 v[54:55], v9 offset:13312
  v_mfma_f32_32x32x16_bf16 a[48:63], v[60:63], v[76:79], a[48:63]
  buffer_load_dwordx4 v[108:111], v5, s[16:19], s95 offen offset:3072
  s_waitcnt vmcnt(11)
  s_waitcnt lgkmcnt(8)
  v_mfma_f32_32x32x16_bf16 a[32:47], v[32:35], v[80:83], a[32:47]
  ds_read_b64_tr_b16 v[56:57], v8 offset:14336
  ds_read_b64_tr_b16 v[58:59], v8 offset:15360
  ds_read_b64_tr_b16 v[60:61], v9 offset:14336
  ds_read_b64_tr_b16 v[62:63], v9 offset:15360
  v_mfma_f32_32x32x16_bf16 a[48:63], v[36:39], v[80:83], a[48:63]
  buffer_load_dwordx4 v[112:115], v6, s[16:19], s95 offen offset:0
  s_waitcnt vmcnt(11)
  s_waitcnt lgkmcnt(8)
  v_mfma_f32_32x32x16_bf16 a[32:47], v[40:43], v[84:87], a[32:47]
  s_barrier
  ds_read_b64_tr_b16 v[32:33], v8 offset:16384
  ds_read_b64_tr_b16 v[34:35], v8 offset:17408
  ds_read_b64_tr_b16 v[36:37], v9 offset:16384
  ds_read_b64_tr_b16 v[38:39], v9 offset:17408
  v_mfma_f32_32x32x16_bf16 a[48:63], v[44:47], v[84:87], a[48:63]
  buffer_load_dwordx4 v[116:119], v6, s[16:19], s95 offen offset:1024
  s_waitcnt vmcnt(11)
  s_waitcnt lgkmcnt(8)
  v_mfma_f32_32x32x16_bf16 a[32:47], v[48:51], v[88:91], a[32:47]
  ds_read_b64_tr_b16 v[40:41], v8 offset:18432
  ds_read_b64_tr_b16 v[42:43], v8 offset:19456
  ds_read_b64_tr_b16 v[44:45], v9 offset:18432
  ds_read_b64_tr_b16 v[46:47], v9 offset:19456
  v_mfma_f32_32x32x16_bf16 a[48:63], v[52:55], v[88:91], a[48:63]
  buffer_load_dwordx4 v[120:123], v6, s[16:19], s95 offen offset:2048
  s_waitcnt vmcnt(11)
  s_waitcnt lgkmcnt(8)
  v_mfma_f32_32x32x16_bf16 a[32:47], v[56:59], v[92:95], a[32:47]
  ds_read_b64_tr_b16 v[48:49], v8 offset:20480
  ds_read_b64_tr_b16 v[50:51], v8 offset:21504
  ds_read_b64_tr_b16 v[52:53], v9 offset:20480
  ds_read_b64_tr_b16 v[54:55], v9 offset:21504
  v_mfma_f32_32x32x16_bf16 a[48:63], v[60:63], v[92:95], a[48:63]
  buffer_load_dwordx4 v[124:127], v6, s[16:19], s95 offen offset:3072
  s_lshr_b32 s61, 0x120e0e0e, s58
  s_and_b32 s61, s61, 255
  s_mul_i32 s98, s61, 114688
  s_lshl_b32 s99, s61, 13
  s_add_u32 s98, s98, 0x118000
  s_add_u32 s99, s99, 0x14000
  s_add_u32 m0, s57, 49152
  s_nop 0
  buffer_load_dwordx4 v1, s[12:15], s98 offen offset:0 lds
  buffer_load_dwordx4 v2, s[12:15], s98 offen offset:1024 lds
  buffer_load_dwordx4 v3, s[12:15], s98 offen offset:2048 lds
  buffer_load_dwordx4 v4, s[12:15], s98 offen offset:3072 lds
  s_waitcnt vmcnt(11)
  s_waitcnt lgkmcnt(8)
  v_mfma_f32_32x32x16_bf16 a[32:47], v[32:35], v[96:99], a[32:47]
  ds_read_b64_tr_b16 v[56:57], v8 offset:22528
  ds_read_b64_tr_b16 v[58:59], v8 offset:23552
  ds_read_b64_tr_b16 v[60:61], v9 offset:22528
  ds_read_b64_tr_b16 v[62:63], v9 offset:23552
  v_mfma_f32_32x32x16_bf16 a[48:63], v[36:39], v[96:99], a[48:63]
  buffer_load_dwordx4 v[64:67], v5, s[16:19], s97 offen offset:0
  s_waitcnt vmcnt(11)
  s_waitcnt lgkmcnt(8)
  v_mfma_f32_32x32x16_bf16 a[32:47], v[40:43], v[100:103], a[32:47]
  ds_read_b64_tr_b16 v[32:33], v8 offset:24576
  ds_read_b64_tr_b16 v[34:35], v8 offset:25600
  ds_read_b64_tr_b16 v[36:37], v9 offset:24576
  ds_read_b64_tr_b16 v[38:39], v9 offset:25600
  v_mfma_f32_32x32x16_bf16 a[48:63], v[44:47], v[100:103], a[48:63]
  buffer_load_dwordx4 v[68:71], v5, s[16:19], s97 offen offset:1024
  s_waitcnt vmcnt(11)
  s_waitcnt lgkmcnt(8)
  v_mfma_f32_32x32x16_bf16 a[32:47], v[48:51], v[104:107], a[32:47]
  ds_read_b64_tr_b16 v[40:41], v8 offset:26624
  ds_read_b64_tr_b16 v[42:43], v8 offset:27648
  ds_read_b64_tr_b16 v[44:45], v9 offset:26624
  ds_read_b64_tr_b16 v[46:47], v9 offset:27648
  v_mfma_f32_32x32x16_bf16 a[48:63], v[52:55], v[104:107], a[48:63]
  buffer_load_dwordx4 v[72:75], v5, s[16:19], s97 offen offset:2048
  s_waitcnt vmcnt(11)
  s_waitcnt lgkmcnt(8)
  v_mfma_f32_32x32x16_bf16 a[32:47], v[56:59], v[108:111], a[32:47]
  ds_read_b64_tr_b16 v[48:49], v8 offset:28672
  ds_read_b64_tr_b16 v[50:51], v8 offset:29696
  ds_read_b64_tr_b16 v[52:53], v9 offset:28672
  ds_read_b64_tr_b16 v[54:55], v9 offset:29696
  v_mfma_f32_32x32x16_bf16 a[48:63], v[60:63], v[108:111], a[48:63]
  buffer_load_dwordx4 v[76:79], v5, s[16:19], s97 offen offset:3072
  s_waitcnt vmcnt(11)
  s_waitcnt lgkmcnt(8)
  v_mfma_f32_32x32x16_bf16 a[32:47], v[32:35], v[112:115], a[32:47]
  ds_read_b64_tr_b16 v[56:57], v8 offset:30720
  ds_read_b64_tr_b16 v[58:59], v8 offset:31744
  ds_read_b64_tr_b16 v[60:61], v9 offset:30720
  ds_read_b64_tr_b16 v[62:63], v9 offset:31744
  v_mfma_f32_32x32x16_bf16 a[48:63], v[36:39], v[112:115], a[48:63]
  buffer_load_dwordx4 v[80:83], v6, s[16:19], s97 offen offset:0
  s_waitcnt vmcnt(11)
  s_waitcnt lgkmcnt(8)
  v_mfma_f32_32x32x16_bf16 a[32:47], v[40:43], v[116:119], a[32:47]
  s_barrier
  ds_read_b64_tr_b16 v[32:33], v8 offset:32768
  ds_read_b64_tr_b16 v[34:35], v8 offset:33792
  ds_read_b64_tr_b16 v[36:37], v9 offset:32768
  ds_read_b64_tr_b16 v[38:39], v9 offset:33792
  v_mfma_f32_32x32x16_bf16 a[48:63], v[44:47], v[116:119], a[48:63]
  buffer_load_dwordx4 v[84:87], v6, s[16:19], s97 offen offset:1024
  s_waitcnt vmcnt(11)
  s_waitcnt lgkmcnt(8)
  v_mfma_f32_32x32x16_bf16 a[32:47], v[48:51], v[120:123], a[32:47]
  ds_read_b64_tr_b16 v[40:41], v8 offset:34816
  ds_read_b64_tr_b16 v[42:43], v8 offset:35840
  ds_read_b64_tr_b16 v[44:45], v9 offset:34816
  ds_read_b64_tr_b16 v[46:47], v9 offset:35840
  v_mfma_f32_32x32x16_bf16 a[48:63], v[52:55], v[120:123], a[48:63]
  buffer_load_dwordx4 v[88:91], v6, s[16:19], s97 offen offset:2048
  s_waitcnt vmcnt(11)
  s_waitcnt lgkmcnt(8)
  v_mfma_f32_32x32x16_bf16 a[32:47], v[56:59], v[124:127], a[32:47]
  ds_read_b64_tr_b16 v[48:49], v8 offset:36864
  ds_read_b64_tr_b16 v[50:51], v8 offset:37888
  ds_read_b64_tr_b16 v[52:53], v9 offset:36864
  ds_read_b64_tr_b16 v[54:55], v9 offset:37888
  v_mfma_f32_32x32x16_bf16 a[48:63], v[60:63], v[124:127], a[48:63]
  buffer_load_dwordx4 v[92:95], v6, s[16:19], s97 offen offset:3072
  s_lshr_b32 s61, 0xf0f0f13, s58
  s_and_b32 s61, s61, 255
  s_mul_i32 s92, s61, 114688
  s_lshl_b32 s93, s61, 13
  s_add_u32 s92, s92, 0x118000
  s_add_u32 s93, s93, 0x14000
  s_add_u32 m0, s57, 0
  s_nop 0
  buffer_load_dwordx4 v1, s[12:15], s92 offen offset:0 lds
  buffer_load_dwordx4 v2, s[12:15], s92 offen offset:1024 lds
  buffer_load_dwordx4 v3, s[12:15], s92 offen offset:2048 lds
  buffer_load_dwordx4 v4, s[12:15], s92 offen offset:3072 lds
  s_waitcnt vmcnt(11)
  s_waitcnt lgkmcnt(8)
  v_mfma_f32_32x32x16_bf16 a[32:47], v[32:35], v[64:67], a[32:47]
  ds_read_b64_tr_b16 v[56:57], v8 offset:38912
  ds_read_b64_tr_b16 v[58:59], v8 offset:39936
  ds_read_b64_tr_b16 v[60:61], v9 offset:38912
  ds_read_b64_tr_b16 v[62:63], v9 offset:39936
  v_mfma_f32_32x32x16_bf16 a[48:63], v[36:39], v[64:67], a[48:63]
  buffer_load_dwordx4 v[96:99], v5, s[16:19], s99 offen offset:0
  s_waitcnt vmcnt(11)
  s_waitcnt lgkmcnt(8)
  v_mfma_f32_32x32x16_bf16 a[32:47], v[40:43], v[68:71], a[32:47]
  ds_read_b64_tr_b16 v[32:33], v8 offset:40960
  ds_read_b64_tr_b16 v[34:35], v8 offset:41984
  ds_read_b64_tr_b16 v[36:37], v9 offset:40960
  ds_read_b64_tr_b16 v[38:39], v9 offset:41984
  v_mfma_f32_32x32x16_bf16 a[48:63], v[44:47], v[68:71], a[48:63]
  buffer_load_dwordx4 v[100:103], v5, s[16:19], s99 offen offset:1024
  s_waitcnt vmcnt(11)
  s_waitcnt lgkmcnt(8)
  v_mfma_f32_32x32x16_bf16 a[32:47], v[48:51], v[72:75], a[32:47]
  ds_read_b64_tr_b16 v[40:41], v8 offset:43008
  ds_read_b64_tr_b16 v[42:43], v8 offset:44032
  ds_read_b64_tr_b16 v[44:45], v9 offset:43008
  ds_read_b64_tr_b16 v[46:47], v9 offset:44032
  v_mfma_f32_32x32x16_bf16 a[48:63], v[52:55], v[72:75], a[48:63]
  buffer_load_dwordx4 v[104:107], v5, s[16:19], s99 offen offset:2048
  s_waitcnt vmcnt(11)
  s_waitcnt lgkmcnt(8)
  v_mfma_f32_32x32x16_bf16 a[32:47], v[56:59], v[76:79], a[32:47]
  ds_read_b64_tr_b16 v[48:49], v8 offset:45056
  ds_read_b64_tr_b16 v[50:51], v8 offset:46080
  ds_read_b64_tr_b16 v[52:53], v9 offset:45056
  ds_read_b64_tr_b16 v[54:55], v9 offset:46080
  v_mfma_f32_32x32x16_bf16 a[48:63], v[60:63], v[76:79], a[48:63]
  buffer_load_dwordx4 v[108:111], v5, s[16:19], s99 offen offset:3072
  s_waitcnt vmcnt(11)
  s_waitcnt lgkmcnt(8)
  v_mfma_f32_32x32x16_bf16 a[32:47], v[32:35], v[80:83], a[32:47]
  ds_read_b64_tr_b16 v[56:57], v8 offset:47104
  ds_read_b64_tr_b16 v[58:59], v8 offset:48128
  ds_read_b64_tr_b16 v[60:61], v9 offset:47104
  ds_read_b64_tr_b16 v[62:63], v9 offset:48128
  v_mfma_f32_32x32x16_bf16 a[48:63], v[36:39], v[80:83], a[48:63]
  buffer_load_dwordx4 v[112:115], v6, s[16:19], s99 offen offset:0
  s_waitcnt vmcnt(11)
  s_waitcnt lgkmcnt(8)
  v_mfma_f32_32x32x16_bf16 a[32:47], v[40:43], v[84:87], a[32:47]
  s_barrier
  ds_read_b64_tr_b16 v[32:33], v8 offset:49152
  ds_read_b64_tr_b16 v[34:35], v8 offset:50176
  ds_read_b64_tr_b16 v[36:37], v9 offset:49152
  ds_read_b64_tr_b16 v[38:39], v9 offset:50176
  v_mfma_f32_32x32x16_bf16 a[48:63], v[44:47], v[84:87], a[48:63]
  buffer_load_dwordx4 v[116:119], v6, s[16:19], s99 offen offset:1024
  s_waitcnt vmcnt(11)
  s_waitcnt lgkmcnt(8)
  v_mfma_f32_32x32x16_bf16 a[32:47], v[48:51], v[88:91], a[32:47]
  ds_read_b64_tr_b16 v[40:41], v8 offset:51200
  ds_read_b64_tr_b16 v[42:43], v8 offset:52224
  ds_read_b64_tr_b16 v[44:45], v9 offset:51200
  ds_read_b64_tr_b16 v[46:47], v9 offset:52224
  v_mfma_f32_32x32x16_bf16 a[48:63], v[52:55], v[88:91], a[48:63]
  buffer_load_dwordx4 v[120:123], v6, s[16:19], s99 offen offset:2048
  s_waitcnt vmcnt(11)
  s_waitcnt lgkmcnt(8)
  v_mfma_f32_32x32x16_bf16 a[32:47], v[56:59], v[92:95], a[32:47]
  ds_read_b64_tr_b16 v[48:49], v8 offset:53248
  ds_read_b64_tr_b16 v[50:51], v8 offset:54272
  ds_read_b64_tr_b16 v[52:53], v9 offset:53248
  ds_read_b64_tr_b16 v[54:55], v9 offset:54272
  v_mfma_f32_32x32x16_bf16 a[48:63], v[60:63], v[92:95], a[48:63]
  buffer_load_dwordx4 v[124:127], v6, s[16:19], s99 offen offset:3072
  s_lshr_b32 s61, 0x10101410, s58
  s_and_b32 s61, s61, 255
  s_mul_i32 s94, s61, 114688
  s_lshl_b32 s95, s61, 13
  s_add_u32 s94, s94, 0x118000
  s_add_u32 s95, s95, 0x14000
  s_add_u32 m0, s57, 16384
  s_nop 0
  buffer_load_dwordx4 v1, s[12:15], s94 offen offset:0 lds
  buffer_load_dwordx4 v2, s[12:15], s94 offen offset:1024 lds
  buffer_load_dwordx4 v3, s[12:15], s94 offen offset:2048 lds
  buffer_load_dwordx4 v4, s[12:15], s94 offen offset:3072 lds
  s_waitcnt vmcnt(11)
  s_waitcnt lgkmcnt(8)
  v_mfma_f32_32x32x16_bf16 a[32:47], v[32:35], v[96:99], a[32:47]
  ds_read_b64_tr_b16 v[56:57], v8 offset:55296
  ds_read_b64_tr_b16 v[58:59], v8 offset:56320
  ds_read_b64_tr_b16 v[60:61], v9 offset:55296
  ds_read_b64_tr_b16 v[62:63], v9 offset:56320
  v_mfma_f32_32x32x16_bf16 a[48:63], v[36:39], v[96:99], a[48:63]
  buffer_load_dwordx4 v[64:67], v5, s[16:19], s93 offen offset:0
  s_waitcnt vmcnt(11)
  s_waitcnt lgkmcnt(8)
  v_mfma_f32_32x32x16_bf16 a[32:47], v[40:43], v[100:103], a[32:47]
  ds_read_b64_tr_b16 v[32:33], v8 offset:57344
  ds_read_b64_tr_b16 v[34:35], v8 offset:58368
  ds_read_b64_tr_b16 v[36:37], v9 offset:57344
  ds_read_b64_tr_b16 v[38:39], v9 offset:58368
  v_mfma_f32_32x32x16_bf16 a[48:63], v[44:47], v[100:103], a[48:63]
  buffer_load_dwordx4 v[68:71], v5, s[16:19], s93 offen offset:1024
  s_waitcnt vmcnt(11)
  s_waitcnt lgkmcnt(8)
  v_mfma_f32_32x32x16_bf16 a[32:47], v[48:51], v[104:107], a[32:47]
  ds_read_b64_tr_b16 v[40:41], v8 offset:59392
  ds_read_b64_tr_b16 v[42:43], v8 offset:60416
  ds_read_b64_tr_b16 v[44:45], v9 offset:59392
  ds_read_b64_tr_b16 v[46:47], v9 offset:60416
  v_mfma_f32_32x32x16_bf16 a[48:63], v[52:55], v[104:107], a[48:63]
  buffer_load_dwordx4 v[72:75], v5, s[16:19], s93 offen offset:2048
  s_waitcnt vmcnt(11)
  s_waitcnt lgkmcnt(8)
  v_mfma_f32_32x32x16_bf16 a[32:47], v[56:59], v[108:111], a[32:47]
  ds_read_b64_tr_b16 v[48:49], v8 offset:61440
  ds_read_b64_tr_b16 v[50:51], v8 offset:62464
  ds_read_b64_tr_b16 v[52:53], v9 offset:61440
  ds_read_b64_tr_b16 v[54:55], v9 offset:62464
  v_mfma_f32_32x32x16_bf16 a[48:63], v[60:63], v[108:111], a[48:63]
  buffer_load_dwordx4 v[76:79], v5, s[16:19], s93 offen offset:3072
  s_waitcnt vmcnt(11)
  s_waitcnt lgkmcnt(8)
  v_mfma_f32_32x32x16_bf16 a[32:47], v[32:35], v[112:115], a[32:47]
  ds_read_b64_tr_b16 v[56:57], v8 offset:63488
  ds_read_b64_tr_b16 v[58:59], v8 offset:64512
  ds_read_b64_tr_b16 v[60:61], v9 offset:63488
  ds_read_b64_tr_b16 v[62:63], v9 offset:64512
  v_mfma_f32_32x32x16_bf16 a[48:63], v[36:39], v[112:115], a[48:63]
  buffer_load_dwordx4 v[80:83], v6, s[16:19], s93 offen offset:0
  s_waitcnt vmcnt(11)
  s_waitcnt lgkmcnt(8)
  v_mfma_f32_32x32x16_bf16 a[32:47], v[40:43], v[116:119], a[32:47]
  s_barrier
  ds_read_b64_tr_b16 v[32:33], v8 offset:0
  ds_read_b64_tr_b16 v[34:35], v8 offset:1024
  ds_read_b64_tr_b16 v[36:37], v9 offset:0
  ds_read_b64_tr_b16 v[38:39], v9 offset:1024
  v_mfma_f32_32x32x16_bf16 a[48:63], v[44:47], v[116:119], a[48:63]
  buffer_load_dwordx4 v[84:87], v6, s[16:19], s93 offen offset:1024
  s_waitcnt vmcnt(11)
  s_waitcnt lgkmcnt(8)
  v_mfma_f32_32x32x16_bf16 a[32:47], v[48:51], v[120:123], a[32:47]
  ds_read_b64_tr_b16 v[40:41], v8 offset:2048
  ds_read_b64_tr_b16 v[42:43], v8 offset:3072
  ds_read_b64_tr_b16 v[44:45], v9 offset:2048
  ds_read_b64_tr_b16 v[46:47], v9 offset:3072
  v_mfma_f32_32x32x16_bf16 a[48:63], v[52:55], v[120:123], a[48:63]
  buffer_load_dwordx4 v[88:91], v6, s[16:19], s93 offen offset:2048
  s_waitcnt vmcnt(11)
  s_waitcnt lgkmcnt(8)
  v_mfma_f32_32x32x16_bf16 a[32:47], v[56:59], v[124:127], a[32:47]
  ds_read_b64_tr_b16 v[48:49], v8 offset:4096
  ds_read_b64_tr_b16 v[50:51], v8 offset:5120
  ds_read_b64_tr_b16 v[52:53], v9 offset:4096
  ds_read_b64_tr_b16 v[54:55], v9 offset:5120
  v_mfma_f32_32x32x16_bf16 a[48:63], v[60:63], v[124:127], a[48:63]
  buffer_load_dwordx4 v[92:95], v6, s[16:19], s93 offen offset:3072
  s_lshr_b32 s61, 0x11151111, s58
  s_and_b32 s61, s61, 255
  s_mul_i32 s96, s61, 114688
  s_lshl_b32 s97, s61, 13
  s_add_u32 s96, s96, 0x118000
  s_add_u32 s97, s97, 0x14000
  s_add_u32 m0, s57, 32768
  s_nop 0
  buffer_load_dwordx4 v1, s[12:15], s96 offen offset:0 lds
  buffer_load_dwordx4 v2, s[12:15], s96 offen offset:1024 lds
  buffer_load_dwordx4 v3, s[12:15], s96 offen offset:2048 lds
  buffer_load_dwordx4 v4, s[12:15], s96 offen offset:3072 lds
  s_waitcnt vmcnt(11)
  s_waitcnt lgkmcnt(8)
  v_mfma_f32_32x32x16_bf16 a[32:47], v[32:35], v[64:67], a[32:47]
  ds_read_b64_tr_b16 v[56:57], v8 offset:6144
  ds_read_b64_tr_b16 v[58:59], v8 offset:7168
  ds_read_b64_tr_b16 v[60:61], v9 offset:6144
  ds_read_b64_tr_b16 v[62:63], v9 offset:7168
  v_mfma_f32_32x32x16_bf16 a[48:63], v[36:39], v[64:67], a[48:63]
  buffer_load_dwordx4 v[96:99], v5, s[16:19], s95 offen offset:0
  s_waitcnt vmcnt(11)
  s_waitcnt lgkmcnt(8)
  v_mfma_f32_32x32x16_bf16 a[32:47], v[40:43], v[68:71], a[32:47]
  ds_read_b64_tr_b16 v[32:33], v8 offset:8192
  ds_read_b64_tr_b16 v[34:35], v8 offset:9216
  ds_read_b64_tr_b16 v[36:37], v9 offset:8192
  ds_read_b64_tr_b16 v[38:39], v9 offset:9216
  v_mfma_f32_32x32x16_bf16 a[48:63], v[44:47], v[68:71], a[48:63]
  buffer_load_dwordx4 v[100:103], v5, s[16:19], s95 offen offset:1024
  s_waitcnt vmcnt(11)
  s_waitcnt lgkmcnt(8)
  v_mfma_f32_32x32x16_bf16 a[32:47], v[48:51], v[72:75], a[32:47]
  ds_read_b64_tr_b16 v[40:41], v8 offset:10240
  ds_read_b64_tr_b16 v[42:43], v8 offset:11264
  ds_read_b64_tr_b16 v[44:45], v9 offset:10240
  ds_read_b64_tr_b16 v[46:47], v9 offset:11264
  v_mfma_f32_32x32x16_bf16 a[48:63], v[52:55], v[72:75], a[48:63]
  buffer_load_dwordx4 v[104:107], v5, s[16:19], s95 offen offset:2048
  s_waitcnt vmcnt(11)
  s_waitcnt lgkmcnt(8)
  v_mfma_f32_32x32x16_bf16 a[32:47], v[56:59], v[76:79], a[32:47]
  ds_read_b64_tr_b16 v[48:49], v8 offset:12288
  ds_read_b64_tr_b16 v[50:51], v8 offset:13312
  ds_read_b64_tr_b16 v[52:53], v9 offset:12288
  ds_read_b64_tr_b16 v[54:55], v9 offset:13312
  v_mfma_f32_32x32x16_bf16 a[48:63], v[60:63], v[76:79], a[48:63]
  buffer_load_dwordx4 v[108:111], v5, s[16:19], s95 offen offset:3072
  s_waitcnt vmcnt(11)
  s_waitcnt lgkmcnt(8)
  v_mfma_f32_32x32x16_bf16 a[32:47], v[32:35], v[80:83], a[32:47]
  ds_read_b64_tr_b16 v[56:57], v8 offset:14336
  ds_read_b64_tr_b16 v[58:59], v8 offset:15360
  ds_read_b64_tr_b16 v[60:61], v9 offset:14336
  ds_read_b64_tr_b16 v[62:63], v9 offset:15360
  v_mfma_f32_32x32x16_bf16 a[48:63], v[36:39], v[80:83], a[48:63]
  buffer_load_dwordx4 v[112:115], v6, s[16:19], s95 offen offset:0
  s_waitcnt vmcnt(11)
  s_waitcnt lgkmcnt(8)
  v_mfma_f32_32x32x16_bf16 a[32:47], v[40:43], v[84:87], a[32:47]
  s_barrier
  ds_read_b64_tr_b16 v[32:33], v8 offset:16384
  ds_read_b64_tr_b16 v[34:35], v8 offset:17408
  ds_read_b64_tr_b16 v[36:37], v9 offset:16384
  ds_read_b64_tr_b16 v[38:39], v9 offset:17408
  v_mfma_f32_32x32x16_bf16 a[48:63], v[44:47], v[84:87], a[48:63]
  buffer_load_dwordx4 v[116:119], v6, s[16:19], s95 offen offset:1024
  s_waitcnt vmcnt(11)
  s_waitcnt lgkmcnt(8)
  v_mfma_f32_32x32x16_bf16 a[32:47], v[48:51], v[88:91], a[32:47]
  ds_read_b64_tr_b16 v[40:41], v8 offset:18432
  ds_read_b64_tr_b16 v[42:43], v8 offset:19456
  ds_read_b64_tr_b16 v[44:45], v9 offset:18432
  ds_read_b64_tr_b16 v[46:47], v9 offset:19456
  v_mfma_f32_32x32x16_bf16 a[48:63], v[52:55], v[88:91], a[48:63]
  buffer_load_dwordx4 v[120:123], v6, s[16:19], s95 offen offset:2048
  s_waitcnt vmcnt(11)
  s_waitcnt lgkmcnt(8)
  v_mfma_f32_32x32x16_bf16 a[32:47], v[56:59], v[92:95], a[32:47]
  ds_read_b64_tr_b16 v[48:49], v8 offset:20480
  ds_read_b64_tr_b16 v[50:51], v8 offset:21504
  ds_read_b64_tr_b16 v[52:53], v9 offset:20480
  ds_read_b64_tr_b16 v[54:55], v9 offset:21504
  v_mfma_f32_32x32x16_bf16 a[48:63], v[60:63], v[92:95], a[48:63]
  buffer_load_dwordx4 v[124:127], v6, s[16:19], s95 offen offset:3072
  s_lshr_b32 s61, 0x13121212, s58
  s_and_b32 s61, s61, 255
  s_mul_i32 s98, s61, 114688
  s_lshl_b32 s99, s61, 13
  s_add_u32 s98, s98, 0x118000
  s_add_u32 s99, s99, 0x14000
  s_add_u32 m0, s57, 49152
  s_nop 0
  buffer_load_dwordx4 v1, s[12:15], s98 offen offset:0 lds
  buffer_load_dwordx4 v2, s[12:15], s98 offen offset:1024 lds
  buffer_load_dwordx4 v3, s[12:15], s98 offen offset:2048 lds
  buffer_load_dwordx4 v4, s[12:15], s98 offen offset:3072 lds
  s_waitcnt vmcnt(11)
  s_waitcnt lgkmcnt(8)
  v_mfma_f32_32x32x16_bf16 a[32:47], v[32:35], v[96:99], a[32:47]
  ds_read_b64_tr_b16 v[56:57], v8 offset:22528
  ds_read_b64_tr_b16 v[58:59], v8 offset:23552
  ds_read_b64_tr_b16 v[60:61], v9 offset:22528
  ds_read_b64_tr_b16 v[62:63], v9 offset:23552
  v_mfma_f32_32x32x16_bf16 a[48:63], v[36:39], v[96:99], a[48:63]
  buffer_load_dwordx4 v[64:67], v5, s[16:19], s97 offen offset:0
  s_waitcnt vmcnt(11)
  s_waitcnt lgkmcnt(8)
  v_mfma_f32_32x32x16_bf16 a[32:47], v[40:43], v[100:103], a[32:47]
  ds_read_b64_tr_b16 v[32:33], v8 offset:24576
  ds_read_b64_tr_b16 v[34:35], v8 offset:25600
  ds_read_b64_tr_b16 v[36:37], v9 offset:24576
  ds_read_b64_tr_b16 v[38:39], v9 offset:25600
  v_mfma_f32_32x32x16_bf16 a[48:63], v[44:47], v[100:103], a[48:63]
  buffer_load_dwordx4 v[68:71], v5, s[16:19], s97 offen offset:1024
  s_waitcnt vmcnt(11)
  s_waitcnt lgkmcnt(8)
  v_mfma_f32_32x32x16_bf16 a[32:47], v[48:51], v[104:107], a[32:47]
  ds_read_b64_tr_b16 v[40:41], v8 offset:26624
  ds_read_b64_tr_b16 v[42:43], v8 offset:27648
  ds_read_b64_tr_b16 v[44:45], v9 offset:26624
  ds_read_b64_tr_b16 v[46:47], v9 offset:27648
  v_mfma_f32_32x32x16_bf16 a[48:63], v[52:55], v[104:107], a[48:63]
  buffer_load_dwordx4 v[72:75], v5, s[16:19], s97 offen offset:2048
  s_waitcnt vmcnt(11)
  s_waitcnt lgkmcnt(8)
  v_mfma_f32_32x32x16_bf16 a[32:47], v[56:59], v[108:111], a[32:47]
  ds_read_b64_tr_b16 v[48:49], v8 offset:28672
  ds_read_b64_tr_b16 v[50:51], v8 offset:29696
  ds_read_b64_tr_b16 v[52:53], v9 offset:28672
  ds_read_b64_tr_b16 v[54:55], v9 offset:29696
  v_mfma_f32_32x32x16_bf16 a[48:63], v[60:63], v[108:111], a[48:63]
  buffer_load_dwordx4 v[76:79], v5, s[16:19], s97 offen offset:3072
  s_waitcnt vmcnt(11)
  s_waitcnt lgkmcnt(8)
  v_mfma_f32_32x32x16_bf16 a[32:47], v[32:35], v[112:115], a[32:47]
  ds_read_b64_tr_b16 v[56:57], v8 offset:30720
  ds_read_b64_tr_b16 v[58:59], v8 offset:31744
  ds_read_b64_tr_b16 v[60:61], v9 offset:30720
  ds_read_b64_tr_b16 v[62:63], v9 offset:31744
  v_mfma_f32_32x32x16_bf16 a[48:63], v[36:39], v[112:115], a[48:63]
  buffer_load_dwordx4 v[80:83], v6, s[16:19], s97 offen offset:0
  s_waitcnt vmcnt(11)
  s_waitcnt lgkmcnt(8)
  v_mfma_f32_32x32x16_bf16 a[32:47], v[40:43], v[116:119], a[32:47]
  s_barrier
  ds_read_b64_tr_b16 v[32:33], v8 offset:32768
  ds_read_b64_tr_b16 v[34:35], v8 offset:33792
  ds_read_b64_tr_b16 v[36:37], v9 offset:32768
  ds_read_b64_tr_b16 v[38:39], v9 offset:33792
  v_mfma_f32_32x32x16_bf16 a[48:63], v[44:47], v[116:119], a[48:63]
  buffer_load_dwordx4 v[84:87], v6, s[16:19], s97 offen offset:1024
  s_waitcnt vmcnt(11)
  s_waitcnt lgkmcnt(8)
  v_mfma_f32_32x32x16_bf16 a[32:47], v[48:51], v[120:123], a[32:47]
  ds_read_b64_tr_b16 v[40:41], v8 offset:34816
  ds_read_b64_tr_b16 v[42:43], v8 offset:35840
  ds_read_b64_tr_b16 v[44:45], v9 offset:34816
  ds_read_b64_tr_b16 v[46:47], v9 offset:35840
  v_mfma_f32_32x32x16_bf16 a[48:63], v[52:55], v[120:123], a[48:63]
  buffer_load_dwordx4 v[88:91], v6, s[16:19], s97 offen offset:2048
  s_waitcnt vmcnt(11)
  s_waitcnt lgkmcnt(8)
  v_mfma_f32_32x32x16_bf16 a[32:47], v[56:59], v[124:127], a[32:47]
  ds_read_b64_tr_b16 v[48:49], v8 offset:36864
  ds_read_b64_tr_b16 v[50:51], v8 offset:37888
  ds_read_b64_tr_b16 v[52:53], v9 offset:36864
  ds_read_b64_tr_b16 v[54:55], v9 offset:37888
  v_mfma_f32_32x32x16_bf16 a[48:63], v[60:63], v[124:127], a[48:63]
  buffer_load_dwordx4 v[92:95], v6, s[16:19], s97 offen offset:3072
  s_lshr_b32 s61, 0x14131314, s58
  s_and_b32 s61, s61, 255
  s_mul_i32 s92, s61, 114688
  s_lshl_b32 s93, s61, 13
  s_add_u32 s92, s92, 0x118000
  s_add_u32 s93, s93, 0x14000
  s_add_u32 m0, s57, 0
  s_nop 0
  buffer_load_dwordx4 v1, s[12:15], s92 offen offset:0 lds
  buffer_load_dwordx4 v2, s[12:15], s92 offen offset:1024 lds
  buffer_load_dwordx4 v3, s[12:15], s92 offen offset:2048 lds
  buffer_load_dwordx4 v4, s[12:15], s92 offen offset:3072 lds
  s_waitcnt vmcnt(11)
  s_waitcnt lgkmcnt(8)
  v_mfma_f32_32x32x16_bf16 a[32:47], v[32:35], v[64:67], a[32:47]
  ds_read_b64_tr_b16 v[56:57], v8 offset:38912
  ds_read_b64_tr_b16 v[58:59], v8 offset:39936
  ds_read_b64_tr_b16 v[60:61], v9 offset:38912
  ds_read_b64_tr_b16 v[62:63], v9 offset:39936
  v_mfma_f32_32x32x16_bf16 a[48:63], v[36:39], v[64:67], a[48:63]
  buffer_load_dwordx4 v[96:99], v5, s[16:19], s99 offen offset:0
  s_waitcnt vmcnt(11)
  s_waitcnt lgkmcnt(8)
  v_mfma_f32_32x32x16_bf16 a[32:47], v[40:43], v[68:71], a[32:47]
  ds_read_b64_tr_b16 v[32:33], v8 offset:40960
  ds_read_b64_tr_b16 v[34:35], v8 offset:41984
  ds_read_b64_tr_b16 v[36:37], v9 offset:40960
  ds_read_b64_tr_b16 v[38:39], v9 offset:41984
  v_mfma_f32_32x32x16_bf16 a[48:63], v[44:47], v[68:71], a[48:63]
  buffer_load_dwordx4 v[100:103], v5, s[16:19], s99 offen offset:1024
  s_waitcnt vmcnt(11)
  s_waitcnt lgkmcnt(8)
  v_mfma_f32_32x32x16_bf16 a[32:47], v[48:51], v[72:75], a[32:47]
  ds_read_b64_tr_b16 v[40:41], v8 offset:43008
  ds_read_b64_tr_b16 v[42:43], v8 offset:44032
  ds_read_b64_tr_b16 v[44:45], v9 offset:43008
  ds_read_b64_tr_b16 v[46:47], v9 offset:44032
  v_mfma_f32_32x32x16_bf16 a[48:63], v[52:55], v[72:75], a[48:63]
  buffer_load_dwordx4 v[104:107], v5, s[16:19], s99 offen offset:2048
  s_waitcnt vmcnt(11)
  s_waitcnt lgkmcnt(8)
  v_mfma_f32_32x32x16_bf16 a[32:47], v[56:59], v[76:79], a[32:47]
  ds_read_b64_tr_b16 v[48:49], v8 offset:45056
  ds_read_b64_tr_b16 v[50:51], v8 offset:46080
  ds_read_b64_tr_b16 v[52:53], v9 offset:45056
  ds_read_b64_tr_b16 v[54:55], v9 offset:46080
  v_mfma_f32_32x32x16_bf16 a[48:63], v[60:63], v[76:79], a[48:63]
  buffer_load_dwordx4 v[108:111], v5, s[16:19], s99 offen offset:3072
  s_waitcnt vmcnt(11)
  s_waitcnt lgkmcnt(8)
  v_mfma_f32_32x32x16_bf16 a[32:47], v[32:35], v[80:83], a[32:47]
  ds_read_b64_tr_b16 v[56:57], v8 offset:47104
  ds_read_b64_tr_b16 v[58:59], v8 offset:48128
  ds_read_b64_tr_b16 v[60:61], v9 offset:47104
  ds_read_b64_tr_b16 v[62:63], v9 offset:48128
  v_mfma_f32_32x32x16_bf16 a[48:63], v[36:39], v[80:83], a[48:63]
  buffer_load_dwordx4 v[112:115], v6, s[16:19], s99 offen offset:0
  s_waitcnt vmcnt(11)
  s_waitcnt lgkmcnt(8)
  v_mfma_f32_32x32x16_bf16 a[32:47], v[40:43], v[84:87], a[32:47]
  s_barrier
  ds_read_b64_tr_b16 v[32:33], v8 offset:49152
  ds_read_b64_tr_b16 v[34:35], v8 offset:50176
  ds_read_b64_tr_b16 v[36:37], v9 offset:49152
  ds_read_b64_tr_b16 v[38:39], v9 offset:50176
  v_mfma_f32_32x32x16_bf16 a[48:63], v[44:47], v[84:87], a[48:63]
  buffer_load_dwordx4 v[116:119], v6, s[16:19], s99 offen offset:1024
  s_waitcnt vmcnt(11)
  s_waitcnt lgkmcnt(8)
  v_mfma_f32_32x32x16_bf16 a[32:47], v[48:51], v[88:91], a[32:47]
  ds_read_b64_tr_b16 v[40:41], v8 offset:51200
  ds_read_b64_tr_b16 v[42:43], v8 offset:52224
  ds_read_b64_tr_b16 v[44:45], v9 offset:51200
  ds_read_b64_tr_b16 v[46:47], v9 offset:52224
  v_mfma_f32_32x32x16_bf16 a[48:63], v[52:55], v[88:91], a[48:63]
  buffer_load_dwordx4 v[120:123], v6, s[16:19], s99 offen offset:2048
  s_waitcnt vmcnt(11)
  s_waitcnt lgkmcnt(8)
  v_mfma_f32_32x32x16_bf16 a[32:47], v[56:59], v[92:95], a[32:47]
  ds_read_b64_tr_b16 v[48:49], v8 offset:53248
  ds_read_b64_tr_b16 v[50:51], v8 offset:54272
  ds_read_b64_tr_b16 v[52:53], v9 offset:53248
  ds_read_b64_tr_b16 v[54:55], v9 offset:54272
  v_mfma_f32_32x32x16_bf16 a[48:63], v[60:63], v[92:95], a[48:63]
  buffer_load_dwordx4 v[124:127], v6, s[16:19], s99 offen offset:3072
  s_lshr_b32 s61, 0x15141515, s58
  s_and_b32 s61, s61, 255
  s_mul_i32 s94, s61, 114688
  s_lshl_b32 s95, s61, 13
  s_add_u32 s94, s94, 0x118000
  s_add_u32 s95, s95, 0x14000
  s_add_u32 m0, s57, 16384
  s_nop 0
  buffer_load_dwordx4 v1, s[12:15], s94 offen offset:0 lds
  buffer_load_dwordx4 v2, s[12:15], s94 offen offset:1024 lds
  buffer_load_dwordx4 v3, s[12:15], s94 offen offset:2048 lds
  buffer_load_dwordx4 v4, s[12:15], s94 offen offset:3072 lds
  s_waitcnt vmcnt(11)
  s_waitcnt lgkmcnt(8)
  v_mfma_f32_32x32x16_bf16 a[32:47], v[32:35], v[96:99], a[32:47]
  ds_read_b64_tr_b16 v[56:57], v8 offset:55296
  ds_read_b64_tr_b16 v[58:59], v8 offset:56320
  ds_read_b64_tr_b16 v[60:61], v9 offset:55296
  ds_read_b64_tr_b16 v[62:63], v9 offset:56320
  v_mfma_f32_32x32x16_bf16 a[48:63], v[36:39], v[96:99], a[48:63]
  buffer_load_dwordx4 v[64:67], v5, s[16:19], s93 offen offset:0
  s_waitcnt vmcnt(11)
  s_waitcnt lgkmcnt(8)
  v_mfma_f32_32x32x16_bf16 a[32:47], v[40:43], v[100:103], a[32:47]
  ds_read_b64_tr_b16 v[32:33], v8 offset:57344
  ds_read_b64_tr_b16 v[34:35], v8 offset:58368
  ds_read_b64_tr_b16 v[36:37], v9 offset:57344
  ds_read_b64_tr_b16 v[38:39], v9 offset:58368
  v_mfma_f32_32x32x16_bf16 a[48:63], v[44:47], v[100:103], a[48:63]
  buffer_load_dwordx4 v[68:71], v5, s[16:19], s93 offen offset:1024
  s_waitcnt vmcnt(11)
  s_waitcnt lgkmcnt(8)
  v_mfma_f32_32x32x16_bf16 a[32:47], v[48:51], v[104:107], a[32:47]
  ds_read_b64_tr_b16 v[40:41], v8 offset:59392
  ds_read_b64_tr_b16 v[42:43], v8 offset:60416
  ds_read_b64_tr_b16 v[44:45], v9 offset:59392
  ds_read_b64_tr_b16 v[46:47], v9 offset:60416
  v_mfma_f32_32x32x16_bf16 a[48:63], v[52:55], v[104:107], a[48:63]
  buffer_load_dwordx4 v[72:75], v5, s[16:19], s93 offen offset:2048
  s_waitcnt vmcnt(11)
  s_waitcnt lgkmcnt(8)
  v_mfma_f32_32x32x16_bf16 a[32:47], v[56:59], v[108:111], a[32:47]
  ds_read_b64_tr_b16 v[48:49], v8 offset:61440
  ds_read_b64_tr_b16 v[50:51], v8 offset:62464
  ds_read_b64_tr_b16 v[52:53], v9 offset:61440
  ds_read_b64_tr_b16 v[54:55], v9 offset:62464
  v_mfma_f32_32x32x16_bf16 a[48:63], v[60:63], v[108:111], a[48:63]
  buffer_load_dwordx4 v[76:79], v5, s[16:19], s93 offen offset:3072
  s_waitcnt vmcnt(11)
  s_waitcnt lgkmcnt(8)
  v_mfma_f32_32x32x16_bf16 a[32:47], v[32:35], v[112:115], a[32:47]
  ds_read_b64_tr_b16 v[56:57], v8 offset:63488
  ds_read_b64_tr_b16 v[58:59], v8 offset:64512
  ds_read_b64_tr_b16 v[60:61], v9 offset:63488
  ds_read_b64_tr_b16 v[62:63], v9 offset:64512
  v_mfma_f32_32x32x16_bf16 a[48:63], v[36:39], v[112:115], a[48:63]
  buffer_load_dwordx4 v[80:83], v6, s[16:19], s93 offen offset:0
  s_waitcnt vmcnt(11)
  s_waitcnt lgkmcnt(8)
  v_mfma_f32_32x32x16_bf16 a[32:47], v[40:43], v[116:119], a[32:47]
  s_barrier
  ds_read_b64_tr_b16 v[32:33], v8 offset:0
  ds_read_b64_tr_b16 v[34:35], v8 offset:1024
  ds_read_b64_tr_b16 v[36:37], v9 offset:0
  ds_read_b64_tr_b16 v[38:39], v9 offset:1024
  v_mfma_f32_32x32x16_bf16 a[48:63], v[44:47], v[116:119], a[48:63]
  buffer_load_dwordx4 v[84:87], v6, s[16:19], s93 offen offset:1024
  s_waitcnt vmcnt(11)
  s_waitcnt lgkmcnt(8)
  v_mfma_f32_32x32x16_bf16 a[32:47], v[48:51], v[120:123], a[32:47]
  ds_read_b64_tr_b16 v[40:41], v8 offset:2048
  ds_read_b64_tr_b16 v[42:43], v8 offset:3072
  ds_read_b64_tr_b16 v[44:45], v9 offset:2048
  ds_read_b64_tr_b16 v[46:47], v9 offset:3072
  v_mfma_f32_32x32x16_bf16 a[48:63], v[52:55], v[120:123], a[48:63]
  buffer_load_dwordx4 v[88:91], v6, s[16:19], s93 offen offset:2048
  s_waitcnt vmcnt(11)
  s_waitcnt lgkmcnt(8)
  v_mfma_f32_32x32x16_bf16 a[32:47], v[56:59], v[124:127], a[32:47]
  ds_read_b64_tr_b16 v[48:49], v8 offset:4096
  ds_read_b64_tr_b16 v[50:51], v8 offset:5120
  ds_read_b64_tr_b16 v[52:53], v9 offset:4096
  ds_read_b64_tr_b16 v[54:55], v9 offset:5120
  v_mfma_f32_32x32x16_bf16 a[48:63], v[60:63], v[124:127], a[48:63]
  buffer_load_dwordx4 v[92:95], v6, s[16:19], s93 offen offset:3072
  s_waitcnt vmcnt(7)
  s_waitcnt lgkmcnt(8)
  v_mfma_f32_32x32x16_bf16 a[32:47], v[32:35], v[64:67], a[32:47]
  ds_read_b64_tr_b16 v[56:57], v8 offset:6144
  ds_read_b64_tr_b16 v[58:59], v8 offset:7168
  ds_read_b64_tr_b16 v[60:61], v9 offset:6144
  ds_read_b64_tr_b16 v[62:63], v9 offset:7168
  v_mfma_f32_32x32x16_bf16 a[48:63], v[36:39], v[64:67], a[48:63]
  buffer_load_dwordx4 v[96:99], v5, s[16:19], s95 offen offset:0
  s_waitcnt vmcnt(7)
  s_waitcnt lgkmcnt(8)
  v_mfma_f32_32x32x16_bf16 a[32:47], v[40:43], v[68:71], a[32:47]
  ds_read_b64_tr_b16 v[32:33], v8 offset:8192
  ds_read_b64_tr_b16 v[34:35], v8 offset:9216
  ds_read_b64_tr_b16 v[36:37], v9 offset:8192
  ds_read_b64_tr_b16 v[38:39], v9 offset:9216
  v_mfma_f32_32x32x16_bf16 a[48:63], v[44:47], v[68:71], a[48:63]
  buffer_load_dwordx4 v[100:103], v5, s[16:19], s95 offen offset:1024
  s_waitcnt vmcnt(7)
  s_waitcnt lgkmcnt(8)
  v_mfma_f32_32x32x16_bf16 a[32:47], v[48:51], v[72:75], a[32:47]
  ds_read_b64_tr_b16 v[40:41], v8 offset:10240
  ds_read_b64_tr_b16 v[42:43], v8 offset:11264
  ds_read_b64_tr_b16 v[44:45], v9 offset:10240
  ds_read_b64_tr_b16 v[46:47], v9 offset:11264
  v_mfma_f32_32x32x16_bf16 a[48:63], v[52:55], v[72:75], a[48:63]
  buffer_load_dwordx4 v[104:107], v5, s[16:19], s95 offen offset:2048
  s_waitcnt vmcnt(7)
  s_waitcnt lgkmcnt(8)
  v_mfma_f32_32x32x16_bf16 a[32:47], v[56:59], v[76:79], a[32:47]
  ds_read_b64_tr_b16 v[48:49], v8 offset:12288
  ds_read_b64_tr_b16 v[50:51], v8 offset:13312
  ds_read_b64_tr_b16 v[52:53], v9 offset:12288
  ds_read_b64_tr_b16 v[54:55], v9 offset:13312
  v_mfma_f32_32x32x16_bf16 a[48:63], v[60:63], v[76:79], a[48:63]
  buffer_load_dwordx4 v[108:111], v5, s[16:19], s95 offen offset:3072
  s_waitcnt vmcnt(7)
  s_waitcnt lgkmcnt(8)
  v_mfma_f32_32x32x16_bf16 a[32:47], v[32:35], v[80:83], a[32:47]
  ds_read_b64_tr_b16 v[56:57], v8 offset:14336
  ds_read_b64_tr_b16 v[58:59], v8 offset:15360
  ds_read_b64_tr_b16 v[60:61], v9 offset:14336
  ds_read_b64_tr_b16 v[62:63], v9 offset:15360
  v_mfma_f32_32x32x16_bf16 a[48:63], v[36:39], v[80:83], a[48:63]
  buffer_load_dwordx4 v[112:115], v6, s[16:19], s95 offen offset:0
  s_waitcnt vmcnt(7)
  s_waitcnt lgkmcnt(8)
  v_mfma_f32_32x32x16_bf16 a[32:47], v[40:43], v[84:87], a[32:47]
  s_barrier
  ds_read_b64_tr_b16 v[32:33], v8 offset:16384
  ds_read_b64_tr_b16 v[34:35], v8 offset:17408
  ds_read_b64_tr_b16 v[36:37], v9 offset:16384
  ds_read_b64_tr_b16 v[38:39], v9 offset:17408
  v_mfma_f32_32x32x16_bf16 a[48:63], v[44:47], v[84:87], a[48:63]
  buffer_load_dwordx4 v[116:119], v6, s[16:19], s95 offen offset:1024
  s_waitcnt vmcnt(7)
  s_waitcnt lgkmcnt(8)
  v_mfma_f32_32x32x16_bf16 a[32:47], v[48:51], v[88:91], a[32:47]
  ds_read_b64_tr_b16 v[40:41], v8 offset:18432
  ds_read_b64_tr_b16 v[42:43], v8 offset:19456
  ds_read_b64_tr_b16 v[44:45], v9 offset:18432
  ds_read_b64_tr_b16 v[46:47], v9 offset:19456
  v_mfma_f32_32x32x16_bf16 a[48:63], v[52:55], v[88:91], a[48:63]
  buffer_load_dwordx4 v[120:123], v6, s[16:19], s95 offen offset:2048
  s_waitcnt vmcnt(7)
  s_waitcnt lgkmcnt(8)
  v_mfma_f32_32x32x16_bf16 a[32:47], v[56:59], v[92:95], a[32:47]
  ds_read_b64_tr_b16 v[48:49], v8 offset:20480
  ds_read_b64_tr_b16 v[50:51], v8 offset:21504
  ds_read_b64_tr_b16 v[52:53], v9 offset:20480
  ds_read_b64_tr_b16 v[54:55], v9 offset:21504
  v_mfma_f32_32x32x16_bf16 a[48:63], v[60:63], v[92:95], a[48:63]
  buffer_load_dwordx4 v[124:127], v6, s[16:19], s95 offen offset:3072
  s_waitcnt vmcnt(7)
  s_waitcnt lgkmcnt(8)
  v_mfma_f32_32x32x16_bf16 a[32:47], v[32:35], v[96:99], a[32:47]
  ds_read_b64_tr_b16 v[56:57], v8 offset:22528
  ds_read_b64_tr_b16 v[58:59], v8 offset:23552
  ds_read_b64_tr_b16 v[60:61], v9 offset:22528
  ds_read_b64_tr_b16 v[62:63], v9 offset:23552
  v_mfma_f32_32x32x16_bf16 a[48:63], v[36:39], v[96:99], a[48:63]
  s_waitcnt vmcnt(6)
  s_waitcnt lgkmcnt(8)
  v_mfma_f32_32x32x16_bf16 a[32:47], v[40:43], v[100:103], a[32:47]
  ds_read_b64_tr_b16 v[32:33], v8 offset:24576
  ds_read_b64_tr_b16 v[34:35], v8 offset:25600
  ds_read_b64_tr_b16 v[36:37], v9 offset:24576
  ds_read_b64_tr_b16 v[38:39], v9 offset:25600
  v_mfma_f32_32x32x16_bf16 a[48:63], v[44:47], v[100:103], a[48:63]
  s_waitcnt vmcnt(5)
  s_waitcnt lgkmcnt(8)
  v_mfma_f32_32x32x16_bf16 a[32:47], v[48:51], v[104:107], a[32:47]
  ds_read_b64_tr_b16 v[40:41], v8 offset:26624
  ds_read_b64_tr_b16 v[42:43], v8 offset:27648
  ds_read_b64_tr_b16 v[44:45], v9 offset:26624
  ds_read_b64_tr_b16 v[46:47], v9 offset:27648
  v_mfma_f32_32x32x16_bf16 a[48:63], v[52:55], v[104:107], a[48:63]
  s_waitcnt vmcnt(4)
  s_waitcnt lgkmcnt(8)
  v_mfma_f32_32x32x16_bf16 a[32:47], v[56:59], v[108:111], a[32:47]
  ds_read_b64_tr_b16 v[48:49], v8 offset:28672
  ds_read_b64_tr_b16 v[50:51], v8 offset:29696
  ds_read_b64_tr_b16 v[52:53], v9 offset:28672
  ds_read_b64_tr_b16 v[54:55], v9 offset:29696
  v_mfma_f32_32x32x16_bf16 a[48:63], v[60:63], v[108:111], a[48:63]
  s_waitcnt vmcnt(3)
  s_waitcnt lgkmcnt(8)
  v_mfma_f32_32x32x16_bf16 a[32:47], v[32:35], v[112:115], a[32:47]
  ds_read_b64_tr_b16 v[56:57], v8 offset:30720
  ds_read_b64_tr_b16 v[58:59], v8 offset:31744
  ds_read_b64_tr_b16 v[60:61], v9 offset:30720
  ds_read_b64_tr_b16 v[62:63], v9 offset:31744
  v_mfma_f32_32x32x16_bf16 a[48:63], v[36:39], v[112:115], a[48:63]
  s_waitcnt vmcnt(2)
  s_waitcnt lgkmcnt(8)
  v_mfma_f32_32x32x16_bf16 a[32:47], v[40:43], v[116:119], a[32:47]
  v_mfma_f32_32x32x16_bf16 a[48:63], v[44:47], v[116:119], a[48:63]
  s_waitcnt vmcnt(1)
  s_waitcnt lgkmcnt(4)
  v_mfma_f32_32x32x16_bf16 a[32:47], v[48:51], v[120:123], a[32:47]
  v_mfma_f32_32x32x16_bf16 a[48:63], v[52:55], v[120:123], a[48:63]
  s_waitcnt vmcnt(0)
  s_waitcnt lgkmcnt(2)
  v_mfma_f32_32x32x16_bf16 a[32:47], v[56:59], v[124:127], a[32:47]
  s_waitcnt lgkmcnt(0)
  v_mfma_f32_32x32x16_bf16 a[48:63], v[60:63], v[124:127], a[48:63]
  s_nop 9
  buffer_store_dwordx4 a[32:35], v5, s[20:23], s67 offen offset:0 sc1
  buffer_store_dwordx4 a[36:39], v5, s[20:23], s67 offen offset:1024 sc1
  buffer_store_dwordx4 a[40:43], v5, s[20:23], s67 offen offset:2048 sc1
  buffer_store_dwordx4 a[44:47], v5, s[20:23], s67 offen offset:3072 sc1
  buffer_store_dwordx4 a[48:51], v6, s[20:23], s67 offen offset:0 sc1
  buffer_store_dwordx4 a[52:55], v6, s[20:23], s67 offen offset:1024 sc1
  buffer_store_dwordx4 a[56:59], v6, s[20:23], s67 offen offset:2048 sc1
  buffer_store_dwordx4 a[60:63], v6, s[20:23], s67 offen offset:3072 sc1
  v_mov_b32 v11, 1
  s_waitcnt vmcnt(0)
  s_barrier
  s_cmp_eq_u32 s56, 0
  s_cbranch_scc0 K2_FIN
  buffer_store_dword v11, v10, s[20:23], s66 offen offset:0 sc1
K2_FIN:
K2_END:
K1_END:
  s_endpgm
.section .rodata,"a"
.p2align 6
.amdhsa_kernel recurrent_scan__sliding_block_cached__glu_gated_bilinear__prompt_kernel
  .amdhsa_next_free_vgpr 512
  .amdhsa_next_free_sgpr 102
  .amdhsa_accum_offset 256
  .amdhsa_group_segment_fixed_size 0
  .amdhsa_kernarg_size 96
  .amdhsa_user_sgpr_count 2
  .amdhsa_user_sgpr_kernarg_segment_ptr 1
  .amdhsa_system_sgpr_workgroup_id_x 1
.end_amdhsa_kernel
```
